```python
import torch

def _softmax(x, axis=-1):
    return torch.softmax(x, dim=axis)

def _gelu(x):
    return torch.nn.functional.gelu(x, approximate='tanh')

def _silu(x):
    return torch.nn.functional.silu(x)

def _sigmoid(x):
    return torch.sigmoid(x)

def _layernorm(x, axis=-1, eps=1e-05):
    m = x.mean(dim=axis, keepdim=True)
    v = x.var(dim=axis, keepdim=True, unbiased=False)
    return (x - m) / torch.sqrt(v + eps)

def _scatter_add(tgt, idx, src, axis=0):
    return tgt.clone().index_add_(axis, idx, src)

def _segment_sum(src, seg, n):
    out = torch.zeros((n,) + src.shape[1:], dtype=src.dtype)
    return out.index_add_(0, seg, src)

def _pad(x, pw):
    flat = tuple((v for pair in reversed(pw) for v in pair))
    return torch.nn.functional.pad(x, flat)
kernel_name = 'sequential_preLN__memory_aug_recurrent_mem_tr__glu_gated_glu__prompt'

def setup_inputs():

    _w = lambda a: (lambda t: t.to(torch.bfloat16) if t.is_floating_point() else t)(torch.as_tensor(a))

    def _A_setup():
        B, S, Dm = (1, 2048, 1024)
        H, Dh = (32, 128)
        M, seg = (8, 32)
        seg = min(seg, S)
        S = S // seg * seg
        return {'x': _w((lambda *s: torch.randn(*s, dtype=torch.bfloat16) * 0.05)(B, S, Dm)), 'mem0': _w((lambda *s: torch.randn(*s, dtype=torch.bfloat16) * 0.2)(B, M, Dm)), 'Wq': _w((lambda *s: torch.randn(*s, dtype=torch.bfloat16) * 1.6)(Dm, H, Dh) * Dm ** (-0.5)), 'Wk': _w((lambda *s: torch.randn(*s, dtype=torch.bfloat16) * 1.6)(Dm, H, Dh) * Dm ** (-0.5)), 'Wv': _w((lambda *s: torch.randn(*s, dtype=torch.bfloat16) * 0.2)(Dm, H, Dh) * Dm ** (-0.5)), 'Wo': _w((lambda *s: torch.randn(*s, dtype=torch.bfloat16) * 0.2)(H, Dh, Dm) * (H * Dh) ** (-0.5)), 'seg_len': seg}
    _A_in = _A_setup()

    def _B_setup():
        B, S, D, F = (1, 2048, 1024, 3584)
        return {'x': _w((lambda *s: torch.randn(*s, dtype=torch.bfloat16) * 0.05)(B, S, D)), 'w_gate': _w((lambda *s: torch.randn(*s, dtype=torch.bfloat16) * 0.05)(D, F)), 'w_up': _w((lambda *s: torch.randn(*s, dtype=torch.bfloat16) * 0.05)(D, F)), 'w_down': _w((lambda *s: torch.randn(*s, dtype=torch.bfloat16) * 0.05)(F, D))}
    _B_in = _B_setup()
    return {'A_x': _A_in['x'], 'A_mem0': _A_in['mem0'], 'A_Wq': _A_in['Wq'], 'A_Wk': _A_in['Wk'], 'A_Wv': _A_in['Wv'], 'A_Wo': _A_in['Wo'], 'A_seg_len': _A_in['seg_len'], 'B_x': _B_in['x'], 'B_w_gate': _B_in['w_gate'], 'B_w_up': _B_in['w_up'], 'B_w_down': _B_in['w_down']}

def reference(A_x, A_mem0, A_Wq, A_Wk, A_Wv, A_Wo, A_seg_len, B_x, B_w_gate, B_w_up, B_w_down):

    def _A_ref(x, mem0, Wq, Wk, Wv, Wo, seg_len):
        B, S, Dm = x.shape
        H, Dh = (Wq.shape[1], Wq.shape[2])
        M = mem0.shape[1]
        scale = Dh ** (-0.5)
        n_seg = S // seg_len
        L = M + seg_len
        idx = torch.arange(L)
        mask = (idx[:, None] < M) | (idx[:, None] >= idx[None, :])
        mem = mem0
        outs = []
        for s in range(n_seg):
            xs = x[:, s * seg_len:(s + 1) * seg_len, :].clone()
            h = torch.concatenate([mem, xs], axis=1)
            q = torch.einsum('btd,dhe->bhte', h, Wq)
            k = torch.einsum('btd,dhe->bhte', h, Wk)
            v = torch.einsum('btd,dhe->bhte', h, Wv)
            scores = torch.einsum('bhqe,bhke->bhqk', q, k) * scale
            scores = torch.where(mask[None, None], scores, -1000000000.0)
            p = _softmax(scores, axis=-1)
            o = torch.einsum('bhqk,bhke->bhqe', p, v)
            o = torch.einsum('bhte,hed->btd', o, Wo)
            mem = o[:, :M, :].clone()
            outs.append(o[:, M:, :])
        return torch.concatenate(outs, axis=1)

    def _B_ref(x, w_gate, w_up, w_down):
        g = torch.einsum('bsd,df->bsf', x, w_gate)
        u = torch.einsum('bsd,df->bsf', x, w_up)
        h = _sigmoid(g) * u
        return torch.einsum('bsf,fd->bsd', h, w_down)
    x = A_x
    h = x + _A_ref(_layernorm(x, axis=-1), A_mem0, A_Wq, A_Wk, A_Wv, A_Wo, A_seg_len)
    h2 = h + _B_ref(_layernorm(h, axis=-1), B_w_gate, B_w_up, B_w_down)
    return h2
```

```asm
; @launch grid=(256,1,1) block=(256,1,1) lds=163840
.amdgcn_target "amdgcn-amd-amdhsa--gfx950"
.text
.globl sequential_preLN__memory_aug_recurrent_mem_tr__glu_gated_glu__prompt_kernel
.p2align 8
.type sequential_preLN__memory_aug_recurrent_mem_tr__glu_gated_glu__prompt_kernel,@function
sequential_preLN__memory_aug_recurrent_mem_tr__glu_gated_glu__prompt_kernel:
    s_cmp_ge_u32 s2, 256
    s_cbranch_scc1 MG_EXIT
    s_load_dwordx2 s[52:53], s[0:1], 104
    s_load_dwordx2 s[64:65], s[0:1], 0
    s_load_dwordx2 s[66:67], s[0:1], 8
    s_load_dwordx2 s[68:69], s[0:1], 96
    s_load_dwordx2 s[50:51], s[0:1], 16
    v_lshrrev_b32 v1, 6, v0
    v_and_b32 v5, 63, v0
    v_readfirstlane_b32 s21, v1
    v_lshlrev_b32 v5, 4, v5
    s_mov_b32 s40, 0x00ff00ff
    s_mov_b32 s41, 0x00ff00ff
    s_mov_b32 s58, 0xff00ff00
    s_mov_b32 s59, 0xff00ff00
    s_mov_b32 s42, 400000
    s_mov_b32 s63, 0x3e0293ee
    s_waitcnt lgkmcnt(0)
    s_add_u32 s4, s52, 0x4c00000
    s_addc_u32 s5, s53, 0
    s_and_b32 s5, s5, 0xffff
    s_mov_b32 s6, 0x1000000
    s_mov_b32 s7, 0x00020000
    s_add_u32 s8, s52, 0x400000
    s_addc_u32 s9, s53, 0
    s_and_b32 s9, s9, 0xffff
    s_mov_b32 s10, 0x2000000
    s_mov_b32 s11, 0x00020000
    s_add_u32 s12, s52, 0xb000000
    s_addc_u32 s13, s53, 0
    s_and_b32 s13, s13, 0xffff
    s_mov_b32 s14, 0x4000000
    s_mov_b32 s15, 0x00020000
    s_mov_b32 s72, s64
    s_mov_b32 s73, s65
    s_and_b32 s73, s73, 0xffff
    s_mov_b32 s74, 0x400000
    s_mov_b32 s75, 0x00020000
    s_mov_b32 s92, s68
    s_mov_b32 s93, s69
    s_and_b32 s93, s93, 0xffff
    s_mov_b32 s94, 0x100
    s_mov_b32 s95, 0x00020000
    s_getreg_b32 s23, hwreg(HW_REG_XCC_ID, 0, 4)
    s_and_b32 s23, s23, 7
    s_cmp_eq_u32 s21, 0
    s_cbranch_scc0 PM_NT
    s_lshl_b32 s70, s23, 4
    v_mov_b32 v180, 1
    v_mov_b32 v181, s70
    s_mov_b64 exec, 1
    buffer_atomic_add v180, v181, s[92:95], 0 offen sc0
    s_mov_b64 exec, -1
PM_NT:
    v_and_b32 v149, 63, v0
    v_and_b32 v152, 7, v149
    v_bfe_u32 v153, v149, 3, 1
    v_lshrrev_b32 v154, 4, v149
    s_lshr_b32 s70, s2, 2
    s_and_b32 s71, s2, 3
    s_lshl_b32 s71, s71, 3
    v_add_u32 v155, s71, v152
    v_lshlrev_b32 v151, 11, v155
    v_lshl_add_u32 v151, v154, 5, v151
    v_lshl_add_u32 v151, v153, 3, v151
    s_lshl_b32 s90, s21, 9
    s_lshl_b32 s91, s70, 16
    s_add_u32 s90, s90, s91
    v_add_u32 v151, s90, v151
    buffer_load_dwordx2 v[160:161], v151, s[72:75], 0 offen offset:0
    buffer_load_dwordx2 v[162:163], v151, s[72:75], 0 offen offset:16
    buffer_load_dwordx2 v[164:165], v151, s[72:75], 0 offen offset:128
    buffer_load_dwordx2 v[166:167], v151, s[72:75], 0 offen offset:144
    buffer_load_dwordx2 v[168:169], v151, s[72:75], 0 offen offset:256
    buffer_load_dwordx2 v[170:171], v151, s[72:75], 0 offen offset:272
    buffer_load_dwordx2 v[172:173], v151, s[72:75], 0 offen offset:384
    buffer_load_dwordx2 v[174:175], v151, s[72:75], 0 offen offset:400
    v_lshlrev_b32 v129, 4, v0
    s_lshl_b32 s3, s2, 12
    v_add_u32 v129, s3, v129
    s_mov_b32 s76, s66
    s_mov_b32 s77, s67
    s_and_b32 s77, s77, 0xffff
    s_mov_b32 s78, 0x4000
    s_mov_b32 s79, 0x00020000
    s_cmp_lt_u32 s2, 4
    s_cbranch_scc0 PM_N0
    v_lshrrev_b32 v130, 4, v129
    v_bfe_u32 v131, v130, 1, 3
    v_lshlrev_b32 v131, 11, v131
    v_lshrrev_b32 v140, 4, v130
    v_lshl_add_u32 v131, v140, 5, v131
    v_and_b32 v140, 1, v130
    v_lshl_add_u32 v131, v140, 2, v131
    buffer_load_dword v176, v131, s[76:79], 0 offen offset:0
    buffer_load_dword v177, v131, s[76:79], 0 offen offset:8
    buffer_load_dword v178, v131, s[76:79], 0 offen offset:16
    buffer_load_dword v179, v131, s[76:79], 0 offen offset:24
PM_N0:
    v_lshl_add_u32 v156, v153, 5, v155
    v_lshlrev_b32 v156, 4, v156
    v_lshl_add_u32 v156, v154, 10, v156
    s_lshl_b32 s90, s21, 14
    s_add_u32 s90, s90, s91
    v_add_u32 v156, s90, v156
    v_lshlrev_b32 v157, 2, v152
    v_add_u32 v157, 131072, v157
    s_lshl_b32 s90, s21, 5
    v_add_u32 v158, s90, v157
    v_mov_b32 v132, -1
    v_mov_b32 v136, 0
    v_mov_b32 v133, -1
    v_mov_b32 v137, 0
    v_mov_b32 v134, -1
    v_mov_b32 v138, 0
    v_mov_b32 v135, -1
    v_mov_b32 v139, 0
    s_mov_b32 s80, s52
    s_mov_b32 s81, s53
    s_and_b32 s81, s81, 0xffff
    s_mov_b32 s82, 0x400000
    s_mov_b32 s83, 0x00020000
    s_add_u32 s84, s52, 0x7000000
    s_addc_u32 s85, s53, 0
    s_and_b32 s85, s85, 0xffff
    s_mov_b32 s86, 0x2100000
    s_mov_b32 s87, 0x00020000
    s_mov_b32 s70, 13631488
    buffer_store_dwordx4 v[132:135], v129, s[4:7], s70 offen sc1
    buffer_store_dwordx4 v[132:135], v129, s[84:87], 0 offen sc1
    s_mov_b32 s70, 33554432
    buffer_store_dwordx4 v[132:135], v129, s[84:87], s70 offen sc1
    s_lshr_b32 s71, s2, 3
    s_mul_i32 s71, s71, 2097152
    s_and_b32 s3, s2, 7
    s_lshl_b32 s3, s3, 12
    s_add_u32 s71, s71, s3
    s_lshl_b32 s70, s21, 10
    v_add_u32 v130, s70, v5
    buffer_store_dwordx4 v[132:135], v130, s[12:15], s71 offen sc1
    s_add_u32 s71, s71, 32768
    buffer_store_dwordx4 v[132:135], v130, s[12:15], s71 offen sc1
    s_add_u32 s71, s71, 32768
    buffer_store_dwordx4 v[132:135], v130, s[12:15], s71 offen sc1
    s_add_u32 s71, s71, 32768
    v_lshrrev_b32 v131, 11, v129
    v_lshlrev_b32 v131, 12, v131
    v_and_b32 v140, 2047, v129
    v_add_u32 v131, v131, v140
    s_mov_b32 s70, 2048
    buffer_store_dwordx4 v[132:135], v131, s[4:7], s70 offen sc1
    s_add_u32 s70, s70, 2097152
    s_mov_b32 s70, 8388608
    buffer_store_dwordx4 v[132:135], v129, s[4:7], s70 offen sc1
    s_add_u32 s70, s70, 1048576
    s_mov_b32 s71, 299008
    v_cmp_gt_u32 vcc, s71, v129
    s_and_saveexec_b64 s[90:91], vcc
    s_cbranch_execz PM_NF
    s_mov_b32 s70, 14688256
    buffer_store_dwordx4 v[136:139], v129, s[4:7], s70 offen sc1
PM_NF:
    s_mov_b64 exec, s[90:91]
    s_cmp_eq_u32 s2, 17
    s_cbranch_scc0 PM_N2
    s_mov_b32 s70, 14684160
    buffer_store_dwordx4 v[132:135], v130, s[4:7], s70 offen sc1
PM_N2:
    s_cmp_ge_u32 s2, 16
    s_cbranch_scc1 PM_LN
    s_cmp_lt_u32 s2, 4
    s_cbranch_scc1 PM_LN
    s_mov_b32 s70, 12582912
    buffer_store_dwordx4 v[132:135], v129, s[4:7], s70 offen sc1
PM_LN:
    s_cmp_eq_u32 s21, 0
    s_cbranch_scc0 PM_NB
    s_waitcnt vmcnt(16)
    v_mov_b32 v181, 144384
    s_mov_b64 exec, 1
    ds_write_b32 v181, v180
    s_mov_b64 exec, -1
    s_waitcnt lgkmcnt(0)
PM_NB:
    s_barrier
    v_mov_b32 v181, 144384
    ds_read_b32 v180, v181
    s_waitcnt lgkmcnt(0)
    v_readfirstlane_b32 s22, v180
    s_cmp_lt_u32 s23, 2
    s_cbranch_scc0 PM_WK
    s_cmp_lt_u32 s22, 32
    s_cbranch_scc0 PM_WK
    s_and_b32 s22, s22, 31
    s_and_b32 s23, s23, 1
    v_lshrrev_b32 v8, 4, v5
    v_mov_b32 v0, 0xeeee
    v_mov_b32 v9, 0x4444
    v_cndmask_b32 v0, v0, v9, s[40:41]
    s_lshl_b32 s46, s21, 11
    v_add_u32 v1, s46, v5
    v_lshrrev_b32 v9, 5, v8
    v_lshlrev_b32 v9, 10, v9
    v_bfe_u32 v10, v8, 4, 1
    v_lshl_add_u32 v9, v10, 9, v9
    v_bfe_u32 v10, v8, 3, 1
    v_lshl_add_u32 v9, v10, 8, v9
    v_and_b32 v10, 7, v8
    v_lshl_add_u32 v9, v10, 4, v9
    v_add_u32 v4, s46, v9
    s_lshl_b32 s46, s21, 16
    s_mul_i32 s47, s22, 64
    s_add_u32 s46, s46, s47
    v_lshrrev_b32 v9, 5, v8
    v_lshlrev_b32 v9, 13, v9
    v_bfe_u32 v10, v8, 4, 1
    v_mul_u32_u24 v10, 4096, v10
    v_add_u32 v9, v9, v10
    v_bfe_u32 v10, v8, 1, 1
    v_mul_u32_u24 v10, 2048, v10
    v_add_u32 v9, v9, v10
    v_bfe_u32 v10, v8, 2, 2
    v_lshl_add_u32 v9, v10, 4, v9
    v_and_b32 v10, 1, v8
    v_lshl_add_u32 v9, v10, 3, v9
    v_add_u32 v2, s46, v9
    s_lshl_b32 s46, s22, 8
    s_and_b32 s47, s21, 1
    s_lshl_b32 s47, s47, 7
    s_add_u32 s46, s46, s47
    s_lshr_b32 s47, s21, 1
    s_lshl_b32 s47, s47, 6
    s_add_u32 s46, s46, s47
    v_and_b32 v9, 3, v8
    v_lshlrev_b32 v9, 4, v9
    v_lshrrev_b32 v10, 4, v8
    v_lshl_add_u32 v9, v10, 2, v9
    v_add_u32 v9, s46, v9
    v_and_b32 v10, 12, v8
    v_cmp_eq_u32 vcc, 0, v10
    v_mov_b32 v3, 0x40000000
    s_nop 1
    v_cndmask_b32 v3, v3, v9, vcc
    s_lshl_b32 s46, s23, 13
    s_add_u32 s24, s46, 12582912
    s_add_u32 s25, s24, 16384
    s_lshl_b32 s46, s23, 18
    s_add_u32 s46, s46, 13631488
    s_add_u32 s28, s46, 0
    s_add_u32 s29, s46, 16384
    s_add_u32 s30, s46, 32768
    s_add_u32 s31, s46, 49152
    s_lshl_b32 s47, s22, 13
    s_add_u32 s26, s46, s47
    s_add_u32 s27, s26, 1024
    s_lshr_b32 s46, s21, 1
    s_mul_i32 s46, s46, 4096
    s_and_b32 s47, s21, 1
    s_mul_i32 s47, s47, 2048
    s_add_u32 s57, s46, s47
    s_mul_i32 s60, s22, 2097152
    s_lshl_b32 s36, s22, 13
    s_add_u32 s37, s36, 16777216
    s_lshl_b32 s46, s21, 12
    s_add_u32 s56, s46, 147456
    s_lshl_b32 s38, s22, 12
    s_add_u32 s38, s38, 2048
    s_lshl_b32 s46, s21, 9
    s_add_u32 s38, s38, s46
    s_lshl_b32 s39, s22, 11
    s_add_u32 s39, s39, 8388608
    s_add_u32 s39, s39, s46
    s_mul_i32 s46, s21, 1536
    s_add_u32 s54, s46, 131072
    s_lshr_b32 s46, s21, 1
    s_lshl_b32 s46, s46, 10
    s_and_b32 s47, s21, 1
    s_lshl_b32 s47, s47, 3
    s_add_u32 s46, s46, s47
    s_add_u32 s55, s46, 139264
    s_mov_b32 s20, 0
    v_lshrrev_b32 v8, 4, v5
    v_and_b32 v9, 1, v8
    v_cmp_eq_u32 vcc, 0, v9
    v_mov_b32 v0, 0xeeee
    v_mov_b32 v9, 0x4444
    v_cndmask_b32 v0, v0, v9, vcc
    s_lshr_b32 s46, s22, 1
    s_lshl_b32 s46, s46, 9
    s_and_b32 s47, s22, 1
    s_lshl_b32 s47, s47, 7
    s_add_u32 s46, s46, s47
    s_lshr_b32 s47, s21, 1
    s_lshl_b32 s47, s47, 6
    s_add_u32 s46, s46, s47
    s_and_b32 s47, s21, 1
    s_lshl_b32 s47, s47, 4
    s_add_u32 s46, s46, s47
    v_bfe_u32 v9, v8, 1, 1
    v_lshlrev_b32 v9, 8, v9
    v_and_b32 v10, 1, v8
    v_lshl_add_u32 v9, v10, 5, v9
    v_lshrrev_b32 v10, 4, v8
    v_lshl_add_u32 v9, v10, 2, v9
    v_add_u32 v9, s46, v9
    v_and_b32 v10, 12, v8
    v_cmp_eq_u32 vcc, 0, v10
    v_mov_b32 v3, 0x40000000
    s_nop 1
    v_cndmask_b32 v3, v3, v9, vcc
    s_mov_b32 s43, 63
    v_lshrrev_b32 v8, 4, v5
    v_add_u32 v12, 141312, v5
    v_and_b32 v11, 1, v8
    v_bfe_u32 v9, v8, 3, 1
    v_lshl_add_u32 v11, v9, 2, v11
    v_bfe_u32 v9, v8, 1, 2
    v_lshrrev_b32 v10, 4, v8
    v_xor_b32 v9, v9, v10
    v_lshl_add_u32 v11, v9, 6, v11
    v_and_b32 v9, 1, v11
    v_lshlrev_b32 v9, 4, v9
    v_mov_b32 v13, 0x3f80
    v_lshlrev_b32 v13, v9, v13
    v_lshrrev_b32 v9, 1, v11
    v_cmp_eq_u32 vcc, 0, v9
    s_nop 1
    v_cndmask_b32 v16, 0, v13, vcc
    v_cmp_eq_u32 vcc, 1, v9
    s_nop 1
    v_cndmask_b32 v17, 0, v13, vcc
    v_cmp_eq_u32 vcc, 2, v9
    s_nop 1
    v_cndmask_b32 v18, 0, v13, vcc
    v_cmp_eq_u32 vcc, 3, v9
    s_nop 1
    v_cndmask_b32 v19, 0, v13, vcc
    ds_write_b128 v12, v[16:19] offset:0
    s_waitcnt lgkmcnt(0)
    v_and_b32 v11, 1, v8
    v_bfe_u32 v9, v8, 3, 1
    v_lshl_add_u32 v11, v9, 2, v11
    v_add_u32 v11, 2, v11
    v_bfe_u32 v9, v8, 1, 2
    v_lshrrev_b32 v10, 4, v8
    v_xor_b32 v9, v9, v10
    v_lshl_add_u32 v11, v9, 6, v11
    v_and_b32 v9, 1, v11
    v_lshlrev_b32 v9, 4, v9
    v_mov_b32 v13, 0x3f80
    v_lshlrev_b32 v13, v9, v13
    v_lshrrev_b32 v9, 1, v11
    v_cmp_eq_u32 vcc, 0, v9
    s_nop 1
    v_cndmask_b32 v16, 0, v13, vcc
    v_cmp_eq_u32 vcc, 1, v9
    s_nop 1
    v_cndmask_b32 v17, 0, v13, vcc
    v_cmp_eq_u32 vcc, 2, v9
    s_nop 1
    v_cndmask_b32 v18, 0, v13, vcc
    v_cmp_eq_u32 vcc, 3, v9
    s_nop 1
    v_cndmask_b32 v19, 0, v13, vcc
    ds_write_b128 v12, v[16:19] offset:1024
    s_waitcnt lgkmcnt(0)
    v_and_b32 v11, 7, v8
    v_and_b32 v9, 1, v11
    v_lshlrev_b32 v9, 4, v9
    v_mov_b32 v13, 0x3f80
    v_lshlrev_b32 v13, v9, v13
    v_lshrrev_b32 v9, 1, v11
    v_cmp_eq_u32 vcc, 0, v9
    s_nop 1
    v_cndmask_b32 v16, 0, v13, vcc
    v_cmp_eq_u32 vcc, 1, v9
    s_nop 1
    v_cndmask_b32 v17, 0, v13, vcc
    v_cmp_eq_u32 vcc, 2, v9
    s_nop 1
    v_cndmask_b32 v18, 0, v13, vcc
    v_cmp_eq_u32 vcc, 3, v9
    s_nop 1
    v_cndmask_b32 v19, 0, v13, vcc
    ds_write_b128 v12, v[16:19] offset:2048
    s_waitcnt lgkmcnt(0)
    v_lshrrev_b32 v8, 4, v5
    v_lshrrev_b32 v9, 4, v8
    v_and_b32 v10, 1, v9
    v_lshrrev_b32 v11, 1, v9
    v_lshl_or_b32 v10, v11, 2, v10
    v_and_b32 v11, 15, v8
    v_xor_b32 v10, v10, v11
    v_lshlrev_b32 v9, 13, v9
    v_lshl_add_u32 v9, v10, 4, v9
    s_lshl_b32 s46, s22, 8
    v_add_u32 v12, s46, v9
    v_lshrrev_b32 v9, 4, v8
    v_lshlrev_b32 v9, 3, v9
    v_bfe_u32 v10, v8, 2, 2
    v_add_u32 v9, v9, v10
    v_lshlrev_b32 v9, 8, v9
    v_and_b32 v11, 1, v10
    v_lshrrev_b32 v10, 1, v10
    v_lshl_or_b32 v10, v10, 2, v11
    v_bfe_u32 v11, v8, 1, 1
    v_lshlrev_b32 v11, 1, v11
    s_lshl_b32 s46, s21, 2
    v_add_u32 v11, s46, v11
    v_xor_b32 v10, v10, v11
    v_lshl_add_u32 v9, v10, 4, v9
    v_and_b32 v10, 1, v8
    v_lshl_add_u32 v9, v10, 3, v9
    s_and_b32 s46, s21, 1
    s_xor_b32 s46, s46, 0
    s_lshl_b32 s46, s46, 15
    v_add_u32 v14, s46, v9
    v_xor_b32 v15, 16, v14
    v_add_u32 v18, 65536, v14
    v_add_u32 v19, 65536, v15
    s_and_b32 s46, s21, 1
    s_xor_b32 s46, s46, 1
    s_lshl_b32 s46, s46, 15
    v_add_u32 v16, s46, v9
    v_xor_b32 v17, 16, v16
    v_add_u32 v20, 65536, v16
    v_add_u32 v21, 65536, v17
    s_lshl_b32 s46, s23, 10
    v_add_u32 v9, s46, v5
    v_xor_b32 v24, 0, v9
    v_xor_b32 v25, 32, v9
    v_xor_b32 v26, 64, v9
    v_xor_b32 v27, 96, v9
    v_bfe_u32 v9, v8, 4, 1
    v_lshlrev_b32 v9, 5, v9
    v_lshrrev_b32 v10, 5, v8
    v_lshl_add_u32 v9, v10, 2, v9
    v_bfe_u32 v10, v8, 2, 2
    v_add_u32 v9, v9, v10
    v_lshlrev_b32 v9, 10, v9
    v_lshl_add_u32 v9, v10, 5, v9
    v_and_b32 v10, 3, v8
    v_lshl_add_u32 v9, v10, 3, v9
    s_lshl_b32 s46, s21, 8
    v_add_u32 v9, s46, v9
    v_xor_b32 v32, 0, v9
    v_add_u32 v40, 65536, v32
    v_xor_b32 v33, 32, v9
    v_add_u32 v41, 65536, v33
    v_xor_b32 v34, 64, v9
    v_add_u32 v42, 65536, v34
    v_xor_b32 v35, 96, v9
    v_add_u32 v43, 65536, v35
    v_xor_b32 v36, 128, v9
    v_add_u32 v44, 65536, v36
    v_xor_b32 v37, 160, v9
    v_add_u32 v45, 65536, v37
    v_xor_b32 v38, 192, v9
    v_add_u32 v46, 65536, v38
    v_xor_b32 v39, 224, v9
    v_add_u32 v47, 65536, v39
    s_lshl_b32 s46, s21, 14
    v_add_u32 v48, s46, v5
    s_mov_b32 s16, s50
    s_mov_b32 s17, s51
    s_and_b32 s17, s17, 0xffff
    s_mov_b32 s18, 0x800000
    s_mov_b32 s19, 0x00020000
    s_lshl_b32 s46, s23, 22
    s_lshl_b32 s47, s21, 19
    s_add_u32 s46, s46, s47
    s_add_u32 s46, s46, 0
    s_lshl_b32 s47, s21, 14
    s_add_u32 m0, s47, 0
    buffer_load_dwordx4 v12, s[16:19], s46 offen lds
    s_add_u32 s46, s46, 32768
    s_add_u32 m0, m0, 1024
    s_nop 0
    buffer_load_dwordx4 v12, s[16:19], s46 offen lds
    s_add_u32 s46, s46, 32768
    s_add_u32 m0, m0, 1024
    s_nop 0
    buffer_load_dwordx4 v12, s[16:19], s46 offen lds
    s_add_u32 s46, s46, 32768
    s_add_u32 m0, m0, 1024
    s_nop 0
    buffer_load_dwordx4 v12, s[16:19], s46 offen lds
    s_add_u32 s46, s46, 32768
    s_add_u32 m0, m0, 1024
    s_nop 0
    buffer_load_dwordx4 v12, s[16:19], s46 offen lds
    s_add_u32 s46, s46, 32768
    s_add_u32 m0, m0, 1024
    s_nop 0
    buffer_load_dwordx4 v12, s[16:19], s46 offen lds
    s_add_u32 s46, s46, 32768
    s_add_u32 m0, m0, 1024
    s_nop 0
    buffer_load_dwordx4 v12, s[16:19], s46 offen lds
    s_add_u32 s46, s46, 32768
    s_add_u32 m0, m0, 1024
    s_nop 0
    buffer_load_dwordx4 v12, s[16:19], s46 offen lds
    s_add_u32 s46, s46, 32768
    s_add_u32 m0, m0, 1024
    s_nop 0
    buffer_load_dwordx4 v12, s[16:19], s46 offen lds
    s_add_u32 s46, s46, 32768
    s_add_u32 m0, m0, 1024
    s_nop 0
    buffer_load_dwordx4 v12, s[16:19], s46 offen lds
    s_add_u32 s46, s46, 32768
    s_add_u32 m0, m0, 1024
    s_nop 0
    buffer_load_dwordx4 v12, s[16:19], s46 offen lds
    s_add_u32 s46, s46, 32768
    s_add_u32 m0, m0, 1024
    s_nop 0
    buffer_load_dwordx4 v12, s[16:19], s46 offen lds
    s_add_u32 s46, s46, 32768
    s_add_u32 m0, m0, 1024
    s_nop 0
    buffer_load_dwordx4 v12, s[16:19], s46 offen lds
    s_add_u32 s46, s46, 32768
    s_add_u32 m0, m0, 1024
    s_nop 0
    buffer_load_dwordx4 v12, s[16:19], s46 offen lds
    s_add_u32 s46, s46, 32768
    s_add_u32 m0, m0, 1024
    s_nop 0
    buffer_load_dwordx4 v12, s[16:19], s46 offen lds
    s_add_u32 s46, s46, 32768
    s_add_u32 m0, m0, 1024
    s_nop 0
    buffer_load_dwordx4 v12, s[16:19], s46 offen lds
    s_waitcnt vmcnt(24)
    s_cmp_lt_u32 s2, 4
    s_cbranch_scc0 PM_N1R
    v_min_u32 v176, -2, v176
    v_min_u32 v177, -2, v177
    v_min_u32 v178, -2, v178
    v_min_u32 v179, -2, v179
    s_mov_b32 s70, 12582912
    buffer_store_dwordx4 v[176:179], v129, s[4:7], s70 offen sc1
PM_N1R:
    v_lshlrev_b32 v192, 16, v160
    v_and_b32 v193, 0xffff0000, v160
    v_lshlrev_b32 v194, 16, v161
    v_and_b32 v195, 0xffff0000, v161
    v_lshlrev_b32 v196, 16, v162
    v_and_b32 v197, 0xffff0000, v162
    v_lshlrev_b32 v198, 16, v163
    v_and_b32 v199, 0xffff0000, v163
    v_lshlrev_b32 v200, 16, v164
    v_and_b32 v201, 0xffff0000, v164
    v_lshlrev_b32 v202, 16, v165
    v_and_b32 v203, 0xffff0000, v165
    v_lshlrev_b32 v204, 16, v166
    v_and_b32 v205, 0xffff0000, v166
    v_lshlrev_b32 v206, 16, v167
    v_and_b32 v207, 0xffff0000, v167
    v_lshlrev_b32 v208, 16, v168
    v_and_b32 v209, 0xffff0000, v168
    v_lshlrev_b32 v210, 16, v169
    v_and_b32 v211, 0xffff0000, v169
    v_lshlrev_b32 v212, 16, v170
    v_and_b32 v213, 0xffff0000, v170
    v_lshlrev_b32 v214, 16, v171
    v_and_b32 v215, 0xffff0000, v171
    v_lshlrev_b32 v216, 16, v172
    v_and_b32 v217, 0xffff0000, v172
    v_lshlrev_b32 v218, 16, v173
    v_and_b32 v219, 0xffff0000, v173
    v_lshlrev_b32 v220, 16, v174
    v_and_b32 v221, 0xffff0000, v174
    v_lshlrev_b32 v222, 16, v175
    v_and_b32 v223, 0xffff0000, v175
    v_add_f32 v144, v192, v196
    v_add_f32 v145, v193, v197
    v_add_f32 v146, v194, v198
    v_add_f32 v147, v195, v199
    v_add_f32 v144, v144, v200
    v_add_f32 v145, v145, v201
    v_add_f32 v146, v146, v202
    v_add_f32 v147, v147, v203
    v_add_f32 v144, v144, v204
    v_add_f32 v145, v145, v205
    v_add_f32 v146, v146, v206
    v_add_f32 v147, v147, v207
    v_add_f32 v144, v144, v208
    v_add_f32 v145, v145, v209
    v_add_f32 v146, v146, v210
    v_add_f32 v147, v147, v211
    v_add_f32 v144, v144, v212
    v_add_f32 v145, v145, v213
    v_add_f32 v146, v146, v214
    v_add_f32 v147, v147, v215
    v_add_f32 v144, v144, v216
    v_add_f32 v145, v145, v217
    v_add_f32 v146, v146, v218
    v_add_f32 v147, v147, v219
    v_add_f32 v144, v144, v220
    v_add_f32 v145, v145, v221
    v_add_f32 v146, v146, v222
    v_add_f32 v147, v147, v223
    v_add_f32 v144, v144, v145
    v_add_f32 v146, v146, v147
    v_add_f32 v144, v144, v146
    s_nop 1
    v_add_f32_dpp v144, v144, v144 row_ror:8 row_mask:0xf bank_mask:0xf
    v_mov_b32 v159, v144
    s_nop 1
    v_permlane16_swap_b32 v144, v159
    s_nop 1
    v_add_f32 v144, v144, v159
    v_mov_b32 v159, v144
    s_nop 1
    v_permlane32_swap_b32 v144, v159
    s_nop 1
    v_add_f32 v144, v144, v159
    ds_write_b32 v158, v144
    s_waitcnt lgkmcnt(0)
    s_barrier
    ds_read_b32 v144, v157 offset:0
    ds_read_b32 v145, v157 offset:32
    ds_read_b32 v146, v157 offset:64
    ds_read_b32 v147, v157 offset:96
    s_waitcnt lgkmcnt(0)
    v_add_f32 v144, v144, v145
    v_add_f32 v146, v146, v147
    v_add_f32 v148, v144, v146
    v_mul_f32 v148, 0x3a800000, v148
    v_mov_b32 v144, 0
    v_mov_b32 v145, 0
    v_mov_b32 v146, 0
    v_mov_b32 v147, 0
    v_sub_f32 v224, v192, v148
    v_sub_f32 v225, v193, v148
    v_sub_f32 v226, v194, v148
    v_sub_f32 v227, v195, v148
    v_fmac_f32 v144, v224, v224
    v_fmac_f32 v145, v225, v225
    v_fmac_f32 v146, v226, v226
    v_fmac_f32 v147, v227, v227
    v_sub_f32 v224, v196, v148
    v_sub_f32 v225, v197, v148
    v_sub_f32 v226, v198, v148
    v_sub_f32 v227, v199, v148
    v_fmac_f32 v144, v224, v224
    v_fmac_f32 v145, v225, v225
    v_fmac_f32 v146, v226, v226
    v_fmac_f32 v147, v227, v227
    v_sub_f32 v224, v200, v148
    v_sub_f32 v225, v201, v148
    v_sub_f32 v226, v202, v148
    v_sub_f32 v227, v203, v148
    v_fmac_f32 v144, v224, v224
    v_fmac_f32 v145, v225, v225
    v_fmac_f32 v146, v226, v226
    v_fmac_f32 v147, v227, v227
    v_sub_f32 v224, v204, v148
    v_sub_f32 v225, v205, v148
    v_sub_f32 v226, v206, v148
    v_sub_f32 v227, v207, v148
    v_fmac_f32 v144, v224, v224
    v_fmac_f32 v145, v225, v225
    v_fmac_f32 v146, v226, v226
    v_fmac_f32 v147, v227, v227
    v_sub_f32 v224, v208, v148
    v_sub_f32 v225, v209, v148
    v_sub_f32 v226, v210, v148
    v_sub_f32 v227, v211, v148
    v_fmac_f32 v144, v224, v224
    v_fmac_f32 v145, v225, v225
    v_fmac_f32 v146, v226, v226
    v_fmac_f32 v147, v227, v227
    v_sub_f32 v224, v212, v148
    v_sub_f32 v225, v213, v148
    v_sub_f32 v226, v214, v148
    v_sub_f32 v227, v215, v148
    v_fmac_f32 v144, v224, v224
    v_fmac_f32 v145, v225, v225
    v_fmac_f32 v146, v226, v226
    v_fmac_f32 v147, v227, v227
    v_sub_f32 v224, v216, v148
    v_sub_f32 v225, v217, v148
    v_sub_f32 v226, v218, v148
    v_sub_f32 v227, v219, v148
    v_fmac_f32 v144, v224, v224
    v_fmac_f32 v145, v225, v225
    v_fmac_f32 v146, v226, v226
    v_fmac_f32 v147, v227, v227
    v_sub_f32 v224, v220, v148
    v_sub_f32 v225, v221, v148
    v_sub_f32 v226, v222, v148
    v_sub_f32 v227, v223, v148
    v_fmac_f32 v144, v224, v224
    v_fmac_f32 v145, v225, v225
    v_fmac_f32 v146, v226, v226
    v_fmac_f32 v147, v227, v227
    v_add_f32 v144, v144, v145
    v_add_f32 v146, v146, v147
    v_add_f32 v149, v144, v146
    s_nop 1
    v_add_f32_dpp v149, v149, v149 row_ror:8 row_mask:0xf bank_mask:0xf
    v_mov_b32 v159, v149
    s_nop 1
    v_permlane16_swap_b32 v149, v159
    s_nop 1
    v_add_f32 v149, v149, v159
    v_mov_b32 v159, v149
    s_nop 1
    v_permlane32_swap_b32 v149, v159
    s_nop 1
    v_add_f32 v149, v149, v159
    ds_write_b32 v158, v149 offset:128
    s_waitcnt lgkmcnt(0)
    s_barrier
    ds_read_b32 v144, v157 offset:128
    ds_read_b32 v145, v157 offset:160
    ds_read_b32 v146, v157 offset:192
    ds_read_b32 v147, v157 offset:224
    s_waitcnt lgkmcnt(0)
    v_add_f32 v144, v144, v145
    v_add_f32 v146, v146, v147
    v_add_f32 v149, v144, v146
    v_mul_f32 v149, 0x3a800000, v149
    v_cvt_pk_bf16_f32 v149, v149, v149
    v_and_b32 v149, 0xffff0000, v149
    v_add_f32 v149, 0x3727c5ac, v149
    v_cvt_pk_bf16_f32 v149, v149, v149
    v_and_b32 v149, 0xffff0000, v149
    v_sqrt_f32 v149, v149
    s_nop 0
    v_cvt_pk_bf16_f32 v149, v149, v149
    v_and_b32 v149, 0xffff0000, v149
    v_rcp_f32 v149, v149
    v_cvt_pk_bf16_f32 v148, v148, v148
    v_and_b32 v148, 0xffff0000, v148
    v_sub_f32 v192, v192, v148
    v_sub_f32 v193, v193, v148
    v_sub_f32 v194, v194, v148
    v_sub_f32 v195, v195, v148
    v_sub_f32 v196, v196, v148
    v_sub_f32 v197, v197, v148
    v_sub_f32 v198, v198, v148
    v_sub_f32 v199, v199, v148
    v_sub_f32 v200, v200, v148
    v_sub_f32 v201, v201, v148
    v_sub_f32 v202, v202, v148
    v_sub_f32 v203, v203, v148
    v_sub_f32 v204, v204, v148
    v_sub_f32 v205, v205, v148
    v_sub_f32 v206, v206, v148
    v_sub_f32 v207, v207, v148
    v_sub_f32 v208, v208, v148
    v_sub_f32 v209, v209, v148
    v_sub_f32 v210, v210, v148
    v_sub_f32 v211, v211, v148
    v_sub_f32 v212, v212, v148
    v_sub_f32 v213, v213, v148
    v_sub_f32 v214, v214, v148
    v_sub_f32 v215, v215, v148
    v_sub_f32 v216, v216, v148
    v_sub_f32 v217, v217, v148
    v_sub_f32 v218, v218, v148
    v_sub_f32 v219, v219, v148
    v_sub_f32 v220, v220, v148
    v_sub_f32 v221, v221, v148
    v_sub_f32 v222, v222, v148
    v_sub_f32 v223, v223, v148
    v_cvt_pk_bf16_f32 v224, v192, v193
    v_cvt_pk_bf16_f32 v225, v194, v195
    v_cvt_pk_bf16_f32 v226, v196, v197
    v_cvt_pk_bf16_f32 v227, v198, v199
    v_cvt_pk_bf16_f32 v228, v200, v201
    v_cvt_pk_bf16_f32 v229, v202, v203
    v_cvt_pk_bf16_f32 v230, v204, v205
    v_cvt_pk_bf16_f32 v231, v206, v207
    v_cvt_pk_bf16_f32 v232, v208, v209
    v_cvt_pk_bf16_f32 v233, v210, v211
    v_cvt_pk_bf16_f32 v234, v212, v213
    v_cvt_pk_bf16_f32 v235, v214, v215
    v_cvt_pk_bf16_f32 v236, v216, v217
    v_cvt_pk_bf16_f32 v237, v218, v219
    v_cvt_pk_bf16_f32 v238, v220, v221
    v_cvt_pk_bf16_f32 v239, v222, v223
    v_lshlrev_b32 v192, 16, v224
    v_and_b32 v193, 0xffff0000, v224
    v_lshlrev_b32 v194, 16, v225
    v_and_b32 v195, 0xffff0000, v225
    v_lshlrev_b32 v196, 16, v226
    v_and_b32 v197, 0xffff0000, v226
    v_lshlrev_b32 v198, 16, v227
    v_and_b32 v199, 0xffff0000, v227
    v_lshlrev_b32 v200, 16, v228
    v_and_b32 v201, 0xffff0000, v228
    v_lshlrev_b32 v202, 16, v229
    v_and_b32 v203, 0xffff0000, v229
    v_lshlrev_b32 v204, 16, v230
    v_and_b32 v205, 0xffff0000, v230
    v_lshlrev_b32 v206, 16, v231
    v_and_b32 v207, 0xffff0000, v231
    v_lshlrev_b32 v208, 16, v232
    v_and_b32 v209, 0xffff0000, v232
    v_lshlrev_b32 v210, 16, v233
    v_and_b32 v211, 0xffff0000, v233
    v_lshlrev_b32 v212, 16, v234
    v_and_b32 v213, 0xffff0000, v234
    v_lshlrev_b32 v214, 16, v235
    v_and_b32 v215, 0xffff0000, v235
    v_lshlrev_b32 v216, 16, v236
    v_and_b32 v217, 0xffff0000, v236
    v_lshlrev_b32 v218, 16, v237
    v_and_b32 v219, 0xffff0000, v237
    v_lshlrev_b32 v220, 16, v238
    v_and_b32 v221, 0xffff0000, v238
    v_lshlrev_b32 v222, 16, v239
    v_and_b32 v223, 0xffff0000, v239
    v_mul_f32 v192, v192, v149
    v_mul_f32 v193, v193, v149
    v_mul_f32 v194, v194, v149
    v_mul_f32 v195, v195, v149
    v_mul_f32 v196, v196, v149
    v_mul_f32 v197, v197, v149
    v_mul_f32 v198, v198, v149
    v_mul_f32 v199, v199, v149
    v_mul_f32 v200, v200, v149
    v_mul_f32 v201, v201, v149
    v_mul_f32 v202, v202, v149
    v_mul_f32 v203, v203, v149
    v_mul_f32 v204, v204, v149
    v_mul_f32 v205, v205, v149
    v_mul_f32 v206, v206, v149
    v_mul_f32 v207, v207, v149
    v_mul_f32 v208, v208, v149
    v_mul_f32 v209, v209, v149
    v_mul_f32 v210, v210, v149
    v_mul_f32 v211, v211, v149
    v_mul_f32 v212, v212, v149
    v_mul_f32 v213, v213, v149
    v_mul_f32 v214, v214, v149
    v_mul_f32 v215, v215, v149
    v_mul_f32 v216, v216, v149
    v_mul_f32 v217, v217, v149
    v_mul_f32 v218, v218, v149
    v_mul_f32 v219, v219, v149
    v_mul_f32 v220, v220, v149
    v_mul_f32 v221, v221, v149
    v_mul_f32 v222, v222, v149
    v_mul_f32 v223, v223, v149
    v_cvt_pk_bf16_f32 v224, v192, v193
    v_cvt_pk_bf16_f32 v225, v194, v195
    v_cvt_pk_bf16_f32 v226, v196, v197
    v_cvt_pk_bf16_f32 v227, v198, v199
    v_cvt_pk_bf16_f32 v228, v200, v201
    v_cvt_pk_bf16_f32 v229, v202, v203
    v_cvt_pk_bf16_f32 v230, v204, v205
    v_cvt_pk_bf16_f32 v231, v206, v207
    v_cvt_pk_bf16_f32 v232, v208, v209
    v_cvt_pk_bf16_f32 v233, v210, v211
    v_cvt_pk_bf16_f32 v234, v212, v213
    v_cvt_pk_bf16_f32 v235, v214, v215
    v_cvt_pk_bf16_f32 v236, v216, v217
    v_cvt_pk_bf16_f32 v237, v218, v219
    v_cvt_pk_bf16_f32 v238, v220, v221
    v_cvt_pk_bf16_f32 v239, v222, v223
    s_mov_b32 s70, 0
    buffer_store_dwordx4 v[224:227], v156, s[80:83], s70 offen sc1
    s_mov_b32 s70, 4096
    buffer_store_dwordx4 v[228:231], v156, s[80:83], s70 offen sc1
    s_mov_b32 s70, 8192
    buffer_store_dwordx4 v[232:235], v156, s[80:83], s70 offen sc1
    s_mov_b32 s70, 12288
    buffer_store_dwordx4 v[236:239], v156, s[80:83], s70 offen sc1
    s_mov_b32 s99, 0
    s_mov_b32 s61, 1
    s_branch RC_CONT
PM_WK:
    s_waitcnt vmcnt(8)
    s_cmp_lt_u32 s2, 4
    s_cbranch_scc0 PM_N1W
    v_min_u32 v176, -2, v176
    v_min_u32 v177, -2, v177
    v_min_u32 v178, -2, v178
    v_min_u32 v179, -2, v179
    s_mov_b32 s70, 12582912
    buffer_store_dwordx4 v[176:179], v129, s[4:7], s70 offen sc1
PM_N1W:
    v_lshlrev_b32 v192, 16, v160
    v_and_b32 v193, 0xffff0000, v160
    v_lshlrev_b32 v194, 16, v161
    v_and_b32 v195, 0xffff0000, v161
    v_lshlrev_b32 v196, 16, v162
    v_and_b32 v197, 0xffff0000, v162
    v_lshlrev_b32 v198, 16, v163
    v_and_b32 v199, 0xffff0000, v163
    v_lshlrev_b32 v200, 16, v164
    v_and_b32 v201, 0xffff0000, v164
    v_lshlrev_b32 v202, 16, v165
    v_and_b32 v203, 0xffff0000, v165
    v_lshlrev_b32 v204, 16, v166
    v_and_b32 v205, 0xffff0000, v166
    v_lshlrev_b32 v206, 16, v167
    v_and_b32 v207, 0xffff0000, v167
    v_lshlrev_b32 v208, 16, v168
    v_and_b32 v209, 0xffff0000, v168
    v_lshlrev_b32 v210, 16, v169
    v_and_b32 v211, 0xffff0000, v169
    v_lshlrev_b32 v212, 16, v170
    v_and_b32 v213, 0xffff0000, v170
    v_lshlrev_b32 v214, 16, v171
    v_and_b32 v215, 0xffff0000, v171
    v_lshlrev_b32 v216, 16, v172
    v_and_b32 v217, 0xffff0000, v172
    v_lshlrev_b32 v218, 16, v173
    v_and_b32 v219, 0xffff0000, v173
    v_lshlrev_b32 v220, 16, v174
    v_and_b32 v221, 0xffff0000, v174
    v_lshlrev_b32 v222, 16, v175
    v_and_b32 v223, 0xffff0000, v175
    v_add_f32 v144, v192, v196
    v_add_f32 v145, v193, v197
    v_add_f32 v146, v194, v198
    v_add_f32 v147, v195, v199
    v_add_f32 v144, v144, v200
    v_add_f32 v145, v145, v201
    v_add_f32 v146, v146, v202
    v_add_f32 v147, v147, v203
    v_add_f32 v144, v144, v204
    v_add_f32 v145, v145, v205
    v_add_f32 v146, v146, v206
    v_add_f32 v147, v147, v207
    v_add_f32 v144, v144, v208
    v_add_f32 v145, v145, v209
    v_add_f32 v146, v146, v210
    v_add_f32 v147, v147, v211
    v_add_f32 v144, v144, v212
    v_add_f32 v145, v145, v213
    v_add_f32 v146, v146, v214
    v_add_f32 v147, v147, v215
    v_add_f32 v144, v144, v216
    v_add_f32 v145, v145, v217
    v_add_f32 v146, v146, v218
    v_add_f32 v147, v147, v219
    v_add_f32 v144, v144, v220
    v_add_f32 v145, v145, v221
    v_add_f32 v146, v146, v222
    v_add_f32 v147, v147, v223
    v_add_f32 v144, v144, v145
    v_add_f32 v146, v146, v147
    v_add_f32 v144, v144, v146
    s_nop 1
    v_add_f32_dpp v144, v144, v144 row_ror:8 row_mask:0xf bank_mask:0xf
    v_mov_b32 v159, v144
    s_nop 1
    v_permlane16_swap_b32 v144, v159
    s_nop 1
    v_add_f32 v144, v144, v159
    v_mov_b32 v159, v144
    s_nop 1
    v_permlane32_swap_b32 v144, v159
    s_nop 1
    v_add_f32 v144, v144, v159
    ds_write_b32 v158, v144
    s_waitcnt lgkmcnt(0)
    s_barrier
    ds_read_b32 v144, v157 offset:0
    ds_read_b32 v145, v157 offset:32
    ds_read_b32 v146, v157 offset:64
    ds_read_b32 v147, v157 offset:96
    s_waitcnt lgkmcnt(0)
    v_add_f32 v144, v144, v145
    v_add_f32 v146, v146, v147
    v_add_f32 v148, v144, v146
    v_mul_f32 v148, 0x3a800000, v148
    v_mov_b32 v144, 0
    v_mov_b32 v145, 0
    v_mov_b32 v146, 0
    v_mov_b32 v147, 0
    v_sub_f32 v224, v192, v148
    v_sub_f32 v225, v193, v148
    v_sub_f32 v226, v194, v148
    v_sub_f32 v227, v195, v148
    v_fmac_f32 v144, v224, v224
    v_fmac_f32 v145, v225, v225
    v_fmac_f32 v146, v226, v226
    v_fmac_f32 v147, v227, v227
    v_sub_f32 v224, v196, v148
    v_sub_f32 v225, v197, v148
    v_sub_f32 v226, v198, v148
    v_sub_f32 v227, v199, v148
    v_fmac_f32 v144, v224, v224
    v_fmac_f32 v145, v225, v225
    v_fmac_f32 v146, v226, v226
    v_fmac_f32 v147, v227, v227
    v_sub_f32 v224, v200, v148
    v_sub_f32 v225, v201, v148
    v_sub_f32 v226, v202, v148
    v_sub_f32 v227, v203, v148
    v_fmac_f32 v144, v224, v224
    v_fmac_f32 v145, v225, v225
    v_fmac_f32 v146, v226, v226
    v_fmac_f32 v147, v227, v227
    v_sub_f32 v224, v204, v148
    v_sub_f32 v225, v205, v148
    v_sub_f32 v226, v206, v148
    v_sub_f32 v227, v207, v148
    v_fmac_f32 v144, v224, v224
    v_fmac_f32 v145, v225, v225
    v_fmac_f32 v146, v226, v226
    v_fmac_f32 v147, v227, v227
    v_sub_f32 v224, v208, v148
    v_sub_f32 v225, v209, v148
    v_sub_f32 v226, v210, v148
    v_sub_f32 v227, v211, v148
    v_fmac_f32 v144, v224, v224
    v_fmac_f32 v145, v225, v225
    v_fmac_f32 v146, v226, v226
    v_fmac_f32 v147, v227, v227
    v_sub_f32 v224, v212, v148
    v_sub_f32 v225, v213, v148
    v_sub_f32 v226, v214, v148
    v_sub_f32 v227, v215, v148
    v_fmac_f32 v144, v224, v224
    v_fmac_f32 v145, v225, v225
    v_fmac_f32 v146, v226, v226
    v_fmac_f32 v147, v227, v227
    v_sub_f32 v224, v216, v148
    v_sub_f32 v225, v217, v148
    v_sub_f32 v226, v218, v148
    v_sub_f32 v227, v219, v148
    v_fmac_f32 v144, v224, v224
    v_fmac_f32 v145, v225, v225
    v_fmac_f32 v146, v226, v226
    v_fmac_f32 v147, v227, v227
    v_sub_f32 v224, v220, v148
    v_sub_f32 v225, v221, v148
    v_sub_f32 v226, v222, v148
    v_sub_f32 v227, v223, v148
    v_fmac_f32 v144, v224, v224
    v_fmac_f32 v145, v225, v225
    v_fmac_f32 v146, v226, v226
    v_fmac_f32 v147, v227, v227
    v_add_f32 v144, v144, v145
    v_add_f32 v146, v146, v147
    v_add_f32 v149, v144, v146
    s_nop 1
    v_add_f32_dpp v149, v149, v149 row_ror:8 row_mask:0xf bank_mask:0xf
    v_mov_b32 v159, v149
    s_nop 1
    v_permlane16_swap_b32 v149, v159
    s_nop 1
    v_add_f32 v149, v149, v159
    v_mov_b32 v159, v149
    s_nop 1
    v_permlane32_swap_b32 v149, v159
    s_nop 1
    v_add_f32 v149, v149, v159
    ds_write_b32 v158, v149 offset:128
    s_waitcnt lgkmcnt(0)
    s_barrier
    ds_read_b32 v144, v157 offset:128
    ds_read_b32 v145, v157 offset:160
    ds_read_b32 v146, v157 offset:192
    ds_read_b32 v147, v157 offset:224
    s_waitcnt lgkmcnt(0)
    v_add_f32 v144, v144, v145
    v_add_f32 v146, v146, v147
    v_add_f32 v149, v144, v146
    v_mul_f32 v149, 0x3a800000, v149
    v_cvt_pk_bf16_f32 v149, v149, v149
    v_and_b32 v149, 0xffff0000, v149
    v_add_f32 v149, 0x3727c5ac, v149
    v_cvt_pk_bf16_f32 v149, v149, v149
    v_and_b32 v149, 0xffff0000, v149
    v_sqrt_f32 v149, v149
    s_nop 0
    v_cvt_pk_bf16_f32 v149, v149, v149
    v_and_b32 v149, 0xffff0000, v149
    v_rcp_f32 v149, v149
    v_cvt_pk_bf16_f32 v148, v148, v148
    v_and_b32 v148, 0xffff0000, v148
    v_sub_f32 v192, v192, v148
    v_sub_f32 v193, v193, v148
    v_sub_f32 v194, v194, v148
    v_sub_f32 v195, v195, v148
    v_sub_f32 v196, v196, v148
    v_sub_f32 v197, v197, v148
    v_sub_f32 v198, v198, v148
    v_sub_f32 v199, v199, v148
    v_sub_f32 v200, v200, v148
    v_sub_f32 v201, v201, v148
    v_sub_f32 v202, v202, v148
    v_sub_f32 v203, v203, v148
    v_sub_f32 v204, v204, v148
    v_sub_f32 v205, v205, v148
    v_sub_f32 v206, v206, v148
    v_sub_f32 v207, v207, v148
    v_sub_f32 v208, v208, v148
    v_sub_f32 v209, v209, v148
    v_sub_f32 v210, v210, v148
    v_sub_f32 v211, v211, v148
    v_sub_f32 v212, v212, v148
    v_sub_f32 v213, v213, v148
    v_sub_f32 v214, v214, v148
    v_sub_f32 v215, v215, v148
    v_sub_f32 v216, v216, v148
    v_sub_f32 v217, v217, v148
    v_sub_f32 v218, v218, v148
    v_sub_f32 v219, v219, v148
    v_sub_f32 v220, v220, v148
    v_sub_f32 v221, v221, v148
    v_sub_f32 v222, v222, v148
    v_sub_f32 v223, v223, v148
    v_cvt_pk_bf16_f32 v224, v192, v193
    v_cvt_pk_bf16_f32 v225, v194, v195
    v_cvt_pk_bf16_f32 v226, v196, v197
    v_cvt_pk_bf16_f32 v227, v198, v199
    v_cvt_pk_bf16_f32 v228, v200, v201
    v_cvt_pk_bf16_f32 v229, v202, v203
    v_cvt_pk_bf16_f32 v230, v204, v205
    v_cvt_pk_bf16_f32 v231, v206, v207
    v_cvt_pk_bf16_f32 v232, v208, v209
    v_cvt_pk_bf16_f32 v233, v210, v211
    v_cvt_pk_bf16_f32 v234, v212, v213
    v_cvt_pk_bf16_f32 v235, v214, v215
    v_cvt_pk_bf16_f32 v236, v216, v217
    v_cvt_pk_bf16_f32 v237, v218, v219
    v_cvt_pk_bf16_f32 v238, v220, v221
    v_cvt_pk_bf16_f32 v239, v222, v223
    v_lshlrev_b32 v192, 16, v224
    v_and_b32 v193, 0xffff0000, v224
    v_lshlrev_b32 v194, 16, v225
    v_and_b32 v195, 0xffff0000, v225
    v_lshlrev_b32 v196, 16, v226
    v_and_b32 v197, 0xffff0000, v226
    v_lshlrev_b32 v198, 16, v227
    v_and_b32 v199, 0xffff0000, v227
    v_lshlrev_b32 v200, 16, v228
    v_and_b32 v201, 0xffff0000, v228
    v_lshlrev_b32 v202, 16, v229
    v_and_b32 v203, 0xffff0000, v229
    v_lshlrev_b32 v204, 16, v230
    v_and_b32 v205, 0xffff0000, v230
    v_lshlrev_b32 v206, 16, v231
    v_and_b32 v207, 0xffff0000, v231
    v_lshlrev_b32 v208, 16, v232
    v_and_b32 v209, 0xffff0000, v232
    v_lshlrev_b32 v210, 16, v233
    v_and_b32 v211, 0xffff0000, v233
    v_lshlrev_b32 v212, 16, v234
    v_and_b32 v213, 0xffff0000, v234
    v_lshlrev_b32 v214, 16, v235
    v_and_b32 v215, 0xffff0000, v235
    v_lshlrev_b32 v216, 16, v236
    v_and_b32 v217, 0xffff0000, v236
    v_lshlrev_b32 v218, 16, v237
    v_and_b32 v219, 0xffff0000, v237
    v_lshlrev_b32 v220, 16, v238
    v_and_b32 v221, 0xffff0000, v238
    v_lshlrev_b32 v222, 16, v239
    v_and_b32 v223, 0xffff0000, v239
    v_mul_f32 v192, v192, v149
    v_mul_f32 v193, v193, v149
    v_mul_f32 v194, v194, v149
    v_mul_f32 v195, v195, v149
    v_mul_f32 v196, v196, v149
    v_mul_f32 v197, v197, v149
    v_mul_f32 v198, v198, v149
    v_mul_f32 v199, v199, v149
    v_mul_f32 v200, v200, v149
    v_mul_f32 v201, v201, v149
    v_mul_f32 v202, v202, v149
    v_mul_f32 v203, v203, v149
    v_mul_f32 v204, v204, v149
    v_mul_f32 v205, v205, v149
    v_mul_f32 v206, v206, v149
    v_mul_f32 v207, v207, v149
    v_mul_f32 v208, v208, v149
    v_mul_f32 v209, v209, v149
    v_mul_f32 v210, v210, v149
    v_mul_f32 v211, v211, v149
    v_mul_f32 v212, v212, v149
    v_mul_f32 v213, v213, v149
    v_mul_f32 v214, v214, v149
    v_mul_f32 v215, v215, v149
    v_mul_f32 v216, v216, v149
    v_mul_f32 v217, v217, v149
    v_mul_f32 v218, v218, v149
    v_mul_f32 v219, v219, v149
    v_mul_f32 v220, v220, v149
    v_mul_f32 v221, v221, v149
    v_mul_f32 v222, v222, v149
    v_mul_f32 v223, v223, v149
    v_cvt_pk_bf16_f32 v224, v192, v193
    v_cvt_pk_bf16_f32 v225, v194, v195
    v_cvt_pk_bf16_f32 v226, v196, v197
    v_cvt_pk_bf16_f32 v227, v198, v199
    v_cvt_pk_bf16_f32 v228, v200, v201
    v_cvt_pk_bf16_f32 v229, v202, v203
    v_cvt_pk_bf16_f32 v230, v204, v205
    v_cvt_pk_bf16_f32 v231, v206, v207
    v_cvt_pk_bf16_f32 v232, v208, v209
    v_cvt_pk_bf16_f32 v233, v210, v211
    v_cvt_pk_bf16_f32 v234, v212, v213
    v_cvt_pk_bf16_f32 v235, v214, v215
    v_cvt_pk_bf16_f32 v236, v216, v217
    v_cvt_pk_bf16_f32 v237, v218, v219
    v_cvt_pk_bf16_f32 v238, v220, v221
    v_cvt_pk_bf16_f32 v239, v222, v223
    s_mov_b32 s70, 0
    buffer_store_dwordx4 v[224:227], v156, s[80:83], s70 offen sc1
    s_mov_b32 s70, 4096
    buffer_store_dwordx4 v[228:231], v156, s[80:83], s70 offen sc1
    s_mov_b32 s70, 8192
    buffer_store_dwordx4 v[232:235], v156, s[80:83], s70 offen sc1
    s_mov_b32 s70, 12288
    buffer_store_dwordx4 v[236:239], v156, s[80:83], s70 offen sc1
    s_mov_b32 s99, 0
    s_mov_b32 s61, 1
    s_branch MG_WORK
MG_FALL:
    s_waitcnt vmcnt(0)
    s_barrier
    s_mov_b32 s99, 1
    s_mov_b32 s61, 2
    s_and_b32 s23, s2, 1
    s_lshr_b32 s22, s2, 1
    v_lshrrev_b32 v0, 4, v5
    s_lshl_b32 s70, s21, 6
    v_or_b32 v0, s70, v0
MG_ROLE:
    s_cmp_lt_u32 s23, 2
    s_cbranch_scc0 MG_WORK
    s_cmp_lt_u32 s22, 32
    s_cbranch_scc0 MG_WORK
    s_and_b32 s22, s22, 31
    s_and_b32 s23, s23, 1
    v_lshrrev_b32 v8, 4, v5
    v_mov_b32 v0, 0xeeee
    v_mov_b32 v9, 0x4444
    v_cndmask_b32 v0, v0, v9, s[40:41]
    s_lshl_b32 s46, s21, 11
    v_add_u32 v1, s46, v5
    v_lshrrev_b32 v9, 5, v8
    v_lshlrev_b32 v9, 10, v9
    v_bfe_u32 v10, v8, 4, 1
    v_lshl_add_u32 v9, v10, 9, v9
    v_bfe_u32 v10, v8, 3, 1
    v_lshl_add_u32 v9, v10, 8, v9
    v_and_b32 v10, 7, v8
    v_lshl_add_u32 v9, v10, 4, v9
    v_add_u32 v4, s46, v9
    s_lshl_b32 s46, s21, 16
    s_mul_i32 s47, s22, 64
    s_add_u32 s46, s46, s47
    v_lshrrev_b32 v9, 5, v8
    v_lshlrev_b32 v9, 13, v9
    v_bfe_u32 v10, v8, 4, 1
    v_mul_u32_u24 v10, 4096, v10
    v_add_u32 v9, v9, v10
    v_bfe_u32 v10, v8, 1, 1
    v_mul_u32_u24 v10, 2048, v10
    v_add_u32 v9, v9, v10
    v_bfe_u32 v10, v8, 2, 2
    v_lshl_add_u32 v9, v10, 4, v9
    v_and_b32 v10, 1, v8
    v_lshl_add_u32 v9, v10, 3, v9
    v_add_u32 v2, s46, v9
    s_lshl_b32 s46, s22, 8
    s_and_b32 s47, s21, 1
    s_lshl_b32 s47, s47, 7
    s_add_u32 s46, s46, s47
    s_lshr_b32 s47, s21, 1
    s_lshl_b32 s47, s47, 6
    s_add_u32 s46, s46, s47
    v_and_b32 v9, 3, v8
    v_lshlrev_b32 v9, 4, v9
    v_lshrrev_b32 v10, 4, v8
    v_lshl_add_u32 v9, v10, 2, v9
    v_add_u32 v9, s46, v9
    v_and_b32 v10, 12, v8
    v_cmp_eq_u32 vcc, 0, v10
    v_mov_b32 v3, 0x40000000
    s_nop 1
    v_cndmask_b32 v3, v3, v9, vcc
    s_lshl_b32 s46, s23, 13
    s_add_u32 s24, s46, 12582912
    s_add_u32 s25, s24, 16384
    s_lshl_b32 s46, s23, 18
    s_add_u32 s46, s46, 13631488
    s_add_u32 s28, s46, 0
    s_add_u32 s29, s46, 16384
    s_add_u32 s30, s46, 32768
    s_add_u32 s31, s46, 49152
    s_lshl_b32 s47, s22, 13
    s_add_u32 s26, s46, s47
    s_add_u32 s27, s26, 1024
    s_lshr_b32 s46, s21, 1
    s_mul_i32 s46, s46, 4096
    s_and_b32 s47, s21, 1
    s_mul_i32 s47, s47, 2048
    s_add_u32 s57, s46, s47
    s_mul_i32 s60, s22, 2097152
    s_lshl_b32 s36, s22, 13
    s_add_u32 s37, s36, 16777216
    s_lshl_b32 s46, s21, 12
    s_add_u32 s56, s46, 147456
    s_lshl_b32 s38, s22, 12
    s_add_u32 s38, s38, 2048
    s_lshl_b32 s46, s21, 9
    s_add_u32 s38, s38, s46
    s_lshl_b32 s39, s22, 11
    s_add_u32 s39, s39, 8388608
    s_add_u32 s39, s39, s46
    s_mul_i32 s46, s21, 1536
    s_add_u32 s54, s46, 131072
    s_lshr_b32 s46, s21, 1
    s_lshl_b32 s46, s46, 10
    s_and_b32 s47, s21, 1
    s_lshl_b32 s47, s47, 3
    s_add_u32 s46, s46, s47
    s_add_u32 s55, s46, 139264
    s_mov_b32 s20, 0
    v_lshrrev_b32 v8, 4, v5
    v_and_b32 v9, 1, v8
    v_cmp_eq_u32 vcc, 0, v9
    v_mov_b32 v0, 0xeeee
    v_mov_b32 v9, 0x4444
    v_cndmask_b32 v0, v0, v9, vcc
    s_lshr_b32 s46, s22, 1
    s_lshl_b32 s46, s46, 9
    s_and_b32 s47, s22, 1
    s_lshl_b32 s47, s47, 7
    s_add_u32 s46, s46, s47
    s_lshr_b32 s47, s21, 1
    s_lshl_b32 s47, s47, 6
    s_add_u32 s46, s46, s47
    s_and_b32 s47, s21, 1
    s_lshl_b32 s47, s47, 4
    s_add_u32 s46, s46, s47
    v_bfe_u32 v9, v8, 1, 1
    v_lshlrev_b32 v9, 8, v9
    v_and_b32 v10, 1, v8
    v_lshl_add_u32 v9, v10, 5, v9
    v_lshrrev_b32 v10, 4, v8
    v_lshl_add_u32 v9, v10, 2, v9
    v_add_u32 v9, s46, v9
    v_and_b32 v10, 12, v8
    v_cmp_eq_u32 vcc, 0, v10
    v_mov_b32 v3, 0x40000000
    s_nop 1
    v_cndmask_b32 v3, v3, v9, vcc
    s_mov_b32 s43, 63
    v_lshrrev_b32 v8, 4, v5
    v_add_u32 v12, 141312, v5
    v_and_b32 v11, 1, v8
    v_bfe_u32 v9, v8, 3, 1
    v_lshl_add_u32 v11, v9, 2, v11
    v_bfe_u32 v9, v8, 1, 2
    v_lshrrev_b32 v10, 4, v8
    v_xor_b32 v9, v9, v10
    v_lshl_add_u32 v11, v9, 6, v11
    v_and_b32 v9, 1, v11
    v_lshlrev_b32 v9, 4, v9
    v_mov_b32 v13, 0x3f80
    v_lshlrev_b32 v13, v9, v13
    v_lshrrev_b32 v9, 1, v11
    v_cmp_eq_u32 vcc, 0, v9
    s_nop 1
    v_cndmask_b32 v16, 0, v13, vcc
    v_cmp_eq_u32 vcc, 1, v9
    s_nop 1
    v_cndmask_b32 v17, 0, v13, vcc
    v_cmp_eq_u32 vcc, 2, v9
    s_nop 1
    v_cndmask_b32 v18, 0, v13, vcc
    v_cmp_eq_u32 vcc, 3, v9
    s_nop 1
    v_cndmask_b32 v19, 0, v13, vcc
    ds_write_b128 v12, v[16:19] offset:0
    s_waitcnt lgkmcnt(0)
    v_and_b32 v11, 1, v8
    v_bfe_u32 v9, v8, 3, 1
    v_lshl_add_u32 v11, v9, 2, v11
    v_add_u32 v11, 2, v11
    v_bfe_u32 v9, v8, 1, 2
    v_lshrrev_b32 v10, 4, v8
    v_xor_b32 v9, v9, v10
    v_lshl_add_u32 v11, v9, 6, v11
    v_and_b32 v9, 1, v11
    v_lshlrev_b32 v9, 4, v9
    v_mov_b32 v13, 0x3f80
    v_lshlrev_b32 v13, v9, v13
    v_lshrrev_b32 v9, 1, v11
    v_cmp_eq_u32 vcc, 0, v9
    s_nop 1
    v_cndmask_b32 v16, 0, v13, vcc
    v_cmp_eq_u32 vcc, 1, v9
    s_nop 1
    v_cndmask_b32 v17, 0, v13, vcc
    v_cmp_eq_u32 vcc, 2, v9
    s_nop 1
    v_cndmask_b32 v18, 0, v13, vcc
    v_cmp_eq_u32 vcc, 3, v9
    s_nop 1
    v_cndmask_b32 v19, 0, v13, vcc
    ds_write_b128 v12, v[16:19] offset:1024
    s_waitcnt lgkmcnt(0)
    v_and_b32 v11, 7, v8
    v_and_b32 v9, 1, v11
    v_lshlrev_b32 v9, 4, v9
    v_mov_b32 v13, 0x3f80
    v_lshlrev_b32 v13, v9, v13
    v_lshrrev_b32 v9, 1, v11
    v_cmp_eq_u32 vcc, 0, v9
    s_nop 1
    v_cndmask_b32 v16, 0, v13, vcc
    v_cmp_eq_u32 vcc, 1, v9
    s_nop 1
    v_cndmask_b32 v17, 0, v13, vcc
    v_cmp_eq_u32 vcc, 2, v9
    s_nop 1
    v_cndmask_b32 v18, 0, v13, vcc
    v_cmp_eq_u32 vcc, 3, v9
    s_nop 1
    v_cndmask_b32 v19, 0, v13, vcc
    ds_write_b128 v12, v[16:19] offset:2048
    s_waitcnt lgkmcnt(0)
    v_lshrrev_b32 v8, 4, v5
    v_lshrrev_b32 v9, 4, v8
    v_and_b32 v10, 1, v9
    v_lshrrev_b32 v11, 1, v9
    v_lshl_or_b32 v10, v11, 2, v10
    v_and_b32 v11, 15, v8
    v_xor_b32 v10, v10, v11
    v_lshlrev_b32 v9, 13, v9
    v_lshl_add_u32 v9, v10, 4, v9
    s_lshl_b32 s46, s22, 8
    v_add_u32 v12, s46, v9
    v_lshrrev_b32 v9, 4, v8
    v_lshlrev_b32 v9, 3, v9
    v_bfe_u32 v10, v8, 2, 2
    v_add_u32 v9, v9, v10
    v_lshlrev_b32 v9, 8, v9
    v_and_b32 v11, 1, v10
    v_lshrrev_b32 v10, 1, v10
    v_lshl_or_b32 v10, v10, 2, v11
    v_bfe_u32 v11, v8, 1, 1
    v_lshlrev_b32 v11, 1, v11
    s_lshl_b32 s46, s21, 2
    v_add_u32 v11, s46, v11
    v_xor_b32 v10, v10, v11
    v_lshl_add_u32 v9, v10, 4, v9
    v_and_b32 v10, 1, v8
    v_lshl_add_u32 v9, v10, 3, v9
    s_and_b32 s46, s21, 1
    s_xor_b32 s46, s46, 0
    s_lshl_b32 s46, s46, 15
    v_add_u32 v14, s46, v9
    v_xor_b32 v15, 16, v14
    v_add_u32 v18, 65536, v14
    v_add_u32 v19, 65536, v15
    s_and_b32 s46, s21, 1
    s_xor_b32 s46, s46, 1
    s_lshl_b32 s46, s46, 15
    v_add_u32 v16, s46, v9
    v_xor_b32 v17, 16, v16
    v_add_u32 v20, 65536, v16
    v_add_u32 v21, 65536, v17
    s_lshl_b32 s46, s23, 10
    v_add_u32 v9, s46, v5
    v_xor_b32 v24, 0, v9
    v_xor_b32 v25, 32, v9
    v_xor_b32 v26, 64, v9
    v_xor_b32 v27, 96, v9
    v_bfe_u32 v9, v8, 4, 1
    v_lshlrev_b32 v9, 5, v9
    v_lshrrev_b32 v10, 5, v8
    v_lshl_add_u32 v9, v10, 2, v9
    v_bfe_u32 v10, v8, 2, 2
    v_add_u32 v9, v9, v10
    v_lshlrev_b32 v9, 10, v9
    v_lshl_add_u32 v9, v10, 5, v9
    v_and_b32 v10, 3, v8
    v_lshl_add_u32 v9, v10, 3, v9
    s_lshl_b32 s46, s21, 8
    v_add_u32 v9, s46, v9
    v_xor_b32 v32, 0, v9
    v_add_u32 v40, 65536, v32
    v_xor_b32 v33, 32, v9
    v_add_u32 v41, 65536, v33
    v_xor_b32 v34, 64, v9
    v_add_u32 v42, 65536, v34
    v_xor_b32 v35, 96, v9
    v_add_u32 v43, 65536, v35
    v_xor_b32 v36, 128, v9
    v_add_u32 v44, 65536, v36
    v_xor_b32 v37, 160, v9
    v_add_u32 v45, 65536, v37
    v_xor_b32 v38, 192, v9
    v_add_u32 v46, 65536, v38
    v_xor_b32 v39, 224, v9
    v_add_u32 v47, 65536, v39
    s_lshl_b32 s46, s21, 14
    v_add_u32 v48, s46, v5
    s_load_dwordx2 s[50:51], s[0:1], 16
    s_waitcnt lgkmcnt(0)
    s_mov_b32 s16, s50
    s_mov_b32 s17, s51
    s_and_b32 s17, s17, 0xffff
    s_mov_b32 s18, 0x800000
    s_mov_b32 s19, 0x00020000
    s_lshl_b32 s46, s23, 22
    s_lshl_b32 s47, s21, 19
    s_add_u32 s46, s46, s47
    s_add_u32 s46, s46, 0
    s_lshl_b32 s47, s21, 14
    s_add_u32 m0, s47, 0
    buffer_load_dwordx4 v12, s[16:19], s46 offen lds
    s_add_u32 s46, s46, 32768
    s_add_u32 m0, m0, 1024
    s_nop 0
    buffer_load_dwordx4 v12, s[16:19], s46 offen lds
    s_add_u32 s46, s46, 32768
    s_add_u32 m0, m0, 1024
    s_nop 0
    buffer_load_dwordx4 v12, s[16:19], s46 offen lds
    s_add_u32 s46, s46, 32768
    s_add_u32 m0, m0, 1024
    s_nop 0
    buffer_load_dwordx4 v12, s[16:19], s46 offen lds
    s_add_u32 s46, s46, 32768
    s_add_u32 m0, m0, 1024
    s_nop 0
    buffer_load_dwordx4 v12, s[16:19], s46 offen lds
    s_add_u32 s46, s46, 32768
    s_add_u32 m0, m0, 1024
    s_nop 0
    buffer_load_dwordx4 v12, s[16:19], s46 offen lds
    s_add_u32 s46, s46, 32768
    s_add_u32 m0, m0, 1024
    s_nop 0
    buffer_load_dwordx4 v12, s[16:19], s46 offen lds
    s_add_u32 s46, s46, 32768
    s_add_u32 m0, m0, 1024
    s_nop 0
    buffer_load_dwordx4 v12, s[16:19], s46 offen lds
    s_add_u32 s46, s46, 32768
    s_add_u32 m0, m0, 1024
    s_nop 0
    buffer_load_dwordx4 v12, s[16:19], s46 offen lds
    s_add_u32 s46, s46, 32768
    s_add_u32 m0, m0, 1024
    s_nop 0
    buffer_load_dwordx4 v12, s[16:19], s46 offen lds
    s_add_u32 s46, s46, 32768
    s_add_u32 m0, m0, 1024
    s_nop 0
    buffer_load_dwordx4 v12, s[16:19], s46 offen lds
    s_add_u32 s46, s46, 32768
    s_add_u32 m0, m0, 1024
    s_nop 0
    buffer_load_dwordx4 v12, s[16:19], s46 offen lds
    s_add_u32 s46, s46, 32768
    s_add_u32 m0, m0, 1024
    s_nop 0
    buffer_load_dwordx4 v12, s[16:19], s46 offen lds
    s_add_u32 s46, s46, 32768
    s_add_u32 m0, m0, 1024
    s_nop 0
    buffer_load_dwordx4 v12, s[16:19], s46 offen lds
    s_add_u32 s46, s46, 32768
    s_add_u32 m0, m0, 1024
    s_nop 0
    buffer_load_dwordx4 v12, s[16:19], s46 offen lds
    s_add_u32 s46, s46, 32768
    s_add_u32 m0, m0, 1024
    s_nop 0
    buffer_load_dwordx4 v12, s[16:19], s46 offen lds
RC_CONT:
    s_lshl_b32 s46, s23, 22
    s_lshl_b32 s47, s21, 19
    s_add_u32 s46, s46, s47
    s_add_u32 s46, s46, 2097152
    s_lshl_b32 s47, s21, 14
    s_add_u32 m0, s47, 65536
    buffer_load_dwordx4 v12, s[16:19], s46 offen lds
    s_add_u32 s46, s46, 32768
    s_add_u32 m0, m0, 1024
    s_nop 0
    buffer_load_dwordx4 v12, s[16:19], s46 offen lds
    s_add_u32 s46, s46, 32768
    s_add_u32 m0, m0, 1024
    s_nop 0
    buffer_load_dwordx4 v12, s[16:19], s46 offen lds
    s_add_u32 s46, s46, 32768
    s_add_u32 m0, m0, 1024
    s_nop 0
    buffer_load_dwordx4 v12, s[16:19], s46 offen lds
    s_add_u32 s46, s46, 32768
    s_add_u32 m0, m0, 1024
    s_nop 0
    buffer_load_dwordx4 v12, s[16:19], s46 offen lds
    s_add_u32 s46, s46, 32768
    s_add_u32 m0, m0, 1024
    s_nop 0
    buffer_load_dwordx4 v12, s[16:19], s46 offen lds
    s_add_u32 s46, s46, 32768
    s_add_u32 m0, m0, 1024
    s_nop 0
    buffer_load_dwordx4 v12, s[16:19], s46 offen lds
    s_add_u32 s46, s46, 32768
    s_add_u32 m0, m0, 1024
    s_nop 0
    buffer_load_dwordx4 v12, s[16:19], s46 offen lds
    s_add_u32 s46, s46, 32768
    s_add_u32 m0, m0, 1024
    s_nop 0
    buffer_load_dwordx4 v12, s[16:19], s46 offen lds
    s_add_u32 s46, s46, 32768
    s_add_u32 m0, m0, 1024
    s_nop 0
    buffer_load_dwordx4 v12, s[16:19], s46 offen lds
    s_add_u32 s46, s46, 32768
    s_add_u32 m0, m0, 1024
    s_nop 0
    buffer_load_dwordx4 v12, s[16:19], s46 offen lds
    s_add_u32 s46, s46, 32768
    s_add_u32 m0, m0, 1024
    s_nop 0
    buffer_load_dwordx4 v12, s[16:19], s46 offen lds
    s_add_u32 s46, s46, 32768
    s_add_u32 m0, m0, 1024
    s_nop 0
    buffer_load_dwordx4 v12, s[16:19], s46 offen lds
    s_add_u32 s46, s46, 32768
    s_add_u32 m0, m0, 1024
    s_nop 0
    buffer_load_dwordx4 v12, s[16:19], s46 offen lds
    s_add_u32 s46, s46, 32768
    s_add_u32 m0, m0, 1024
    s_nop 0
    buffer_load_dwordx4 v12, s[16:19], s46 offen lds
    s_add_u32 s46, s46, 32768
    s_add_u32 m0, m0, 1024
    s_nop 0
    buffer_load_dwordx4 v12, s[16:19], s46 offen lds
    s_cmp_eq_u32 s99, 0
    s_cbranch_scc0 RC_NOSIG
    s_waitcnt vmcnt(16)
    s_barrier
    s_cmp_eq_u32 s21, 0
    s_cbranch_scc0 RC_SG
    s_getreg_b32 s70, hwreg(HW_REG_XCC_ID, 0, 4)
    s_and_b32 s70, s70, 7
    s_lshl_b32 s70, s70, 4
    s_add_u32 s70, s70, 128
    v_mov_b32 v8, 1
    v_mov_b32 v10, s70
    s_mov_b64 exec, 1
    buffer_atomic_add v8, v10, s[92:95], 0 offen sc1
    s_mov_b64 exec, -1
RC_SG:
RC_NOSIG:
    s_waitcnt vmcnt(16)
    s_barrier
    s_lshr_b32 s46, s21, 1
    s_cmp_eq_u32 s46, 0
    s_cbranch_scc0 RC_ST0A
    ds_read_b64_tr_b16 a[0:1], v14 offset:0
    ds_read_b64_tr_b16 a[2:3], v14 offset:1024
    ds_read_b64_tr_b16 a[4:5], v14 offset:8192
    ds_read_b64_tr_b16 a[6:7], v14 offset:9216
    s_waitcnt lgkmcnt(8)
    ds_read_b64_tr_b16 a[8:9], v15 offset:0
    ds_read_b64_tr_b16 a[10:11], v15 offset:1024
    ds_read_b64_tr_b16 a[12:13], v15 offset:8192
    ds_read_b64_tr_b16 a[14:15], v15 offset:9216
    s_waitcnt lgkmcnt(8)
    ds_read_b64_tr_b16 a[16:17], v14 offset:16384
    ds_read_b64_tr_b16 a[18:19], v14 offset:17408
    ds_read_b64_tr_b16 a[20:21], v14 offset:24576
    ds_read_b64_tr_b16 a[22:23], v14 offset:25600
    s_waitcnt lgkmcnt(8)
    ds_read_b64_tr_b16 a[24:25], v15 offset:16384
    ds_read_b64_tr_b16 a[26:27], v15 offset:17408
    ds_read_b64_tr_b16 a[28:29], v15 offset:24576
    ds_read_b64_tr_b16 a[30:31], v15 offset:25600
    s_waitcnt lgkmcnt(8)
    ds_read_b64_tr_b16 a[32:33], v16 offset:0
    ds_read_b64_tr_b16 a[34:35], v16 offset:1024
    ds_read_b64_tr_b16 a[36:37], v16 offset:8192
    ds_read_b64_tr_b16 a[38:39], v16 offset:9216
    s_waitcnt lgkmcnt(8)
    ds_read_b64_tr_b16 a[40:41], v17 offset:0
    ds_read_b64_tr_b16 a[42:43], v17 offset:1024
    ds_read_b64_tr_b16 a[44:45], v17 offset:8192
    ds_read_b64_tr_b16 a[46:47], v17 offset:9216
    s_waitcnt lgkmcnt(8)
    ds_read_b64_tr_b16 a[48:49], v16 offset:16384
    ds_read_b64_tr_b16 a[50:51], v16 offset:17408
    ds_read_b64_tr_b16 a[52:53], v16 offset:24576
    ds_read_b64_tr_b16 a[54:55], v16 offset:25600
    s_waitcnt lgkmcnt(8)
    ds_read_b64_tr_b16 a[56:57], v17 offset:16384
    ds_read_b64_tr_b16 a[58:59], v17 offset:17408
    ds_read_b64_tr_b16 a[60:61], v17 offset:24576
    ds_read_b64_tr_b16 a[62:63], v17 offset:25600
    s_waitcnt lgkmcnt(8)
    s_branch RC_ST0B
RC_ST0A:
    ds_read_b64_tr_b16 a[64:65], v14 offset:0
    ds_read_b64_tr_b16 a[66:67], v14 offset:1024
    ds_read_b64_tr_b16 a[68:69], v14 offset:8192
    ds_read_b64_tr_b16 a[70:71], v14 offset:9216
    s_waitcnt lgkmcnt(8)
    ds_read_b64_tr_b16 a[72:73], v15 offset:0
    ds_read_b64_tr_b16 a[74:75], v15 offset:1024
    ds_read_b64_tr_b16 a[76:77], v15 offset:8192
    ds_read_b64_tr_b16 a[78:79], v15 offset:9216
    s_waitcnt lgkmcnt(8)
    ds_read_b64_tr_b16 a[80:81], v14 offset:16384
    ds_read_b64_tr_b16 a[82:83], v14 offset:17408
    ds_read_b64_tr_b16 a[84:85], v14 offset:24576
    ds_read_b64_tr_b16 a[86:87], v14 offset:25600
    s_waitcnt lgkmcnt(8)
    ds_read_b64_tr_b16 a[88:89], v15 offset:16384
    ds_read_b64_tr_b16 a[90:91], v15 offset:17408
    ds_read_b64_tr_b16 a[92:93], v15 offset:24576
    ds_read_b64_tr_b16 a[94:95], v15 offset:25600
    s_waitcnt lgkmcnt(8)
    ds_read_b64_tr_b16 a[96:97], v16 offset:0
    ds_read_b64_tr_b16 a[98:99], v16 offset:1024
    ds_read_b64_tr_b16 a[100:101], v16 offset:8192
    ds_read_b64_tr_b16 a[102:103], v16 offset:9216
    s_waitcnt lgkmcnt(8)
    ds_read_b64_tr_b16 a[104:105], v17 offset:0
    ds_read_b64_tr_b16 a[106:107], v17 offset:1024
    ds_read_b64_tr_b16 a[108:109], v17 offset:8192
    ds_read_b64_tr_b16 a[110:111], v17 offset:9216
    s_waitcnt lgkmcnt(8)
    ds_read_b64_tr_b16 a[112:113], v16 offset:16384
    ds_read_b64_tr_b16 a[114:115], v16 offset:17408
    ds_read_b64_tr_b16 a[116:117], v16 offset:24576
    ds_read_b64_tr_b16 a[118:119], v16 offset:25600
    s_waitcnt lgkmcnt(8)
    ds_read_b64_tr_b16 a[120:121], v17 offset:16384
    ds_read_b64_tr_b16 a[122:123], v17 offset:17408
    ds_read_b64_tr_b16 a[124:125], v17 offset:24576
    ds_read_b64_tr_b16 a[126:127], v17 offset:25600
    s_waitcnt lgkmcnt(8)
RC_ST0B:
    s_waitcnt lgkmcnt(0)
    s_barrier
    s_load_dwordx2 s[50:51], s[0:1], 24
    s_waitcnt lgkmcnt(0)
    s_mov_b32 s16, s50
    s_mov_b32 s17, s51
    s_and_b32 s17, s17, 0xffff
    s_mov_b32 s18, 0x800000
    s_mov_b32 s19, 0x00020000
    s_lshl_b32 s46, s23, 22
    s_lshl_b32 s47, s21, 19
    s_add_u32 s46, s46, s47
    s_add_u32 s46, s46, 0
    s_lshl_b32 s47, s21, 14
    s_add_u32 m0, s47, 0
    buffer_load_dwordx4 v12, s[16:19], s46 offen lds
    s_add_u32 s46, s46, 32768
    s_add_u32 m0, m0, 1024
    s_nop 0
    buffer_load_dwordx4 v12, s[16:19], s46 offen lds
    s_add_u32 s46, s46, 32768
    s_add_u32 m0, m0, 1024
    s_nop 0
    buffer_load_dwordx4 v12, s[16:19], s46 offen lds
    s_add_u32 s46, s46, 32768
    s_add_u32 m0, m0, 1024
    s_nop 0
    buffer_load_dwordx4 v12, s[16:19], s46 offen lds
    s_add_u32 s46, s46, 32768
    s_add_u32 m0, m0, 1024
    s_nop 0
    buffer_load_dwordx4 v12, s[16:19], s46 offen lds
    s_add_u32 s46, s46, 32768
    s_add_u32 m0, m0, 1024
    s_nop 0
    buffer_load_dwordx4 v12, s[16:19], s46 offen lds
    s_add_u32 s46, s46, 32768
    s_add_u32 m0, m0, 1024
    s_nop 0
    buffer_load_dwordx4 v12, s[16:19], s46 offen lds
    s_add_u32 s46, s46, 32768
    s_add_u32 m0, m0, 1024
    s_nop 0
    buffer_load_dwordx4 v12, s[16:19], s46 offen lds
    s_add_u32 s46, s46, 32768
    s_add_u32 m0, m0, 1024
    s_nop 0
    buffer_load_dwordx4 v12, s[16:19], s46 offen lds
    s_add_u32 s46, s46, 32768
    s_add_u32 m0, m0, 1024
    s_nop 0
    buffer_load_dwordx4 v12, s[16:19], s46 offen lds
    s_add_u32 s46, s46, 32768
    s_add_u32 m0, m0, 1024
    s_nop 0
    buffer_load_dwordx4 v12, s[16:19], s46 offen lds
    s_add_u32 s46, s46, 32768
    s_add_u32 m0, m0, 1024
    s_nop 0
    buffer_load_dwordx4 v12, s[16:19], s46 offen lds
    s_add_u32 s46, s46, 32768
    s_add_u32 m0, m0, 1024
    s_nop 0
    buffer_load_dwordx4 v12, s[16:19], s46 offen lds
    s_add_u32 s46, s46, 32768
    s_add_u32 m0, m0, 1024
    s_nop 0
    buffer_load_dwordx4 v12, s[16:19], s46 offen lds
    s_add_u32 s46, s46, 32768
    s_add_u32 m0, m0, 1024
    s_nop 0
    buffer_load_dwordx4 v12, s[16:19], s46 offen lds
    s_add_u32 s46, s46, 32768
    s_add_u32 m0, m0, 1024
    s_nop 0
    buffer_load_dwordx4 v12, s[16:19], s46 offen lds
    s_waitcnt vmcnt(16)
    s_barrier
    s_lshr_b32 s46, s21, 1
    s_cmp_eq_u32 s46, 1
    s_cbranch_scc0 RC_ST1A
    ds_read_b64_tr_b16 a[0:1], v18 offset:0
    ds_read_b64_tr_b16 a[2:3], v18 offset:1024
    ds_read_b64_tr_b16 a[4:5], v18 offset:8192
    ds_read_b64_tr_b16 a[6:7], v18 offset:9216
    s_waitcnt lgkmcnt(8)
    ds_read_b64_tr_b16 a[8:9], v19 offset:0
    ds_read_b64_tr_b16 a[10:11], v19 offset:1024
    ds_read_b64_tr_b16 a[12:13], v19 offset:8192
    ds_read_b64_tr_b16 a[14:15], v19 offset:9216
    s_waitcnt lgkmcnt(8)
    ds_read_b64_tr_b16 a[16:17], v18 offset:16384
    ds_read_b64_tr_b16 a[18:19], v18 offset:17408
    ds_read_b64_tr_b16 a[20:21], v18 offset:24576
    ds_read_b64_tr_b16 a[22:23], v18 offset:25600
    s_waitcnt lgkmcnt(8)
    ds_read_b64_tr_b16 a[24:25], v19 offset:16384
    ds_read_b64_tr_b16 a[26:27], v19 offset:17408
    ds_read_b64_tr_b16 a[28:29], v19 offset:24576
    ds_read_b64_tr_b16 a[30:31], v19 offset:25600
    s_waitcnt lgkmcnt(8)
    ds_read_b64_tr_b16 a[32:33], v20 offset:0
    ds_read_b64_tr_b16 a[34:35], v20 offset:1024
    ds_read_b64_tr_b16 a[36:37], v20 offset:8192
    ds_read_b64_tr_b16 a[38:39], v20 offset:9216
    s_waitcnt lgkmcnt(8)
    ds_read_b64_tr_b16 a[40:41], v21 offset:0
    ds_read_b64_tr_b16 a[42:43], v21 offset:1024
    ds_read_b64_tr_b16 a[44:45], v21 offset:8192
    ds_read_b64_tr_b16 a[46:47], v21 offset:9216
    s_waitcnt lgkmcnt(8)
    ds_read_b64_tr_b16 a[48:49], v20 offset:16384
    ds_read_b64_tr_b16 a[50:51], v20 offset:17408
    ds_read_b64_tr_b16 a[52:53], v20 offset:24576
    ds_read_b64_tr_b16 a[54:55], v20 offset:25600
    s_waitcnt lgkmcnt(8)
    ds_read_b64_tr_b16 a[56:57], v21 offset:16384
    ds_read_b64_tr_b16 a[58:59], v21 offset:17408
    ds_read_b64_tr_b16 a[60:61], v21 offset:24576
    ds_read_b64_tr_b16 a[62:63], v21 offset:25600
    s_waitcnt lgkmcnt(8)
    s_branch RC_ST1B
RC_ST1A:
    ds_read_b64_tr_b16 a[64:65], v18 offset:0
    ds_read_b64_tr_b16 a[66:67], v18 offset:1024
    ds_read_b64_tr_b16 a[68:69], v18 offset:8192
    ds_read_b64_tr_b16 a[70:71], v18 offset:9216
    s_waitcnt lgkmcnt(8)
    ds_read_b64_tr_b16 a[72:73], v19 offset:0
    ds_read_b64_tr_b16 a[74:75], v19 offset:1024
    ds_read_b64_tr_b16 a[76:77], v19 offset:8192
    ds_read_b64_tr_b16 a[78:79], v19 offset:9216
    s_waitcnt lgkmcnt(8)
    ds_read_b64_tr_b16 a[80:81], v18 offset:16384
    ds_read_b64_tr_b16 a[82:83], v18 offset:17408
    ds_read_b64_tr_b16 a[84:85], v18 offset:24576
    ds_read_b64_tr_b16 a[86:87], v18 offset:25600
    s_waitcnt lgkmcnt(8)
    ds_read_b64_tr_b16 a[88:89], v19 offset:16384
    ds_read_b64_tr_b16 a[90:91], v19 offset:17408
    ds_read_b64_tr_b16 a[92:93], v19 offset:24576
    ds_read_b64_tr_b16 a[94:95], v19 offset:25600
    s_waitcnt lgkmcnt(8)
    ds_read_b64_tr_b16 a[96:97], v20 offset:0
    ds_read_b64_tr_b16 a[98:99], v20 offset:1024
    ds_read_b64_tr_b16 a[100:101], v20 offset:8192
    ds_read_b64_tr_b16 a[102:103], v20 offset:9216
    s_waitcnt lgkmcnt(8)
    ds_read_b64_tr_b16 a[104:105], v21 offset:0
    ds_read_b64_tr_b16 a[106:107], v21 offset:1024
    ds_read_b64_tr_b16 a[108:109], v21 offset:8192
    ds_read_b64_tr_b16 a[110:111], v21 offset:9216
    s_waitcnt lgkmcnt(8)
    ds_read_b64_tr_b16 a[112:113], v20 offset:16384
    ds_read_b64_tr_b16 a[114:115], v20 offset:17408
    ds_read_b64_tr_b16 a[116:117], v20 offset:24576
    ds_read_b64_tr_b16 a[118:119], v20 offset:25600
    s_waitcnt lgkmcnt(8)
    ds_read_b64_tr_b16 a[120:121], v21 offset:16384
    ds_read_b64_tr_b16 a[122:123], v21 offset:17408
    ds_read_b64_tr_b16 a[124:125], v21 offset:24576
    ds_read_b64_tr_b16 a[126:127], v21 offset:25600
    s_waitcnt lgkmcnt(8)
RC_ST1B:
    s_waitcnt lgkmcnt(0)
    s_barrier
    s_lshl_b32 s46, s23, 22
    s_lshl_b32 s47, s21, 19
    s_add_u32 s46, s46, s47
    s_add_u32 s46, s46, 2097152
    s_lshl_b32 s47, s21, 14
    s_add_u32 m0, s47, 65536
    buffer_load_dwordx4 v12, s[16:19], s46 offen lds
    s_add_u32 s46, s46, 32768
    s_add_u32 m0, m0, 1024
    s_nop 0
    buffer_load_dwordx4 v12, s[16:19], s46 offen lds
    s_add_u32 s46, s46, 32768
    s_add_u32 m0, m0, 1024
    s_nop 0
    buffer_load_dwordx4 v12, s[16:19], s46 offen lds
    s_add_u32 s46, s46, 32768
    s_add_u32 m0, m0, 1024
    s_nop 0
    buffer_load_dwordx4 v12, s[16:19], s46 offen lds
    s_add_u32 s46, s46, 32768
    s_add_u32 m0, m0, 1024
    s_nop 0
    buffer_load_dwordx4 v12, s[16:19], s46 offen lds
    s_add_u32 s46, s46, 32768
    s_add_u32 m0, m0, 1024
    s_nop 0
    buffer_load_dwordx4 v12, s[16:19], s46 offen lds
    s_add_u32 s46, s46, 32768
    s_add_u32 m0, m0, 1024
    s_nop 0
    buffer_load_dwordx4 v12, s[16:19], s46 offen lds
    s_add_u32 s46, s46, 32768
    s_add_u32 m0, m0, 1024
    s_nop 0
    buffer_load_dwordx4 v12, s[16:19], s46 offen lds
    s_add_u32 s46, s46, 32768
    s_add_u32 m0, m0, 1024
    s_nop 0
    buffer_load_dwordx4 v12, s[16:19], s46 offen lds
    s_add_u32 s46, s46, 32768
    s_add_u32 m0, m0, 1024
    s_nop 0
    buffer_load_dwordx4 v12, s[16:19], s46 offen lds
    s_add_u32 s46, s46, 32768
    s_add_u32 m0, m0, 1024
    s_nop 0
    buffer_load_dwordx4 v12, s[16:19], s46 offen lds
    s_add_u32 s46, s46, 32768
    s_add_u32 m0, m0, 1024
    s_nop 0
    buffer_load_dwordx4 v12, s[16:19], s46 offen lds
    s_add_u32 s46, s46, 32768
    s_add_u32 m0, m0, 1024
    s_nop 0
    buffer_load_dwordx4 v12, s[16:19], s46 offen lds
    s_add_u32 s46, s46, 32768
    s_add_u32 m0, m0, 1024
    s_nop 0
    buffer_load_dwordx4 v12, s[16:19], s46 offen lds
    s_add_u32 s46, s46, 32768
    s_add_u32 m0, m0, 1024
    s_nop 0
    buffer_load_dwordx4 v12, s[16:19], s46 offen lds
    s_add_u32 s46, s46, 32768
    s_add_u32 m0, m0, 1024
    s_nop 0
    buffer_load_dwordx4 v12, s[16:19], s46 offen lds
    s_waitcnt vmcnt(16)
    s_barrier
    s_lshr_b32 s46, s21, 1
    s_cmp_eq_u32 s46, 0
    s_cbranch_scc0 RC_ST2A
    ds_read_b64_tr_b16 a[128:129], v14 offset:0
    ds_read_b64_tr_b16 a[130:131], v14 offset:1024
    ds_read_b64_tr_b16 a[132:133], v14 offset:8192
    ds_read_b64_tr_b16 a[134:135], v14 offset:9216
    s_waitcnt lgkmcnt(8)
    ds_read_b64_tr_b16 a[136:137], v15 offset:0
    ds_read_b64_tr_b16 a[138:139], v15 offset:1024
    ds_read_b64_tr_b16 a[140:141], v15 offset:8192
    ds_read_b64_tr_b16 a[142:143], v15 offset:9216
    s_waitcnt lgkmcnt(8)
    ds_read_b64_tr_b16 a[144:145], v14 offset:16384
    ds_read_b64_tr_b16 a[146:147], v14 offset:17408
    ds_read_b64_tr_b16 a[148:149], v14 offset:24576
    ds_read_b64_tr_b16 a[150:151], v14 offset:25600
    s_waitcnt lgkmcnt(8)
    ds_read_b64_tr_b16 a[152:153], v15 offset:16384
    ds_read_b64_tr_b16 a[154:155], v15 offset:17408
    ds_read_b64_tr_b16 a[156:157], v15 offset:24576
    ds_read_b64_tr_b16 a[158:159], v15 offset:25600
    s_waitcnt lgkmcnt(8)
    ds_read_b64_tr_b16 a[160:161], v16 offset:0
    ds_read_b64_tr_b16 a[162:163], v16 offset:1024
    ds_read_b64_tr_b16 a[164:165], v16 offset:8192
    ds_read_b64_tr_b16 a[166:167], v16 offset:9216
    s_waitcnt lgkmcnt(8)
    ds_read_b64_tr_b16 a[168:169], v17 offset:0
    ds_read_b64_tr_b16 a[170:171], v17 offset:1024
    ds_read_b64_tr_b16 a[172:173], v17 offset:8192
    ds_read_b64_tr_b16 a[174:175], v17 offset:9216
    s_waitcnt lgkmcnt(8)
    ds_read_b64_tr_b16 a[176:177], v16 offset:16384
    ds_read_b64_tr_b16 a[178:179], v16 offset:17408
    ds_read_b64_tr_b16 a[180:181], v16 offset:24576
    ds_read_b64_tr_b16 a[182:183], v16 offset:25600
    s_waitcnt lgkmcnt(8)
    ds_read_b64_tr_b16 a[184:185], v17 offset:16384
    ds_read_b64_tr_b16 a[186:187], v17 offset:17408
    ds_read_b64_tr_b16 a[188:189], v17 offset:24576
    ds_read_b64_tr_b16 a[190:191], v17 offset:25600
    s_waitcnt lgkmcnt(8)
    s_branch RC_ST2B
RC_ST2A:
    ds_read_b64_tr_b16 a[192:193], v14 offset:0
    ds_read_b64_tr_b16 a[194:195], v14 offset:1024
    ds_read_b64_tr_b16 a[196:197], v14 offset:8192
    ds_read_b64_tr_b16 a[198:199], v14 offset:9216
    s_waitcnt lgkmcnt(8)
    ds_read_b64_tr_b16 a[200:201], v15 offset:0
    ds_read_b64_tr_b16 a[202:203], v15 offset:1024
    ds_read_b64_tr_b16 a[204:205], v15 offset:8192
    ds_read_b64_tr_b16 a[206:207], v15 offset:9216
    s_waitcnt lgkmcnt(8)
    ds_read_b64_tr_b16 a[208:209], v14 offset:16384
    ds_read_b64_tr_b16 a[210:211], v14 offset:17408
    ds_read_b64_tr_b16 a[212:213], v14 offset:24576
    ds_read_b64_tr_b16 a[214:215], v14 offset:25600
    s_waitcnt lgkmcnt(8)
    ds_read_b64_tr_b16 a[216:217], v15 offset:16384
    ds_read_b64_tr_b16 a[218:219], v15 offset:17408
    ds_read_b64_tr_b16 a[220:221], v15 offset:24576
    ds_read_b64_tr_b16 a[222:223], v15 offset:25600
    s_waitcnt lgkmcnt(8)
    ds_read_b64_tr_b16 a[224:225], v16 offset:0
    ds_read_b64_tr_b16 a[226:227], v16 offset:1024
    ds_read_b64_tr_b16 a[228:229], v16 offset:8192
    ds_read_b64_tr_b16 a[230:231], v16 offset:9216
    s_waitcnt lgkmcnt(8)
    ds_read_b64_tr_b16 a[232:233], v17 offset:0
    ds_read_b64_tr_b16 a[234:235], v17 offset:1024
    ds_read_b64_tr_b16 a[236:237], v17 offset:8192
    ds_read_b64_tr_b16 a[238:239], v17 offset:9216
    s_waitcnt lgkmcnt(8)
    ds_read_b64_tr_b16 a[240:241], v16 offset:16384
    ds_read_b64_tr_b16 a[242:243], v16 offset:17408
    ds_read_b64_tr_b16 a[244:245], v16 offset:24576
    ds_read_b64_tr_b16 a[246:247], v16 offset:25600
    s_waitcnt lgkmcnt(8)
    ds_read_b64_tr_b16 a[248:249], v17 offset:16384
    ds_read_b64_tr_b16 a[250:251], v17 offset:17408
    ds_read_b64_tr_b16 a[252:253], v17 offset:24576
    ds_read_b64_tr_b16 a[254:255], v17 offset:25600
    s_waitcnt lgkmcnt(8)
RC_ST2B:
    s_waitcnt lgkmcnt(0)
    s_barrier
    s_load_dwordx2 s[50:51], s[0:1], 32
    s_waitcnt lgkmcnt(0)
    s_mov_b32 s16, s50
    s_mov_b32 s17, s51
    s_and_b32 s17, s17, 0xffff
    s_mov_b32 s18, 0x800000
    s_mov_b32 s19, 0x00020000
    s_lshl_b32 s46, s23, 22
    s_lshl_b32 s47, s21, 19
    s_add_u32 s46, s46, s47
    s_add_u32 s46, s46, 0
    s_lshl_b32 s47, s21, 14
    s_add_u32 m0, s47, 0
    buffer_load_dwordx4 v12, s[16:19], s46 offen lds
    s_add_u32 s46, s46, 32768
    s_add_u32 m0, m0, 1024
    s_nop 0
    buffer_load_dwordx4 v12, s[16:19], s46 offen lds
    s_add_u32 s46, s46, 32768
    s_add_u32 m0, m0, 1024
    s_nop 0
    buffer_load_dwordx4 v12, s[16:19], s46 offen lds
    s_add_u32 s46, s46, 32768
    s_add_u32 m0, m0, 1024
    s_nop 0
    buffer_load_dwordx4 v12, s[16:19], s46 offen lds
    s_add_u32 s46, s46, 32768
    s_add_u32 m0, m0, 1024
    s_nop 0
    buffer_load_dwordx4 v12, s[16:19], s46 offen lds
    s_add_u32 s46, s46, 32768
    s_add_u32 m0, m0, 1024
    s_nop 0
    buffer_load_dwordx4 v12, s[16:19], s46 offen lds
    s_add_u32 s46, s46, 32768
    s_add_u32 m0, m0, 1024
    s_nop 0
    buffer_load_dwordx4 v12, s[16:19], s46 offen lds
    s_add_u32 s46, s46, 32768
    s_add_u32 m0, m0, 1024
    s_nop 0
    buffer_load_dwordx4 v12, s[16:19], s46 offen lds
    s_add_u32 s46, s46, 32768
    s_add_u32 m0, m0, 1024
    s_nop 0
    buffer_load_dwordx4 v12, s[16:19], s46 offen lds
    s_add_u32 s46, s46, 32768
    s_add_u32 m0, m0, 1024
    s_nop 0
    buffer_load_dwordx4 v12, s[16:19], s46 offen lds
    s_add_u32 s46, s46, 32768
    s_add_u32 m0, m0, 1024
    s_nop 0
    buffer_load_dwordx4 v12, s[16:19], s46 offen lds
    s_add_u32 s46, s46, 32768
    s_add_u32 m0, m0, 1024
    s_nop 0
    buffer_load_dwordx4 v12, s[16:19], s46 offen lds
    s_add_u32 s46, s46, 32768
    s_add_u32 m0, m0, 1024
    s_nop 0
    buffer_load_dwordx4 v12, s[16:19], s46 offen lds
    s_add_u32 s46, s46, 32768
    s_add_u32 m0, m0, 1024
    s_nop 0
    buffer_load_dwordx4 v12, s[16:19], s46 offen lds
    s_add_u32 s46, s46, 32768
    s_add_u32 m0, m0, 1024
    s_nop 0
    buffer_load_dwordx4 v12, s[16:19], s46 offen lds
    s_add_u32 s46, s46, 32768
    s_add_u32 m0, m0, 1024
    s_nop 0
    buffer_load_dwordx4 v12, s[16:19], s46 offen lds
    s_waitcnt vmcnt(16)
    s_barrier
    s_lshr_b32 s46, s21, 1
    s_cmp_eq_u32 s46, 1
    s_cbranch_scc0 RC_ST3A
    ds_read_b64_tr_b16 a[128:129], v18 offset:0
    ds_read_b64_tr_b16 a[130:131], v18 offset:1024
    ds_read_b64_tr_b16 a[132:133], v18 offset:8192
    ds_read_b64_tr_b16 a[134:135], v18 offset:9216
    s_waitcnt lgkmcnt(8)
    ds_read_b64_tr_b16 a[136:137], v19 offset:0
    ds_read_b64_tr_b16 a[138:139], v19 offset:1024
    ds_read_b64_tr_b16 a[140:141], v19 offset:8192
    ds_read_b64_tr_b16 a[142:143], v19 offset:9216
    s_waitcnt lgkmcnt(8)
    ds_read_b64_tr_b16 a[144:145], v18 offset:16384
    ds_read_b64_tr_b16 a[146:147], v18 offset:17408
    ds_read_b64_tr_b16 a[148:149], v18 offset:24576
    ds_read_b64_tr_b16 a[150:151], v18 offset:25600
    s_waitcnt lgkmcnt(8)
    ds_read_b64_tr_b16 a[152:153], v19 offset:16384
    ds_read_b64_tr_b16 a[154:155], v19 offset:17408
    ds_read_b64_tr_b16 a[156:157], v19 offset:24576
    ds_read_b64_tr_b16 a[158:159], v19 offset:25600
    s_waitcnt lgkmcnt(8)
    ds_read_b64_tr_b16 a[160:161], v20 offset:0
    ds_read_b64_tr_b16 a[162:163], v20 offset:1024
    ds_read_b64_tr_b16 a[164:165], v20 offset:8192
    ds_read_b64_tr_b16 a[166:167], v20 offset:9216
    s_waitcnt lgkmcnt(8)
    ds_read_b64_tr_b16 a[168:169], v21 offset:0
    ds_read_b64_tr_b16 a[170:171], v21 offset:1024
    ds_read_b64_tr_b16 a[172:173], v21 offset:8192
    ds_read_b64_tr_b16 a[174:175], v21 offset:9216
    s_waitcnt lgkmcnt(8)
    ds_read_b64_tr_b16 a[176:177], v20 offset:16384
    ds_read_b64_tr_b16 a[178:179], v20 offset:17408
    ds_read_b64_tr_b16 a[180:181], v20 offset:24576
    ds_read_b64_tr_b16 a[182:183], v20 offset:25600
    s_waitcnt lgkmcnt(8)
    ds_read_b64_tr_b16 a[184:185], v21 offset:16384
    ds_read_b64_tr_b16 a[186:187], v21 offset:17408
    ds_read_b64_tr_b16 a[188:189], v21 offset:24576
    ds_read_b64_tr_b16 a[190:191], v21 offset:25600
    s_waitcnt lgkmcnt(8)
    s_branch RC_ST3B
RC_ST3A:
    ds_read_b64_tr_b16 a[192:193], v18 offset:0
    ds_read_b64_tr_b16 a[194:195], v18 offset:1024
    ds_read_b64_tr_b16 a[196:197], v18 offset:8192
    ds_read_b64_tr_b16 a[198:199], v18 offset:9216
    s_waitcnt lgkmcnt(8)
    ds_read_b64_tr_b16 a[200:201], v19 offset:0
    ds_read_b64_tr_b16 a[202:203], v19 offset:1024
    ds_read_b64_tr_b16 a[204:205], v19 offset:8192
    ds_read_b64_tr_b16 a[206:207], v19 offset:9216
    s_waitcnt lgkmcnt(8)
    ds_read_b64_tr_b16 a[208:209], v18 offset:16384
    ds_read_b64_tr_b16 a[210:211], v18 offset:17408
    ds_read_b64_tr_b16 a[212:213], v18 offset:24576
    ds_read_b64_tr_b16 a[214:215], v18 offset:25600
    s_waitcnt lgkmcnt(8)
    ds_read_b64_tr_b16 a[216:217], v19 offset:16384
    ds_read_b64_tr_b16 a[218:219], v19 offset:17408
    ds_read_b64_tr_b16 a[220:221], v19 offset:24576
    ds_read_b64_tr_b16 a[222:223], v19 offset:25600
    s_waitcnt lgkmcnt(8)
    ds_read_b64_tr_b16 a[224:225], v20 offset:0
    ds_read_b64_tr_b16 a[226:227], v20 offset:1024
    ds_read_b64_tr_b16 a[228:229], v20 offset:8192
    ds_read_b64_tr_b16 a[230:231], v20 offset:9216
    s_waitcnt lgkmcnt(8)
    ds_read_b64_tr_b16 a[232:233], v21 offset:0
    ds_read_b64_tr_b16 a[234:235], v21 offset:1024
    ds_read_b64_tr_b16 a[236:237], v21 offset:8192
    ds_read_b64_tr_b16 a[238:239], v21 offset:9216
    s_waitcnt lgkmcnt(8)
    ds_read_b64_tr_b16 a[240:241], v20 offset:16384
    ds_read_b64_tr_b16 a[242:243], v20 offset:17408
    ds_read_b64_tr_b16 a[244:245], v20 offset:24576
    ds_read_b64_tr_b16 a[246:247], v20 offset:25600
    s_waitcnt lgkmcnt(8)
    ds_read_b64_tr_b16 a[248:249], v21 offset:16384
    ds_read_b64_tr_b16 a[250:251], v21 offset:17408
    ds_read_b64_tr_b16 a[252:253], v21 offset:24576
    ds_read_b64_tr_b16 a[254:255], v21 offset:25600
    s_waitcnt lgkmcnt(8)
RC_ST3B:
    s_waitcnt lgkmcnt(0)
    s_barrier
    s_lshl_b32 s46, s23, 22
    s_lshl_b32 s47, s21, 19
    s_add_u32 s46, s46, s47
    s_add_u32 s46, s46, 2097152
    s_lshl_b32 s47, s21, 14
    s_add_u32 m0, s47, 65536
    buffer_load_dwordx4 v12, s[16:19], s46 offen lds
    s_add_u32 s46, s46, 32768
    s_add_u32 m0, m0, 1024
    s_nop 0
    buffer_load_dwordx4 v12, s[16:19], s46 offen lds
    s_add_u32 s46, s46, 32768
    s_add_u32 m0, m0, 1024
    s_nop 0
    buffer_load_dwordx4 v12, s[16:19], s46 offen lds
    s_add_u32 s46, s46, 32768
    s_add_u32 m0, m0, 1024
    s_nop 0
    buffer_load_dwordx4 v12, s[16:19], s46 offen lds
    s_add_u32 s46, s46, 32768
    s_add_u32 m0, m0, 1024
    s_nop 0
    buffer_load_dwordx4 v12, s[16:19], s46 offen lds
    s_add_u32 s46, s46, 32768
    s_add_u32 m0, m0, 1024
    s_nop 0
    buffer_load_dwordx4 v12, s[16:19], s46 offen lds
    s_add_u32 s46, s46, 32768
    s_add_u32 m0, m0, 1024
    s_nop 0
    buffer_load_dwordx4 v12, s[16:19], s46 offen lds
    s_add_u32 s46, s46, 32768
    s_add_u32 m0, m0, 1024
    s_nop 0
    buffer_load_dwordx4 v12, s[16:19], s46 offen lds
    s_add_u32 s46, s46, 32768
    s_add_u32 m0, m0, 1024
    s_nop 0
    buffer_load_dwordx4 v12, s[16:19], s46 offen lds
    s_add_u32 s46, s46, 32768
    s_add_u32 m0, m0, 1024
    s_nop 0
    buffer_load_dwordx4 v12, s[16:19], s46 offen lds
    s_add_u32 s46, s46, 32768
    s_add_u32 m0, m0, 1024
    s_nop 0
    buffer_load_dwordx4 v12, s[16:19], s46 offen lds
    s_add_u32 s46, s46, 32768
    s_add_u32 m0, m0, 1024
    s_nop 0
    buffer_load_dwordx4 v12, s[16:19], s46 offen lds
    s_add_u32 s46, s46, 32768
    s_add_u32 m0, m0, 1024
    s_nop 0
    buffer_load_dwordx4 v12, s[16:19], s46 offen lds
    s_add_u32 s46, s46, 32768
    s_add_u32 m0, m0, 1024
    s_nop 0
    buffer_load_dwordx4 v12, s[16:19], s46 offen lds
    s_add_u32 s46, s46, 32768
    s_add_u32 m0, m0, 1024
    s_nop 0
    buffer_load_dwordx4 v12, s[16:19], s46 offen lds
    s_add_u32 s46, s46, 32768
    s_add_u32 m0, m0, 1024
    s_nop 0
    buffer_load_dwordx4 v12, s[16:19], s46 offen lds
    s_waitcnt vmcnt(16)
    s_barrier
    s_lshr_b32 s46, s21, 1
    s_cmp_eq_u32 s46, 0
    s_cbranch_scc0 RC_ST4A
    ds_read_b64_tr_b16 v[128:129], v14 offset:0
    ds_read_b64_tr_b16 v[130:131], v14 offset:1024
    ds_read_b64_tr_b16 v[132:133], v14 offset:8192
    ds_read_b64_tr_b16 v[134:135], v14 offset:9216
    s_waitcnt lgkmcnt(8)
    ds_read_b64_tr_b16 v[136:137], v15 offset:0
    ds_read_b64_tr_b16 v[138:139], v15 offset:1024
    ds_read_b64_tr_b16 v[140:141], v15 offset:8192
    ds_read_b64_tr_b16 v[142:143], v15 offset:9216
    s_waitcnt lgkmcnt(8)
    ds_read_b64_tr_b16 v[144:145], v14 offset:16384
    ds_read_b64_tr_b16 v[146:147], v14 offset:17408
    ds_read_b64_tr_b16 v[148:149], v14 offset:24576
    ds_read_b64_tr_b16 v[150:151], v14 offset:25600
    s_waitcnt lgkmcnt(8)
    ds_read_b64_tr_b16 v[152:153], v15 offset:16384
    ds_read_b64_tr_b16 v[154:155], v15 offset:17408
    ds_read_b64_tr_b16 v[156:157], v15 offset:24576
    ds_read_b64_tr_b16 v[158:159], v15 offset:25600
    s_waitcnt lgkmcnt(8)
    ds_read_b64_tr_b16 v[160:161], v16 offset:0
    ds_read_b64_tr_b16 v[162:163], v16 offset:1024
    ds_read_b64_tr_b16 v[164:165], v16 offset:8192
    ds_read_b64_tr_b16 v[166:167], v16 offset:9216
    s_waitcnt lgkmcnt(8)
    ds_read_b64_tr_b16 v[168:169], v17 offset:0
    ds_read_b64_tr_b16 v[170:171], v17 offset:1024
    ds_read_b64_tr_b16 v[172:173], v17 offset:8192
    ds_read_b64_tr_b16 v[174:175], v17 offset:9216
    s_waitcnt lgkmcnt(8)
    ds_read_b64_tr_b16 v[176:177], v16 offset:16384
    ds_read_b64_tr_b16 v[178:179], v16 offset:17408
    ds_read_b64_tr_b16 v[180:181], v16 offset:24576
    ds_read_b64_tr_b16 v[182:183], v16 offset:25600
    s_waitcnt lgkmcnt(8)
    ds_read_b64_tr_b16 v[184:185], v17 offset:16384
    ds_read_b64_tr_b16 v[186:187], v17 offset:17408
    ds_read_b64_tr_b16 v[188:189], v17 offset:24576
    ds_read_b64_tr_b16 v[190:191], v17 offset:25600
    s_waitcnt lgkmcnt(8)
    s_branch RC_ST4B
RC_ST4A:
    ds_read_b64_tr_b16 v[64:65], v14 offset:0
    ds_read_b64_tr_b16 v[66:67], v14 offset:1024
    ds_read_b64_tr_b16 v[68:69], v14 offset:8192
    ds_read_b64_tr_b16 v[70:71], v14 offset:9216
    s_waitcnt lgkmcnt(8)
    ds_read_b64_tr_b16 v[72:73], v15 offset:0
    ds_read_b64_tr_b16 v[74:75], v15 offset:1024
    ds_read_b64_tr_b16 v[76:77], v15 offset:8192
    ds_read_b64_tr_b16 v[78:79], v15 offset:9216
    s_waitcnt lgkmcnt(8)
    ds_read_b64_tr_b16 v[80:81], v14 offset:16384
    ds_read_b64_tr_b16 v[82:83], v14 offset:17408
    ds_read_b64_tr_b16 v[84:85], v14 offset:24576
    ds_read_b64_tr_b16 v[86:87], v14 offset:25600
    s_waitcnt lgkmcnt(8)
    ds_read_b64_tr_b16 v[88:89], v15 offset:16384
    ds_read_b64_tr_b16 v[90:91], v15 offset:17408
    ds_read_b64_tr_b16 v[92:93], v15 offset:24576
    ds_read_b64_tr_b16 v[94:95], v15 offset:25600
    s_waitcnt lgkmcnt(8)
    ds_read_b64_tr_b16 v[96:97], v16 offset:0
    ds_read_b64_tr_b16 v[98:99], v16 offset:1024
    ds_read_b64_tr_b16 v[100:101], v16 offset:8192
    ds_read_b64_tr_b16 v[102:103], v16 offset:9216
    s_waitcnt lgkmcnt(8)
    ds_read_b64_tr_b16 v[104:105], v17 offset:0
    ds_read_b64_tr_b16 v[106:107], v17 offset:1024
    ds_read_b64_tr_b16 v[108:109], v17 offset:8192
    ds_read_b64_tr_b16 v[110:111], v17 offset:9216
    s_waitcnt lgkmcnt(8)
    ds_read_b64_tr_b16 v[112:113], v16 offset:16384
    ds_read_b64_tr_b16 v[114:115], v16 offset:17408
    ds_read_b64_tr_b16 v[116:117], v16 offset:24576
    ds_read_b64_tr_b16 v[118:119], v16 offset:25600
    s_waitcnt lgkmcnt(8)
    ds_read_b64_tr_b16 v[120:121], v17 offset:16384
    ds_read_b64_tr_b16 v[122:123], v17 offset:17408
    ds_read_b64_tr_b16 v[124:125], v17 offset:24576
    ds_read_b64_tr_b16 v[126:127], v17 offset:25600
    s_waitcnt lgkmcnt(8)
RC_ST4B:
    s_waitcnt lgkmcnt(0)
    s_barrier
    s_load_dwordx2 s[50:51], s[0:1], 40
    s_waitcnt lgkmcnt(0)
    s_mov_b32 s16, s50
    s_mov_b32 s17, s51
    s_and_b32 s17, s17, 0xffff
    s_mov_b32 s18, 0x800000
    s_mov_b32 s19, 0x00020000
    s_lshl_b32 s46, s22, 7
    s_lshl_b32 s47, s21, 4
    s_add_u32 s46, s46, s47
    s_add_u32 s46, s46, 0
    s_lshl_b32 s46, s46, 11
    s_lshl_b32 s47, s21, 14
    s_add_u32 m0, s47, 0
    buffer_load_dwordx4 v24, s[16:19], s46 offen lds
    s_add_u32 s46, s46, 2048
    s_add_u32 m0, m0, 1024
    s_nop 0
    buffer_load_dwordx4 v25, s[16:19], s46 offen lds
    s_add_u32 s46, s46, 2048
    s_add_u32 m0, m0, 1024
    s_nop 0
    buffer_load_dwordx4 v26, s[16:19], s46 offen lds
    s_add_u32 s46, s46, 2048
    s_add_u32 m0, m0, 1024
    s_nop 0
    buffer_load_dwordx4 v27, s[16:19], s46 offen lds
    s_add_u32 s46, s46, 2048
    s_add_u32 m0, m0, 1024
    s_nop 0
    buffer_load_dwordx4 v24, s[16:19], s46 offen lds
    s_add_u32 s46, s46, 2048
    s_add_u32 m0, m0, 1024
    s_nop 0
    buffer_load_dwordx4 v25, s[16:19], s46 offen lds
    s_add_u32 s46, s46, 2048
    s_add_u32 m0, m0, 1024
    s_nop 0
    buffer_load_dwordx4 v26, s[16:19], s46 offen lds
    s_add_u32 s46, s46, 2048
    s_add_u32 m0, m0, 1024
    s_nop 0
    buffer_load_dwordx4 v27, s[16:19], s46 offen lds
    s_add_u32 s46, s46, 2048
    s_add_u32 m0, m0, 1024
    s_nop 0
    buffer_load_dwordx4 v24, s[16:19], s46 offen lds
    s_add_u32 s46, s46, 2048
    s_add_u32 m0, m0, 1024
    s_nop 0
    buffer_load_dwordx4 v25, s[16:19], s46 offen lds
    s_add_u32 s46, s46, 2048
    s_add_u32 m0, m0, 1024
    s_nop 0
    buffer_load_dwordx4 v26, s[16:19], s46 offen lds
    s_add_u32 s46, s46, 2048
    s_add_u32 m0, m0, 1024
    s_nop 0
    buffer_load_dwordx4 v27, s[16:19], s46 offen lds
    s_add_u32 s46, s46, 2048
    s_add_u32 m0, m0, 1024
    s_nop 0
    buffer_load_dwordx4 v24, s[16:19], s46 offen lds
    s_add_u32 s46, s46, 2048
    s_add_u32 m0, m0, 1024
    s_nop 0
    buffer_load_dwordx4 v25, s[16:19], s46 offen lds
    s_add_u32 s46, s46, 2048
    s_add_u32 m0, m0, 1024
    s_nop 0
    buffer_load_dwordx4 v26, s[16:19], s46 offen lds
    s_add_u32 s46, s46, 2048
    s_add_u32 m0, m0, 1024
    s_nop 0
    buffer_load_dwordx4 v27, s[16:19], s46 offen lds
    s_waitcnt vmcnt(16)
    s_barrier
    s_lshr_b32 s46, s21, 1
    s_cmp_eq_u32 s46, 1
    s_cbranch_scc0 RC_ST5A
    ds_read_b64_tr_b16 v[128:129], v18 offset:0
    ds_read_b64_tr_b16 v[130:131], v18 offset:1024
    ds_read_b64_tr_b16 v[132:133], v18 offset:8192
    ds_read_b64_tr_b16 v[134:135], v18 offset:9216
    s_waitcnt lgkmcnt(8)
    ds_read_b64_tr_b16 v[136:137], v19 offset:0
    ds_read_b64_tr_b16 v[138:139], v19 offset:1024
    ds_read_b64_tr_b16 v[140:141], v19 offset:8192
    ds_read_b64_tr_b16 v[142:143], v19 offset:9216
    s_waitcnt lgkmcnt(8)
    ds_read_b64_tr_b16 v[144:145], v18 offset:16384
    ds_read_b64_tr_b16 v[146:147], v18 offset:17408
    ds_read_b64_tr_b16 v[148:149], v18 offset:24576
    ds_read_b64_tr_b16 v[150:151], v18 offset:25600
    s_waitcnt lgkmcnt(8)
    ds_read_b64_tr_b16 v[152:153], v19 offset:16384
    ds_read_b64_tr_b16 v[154:155], v19 offset:17408
    ds_read_b64_tr_b16 v[156:157], v19 offset:24576
    ds_read_b64_tr_b16 v[158:159], v19 offset:25600
    s_waitcnt lgkmcnt(8)
    ds_read_b64_tr_b16 v[160:161], v20 offset:0
    ds_read_b64_tr_b16 v[162:163], v20 offset:1024
    ds_read_b64_tr_b16 v[164:165], v20 offset:8192
    ds_read_b64_tr_b16 v[166:167], v20 offset:9216
    s_waitcnt lgkmcnt(8)
    ds_read_b64_tr_b16 v[168:169], v21 offset:0
    ds_read_b64_tr_b16 v[170:171], v21 offset:1024
    ds_read_b64_tr_b16 v[172:173], v21 offset:8192
    ds_read_b64_tr_b16 v[174:175], v21 offset:9216
    s_waitcnt lgkmcnt(8)
    ds_read_b64_tr_b16 v[176:177], v20 offset:16384
    ds_read_b64_tr_b16 v[178:179], v20 offset:17408
    ds_read_b64_tr_b16 v[180:181], v20 offset:24576
    ds_read_b64_tr_b16 v[182:183], v20 offset:25600
    s_waitcnt lgkmcnt(8)
    ds_read_b64_tr_b16 v[184:185], v21 offset:16384
    ds_read_b64_tr_b16 v[186:187], v21 offset:17408
    ds_read_b64_tr_b16 v[188:189], v21 offset:24576
    ds_read_b64_tr_b16 v[190:191], v21 offset:25600
    s_waitcnt lgkmcnt(8)
    s_branch RC_ST5B
RC_ST5A:
    ds_read_b64_tr_b16 v[64:65], v18 offset:0
    ds_read_b64_tr_b16 v[66:67], v18 offset:1024
    ds_read_b64_tr_b16 v[68:69], v18 offset:8192
    ds_read_b64_tr_b16 v[70:71], v18 offset:9216
    s_waitcnt lgkmcnt(8)
    ds_read_b64_tr_b16 v[72:73], v19 offset:0
    ds_read_b64_tr_b16 v[74:75], v19 offset:1024
    ds_read_b64_tr_b16 v[76:77], v19 offset:8192
    ds_read_b64_tr_b16 v[78:79], v19 offset:9216
    s_waitcnt lgkmcnt(8)
    ds_read_b64_tr_b16 v[80:81], v18 offset:16384
    ds_read_b64_tr_b16 v[82:83], v18 offset:17408
    ds_read_b64_tr_b16 v[84:85], v18 offset:24576
    ds_read_b64_tr_b16 v[86:87], v18 offset:25600
    s_waitcnt lgkmcnt(8)
    ds_read_b64_tr_b16 v[88:89], v19 offset:16384
    ds_read_b64_tr_b16 v[90:91], v19 offset:17408
    ds_read_b64_tr_b16 v[92:93], v19 offset:24576
    ds_read_b64_tr_b16 v[94:95], v19 offset:25600
    s_waitcnt lgkmcnt(8)
    ds_read_b64_tr_b16 v[96:97], v20 offset:0
    ds_read_b64_tr_b16 v[98:99], v20 offset:1024
    ds_read_b64_tr_b16 v[100:101], v20 offset:8192
    ds_read_b64_tr_b16 v[102:103], v20 offset:9216
    s_waitcnt lgkmcnt(8)
    ds_read_b64_tr_b16 v[104:105], v21 offset:0
    ds_read_b64_tr_b16 v[106:107], v21 offset:1024
    ds_read_b64_tr_b16 v[108:109], v21 offset:8192
    ds_read_b64_tr_b16 v[110:111], v21 offset:9216
    s_waitcnt lgkmcnt(8)
    ds_read_b64_tr_b16 v[112:113], v20 offset:16384
    ds_read_b64_tr_b16 v[114:115], v20 offset:17408
    ds_read_b64_tr_b16 v[116:117], v20 offset:24576
    ds_read_b64_tr_b16 v[118:119], v20 offset:25600
    s_waitcnt lgkmcnt(8)
    ds_read_b64_tr_b16 v[120:121], v21 offset:16384
    ds_read_b64_tr_b16 v[122:123], v21 offset:17408
    ds_read_b64_tr_b16 v[124:125], v21 offset:24576
    ds_read_b64_tr_b16 v[126:127], v21 offset:25600
    s_waitcnt lgkmcnt(8)
RC_ST5B:
    s_waitcnt lgkmcnt(0)
    s_barrier
    v_lshrrev_b32 v49, 4, v5
    v_cmp_gt_u32 vcc, 8, v49
    v_add_u32 v49, 128, v5
    v_mov_b32 v50, 132
    v_cndmask_b32 v49, v50, v49, vcc
    buffer_load_dword v50, v49, s[92:95], 0 offen sc1
    s_add_u32 s70, s60, 2065920
    s_lshl_b32 s71, s21, 11
    s_add_u32 s70, s70, s71
    v_mov_b32 v51, 0
    buffer_load_dword v52, v51, s[12:15], s70 offen offset:384 sc1
    s_lshl_b32 s46, s22, 7
    s_lshl_b32 s47, s21, 4
    s_add_u32 s46, s46, s47
    s_add_u32 s46, s46, 64
    s_lshl_b32 s46, s46, 11
    s_lshl_b32 s47, s21, 14
    s_add_u32 m0, s47, 65536
    buffer_load_dwordx4 v24, s[16:19], s46 offen lds
    s_add_u32 s46, s46, 2048
    s_add_u32 m0, m0, 1024
    s_nop 0
    buffer_load_dwordx4 v25, s[16:19], s46 offen lds
    s_add_u32 s46, s46, 2048
    s_add_u32 m0, m0, 1024
    s_nop 0
    buffer_load_dwordx4 v26, s[16:19], s46 offen lds
    s_add_u32 s46, s46, 2048
    s_add_u32 m0, m0, 1024
    s_nop 0
    buffer_load_dwordx4 v27, s[16:19], s46 offen lds
    s_add_u32 s46, s46, 2048
    s_add_u32 m0, m0, 1024
    s_nop 0
    buffer_load_dwordx4 v24, s[16:19], s46 offen lds
    s_add_u32 s46, s46, 2048
    s_add_u32 m0, m0, 1024
    s_nop 0
    buffer_load_dwordx4 v25, s[16:19], s46 offen lds
    s_add_u32 s46, s46, 2048
    s_add_u32 m0, m0, 1024
    s_nop 0
    buffer_load_dwordx4 v26, s[16:19], s46 offen lds
    s_add_u32 s46, s46, 2048
    s_add_u32 m0, m0, 1024
    s_nop 0
    buffer_load_dwordx4 v27, s[16:19], s46 offen lds
    s_add_u32 s46, s46, 2048
    s_add_u32 m0, m0, 1024
    s_nop 0
    buffer_load_dwordx4 v24, s[16:19], s46 offen lds
    s_add_u32 s46, s46, 2048
    s_add_u32 m0, m0, 1024
    s_nop 0
    buffer_load_dwordx4 v25, s[16:19], s46 offen lds
    s_add_u32 s46, s46, 2048
    s_add_u32 m0, m0, 1024
    s_nop 0
    buffer_load_dwordx4 v26, s[16:19], s46 offen lds
    s_add_u32 s46, s46, 2048
    s_add_u32 m0, m0, 1024
    s_nop 0
    buffer_load_dwordx4 v27, s[16:19], s46 offen lds
    s_add_u32 s46, s46, 2048
    s_add_u32 m0, m0, 1024
    s_nop 0
    buffer_load_dwordx4 v24, s[16:19], s46 offen lds
    s_add_u32 s46, s46, 2048
    s_add_u32 m0, m0, 1024
    s_nop 0
    buffer_load_dwordx4 v25, s[16:19], s46 offen lds
    s_add_u32 s46, s46, 2048
    s_add_u32 m0, m0, 1024
    s_nop 0
    buffer_load_dwordx4 v26, s[16:19], s46 offen lds
    s_add_u32 s46, s46, 2048
    s_add_u32 m0, m0, 1024
    s_nop 0
    buffer_load_dwordx4 v27, s[16:19], s46 offen lds
    s_waitcnt vmcnt(16)
    s_barrier
    ds_read_b64_tr_b16 v[192:193], v32 offset:0
    ds_read_b64_tr_b16 v[194:195], v32 offset:8192
    ds_read_b64_tr_b16 v[196:197], v32 offset:16384
    ds_read_b64_tr_b16 v[198:199], v32 offset:24576
    s_waitcnt lgkmcnt(8)
    ds_read_b64_tr_b16 v[200:201], v33 offset:0
    ds_read_b64_tr_b16 v[202:203], v33 offset:8192
    ds_read_b64_tr_b16 v[204:205], v33 offset:16384
    ds_read_b64_tr_b16 v[206:207], v33 offset:24576
    s_waitcnt lgkmcnt(8)
    ds_read_b64_tr_b16 v[208:209], v34 offset:0
    ds_read_b64_tr_b16 v[210:211], v34 offset:8192
    ds_read_b64_tr_b16 v[212:213], v34 offset:16384
    ds_read_b64_tr_b16 v[214:215], v34 offset:24576
    s_waitcnt lgkmcnt(8)
    ds_read_b64_tr_b16 v[216:217], v35 offset:0
    ds_read_b64_tr_b16 v[218:219], v35 offset:8192
    ds_read_b64_tr_b16 v[220:221], v35 offset:16384
    ds_read_b64_tr_b16 v[222:223], v35 offset:24576
    s_waitcnt lgkmcnt(8)
    ds_read_b64_tr_b16 v[224:225], v36 offset:0
    ds_read_b64_tr_b16 v[226:227], v36 offset:8192
    ds_read_b64_tr_b16 v[228:229], v36 offset:16384
    ds_read_b64_tr_b16 v[230:231], v36 offset:24576
    s_waitcnt lgkmcnt(8)
    ds_read_b64_tr_b16 v[232:233], v37 offset:0
    ds_read_b64_tr_b16 v[234:235], v37 offset:8192
    ds_read_b64_tr_b16 v[236:237], v37 offset:16384
    ds_read_b64_tr_b16 v[238:239], v37 offset:24576
    s_waitcnt lgkmcnt(8)
    ds_read_b64_tr_b16 v[240:241], v38 offset:0
    ds_read_b64_tr_b16 v[242:243], v38 offset:8192
    ds_read_b64_tr_b16 v[244:245], v38 offset:16384
    ds_read_b64_tr_b16 v[246:247], v38 offset:24576
    s_waitcnt lgkmcnt(8)
    ds_read_b64_tr_b16 v[248:249], v39 offset:0
    ds_read_b64_tr_b16 v[250:251], v39 offset:8192
    ds_read_b64_tr_b16 v[252:253], v39 offset:16384
    ds_read_b64_tr_b16 v[254:255], v39 offset:24576
    s_waitcnt lgkmcnt(8)
    s_waitcnt lgkmcnt(0)
    s_barrier
    v_readlane_b32 s80, v50, 0
    v_readlane_b32 s81, v50, 1
    v_readlane_b32 s82, v50, 2
    v_readlane_b32 s83, v50, 3
    v_readlane_b32 s84, v50, 4
    v_readlane_b32 s85, v50, 5
    v_readlane_b32 s86, v50, 6
    v_readlane_b32 s87, v50, 7
    v_readlane_b32 s71, v50, 8
    s_add_u32 s80, s80, s81
    s_add_u32 s80, s80, s82
    s_add_u32 s80, s80, s83
    s_add_u32 s80, s80, s84
    s_add_u32 s80, s80, s85
    s_add_u32 s80, s80, s86
    s_add_u32 s80, s80, s87
    v_cmp_ne_u32 vcc, 32, v50
    s_and_b32 vcc_lo, vcc_lo, 0xff
    s_cselect_b32 s77, 2, 1
    s_cmp_eq_u32 s71, 256
    s_cselect_b32 s71, 2, 0
    s_cmp_eq_u32 s80, 256
    s_cselect_b32 s76, s77, s71
    ds_write_b128 v48, v[64:67] offset:0
    ds_write_b128 v48, v[68:71] offset:1024
    ds_write_b128 v48, v[72:75] offset:2048
    ds_write_b128 v48, v[76:79] offset:3072
    ds_write_b128 v48, v[80:83] offset:4096
    ds_write_b128 v48, v[84:87] offset:5120
    ds_write_b128 v48, v[88:91] offset:6144
    ds_write_b128 v48, v[92:95] offset:7168
    ds_write_b128 v48, v[96:99] offset:8192
    ds_write_b128 v48, v[100:103] offset:9216
    ds_write_b128 v48, v[104:107] offset:10240
    ds_write_b128 v48, v[108:111] offset:11264
    ds_write_b128 v48, v[112:115] offset:12288
    ds_write_b128 v48, v[116:119] offset:13312
    ds_write_b128 v48, v[120:123] offset:14336
    ds_write_b128 v48, v[124:127] offset:15360
    s_waitcnt lgkmcnt(0)
    s_waitcnt vmcnt(0)
    s_barrier
    ds_read_b64_tr_b16 v[64:65], v40 offset:0
    ds_read_b64_tr_b16 v[66:67], v40 offset:8192
    ds_read_b64_tr_b16 v[68:69], v40 offset:16384
    ds_read_b64_tr_b16 v[70:71], v40 offset:24576
    s_waitcnt lgkmcnt(8)
    ds_read_b64_tr_b16 v[72:73], v41 offset:0
    ds_read_b64_tr_b16 v[74:75], v41 offset:8192
    ds_read_b64_tr_b16 v[76:77], v41 offset:16384
    ds_read_b64_tr_b16 v[78:79], v41 offset:24576
    s_waitcnt lgkmcnt(8)
    ds_read_b64_tr_b16 v[80:81], v42 offset:0
    ds_read_b64_tr_b16 v[82:83], v42 offset:8192
    ds_read_b64_tr_b16 v[84:85], v42 offset:16384
    ds_read_b64_tr_b16 v[86:87], v42 offset:24576
    s_waitcnt lgkmcnt(8)
    ds_read_b64_tr_b16 v[88:89], v43 offset:0
    ds_read_b64_tr_b16 v[90:91], v43 offset:8192
    ds_read_b64_tr_b16 v[92:93], v43 offset:16384
    ds_read_b64_tr_b16 v[94:95], v43 offset:24576
    s_waitcnt lgkmcnt(8)
    ds_read_b64_tr_b16 v[96:97], v44 offset:0
    ds_read_b64_tr_b16 v[98:99], v44 offset:8192
    ds_read_b64_tr_b16 v[100:101], v44 offset:16384
    ds_read_b64_tr_b16 v[102:103], v44 offset:24576
    s_waitcnt lgkmcnt(8)
    ds_read_b64_tr_b16 v[104:105], v45 offset:0
    ds_read_b64_tr_b16 v[106:107], v45 offset:8192
    ds_read_b64_tr_b16 v[108:109], v45 offset:16384
    ds_read_b64_tr_b16 v[110:111], v45 offset:24576
    s_waitcnt lgkmcnt(8)
    ds_read_b64_tr_b16 v[112:113], v46 offset:0
    ds_read_b64_tr_b16 v[114:115], v46 offset:8192
    ds_read_b64_tr_b16 v[116:117], v46 offset:16384
    ds_read_b64_tr_b16 v[118:119], v46 offset:24576
    s_waitcnt lgkmcnt(8)
    ds_read_b64_tr_b16 v[120:121], v47 offset:0
    ds_read_b64_tr_b16 v[122:123], v47 offset:8192
    ds_read_b64_tr_b16 v[124:125], v47 offset:16384
    ds_read_b64_tr_b16 v[126:127], v47 offset:24576
    s_waitcnt lgkmcnt(8)
    s_waitcnt lgkmcnt(0)
    s_barrier
    v_add_u32 v48, 65536, v48
    ds_write_b128 v48, v[64:67] offset:0
    ds_write_b128 v48, v[68:71] offset:1024
    ds_write_b128 v48, v[72:75] offset:2048
    ds_write_b128 v48, v[76:79] offset:3072
    ds_write_b128 v48, v[80:83] offset:4096
    ds_write_b128 v48, v[84:87] offset:5120
    ds_write_b128 v48, v[88:91] offset:6144
    ds_write_b128 v48, v[92:95] offset:7168
    ds_write_b128 v48, v[96:99] offset:8192
    ds_write_b128 v48, v[100:103] offset:9216
    ds_write_b128 v48, v[104:107] offset:10240
    ds_write_b128 v48, v[108:111] offset:11264
    ds_write_b128 v48, v[112:115] offset:12288
    ds_write_b128 v48, v[116:119] offset:13312
    ds_write_b128 v48, v[120:123] offset:14336
    ds_write_b128 v48, v[124:127] offset:15360
    s_waitcnt lgkmcnt(0)
    s_cmp_eq_u32 s99, 0
    s_cbranch_scc0 RC_NOVER
    s_mov_b32 s70, 200000
RC_VP:
    s_cmp_lg_u32 s76, 0
    s_cbranch_scc1 RC_VD
    buffer_load_dword v50, v49, s[92:95], 0 offen sc1
    s_waitcnt vmcnt(0)
    v_readlane_b32 s80, v50, 0
    v_readlane_b32 s81, v50, 1
    v_readlane_b32 s82, v50, 2
    v_readlane_b32 s83, v50, 3
    v_readlane_b32 s84, v50, 4
    v_readlane_b32 s85, v50, 5
    v_readlane_b32 s86, v50, 6
    v_readlane_b32 s87, v50, 7
    v_readlane_b32 s71, v50, 8
    s_add_u32 s80, s80, s81
    s_add_u32 s80, s80, s82
    s_add_u32 s80, s80, s83
    s_add_u32 s80, s80, s84
    s_add_u32 s80, s80, s85
    s_add_u32 s80, s80, s86
    s_add_u32 s80, s80, s87
    v_cmp_ne_u32 vcc, 32, v50
    s_and_b32 vcc_lo, vcc_lo, 0xff
    s_cselect_b32 s77, 2, 1
    s_cmp_eq_u32 s71, 256
    s_cselect_b32 s71, 2, 0
    s_cmp_eq_u32 s80, 256
    s_cselect_b32 s76, s77, s71
    s_cmp_eq_u32 s70, 199900
    s_cbranch_scc0 RC_VN
    s_cmp_eq_u32 s21, 0
    s_cbranch_scc0 RC_VN
    v_mov_b32 v8, 1
    v_mov_b32 v11, 132
    s_mov_b64 exec, 1
    buffer_atomic_add v8, v11, s[92:95], 0 offen sc1
    s_mov_b64 exec, -1
RC_VN:
    s_sub_u32 s70, s70, 1
    s_cmp_lg_u32 s70, 0
    s_cbranch_scc1 RC_VP
RC_VD:
    s_cmp_eq_u32 s76, 1
    s_cbranch_scc0 MG_FALL
RC_NOVER:
    s_cmp_eq_u32 s23, 0
    s_cbranch_scc0 RC_NM1
    s_add_u32 s46, s60, 2065920
    s_lshl_b32 s47, s21, 11
    s_add_u32 s46, s46, s47
    v_mov_b32 v8, 0
    s_mov_b32 s70, -1
    s_mov_b32 s71, -1
    s_add_u32 s47, s46, 0
    s_memtime s[64:65]
    s_waitcnt lgkmcnt(0)
    buffer_load_dword v9, v8, s[12:15], s47 offen sc1
    s_waitcnt vmcnt(0)
    s_memtime s[66:67]
    s_waitcnt lgkmcnt(0)
    s_sub_u32 s66, s66, s64
    s_min_u32 s70, s70, s66
    s_add_u32 s47, s46, 8192
    s_memtime s[64:65]
    s_waitcnt lgkmcnt(0)
    buffer_load_dword v9, v8, s[12:15], s47 offen sc1
    s_waitcnt vmcnt(0)
    s_memtime s[66:67]
    s_waitcnt lgkmcnt(0)
    s_sub_u32 s66, s66, s64
    s_min_u32 s71, s71, s66
    s_add_u32 s47, s46, 8320
    s_memtime s[64:65]
    s_waitcnt lgkmcnt(0)
    buffer_load_dword v9, v8, s[12:15], s47 offen sc1
    s_waitcnt vmcnt(0)
    s_memtime s[66:67]
    s_waitcnt lgkmcnt(0)
    s_sub_u32 s66, s66, s64
    s_min_u32 s71, s71, s66
    s_add_u32 s47, s46, 128
    s_memtime s[64:65]
    s_waitcnt lgkmcnt(0)
    buffer_load_dword v9, v8, s[12:15], s47 offen sc1
    s_waitcnt vmcnt(0)
    s_memtime s[66:67]
    s_waitcnt lgkmcnt(0)
    s_sub_u32 s66, s66, s64
    s_min_u32 s70, s70, s66
    s_lshl_b32 s47, s21, 3
    s_add_u32 s47, s47, 144448
    v_mov_b32 v8, s47
    v_mov_b32 v10, s70
    v_mov_b32 v11, s71
    ds_write_b64 v8, v[10:11]
    s_waitcnt lgkmcnt(0)
    s_barrier
    s_cmp_eq_u32 s21, 0
    s_cbranch_scc0 RC_NM1
    v_mov_b32 v8, 144448
    ds_read_b128 v[12:15], v8
    ds_read_b128 v[16:19], v8 offset:16
    s_waitcnt lgkmcnt(0)
    v_min_u32 v12, v12, v14
    v_min_u32 v13, v13, v15
    v_min_u32 v16, v16, v18
    v_min_u32 v17, v17, v19
    v_min_u32 v12, v12, v16
    v_min_u32 v13, v13, v17
    s_nop 1
    v_readfirstlane_b32 s70, v12
    v_readfirstlane_b32 s71, v13
    v_mov_b32 v8, 0
    s_cmp_lt_u32 s71, s70
    s_cselect_b32 s48, 1, 0
    v_mov_b32 v9, s48
    s_lshl_b32 s47, s22, 7
    s_add_u32 s47, s47, 14684160
    v_cmp_eq_u32 vcc, 0, v5
    s_and_saveexec_b64 s[64:65], vcc
    buffer_store_dword v9, v8, s[4:7], s47 offen sc1
    s_mov_b64 exec, s[64:65]
    s_waitcnt vmcnt(0)
RC_NM1:
    s_lshl_b32 s47, s22, 7
    s_add_u32 s47, s47, 14684160
    v_mov_b32 v8, 0
RC_NM2:
    buffer_load_dword v9, v8, s[4:7], s47 offen sc1
    s_waitcnt vmcnt(0)
    v_cmp_eq_u32 vcc, -1, v9
    s_cbranch_vccz RC_NM3
    s_cmp_eq_u32 s42, 0
    s_cbranch_scc1 RC_NM3
    s_sub_u32 s42, s42, 1
    s_branch RC_NM2
RC_NM3:
    v_readfirstlane_b32 s35, v9
    s_and_b32 s35, s35, 1
    s_lshl_b32 s46, s35, 13
    s_add_u32 s46, s46, s60
    s_lshl_b32 s47, s21, 11
    s_add_u32 s46, s46, s47
    s_lshl_b32 s47, s23, 14
    s_add_u32 s32, s46, s47
    s_xor_b32 s33, s32, 0x4000
    s_add_u32 s34, s32, 98304
    s_waitcnt vmcnt(0) lgkmcnt(0)
    s_barrier
    s_cmp_eq_u32 s61, 1
    s_cbranch_scc0 RC_FB
    s_lshl_b32 s46, s21, 14
    v_add_u32 v7, s46, v5
    ds_read_b128 v[64:67], v7 offset:0
    ds_read_b128 v[68:71], v7 offset:1024
    ds_read_b128 v[72:75], v7 offset:2048
    ds_read_b128 v[76:79], v7 offset:3072
    ds_read_b128 v[80:83], v7 offset:4096
    ds_read_b128 v[84:87], v7 offset:5120
    ds_read_b128 v[88:91], v7 offset:6144
    ds_read_b128 v[92:95], v7 offset:7168
    s_waitcnt lgkmcnt(0)
    ds_read_b128 v[96:99], v7 offset:8192
    ds_read_b128 v[100:103], v7 offset:9216
    ds_read_b128 v[104:107], v7 offset:10240
    ds_read_b128 v[108:111], v7 offset:11264
    ds_read_b128 v[112:115], v7 offset:12288
    ds_read_b128 v[116:119], v7 offset:13312
    ds_read_b128 v[120:123], v7 offset:14336
    ds_read_b128 v[124:127], v7 offset:15360
    s_lshr_b32 s97, s22, 1
    s_lshl_b32 s97, s97, 7
    s_add_u32 s97, s97, 14688256
    s_mov_b32 s96, 0
    s_add_u32 s46, s20, 1
    s_lshr_b32 s46, s46, 2
    s_lshl_b32 s46, s46, 11
    s_add_u32 s46, s46, s97
    buffer_load_dwordx2 v[32:33], off, s[4:7], s46 sc1
    buffer_load_dwordx4 v[8:11], v1, s[4:7], s24 offen sc1
    buffer_load_dwordx4 v[12:15], v1, s[4:7], s24 offen offset:1024 sc1
    v_add_u32 v16, 131072, v1
    v_xor_b32 v20, 0x800, v16
    v_xor_b32 v28, 0x1000, v16
    v_xor_b32 v36, 0x1800, v16
    v_mov_b32 v24, -1
    v_mov_b32 v25, -1
    v_mov_b32 v26, -1
    v_mov_b32 v27, -1
    v_mov_b64 v[40:41], 0
    v_mov_b64 v[42:43], 0
    v_mov_b64 v[44:45], 0
    v_mov_b64 v[46:47], 0
    v_mov_b64 v[48:49], 0
    v_mov_b64 v[50:51], 0
    v_mov_b64 v[52:53], 0
    v_mov_b64 v[54:55], 0
    v_mov_b64 v[56:57], 0
    v_mov_b64 v[58:59], 0
    v_mov_b64 v[60:61], 0
    v_mov_b64 v[62:63], 0
RC_TOP:
    s_cmp_lg_u32 s96, 0x01010101
    s_cbranch_scc1 RC_KVW
RC_KVB:
RC_PM:
    buffer_load_dwordx4 v[8:11], v1, s[4:7], s24 offen sc1
    buffer_load_dwordx4 v[12:15], v1, s[4:7], s24 offen offset:1024 sc1
    s_waitcnt vmcnt(2)
    v_max3_u32 v6, v8, v9, v10
    v_max3_u32 v6, v6, v11, v12
    v_max3_u32 v6, v6, v13, v14
    v_max_u32 v6, v6, v15
    v_cmp_eq_u32 vcc, -1, v6
    s_cbranch_vccz RC_PM_D
    s_cmp_eq_u32 s42, 0
    s_cbranch_scc1 RC_PM_D
    s_sub_u32 s42, s42, 1
    s_branch RC_PM
RC_PM_D:
    ds_write_b128 v16, v[8:11]
    ds_write_b128 v16, v[12:15] offset:1024
    v_smfmac_f32_16x16x64_bf16 v[40:43], v[8:11], a[0:7], v0
    buffer_store_dwordx4 v[24:27], v5, s[12:15], s34 offen sc1
    v_smfmac_f32_16x16x64_bf16 v[44:47], v[8:11], a[8:15], v0
    buffer_store_dwordx4 v[24:27], v5, s[12:15], s34 offen offset:1024 sc1
    v_and_b32 v32, v32, v33
    v_smfmac_f32_16x16x64_bf16 v[48:51], v[8:11], a[128:135], v0
    v_smfmac_f32_16x16x64_bf16 v[52:55], v[8:11], a[136:143], v0
    v_readfirstlane_b32 s96, v32
    s_waitcnt lgkmcnt(0)
    s_barrier
    ds_read_b128 v[16:19], v20 offset:0
    ds_read_b128 v[20:23], v20 offset:1024
    ds_read_b128 v[24:27], v28 offset:0
    ds_read_b128 v[28:31], v28 offset:1024
    ds_read_b128 v[32:35], v36 offset:0
    ds_read_b128 v[36:39], v36 offset:1024
    v_smfmac_f32_16x16x64_bf16 v[40:43], v[12:15], a[16:23], v0
    v_smfmac_f32_16x16x64_bf16 v[44:47], v[12:15], a[24:31], v0
    v_smfmac_f32_16x16x64_bf16 v[48:51], v[12:15], a[144:151], v0
    v_smfmac_f32_16x16x64_bf16 v[52:55], v[12:15], a[152:159], v0
    v_smfmac_f32_16x16x64_bf16 v[56:59], v[8:11], v[128:135], v0
    v_smfmac_f32_16x16x64_bf16 v[60:63], v[8:11], v[136:143], v0
    s_waitcnt lgkmcnt(5)
    v_smfmac_f32_16x16x64_bf16 v[40:43], v[16:19], a[32:39], v0
    v_smfmac_f32_16x16x64_bf16 v[44:47], v[16:19], a[40:47], v0
    v_smfmac_f32_16x16x64_bf16 v[48:51], v[16:19], a[160:167], v0
    v_smfmac_f32_16x16x64_bf16 v[52:55], v[16:19], a[168:175], v0
    s_waitcnt lgkmcnt(4)
    v_smfmac_f32_16x16x64_bf16 v[40:43], v[20:23], a[48:55], v0
    v_smfmac_f32_16x16x64_bf16 v[44:47], v[20:23], a[56:63], v0
    v_smfmac_f32_16x16x64_bf16 v[48:51], v[20:23], a[176:183], v0
    v_smfmac_f32_16x16x64_bf16 v[52:55], v[20:23], a[184:191], v0
    s_waitcnt lgkmcnt(3)
    v_smfmac_f32_16x16x64_bf16 v[40:43], v[24:27], a[64:71], v0
    v_smfmac_f32_16x16x64_bf16 v[44:47], v[24:27], a[72:79], v0
    v_smfmac_f32_16x16x64_bf16 v[48:51], v[24:27], a[192:199], v0
    v_smfmac_f32_16x16x64_bf16 v[52:55], v[24:27], a[200:207], v0
    s_waitcnt lgkmcnt(2)
    v_smfmac_f32_16x16x64_bf16 v[40:43], v[28:31], a[80:87], v0
    v_smfmac_f32_16x16x64_bf16 v[44:47], v[28:31], a[88:95], v0
    v_smfmac_f32_16x16x64_bf16 v[48:51], v[28:31], a[208:215], v0
    v_smfmac_f32_16x16x64_bf16 v[52:55], v[28:31], a[216:223], v0
    s_waitcnt lgkmcnt(1)
    v_smfmac_f32_16x16x64_bf16 v[40:43], v[32:35], a[96:103], v0
    v_smfmac_f32_16x16x64_bf16 v[44:47], v[32:35], a[104:111], v0
    s_waitcnt lgkmcnt(0)
    v_smfmac_f32_16x16x64_bf16 v[40:43], v[36:39], a[112:119], v0
    v_smfmac_f32_16x16x64_bf16 v[44:47], v[36:39], a[120:127], v0
    v_smfmac_f32_16x16x64_bf16 v[48:51], v[32:35], a[224:231], v0
    v_add_f32 v40, v40, v41
    v_smfmac_f32_16x16x64_bf16 v[52:55], v[32:35], a[232:239], v0
    v_add_f32 v42, v42, v43
    v_add_f32 v44, v44, v45
    v_smfmac_f32_16x16x64_bf16 v[48:51], v[36:39], a[240:247], v0
    v_add_f32 v46, v46, v47
    v_cvt_pk_bf16_f32 v45, v44, v46
    v_smfmac_f32_16x16x64_bf16 v[52:55], v[36:39], a[248:255], v0
    v_cvt_pk_bf16_f32 v44, v40, v42
    s_nop 2
    v_add_f32 v48, v48, v49
    v_add_f32 v50, v50, v51
    s_nop 1
    v_add_f32 v52, v52, v53
    v_add_f32 v54, v54, v55
    v_cvt_pk_bf16_f32 v46, v48, v50
    v_cvt_pk_bf16_f32 v47, v52, v54
    buffer_store_dwordx4 v[44:47], v5, s[12:15], s32 offen sc1
    s_lshl_b32 s46, s21, 14
    s_add_u32 s46, s46, 65536
    v_add_u32 v7, s46, v5
    v_add_u32 v6, 141312, v5
    v_smfmac_f32_16x16x64_bf16 v[56:59], v[24:27], v[64:71], v0
    v_smfmac_f32_16x16x64_bf16 v[60:63], v[24:27], v[72:79], v0
    v_smfmac_f32_16x16x64_bf16 v[56:59], v[28:31], v[80:87], v0
    ds_read_b128 v[64:67], v7 offset:0
    ds_read_b128 v[68:71], v7 offset:1024
    v_smfmac_f32_16x16x64_bf16 v[60:63], v[28:31], v[88:95], v0
    ds_read_b128 v[72:75], v7 offset:2048
    ds_read_b128 v[76:79], v7 offset:3072
    v_smfmac_f32_16x16x64_bf16 v[56:59], v[32:35], v[96:103], v0
    ds_read_b128 v[24:27], v6
    ds_read_b128 v[28:31], v6 offset:1024
    v_smfmac_f32_16x16x64_bf16 v[60:63], v[32:35], v[104:111], v0
    ds_read_b128 v[80:83], v7 offset:4096
    ds_read_b128 v[84:87], v7 offset:5120
    v_smfmac_f32_16x16x64_bf16 v[56:59], v[36:39], v[112:119], v0
    ds_read_b128 v[88:91], v7 offset:6144
    ds_read_b128 v[92:95], v7 offset:7168
    v_smfmac_f32_16x16x64_bf16 v[60:63], v[36:39], v[120:127], v0
    ds_read_b128 v[96:99], v7 offset:8192
    ds_read_b128 v[100:103], v7 offset:9216
    v_smfmac_f32_16x16x64_bf16 v[56:59], v[12:15], v[144:151], v0
    ds_read_b128 v[104:107], v7 offset:10240
    ds_read_b128 v[108:111], v7 offset:11264
    v_add_u32 v6, s56, v5
    v_smfmac_f32_16x16x64_bf16 v[60:63], v[12:15], v[152:159], v0
    ds_read_b128 v[112:115], v7 offset:12288
    ds_read_b128 v[116:119], v7 offset:13312
    ds_read_b128 v[32:35], v6
    ds_read_b128 v[36:39], v6 offset:1024
    v_smfmac_f32_16x16x64_bf16 v[56:59], v[16:19], v[160:167], v0
    ds_read_b128 v[120:123], v7 offset:14336
    ds_read_b128 v[124:127], v7 offset:15360
    v_smfmac_f32_16x16x64_bf16 v[60:63], v[16:19], v[168:175], v0
    buffer_load_dwordx4 v[52:55], v5, s[12:15], s33 offen sc1
    v_smfmac_f32_16x16x64_bf16 v[56:59], v[20:23], v[176:183], v0
    v_smfmac_f32_16x16x64_bf16 v[60:63], v[20:23], v[184:191], v0
    s_waitcnt lgkmcnt(14)
    v_mfma_f32_16x16x32_bf16 v[40:43], v[44:47], v[24:27], 0
    v_mfma_f32_16x16x32_bf16 v[48:51], v[44:47], v[28:31], 0
    v_lshrrev_b32 v7, 1, v5
    v_add_f32 v56, v56, v57
    v_add_f32 v58, v58, v59
    v_add_f32 v60, v60, v61
    v_add_f32 v62, v62, v63
    v_cvt_pk_bf16_f32 v61, v60, v62
    v_cvt_pk_bf16_f32 v60, v56, v58
    buffer_store_dwordx2 v[60:61], v7, s[12:15], s32 offen offset:1024 sc1
    s_waitcnt vmcnt(5)
    ds_read_b128 v[8:11], v6 offset:2048
    ds_read_b128 v[12:15], v6 offset:3072
    v_mov_b32 v47, v7
    v_lshrrev_b32 v45, 8, v5
    v_lshlrev_b32 v45, 7, v45
    v_and_b32 v6, 0x70, v5
    v_add_u32 v45, v45, v6
    v_add_u32 v44, s54, v45
    v_and_b32 v7, 0x80, v5
    v_lshl_add_u32 v45, v7, 2, v45
    v_add_u32 v45, 131072, v45
    v_lshrrev_b32 v46, 9, v5
    v_lshl_add_u32 v46, v46, 7, v6
    v_bfe_u32 v6, v5, 8, 1
    v_lshl_add_u32 v46, v6, 3, v46
    v_bfe_u32 v6, v5, 7, 1
    v_lshl_add_u32 v46, v6, 2, v46
    v_add_u32 v46, 132352, v46
    buffer_load_dwordx4 v[52:55], v5, s[12:15], s33 offen sc1
    s_barrier
    s_waitcnt vmcnt(2)
    v_max3_u32 v7, v52, v53, v54
    v_max_u32 v7, v7, v55
    v_cmp_eq_u32 vcc, -1, v7
    s_cbranch_vccz RC_PQ_D
RC_PQ:
    buffer_load_dwordx4 v[52:55], v5, s[12:15], s33 offen sc1
    s_waitcnt vmcnt(1)
    v_max3_u32 v7, v52, v53, v54
    v_max_u32 v7, v7, v55
    v_cmp_eq_u32 vcc, -1, v7
    s_cbranch_vccz RC_PQ_D
    s_cmp_eq_u32 s42, 0
    s_cbranch_scc1 RC_PQ_D
    s_sub_u32 s42, s42, 1
    s_branch RC_PQ
RC_PQ_D:
    s_waitcnt lgkmcnt(0)
    v_mfma_f32_16x16x32_bf16 v[40:43], v[52:55], v[24:27], v[40:43]
    v_mfma_f32_16x16x32_bf16 v[48:51], v[52:55], v[28:31], v[48:51]
    buffer_load_dwordx2 v[62:63], v47, s[12:15], s33 offen offset:1024 sc1
    s_cmp_eq_u32 s20, s43
    s_nop 2
    v_cvt_pk_bf16_f32 v56, v40, v41
    v_cvt_pk_bf16_f32 v57, v42, v43
    s_nop 0
    v_cvt_pk_bf16_f32 v58, v48, v49
    v_cvt_pk_bf16_f32 v59, v50, v51
    s_cbranch_scc1 RC_TAIL
    s_nop 0
    v_mfma_f32_16x16x32_bf16 v[16:19], v[32:35], v[56:59], 0
    v_mfma_f32_16x16x32_bf16 v[20:23], v[36:39], v[56:59], 0
    v_mfma_f32_16x16x32_bf16 v[24:27], v[56:59], v[56:59], 0
    s_cmp_lg_u32 s96, 0x01010101
    s_cbranch_scc1 RC_NKV
    s_mov_b32 m0, s56
    s_nop 0
    buffer_load_dwordx4 v4, s[8:11], s36 offen lds
    s_mov_b64 exec, s[40:41]
    ds_write_b128 v44, v[16:19]
    s_mov_b64 exec, -1
    s_add_u32 m0, s56, 896
    s_nop 0
    buffer_load_dwordx4 v4, s[8:11], s36 offen offset:128 lds
    s_mov_b64 exec, s[40:41]
    ds_write_b128 v44, v[20:23] offset:512
    s_mov_b64 exec, -1
    s_add_u32 m0, s56, 2048
    s_nop 0
    buffer_load_dwordx4 v4, s[8:11], s37 offen lds
    s_mov_b64 exec, s[40:41]
    ds_write_b128 v44, v[24:27] offset:1024
    s_mov_b64 exec, -1
    s_add_u32 m0, s56, 2944
    s_nop 0
    buffer_load_dwordx4 v4, s[8:11], s37 offen offset:128 lds
    s_add_u32 s36, s36, 262144
    s_add_u32 s37, s37, 262144
    s_branch RC_NKV2
RC_NKV:
    s_mov_b64 exec, s[40:41]
    s_nop 1
    ds_write_b128 v44, v[16:19]
    s_nop 1
    ds_write_b128 v44, v[20:23] offset:512
    s_nop 2
    ds_write_b128 v44, v[24:27] offset:1024
    s_mov_b64 exec, -1
    s_waitcnt vmcnt(0)
RC_NKV2:
    s_waitcnt lgkmcnt(0)
    s_barrier
    ds_read2st64_b32 v[48:49], v46 offset0:0 offset1:6
    ds_read2st64_b32 v[50:51], v46 offset0:12 offset1:18
    ds_read_b128 v[32:35], v45 offset:0
    ds_read_b128 v[36:39], v45 offset:1536
    ds_read_b128 v[40:43], v45 offset:3072
    ds_read_b128 v[44:47], v45 offset:4608
    v_and_b32 v28, 0xf0, v5
    v_and_b32 v6, 0x300, v5
    v_lshl_add_u32 v28, v28, 1, v6
    v_add_u32 v28, s55, v28
    v_lshrrev_b32 v29, 8, v5
    v_lshlrev_b32 v29, 7, v29
    v_and_b32 v6, 0x70, v5
    v_add_u32 v29, v29, v6
    s_waitcnt lgkmcnt(4)
    v_pk_add_f32 v[48:49], v[48:49], v[50:51]
    s_waitcnt lgkmcnt(2)
    v_pk_add_f32 v[32:33], v[32:33], v[36:37]
    v_pk_add_f32 v[34:35], v[34:35], v[38:39]
    v_add_f32 v48, v48, v49
    s_waitcnt lgkmcnt(0)
    v_pk_add_f32 v[40:41], v[40:41], v[44:45]
    v_pk_add_f32 v[42:43], v[42:43], v[46:47]
    v_pk_add_f32 v[32:33], v[32:33], v[40:41]
    v_pk_add_f32 v[34:35], v[34:35], v[42:43]
    v_mov_b32 v44, 0x3f803f80
    v_max3_f32 v50, v32, v33, v48
    v_mov_b32 v45, 0x3f803f80
    v_max3_f32 v50, v50, v34, v35
    v_mov_b32 v46, 0x3f803f80
    v_mov_b32 v47, 0x3f803f80
    v_max_f32_dpp v50, v50, v50 row_ror:8 row_mask:0xf bank_mask:0xf
    v_mov_b32 v42, 0x3f003f00
    v_mov_b32 v51, v50
    v_mov_b32 v43, 0x3f003f00
    s_nop 0
    v_permlane32_swap_b32 v50, v51
    s_nop 0
    v_max_f32 v50, v50, v51
    v_mov_b32 v51, v50
    s_nop 1
    v_permlane16_swap_b32 v50, v51
    s_nop 0
    v_max_f32 v50, v50, v51
    v_mul_f32 v50, s63, v50
    v_fma_f32 v32, v32, s63, -v50
    v_fma_f32 v33, v33, s63, -v50
    v_fma_f32 v34, v34, s63, -v50
    v_fma_f32 v35, v35, s63, -v50
    v_fma_f32 v48, v48, s63, -v50
    v_exp_f32 v48, v48
    v_exp_f32 v32, v32
    v_exp_f32 v33, v33
    v_exp_f32 v34, v34
    v_exp_f32 v35, v35
    v_mov_b32_dpp v51, v48 row_ror:8 row_mask:0xf bank_mask:0xf
    v_cvt_pk_bf16_f32 v36, v32, v33
    v_cvt_pk_bf16_f32 v37, v34, v35
    v_cvt_pk_bf16_f32 v40, v48, v51
    v_mov_b32_dpp v38, v36 row_ror:8 row_mask:0xf bank_mask:0xf
    v_mov_b32_dpp v39, v37 row_ror:8 row_mask:0xf bank_mask:0xf
    v_cvt_pk_bf16_f32 v41, v48, v51
    s_waitcnt vmcnt(4)
    v_mfma_f32_16x16x32_bf16 v[52:55], v[44:47], v[36:39], 0
    v_max_u32 v7, v62, v63
    v_cmp_eq_u32 vcc, -1, v7
    v_mfma_f32_16x16x32_bf16 v[16:19], v[8:11], v[36:39], 0
    s_cbranch_vccz RC_PV_D
    v_lshrrev_b32 v6, 1, v5
RC_PV:
    buffer_load_dwordx2 v[62:63], v6, s[12:15], s33 offen offset:1024 sc1
    s_waitcnt vmcnt(0)
    v_max_u32 v7, v62, v63
    v_cmp_eq_u32 vcc, -1, v7
    s_cbranch_vccz RC_PV_D
    s_cmp_eq_u32 s42, 0
    s_cbranch_scc1 RC_PV_D
    s_sub_u32 s42, s42, 1
    s_branch RC_PV
RC_PV_D:
    v_swap_b32 v61, v62
    v_mfma_f32_16x16x32_bf16 v[20:23], v[12:15], v[36:39], 0
    v_mfma_f32_16x16x16_bf16 v[52:55], v[42:43], v[40:41], v[52:55]
    v_mfma_f32_16x16x16_bf16 v[16:19], v[60:61], v[40:41], v[16:19]
    v_mfma_f32_16x16x16_bf16 v[20:23], v[62:63], v[40:41], v[20:23]
    s_nop 1
    v_rcp_f32 v6, v52
    s_nop 2
    v_pk_mul_f32 v[16:17], v[16:17], v[6:7] op_sel_hi:[1,0]
    v_pk_mul_f32 v[18:19], v[18:19], v[6:7] op_sel_hi:[1,0]
    v_pk_mul_f32 v[20:21], v[20:21], v[6:7] op_sel_hi:[1,0]
    v_pk_mul_f32 v[22:23], v[22:23], v[6:7] op_sel_hi:[1,0]
    v_cvt_pk_bf16_f32 v8, v16, v17
    v_cvt_pk_bf16_f32 v9, v20, v21
    v_cvt_pk_bf16_f32 v10, v18, v19
    v_cvt_pk_bf16_f32 v11, v22, v23
    s_mov_b64 exec, s[40:41]
    ds_write2_b64 v28, v[8:9], v[10:11] offset0:0 offset1:2
    s_mov_b64 exec, -1
    v_add_u32 v6, 139264, v5
    v_mov_b64 v[24:25], 0
    v_mov_b64 v[26:27], 0
    v_mov_b64 v[30:31], 0
    v_mov_b64 v[32:33], 0
    v_mov_b64 v[34:35], 0
    v_mov_b64 v[36:37], 0
    v_mov_b64 v[38:39], 0
    v_mov_b64 v[40:41], 0
    s_waitcnt lgkmcnt(0)
    s_barrier
    ds_read_b128 v[8:11], v6
    ds_read_b128 v[12:15], v6 offset:1024
    s_cmp_eq_u32 s23, 0
    s_cbranch_scc0 RC_PUBA1
    v_lshrrev_b32 v62, 8, v5
    v_lshlrev_b32 v62, 7, v62
    v_and_b32 v63, 0x70, v5
    v_add_u32 v62, v62, v63
    s_mov_b64 exec, s[58:59]
    buffer_store_dwordx4 v[56:59], v62, s[4:7], s38 offen sc1
    s_mov_b64 exec, -1
    s_branch RC_PUBA2
RC_PUBA1:
    v_lshlrev_b32 v56, 16, v60
    v_and_b32 v57, 0xffff0000, v60
    v_lshlrev_b32 v58, 16, v61
    v_and_b32 v59, 0xffff0000, v61
    v_pk_add_f32 v[56:57], v[56:57], v[58:59]
    v_cvt_pk_bf16_f32 v60, v56, v57
    v_lshlrev_b32 v56, 16, v62
    v_and_b32 v57, 0xffff0000, v62
    v_lshlrev_b32 v58, 16, v63
    v_and_b32 v59, 0xffff0000, v63
    v_pk_add_f32 v[56:57], v[56:57], v[58:59]
    v_cvt_pk_bf16_f32 v61, v56, v57
    v_lshrrev_b32 v62, 9, v5
    v_lshlrev_b32 v62, 8, v62
    v_bfe_u32 v56, v5, 8, 1
    v_lshl_add_u32 v62, v56, 2, v62
    v_bfe_u32 v56, v5, 7, 1
    v_lshl_add_u32 v62, v56, 7, v62
    v_bfe_u32 v56, v5, 4, 3
    v_lshl_add_u32 v62, v56, 3, v62
    buffer_store_dword v60, v62, s[4:7], s39 offen sc1
    buffer_store_dword v61, v62, s[4:7], s39 offen offset:64 sc1
RC_PUBA2:
    v_mov_b64 v[28:29], 0
    v_mov_b64 v[42:43], 0
    v_mov_b64 v[44:45], 0
    v_mov_b64 v[46:47], 0
    v_mov_b64 v[48:49], 0
    v_mov_b64 v[50:51], 0
    v_mov_b64 v[52:53], 0
    v_mov_b64 v[54:55], 0
    v_lshrrev_b32 v7, 6, v5
    v_mul_u32_u24 v7, 64, v7
    v_and_b32 v6, 0x30, v5
    v_add3_u32 v7, v7, v6, s57
    s_waitcnt lgkmcnt(1)
    v_smfmac_f32_16x16x64_bf16 v[24:27], v[8:11], v[192:199], v0
    v_smfmac_f32_16x16x64_bf16 v[28:31], v[8:11], v[200:207], v0
    s_waitcnt lgkmcnt(0)
    v_smfmac_f32_16x16x64_bf16 v[24:27], v[12:15], v[64:71], v0
    v_smfmac_f32_16x16x64_bf16 v[28:31], v[12:15], v[72:79], v0
    v_smfmac_f32_16x16x64_bf16 v[32:35], v[8:11], v[208:215], v0
    v_mov_b32 v60, -1
    v_smfmac_f32_16x16x64_bf16 v[36:39], v[8:11], v[216:223], v0
    v_add_f32 v24, v24, v25
    v_add_f32 v26, v26, v27
    v_smfmac_f32_16x16x64_bf16 v[32:35], v[12:15], v[80:87], v0
    v_add_f32 v28, v28, v29
    v_add_f32 v30, v30, v31
    v_smfmac_f32_16x16x64_bf16 v[36:39], v[12:15], v[88:95], v0
    v_cvt_pk_bf16_f32 v29, v28, v30
    v_cvt_pk_bf16_f32 v28, v24, v26
    buffer_store_dwordx2 v[28:29], v2, s[4:7], s28 offen
    v_smfmac_f32_16x16x64_bf16 v[40:43], v[8:11], v[224:231], v0
    v_smfmac_f32_16x16x64_bf16 v[44:47], v[8:11], v[232:239], v0
    v_add_f32 v32, v32, v33
    v_add_f32 v34, v34, v35
    v_smfmac_f32_16x16x64_bf16 v[40:43], v[12:15], v[96:103], v0
    v_add_f32 v36, v36, v37
    v_add_f32 v38, v38, v39
    v_smfmac_f32_16x16x64_bf16 v[44:47], v[12:15], v[104:111], v0
    v_cvt_pk_bf16_f32 v37, v36, v38
    v_cvt_pk_bf16_f32 v36, v32, v34
    buffer_store_dwordx2 v[36:37], v2, s[4:7], s29 offen
    v_smfmac_f32_16x16x64_bf16 v[48:51], v[8:11], v[240:247], v0
    v_smfmac_f32_16x16x64_bf16 v[52:55], v[8:11], v[248:255], v0
    v_add_f32 v40, v40, v41
    v_add_f32 v42, v42, v43
    v_smfmac_f32_16x16x64_bf16 v[48:51], v[12:15], v[112:119], v0
    v_add_f32 v44, v44, v45
    v_add_f32 v46, v46, v47
    v_smfmac_f32_16x16x64_bf16 v[52:55], v[12:15], v[120:127], v0
    v_cvt_pk_bf16_f32 v45, v44, v46
    v_cvt_pk_bf16_f32 v44, v40, v42
    buffer_store_dwordx2 v[44:45], v2, s[4:7], s30 offen
    s_lshl_b32 s46, s21, 14
    v_add_u32 v58, s46, v5
    v_add_u32 v6, 141312, v5
    ds_read_b128 v[16:19], v6 offset:2048
    v_mov_b32 v61, -1
    v_mov_b32 v62, -1
    v_mov_b32 v63, -1
    v_add_f32 v48, v48, v49
    v_add_f32 v50, v50, v51
    v_add_f32 v52, v52, v53
    v_add_f32 v54, v54, v55
    v_cvt_pk_bf16_f32 v53, v52, v54
    v_cvt_pk_bf16_f32 v52, v48, v50
    buffer_store_dwordx2 v[52:53], v2, s[4:7], s31 offen
    buffer_load_dwordx4 v[8:11], v7, s[4:7], s26 offen sc1
    buffer_load_dwordx4 v[12:15], v7, s[4:7], s27 offen sc1
    ds_read_b128 v[64:67], v58 offset:0
    ds_read_b128 v[68:71], v58 offset:1024
    ds_read_b128 v[72:75], v58 offset:2048
    ds_read_b128 v[76:79], v58 offset:3072
    ds_read_b128 v[80:83], v58 offset:4096
    ds_read_b128 v[84:87], v58 offset:5120
    ds_read_b128 v[88:91], v58 offset:6144
    ds_read_b128 v[92:95], v58 offset:7168
    ds_read_b128 v[96:99], v58 offset:8192
    ds_read_b128 v[100:103], v58 offset:9216
    ds_read_b128 v[104:107], v58 offset:10240
    ds_read_b128 v[108:111], v58 offset:11264
    ds_read_b128 v[112:115], v58 offset:12288
    ds_read_b128 v[116:119], v58 offset:13312
    s_waitcnt lgkmcnt(8)
    ds_read_b128 v[120:123], v58 offset:14336
    ds_read_b128 v[124:127], v58 offset:15360
RC_PR:
    buffer_load_dwordx4 v[8:11], v7, s[4:7], s26 offen sc1
    buffer_load_dwordx4 v[12:15], v7, s[4:7], s27 offen sc1
    s_waitcnt vmcnt(2)
    v_max3_u32 v6, v8, v9, v10
    v_max3_u32 v6, v6, v11, v12
    v_max3_u32 v6, v6, v13, v14
    v_max_u32 v6, v6, v15
    v_cmp_eq_u32 vcc, -1, v6
    s_cbranch_vccz RC_PR_D
    s_cmp_eq_u32 s42, 0
    s_cbranch_scc1 RC_PR_D
    s_sub_u32 s42, s42, 1
    s_branch RC_PR
RC_PR_D:
    s_waitcnt lgkmcnt(0)
    v_mfma_f32_16x16x32_bf16 v[20:23], v[8:11], v[16:19], 0
    v_mfma_f32_16x16x32_bf16 v[20:23], v[12:15], v[16:19], v[20:23]
    buffer_store_dwordx4 v[60:63], v7, s[4:7], s26 offen
    buffer_store_dwordx4 v[60:63], v7, s[4:7], s27 offen
    s_nop 5
    v_permlane32_swap_b32 v20, v22
    v_permlane32_swap_b32 v21, v23
    s_nop 0
    v_pk_add_f32 v[20:21], v[20:21], v[22:23]
    s_nop 1
    v_permlane16_swap_b32 v20, v21
    s_nop 0
    v_add_f32 v20, v20, v21
    s_nop 1
    v_mov_b32_dpp v21, v20 row_shl:4 row_mask:0xf bank_mask:0xf
    s_nop 0
    v_cvt_pk_bf16_f32 v20, v20, v21
    buffer_store_dword v20, v3, s[4:7], s25 offen
    buffer_store_dword v60, v3, s[4:7], s24 offen
    s_add_u32 s20, s20, 1
    s_add_u32 s46, s20, 1
    s_lshr_b32 s46, s46, 2
    s_lshl_b32 s46, s46, 11
    s_add_u32 s46, s46, s97
    buffer_load_dwordx2 v[32:33], off, s[4:7], s46 sc1
    buffer_load_dwordx4 v[8:11], v1, s[4:7], s25 offen sc1
    buffer_load_dwordx4 v[12:15], v1, s[4:7], s25 offen offset:1024 sc1
    s_add_u32 s46, s24, 16384
    s_and_b32 s46, s46, 0xffff
    s_and_b32 s24, s24, 0xffff0000
    s_or_b32 s24, s24, s46
    s_add_u32 s46, s25, 16384
    s_and_b32 s46, s46, 0xffff
    s_and_b32 s25, s25, 0xffff0000
    s_or_b32 s25, s25, s46
    s_xor_b32 s26, s26, 0x80000
    s_xor_b32 s27, s27, 0x80000
    s_xor_b32 s28, s28, 0x80000
    s_xor_b32 s29, s29, 0x80000
    s_xor_b32 s30, s30, 0x80000
    s_xor_b32 s31, s31, 0x80000
    s_add_u32 s46, s32, 32768
    s_and_b32 s46, s46, 0x1fffff
    s_add_u32 s32, s46, s60
    s_add_u32 s46, s33, 32768
    s_and_b32 s46, s46, 0x1fffff
    s_add_u32 s33, s46, s60
    s_add_u32 s46, s34, 32768
    s_and_b32 s46, s46, 0x1fffff
    s_add_u32 s34, s46, s60
    s_add_u32 s38, s38, 131072
    s_add_u32 s39, s39, 65536
    v_add_u32 v16, 131072, v1
    v_xor_b32 v20, 0x800, v16
    v_xor_b32 v28, 0x1000, v16
    v_xor_b32 v36, 0x1800, v16
    v_mov_b32 v24, -1
    v_mov_b32 v25, -1
    v_mov_b32 v26, -1
    v_mov_b32 v27, -1
    v_mov_b64 v[40:41], 0
    v_mov_b64 v[42:43], 0
    v_mov_b64 v[44:45], 0
    v_mov_b64 v[46:47], 0
    v_mov_b64 v[48:49], 0
    v_mov_b64 v[50:51], 0
    v_mov_b64 v[52:53], 0
    v_mov_b64 v[54:55], 0
    v_mov_b64 v[56:57], 0
    v_mov_b64 v[58:59], 0
    v_mov_b64 v[60:61], 0
    v_mov_b64 v[62:63], 0
    s_branch RC_TOP
RC_KVW:
    s_lshr_b32 s46, s20, 2
    s_lshl_b32 s46, s46, 11
    s_add_u32 s46, s46, s97
RC_KVP:
    buffer_load_dwordx2 v[36:37], off, s[4:7], s46 sc1
    s_waitcnt vmcnt(0)
    v_and_b32 v36, v36, v37
    v_cmp_ne_u32 vcc, 0x01010101, v36
    s_cbranch_vccz RC_KVP_D
    s_cmp_eq_u32 s42, 0
    s_cbranch_scc1 RC_KVP_D
    s_sub_u32 s42, s42, 1
    s_branch RC_KVP
RC_KVP_D:
    s_mov_b32 m0, s56
    s_nop 0
    buffer_load_dwordx4 v4, s[8:11], s36 offen lds
    s_add_u32 m0, s56, 896
    s_nop 0
    buffer_load_dwordx4 v4, s[8:11], s36 offen offset:128 lds
    s_add_u32 m0, s56, 2048
    s_nop 0
    buffer_load_dwordx4 v4, s[8:11], s37 offen lds
    s_add_u32 m0, s56, 2944
    s_nop 0
    buffer_load_dwordx4 v4, s[8:11], s37 offen offset:128 lds
    s_add_u32 s36, s36, 262144
    s_add_u32 s37, s37, 262144
    v_xor_b32 v36, 0x1800, v16
    s_branch RC_KVB
RC_TAIL:
    v_lshrrev_b32 v6, 1, v5
RC_TV:
    buffer_load_dwordx2 v[62:63], v6, s[12:15], s33 offen offset:1024 sc1
    s_waitcnt vmcnt(0)
    v_max_u32 v7, v62, v63
    v_cmp_eq_u32 vcc, -1, v7
    s_cbranch_vccz RC_TV_D
    s_cmp_eq_u32 s42, 0
    s_cbranch_scc1 RC_TV_D
    s_sub_u32 s42, s42, 1
    s_branch RC_TV
RC_TV_D:
    v_swap_b32 v61, v62
    s_cmp_eq_u32 s23, 0
    s_cbranch_scc0 RC_PUBB1
    v_lshrrev_b32 v62, 8, v5
    v_lshlrev_b32 v62, 7, v62
    v_and_b32 v63, 0x70, v5
    v_add_u32 v62, v62, v63
    s_mov_b64 exec, s[58:59]
    buffer_store_dwordx4 v[56:59], v62, s[4:7], s38 offen sc1
    s_mov_b64 exec, -1
    s_branch RC_PUBB2
RC_PUBB1:
    v_lshlrev_b32 v56, 16, v60
    v_and_b32 v57, 0xffff0000, v60
    v_lshlrev_b32 v58, 16, v61
    v_and_b32 v59, 0xffff0000, v61
    v_pk_add_f32 v[56:57], v[56:57], v[58:59]
    v_cvt_pk_bf16_f32 v60, v56, v57
    v_lshlrev_b32 v56, 16, v62
    v_and_b32 v57, 0xffff0000, v62
    v_lshlrev_b32 v58, 16, v63
    v_and_b32 v59, 0xffff0000, v63
    v_pk_add_f32 v[56:57], v[56:57], v[58:59]
    v_cvt_pk_bf16_f32 v61, v56, v57
    v_lshrrev_b32 v62, 9, v5
    v_lshlrev_b32 v62, 8, v62
    v_bfe_u32 v56, v5, 8, 1
    v_lshl_add_u32 v62, v56, 2, v62
    v_bfe_u32 v56, v5, 7, 1
    v_lshl_add_u32 v62, v56, 7, v62
    v_bfe_u32 v56, v5, 4, 3
    v_lshl_add_u32 v62, v56, 3, v62
    buffer_store_dword v60, v62, s[4:7], s39 offen sc1
    buffer_store_dword v61, v62, s[4:7], s39 offen offset:64 sc1
RC_PUBB2:
    s_waitcnt vmcnt(0)
    s_endpgm
RC_FB:
    s_lshl_b32 s46, s21, 14
    v_add_u32 v7, s46, v5
    ds_read_b128 v[64:67], v7 offset:0
    ds_read_b128 v[68:71], v7 offset:1024
    ds_read_b128 v[72:75], v7 offset:2048
    ds_read_b128 v[76:79], v7 offset:3072
    ds_read_b128 v[80:83], v7 offset:4096
    ds_read_b128 v[84:87], v7 offset:5120
    ds_read_b128 v[88:91], v7 offset:6144
    ds_read_b128 v[92:95], v7 offset:7168
    s_waitcnt lgkmcnt(0)
    ds_read_b128 v[96:99], v7 offset:8192
    ds_read_b128 v[100:103], v7 offset:9216
    ds_read_b128 v[104:107], v7 offset:10240
    ds_read_b128 v[108:111], v7 offset:11264
    ds_read_b128 v[112:115], v7 offset:12288
    ds_read_b128 v[116:119], v7 offset:13312
    ds_read_b128 v[120:123], v7 offset:14336
    ds_read_b128 v[124:127], v7 offset:15360
    s_lshr_b32 s97, s22, 1
    s_lshl_b32 s97, s97, 7
    s_add_u32 s97, s97, 14688256
    s_mov_b32 s96, 0
    s_add_u32 s46, s20, 1
    s_lshr_b32 s46, s46, 2
    s_lshl_b32 s46, s46, 11
    s_add_u32 s46, s46, s97
    buffer_load_dwordx2 v[32:33], off, s[4:7], s46 sc1
    buffer_load_dwordx4 v[8:11], v1, s[4:7], s24 offen sc1
    buffer_load_dwordx4 v[12:15], v1, s[4:7], s24 offen offset:1024 sc1
    v_add_u32 v16, 131072, v1
    v_xor_b32 v20, 0x800, v16
    v_xor_b32 v28, 0x1000, v16
    v_xor_b32 v36, 0x1800, v16
    v_mov_b32 v24, -1
    v_mov_b32 v25, -1
    v_mov_b32 v26, -1
    v_mov_b32 v27, -1
    v_mov_b64 v[40:41], 0
    v_mov_b64 v[42:43], 0
    v_mov_b64 v[44:45], 0
    v_mov_b64 v[46:47], 0
    v_mov_b64 v[48:49], 0
    v_mov_b64 v[50:51], 0
    v_mov_b64 v[52:53], 0
    v_mov_b64 v[54:55], 0
    v_mov_b64 v[56:57], 0
    v_mov_b64 v[58:59], 0
    v_mov_b64 v[60:61], 0
    v_mov_b64 v[62:63], 0
RCF_TOP:
    s_cmp_lg_u32 s96, 0x01010101
    s_cbranch_scc1 RCF_KVW
RCF_KVB:
RCF_PM:
    buffer_load_dwordx4 v[8:11], v1, s[4:7], s24 offen sc1
    buffer_load_dwordx4 v[12:15], v1, s[4:7], s24 offen offset:1024 sc1
    s_waitcnt vmcnt(2)
    v_max3_u32 v6, v8, v9, v10
    v_max3_u32 v6, v6, v11, v12
    v_max3_u32 v6, v6, v13, v14
    v_max_u32 v6, v6, v15
    v_cmp_eq_u32 vcc, -1, v6
    s_cbranch_vccz RCF_PM_D
    s_cmp_eq_u32 s42, 0
    s_cbranch_scc1 RCF_PM_D
    s_sub_u32 s42, s42, 1
    s_branch RCF_PM
RCF_PM_D:
    ds_write_b128 v16, v[8:11]
    ds_write_b128 v16, v[12:15] offset:1024
    v_smfmac_f32_16x16x64_bf16 v[40:43], v[8:11], a[0:7], v0
    buffer_store_dwordx4 v[24:27], v5, s[12:15], s34 offen sc1
    v_smfmac_f32_16x16x64_bf16 v[44:47], v[8:11], a[8:15], v0
    buffer_store_dwordx4 v[24:27], v5, s[12:15], s34 offen offset:1024 sc1
    v_and_b32 v32, v32, v33
    v_smfmac_f32_16x16x64_bf16 v[48:51], v[8:11], a[128:135], v0
    v_smfmac_f32_16x16x64_bf16 v[52:55], v[8:11], a[136:143], v0
    v_readfirstlane_b32 s96, v32
    s_waitcnt lgkmcnt(0)
    s_barrier
    ds_read_b128 v[16:19], v20 offset:0
    ds_read_b128 v[20:23], v20 offset:1024
    ds_read_b128 v[24:27], v28 offset:0
    ds_read_b128 v[28:31], v28 offset:1024
    ds_read_b128 v[32:35], v36 offset:0
    ds_read_b128 v[36:39], v36 offset:1024
    v_smfmac_f32_16x16x64_bf16 v[40:43], v[12:15], a[16:23], v0
    v_smfmac_f32_16x16x64_bf16 v[44:47], v[12:15], a[24:31], v0
    v_smfmac_f32_16x16x64_bf16 v[48:51], v[12:15], a[144:151], v0
    v_smfmac_f32_16x16x64_bf16 v[52:55], v[12:15], a[152:159], v0
    v_smfmac_f32_16x16x64_bf16 v[56:59], v[8:11], v[128:135], v0
    v_smfmac_f32_16x16x64_bf16 v[60:63], v[8:11], v[136:143], v0
    s_waitcnt lgkmcnt(5)
    v_smfmac_f32_16x16x64_bf16 v[40:43], v[16:19], a[32:39], v0
    v_smfmac_f32_16x16x64_bf16 v[44:47], v[16:19], a[40:47], v0
    v_smfmac_f32_16x16x64_bf16 v[48:51], v[16:19], a[160:167], v0
    v_smfmac_f32_16x16x64_bf16 v[52:55], v[16:19], a[168:175], v0
    s_waitcnt lgkmcnt(4)
    v_smfmac_f32_16x16x64_bf16 v[40:43], v[20:23], a[48:55], v0
    v_smfmac_f32_16x16x64_bf16 v[44:47], v[20:23], a[56:63], v0
    v_smfmac_f32_16x16x64_bf16 v[48:51], v[20:23], a[176:183], v0
    v_smfmac_f32_16x16x64_bf16 v[52:55], v[20:23], a[184:191], v0
    s_waitcnt lgkmcnt(3)
    v_smfmac_f32_16x16x64_bf16 v[40:43], v[24:27], a[64:71], v0
    v_smfmac_f32_16x16x64_bf16 v[44:47], v[24:27], a[72:79], v0
    v_smfmac_f32_16x16x64_bf16 v[48:51], v[24:27], a[192:199], v0
    v_smfmac_f32_16x16x64_bf16 v[52:55], v[24:27], a[200:207], v0
    s_waitcnt lgkmcnt(2)
    v_smfmac_f32_16x16x64_bf16 v[40:43], v[28:31], a[80:87], v0
    v_smfmac_f32_16x16x64_bf16 v[44:47], v[28:31], a[88:95], v0
    v_smfmac_f32_16x16x64_bf16 v[48:51], v[28:31], a[208:215], v0
    v_smfmac_f32_16x16x64_bf16 v[52:55], v[28:31], a[216:223], v0
    s_waitcnt lgkmcnt(1)
    v_smfmac_f32_16x16x64_bf16 v[40:43], v[32:35], a[96:103], v0
    v_smfmac_f32_16x16x64_bf16 v[44:47], v[32:35], a[104:111], v0
    s_waitcnt lgkmcnt(0)
    v_smfmac_f32_16x16x64_bf16 v[40:43], v[36:39], a[112:119], v0
    v_smfmac_f32_16x16x64_bf16 v[44:47], v[36:39], a[120:127], v0
    v_smfmac_f32_16x16x64_bf16 v[48:51], v[32:35], a[224:231], v0
    v_add_f32 v40, v40, v41
    v_smfmac_f32_16x16x64_bf16 v[52:55], v[32:35], a[232:239], v0
    v_add_f32 v42, v42, v43
    v_add_f32 v44, v44, v45
    v_smfmac_f32_16x16x64_bf16 v[48:51], v[36:39], a[240:247], v0
    v_add_f32 v46, v46, v47
    v_cvt_pk_bf16_f32 v45, v44, v46
    v_smfmac_f32_16x16x64_bf16 v[52:55], v[36:39], a[248:255], v0
    v_cvt_pk_bf16_f32 v44, v40, v42
    s_nop 2
    v_add_f32 v48, v48, v49
    v_add_f32 v50, v50, v51
    s_nop 1
    v_add_f32 v52, v52, v53
    v_add_f32 v54, v54, v55
    v_cvt_pk_bf16_f32 v46, v48, v50
    v_cvt_pk_bf16_f32 v47, v52, v54
    buffer_store_dwordx4 v[44:47], v5, s[12:15], s32 offen sc1
    s_lshl_b32 s46, s21, 14
    s_add_u32 s46, s46, 65536
    v_add_u32 v7, s46, v5
    v_add_u32 v6, 141312, v5
    v_smfmac_f32_16x16x64_bf16 v[56:59], v[24:27], v[64:71], v0
    v_smfmac_f32_16x16x64_bf16 v[60:63], v[24:27], v[72:79], v0
    v_smfmac_f32_16x16x64_bf16 v[56:59], v[28:31], v[80:87], v0
    ds_read_b128 v[64:67], v7 offset:0
    ds_read_b128 v[68:71], v7 offset:1024
    v_smfmac_f32_16x16x64_bf16 v[60:63], v[28:31], v[88:95], v0
    ds_read_b128 v[72:75], v7 offset:2048
    ds_read_b128 v[76:79], v7 offset:3072
    v_smfmac_f32_16x16x64_bf16 v[56:59], v[32:35], v[96:103], v0
    ds_read_b128 v[24:27], v6
    ds_read_b128 v[28:31], v6 offset:1024
    v_smfmac_f32_16x16x64_bf16 v[60:63], v[32:35], v[104:111], v0
    ds_read_b128 v[80:83], v7 offset:4096
    ds_read_b128 v[84:87], v7 offset:5120
    v_smfmac_f32_16x16x64_bf16 v[56:59], v[36:39], v[112:119], v0
    ds_read_b128 v[88:91], v7 offset:6144
    ds_read_b128 v[92:95], v7 offset:7168
    v_smfmac_f32_16x16x64_bf16 v[60:63], v[36:39], v[120:127], v0
    ds_read_b128 v[96:99], v7 offset:8192
    ds_read_b128 v[100:103], v7 offset:9216
    v_smfmac_f32_16x16x64_bf16 v[56:59], v[12:15], v[144:151], v0
    ds_read_b128 v[104:107], v7 offset:10240
    ds_read_b128 v[108:111], v7 offset:11264
    v_add_u32 v6, s56, v5
    v_smfmac_f32_16x16x64_bf16 v[60:63], v[12:15], v[152:159], v0
    ds_read_b128 v[112:115], v7 offset:12288
    ds_read_b128 v[116:119], v7 offset:13312
    ds_read_b128 v[32:35], v6
    ds_read_b128 v[36:39], v6 offset:1024
    v_smfmac_f32_16x16x64_bf16 v[56:59], v[16:19], v[160:167], v0
    ds_read_b128 v[120:123], v7 offset:14336
    ds_read_b128 v[124:127], v7 offset:15360
    v_smfmac_f32_16x16x64_bf16 v[60:63], v[16:19], v[168:175], v0
    buffer_load_dwordx4 v[52:55], v5, s[12:15], s33 offen sc1
    v_smfmac_f32_16x16x64_bf16 v[56:59], v[20:23], v[176:183], v0
    v_smfmac_f32_16x16x64_bf16 v[60:63], v[20:23], v[184:191], v0
    s_waitcnt lgkmcnt(14)
    v_mfma_f32_16x16x32_bf16 v[40:43], v[44:47], v[24:27], 0
    v_mfma_f32_16x16x32_bf16 v[48:51], v[44:47], v[28:31], 0
    v_lshrrev_b32 v7, 1, v5
    v_add_f32 v56, v56, v57
    v_add_f32 v58, v58, v59
    v_add_f32 v60, v60, v61
    v_add_f32 v62, v62, v63
    v_cvt_pk_bf16_f32 v61, v60, v62
    v_cvt_pk_bf16_f32 v60, v56, v58
    buffer_store_dwordx2 v[60:61], v7, s[12:15], s32 offen offset:1024 sc1
    s_waitcnt vmcnt(5)
    ds_read_b128 v[8:11], v6 offset:2048
    ds_read_b128 v[12:15], v6 offset:3072
    v_mov_b32 v47, v7
    v_lshrrev_b32 v45, 8, v5
    v_lshlrev_b32 v45, 7, v45
    v_and_b32 v6, 0x70, v5
    v_add_u32 v45, v45, v6
    v_add_u32 v44, s54, v45
    v_and_b32 v7, 0x80, v5
    v_lshl_add_u32 v45, v7, 2, v45
    v_add_u32 v45, 131072, v45
    v_lshrrev_b32 v46, 9, v5
    v_lshl_add_u32 v46, v46, 7, v6
    v_bfe_u32 v6, v5, 8, 1
    v_lshl_add_u32 v46, v6, 3, v46
    v_bfe_u32 v6, v5, 7, 1
    v_lshl_add_u32 v46, v6, 2, v46
    v_add_u32 v46, 132352, v46
    buffer_load_dwordx4 v[52:55], v5, s[12:15], s33 offen sc1
    s_barrier
    s_waitcnt vmcnt(2)
    v_max3_u32 v7, v52, v53, v54
    v_max_u32 v7, v7, v55
    v_cmp_eq_u32 vcc, -1, v7
    s_cbranch_vccz RCF_PQ_D
RCF_PQ:
    buffer_load_dwordx4 v[52:55], v5, s[12:15], s33 offen sc1
    s_waitcnt vmcnt(1)
    v_max3_u32 v7, v52, v53, v54
    v_max_u32 v7, v7, v55
    v_cmp_eq_u32 vcc, -1, v7
    s_cbranch_vccz RCF_PQ_D
    s_cmp_eq_u32 s42, 0
    s_cbranch_scc1 RCF_PQ_D
    s_sub_u32 s42, s42, 1
    s_branch RCF_PQ
RCF_PQ_D:
    s_waitcnt lgkmcnt(0)
    v_mfma_f32_16x16x32_bf16 v[40:43], v[52:55], v[24:27], v[40:43]
    v_mfma_f32_16x16x32_bf16 v[48:51], v[52:55], v[28:31], v[48:51]
    buffer_load_dwordx2 v[62:63], v47, s[12:15], s33 offen offset:1024 sc1
    s_cmp_eq_u32 s20, s43
    s_nop 2
    v_cvt_pk_bf16_f32 v56, v40, v41
    v_cvt_pk_bf16_f32 v57, v42, v43
    s_nop 0
    v_cvt_pk_bf16_f32 v58, v48, v49
    v_cvt_pk_bf16_f32 v59, v50, v51
    s_cbranch_scc1 RCF_TAIL
    s_nop 0
    v_mfma_f32_16x16x32_bf16 v[16:19], v[32:35], v[56:59], 0
    v_mfma_f32_16x16x32_bf16 v[20:23], v[36:39], v[56:59], 0
    v_mfma_f32_16x16x32_bf16 v[24:27], v[56:59], v[56:59], 0
    s_cmp_lg_u32 s96, 0x01010101
    s_cbranch_scc1 RCF_NKV
    s_mov_b32 m0, s56
    s_nop 0
    buffer_load_dwordx4 v4, s[8:11], s36 offen lds
    s_mov_b64 exec, s[40:41]
    ds_write_b128 v44, v[16:19]
    s_mov_b64 exec, -1
    s_add_u32 m0, s56, 896
    s_nop 0
    buffer_load_dwordx4 v4, s[8:11], s36 offen offset:128 lds
    s_mov_b64 exec, s[40:41]
    ds_write_b128 v44, v[20:23] offset:512
    s_mov_b64 exec, -1
    s_add_u32 m0, s56, 2048
    s_nop 0
    buffer_load_dwordx4 v4, s[8:11], s37 offen lds
    s_mov_b64 exec, s[40:41]
    ds_write_b128 v44, v[24:27] offset:1024
    s_mov_b64 exec, -1
    s_add_u32 m0, s56, 2944
    s_nop 0
    buffer_load_dwordx4 v4, s[8:11], s37 offen offset:128 lds
    s_add_u32 s36, s36, 262144
    s_add_u32 s37, s37, 262144
    s_branch RCF_NKV2
RCF_NKV:
    s_mov_b64 exec, s[40:41]
    s_nop 1
    ds_write_b128 v44, v[16:19]
    s_nop 1
    ds_write_b128 v44, v[20:23] offset:512
    s_nop 2
    ds_write_b128 v44, v[24:27] offset:1024
    s_mov_b64 exec, -1
    s_waitcnt vmcnt(0)
RCF_NKV2:
    s_waitcnt lgkmcnt(0)
    s_barrier
    ds_read2st64_b32 v[48:49], v46 offset0:0 offset1:6
    ds_read2st64_b32 v[50:51], v46 offset0:12 offset1:18
    ds_read_b128 v[32:35], v45 offset:0
    ds_read_b128 v[36:39], v45 offset:1536
    ds_read_b128 v[40:43], v45 offset:3072
    ds_read_b128 v[44:47], v45 offset:4608
    v_and_b32 v28, 0xf0, v5
    v_and_b32 v6, 0x300, v5
    v_lshl_add_u32 v28, v28, 1, v6
    v_add_u32 v28, s55, v28
    v_lshrrev_b32 v29, 8, v5
    v_lshlrev_b32 v29, 7, v29
    v_and_b32 v6, 0x70, v5
    v_add_u32 v29, v29, v6
    s_waitcnt lgkmcnt(4)
    v_pk_add_f32 v[48:49], v[48:49], v[50:51]
    s_waitcnt lgkmcnt(2)
    v_pk_add_f32 v[32:33], v[32:33], v[36:37]
    v_pk_add_f32 v[34:35], v[34:35], v[38:39]
    v_add_f32 v48, v48, v49
    s_waitcnt lgkmcnt(0)
    v_pk_add_f32 v[40:41], v[40:41], v[44:45]
    v_pk_add_f32 v[42:43], v[42:43], v[46:47]
    v_pk_add_f32 v[32:33], v[32:33], v[40:41]
    v_pk_add_f32 v[34:35], v[34:35], v[42:43]
    v_mov_b32 v44, 0x3f803f80
    v_max3_f32 v50, v32, v33, v48
    v_mov_b32 v45, 0x3f803f80
    v_max3_f32 v50, v50, v34, v35
    v_mov_b32 v46, 0x3f803f80
    v_mov_b32 v47, 0x3f803f80
    v_max_f32_dpp v50, v50, v50 row_ror:8 row_mask:0xf bank_mask:0xf
    v_mov_b32 v42, 0x3f003f00
    v_mov_b32 v51, v50
    v_mov_b32 v43, 0x3f003f00
    s_nop 0
    v_permlane32_swap_b32 v50, v51
    s_nop 0
    v_max_f32 v50, v50, v51
    v_mov_b32 v51, v50
    s_nop 1
    v_permlane16_swap_b32 v50, v51
    s_nop 0
    v_max_f32 v50, v50, v51
    v_mul_f32 v50, s63, v50
    v_fma_f32 v32, v32, s63, -v50
    v_fma_f32 v33, v33, s63, -v50
    v_fma_f32 v34, v34, s63, -v50
    v_fma_f32 v35, v35, s63, -v50
    v_fma_f32 v48, v48, s63, -v50
    v_exp_f32 v48, v48
    v_exp_f32 v32, v32
    v_exp_f32 v33, v33
    v_exp_f32 v34, v34
    v_exp_f32 v35, v35
    v_mov_b32_dpp v51, v48 row_ror:8 row_mask:0xf bank_mask:0xf
    v_cvt_pk_bf16_f32 v36, v32, v33
    v_cvt_pk_bf16_f32 v37, v34, v35
    v_cvt_pk_bf16_f32 v40, v48, v51
    v_mov_b32_dpp v38, v36 row_ror:8 row_mask:0xf bank_mask:0xf
    v_mov_b32_dpp v39, v37 row_ror:8 row_mask:0xf bank_mask:0xf
    v_cvt_pk_bf16_f32 v41, v48, v51
    s_waitcnt vmcnt(4)
    v_mfma_f32_16x16x32_bf16 v[52:55], v[44:47], v[36:39], 0
    v_max_u32 v7, v62, v63
    v_cmp_eq_u32 vcc, -1, v7
    v_mfma_f32_16x16x32_bf16 v[16:19], v[8:11], v[36:39], 0
    s_cbranch_vccz RCF_PV_D
    v_lshrrev_b32 v6, 1, v5
RCF_PV:
    buffer_load_dwordx2 v[62:63], v6, s[12:15], s33 offen offset:1024 sc1
    s_waitcnt vmcnt(0)
    v_max_u32 v7, v62, v63
    v_cmp_eq_u32 vcc, -1, v7
    s_cbranch_vccz RCF_PV_D
    s_cmp_eq_u32 s42, 0
    s_cbranch_scc1 RCF_PV_D
    s_sub_u32 s42, s42, 1
    s_branch RCF_PV
RCF_PV_D:
    v_swap_b32 v61, v62
    v_mfma_f32_16x16x32_bf16 v[20:23], v[12:15], v[36:39], 0
    v_mfma_f32_16x16x16_bf16 v[52:55], v[42:43], v[40:41], v[52:55]
    v_mfma_f32_16x16x16_bf16 v[16:19], v[60:61], v[40:41], v[16:19]
    v_mfma_f32_16x16x16_bf16 v[20:23], v[62:63], v[40:41], v[20:23]
    s_nop 1
    v_rcp_f32 v6, v52
    s_nop 2
    v_pk_mul_f32 v[16:17], v[16:17], v[6:7] op_sel_hi:[1,0]
    v_pk_mul_f32 v[18:19], v[18:19], v[6:7] op_sel_hi:[1,0]
    v_pk_mul_f32 v[20:21], v[20:21], v[6:7] op_sel_hi:[1,0]
    v_pk_mul_f32 v[22:23], v[22:23], v[6:7] op_sel_hi:[1,0]
    v_cvt_pk_bf16_f32 v8, v16, v17
    v_cvt_pk_bf16_f32 v9, v20, v21
    v_cvt_pk_bf16_f32 v10, v18, v19
    v_cvt_pk_bf16_f32 v11, v22, v23
    s_mov_b64 exec, s[40:41]
    ds_write2_b64 v28, v[8:9], v[10:11] offset0:0 offset1:2
    s_mov_b64 exec, -1
    v_add_u32 v6, 139264, v5
    v_mov_b64 v[24:25], 0
    v_mov_b64 v[26:27], 0
    v_mov_b64 v[30:31], 0
    v_mov_b64 v[32:33], 0
    v_mov_b64 v[34:35], 0
    v_mov_b64 v[36:37], 0
    v_mov_b64 v[38:39], 0
    v_mov_b64 v[40:41], 0
    s_waitcnt lgkmcnt(0)
    s_barrier
    ds_read_b128 v[8:11], v6
    ds_read_b128 v[12:15], v6 offset:1024
    s_cmp_eq_u32 s23, 0
    s_cbranch_scc0 RCF_PUBA1
    v_lshrrev_b32 v62, 8, v5
    v_lshlrev_b32 v62, 7, v62
    v_and_b32 v63, 0x70, v5
    v_add_u32 v62, v62, v63
    s_mov_b64 exec, s[58:59]
    buffer_store_dwordx4 v[56:59], v62, s[4:7], s38 offen sc1
    s_mov_b64 exec, -1
    s_branch RCF_PUBA2
RCF_PUBA1:
    v_lshlrev_b32 v56, 16, v60
    v_and_b32 v57, 0xffff0000, v60
    v_lshlrev_b32 v58, 16, v61
    v_and_b32 v59, 0xffff0000, v61
    v_pk_add_f32 v[56:57], v[56:57], v[58:59]
    v_cvt_pk_bf16_f32 v60, v56, v57
    v_lshlrev_b32 v56, 16, v62
    v_and_b32 v57, 0xffff0000, v62
    v_lshlrev_b32 v58, 16, v63
    v_and_b32 v59, 0xffff0000, v63
    v_pk_add_f32 v[56:57], v[56:57], v[58:59]
    v_cvt_pk_bf16_f32 v61, v56, v57
    v_lshrrev_b32 v62, 9, v5
    v_lshlrev_b32 v62, 8, v62
    v_bfe_u32 v56, v5, 8, 1
    v_lshl_add_u32 v62, v56, 2, v62
    v_bfe_u32 v56, v5, 7, 1
    v_lshl_add_u32 v62, v56, 7, v62
    v_bfe_u32 v56, v5, 4, 3
    v_lshl_add_u32 v62, v56, 3, v62
    buffer_store_dword v60, v62, s[4:7], s39 offen sc1
    buffer_store_dword v61, v62, s[4:7], s39 offen offset:64 sc1
RCF_PUBA2:
    v_mov_b64 v[28:29], 0
    v_mov_b64 v[42:43], 0
    v_mov_b64 v[44:45], 0
    v_mov_b64 v[46:47], 0
    v_mov_b64 v[48:49], 0
    v_mov_b64 v[50:51], 0
    v_mov_b64 v[52:53], 0
    v_mov_b64 v[54:55], 0
    v_lshrrev_b32 v7, 6, v5
    v_mul_u32_u24 v7, 64, v7
    v_and_b32 v6, 0x30, v5
    v_add3_u32 v7, v7, v6, s57
    s_waitcnt lgkmcnt(1)
    v_smfmac_f32_16x16x64_bf16 v[24:27], v[8:11], v[192:199], v0
    v_smfmac_f32_16x16x64_bf16 v[28:31], v[8:11], v[200:207], v0
    s_waitcnt lgkmcnt(0)
    v_smfmac_f32_16x16x64_bf16 v[24:27], v[12:15], v[64:71], v0
    v_smfmac_f32_16x16x64_bf16 v[28:31], v[12:15], v[72:79], v0
    v_smfmac_f32_16x16x64_bf16 v[32:35], v[8:11], v[208:215], v0
    v_mov_b32 v60, -1
    v_smfmac_f32_16x16x64_bf16 v[36:39], v[8:11], v[216:223], v0
    v_add_f32 v24, v24, v25
    v_add_f32 v26, v26, v27
    v_smfmac_f32_16x16x64_bf16 v[32:35], v[12:15], v[80:87], v0
    v_add_f32 v28, v28, v29
    v_add_f32 v30, v30, v31
    v_smfmac_f32_16x16x64_bf16 v[36:39], v[12:15], v[88:95], v0
    v_cvt_pk_bf16_f32 v29, v28, v30
    v_cvt_pk_bf16_f32 v28, v24, v26
    buffer_store_dwordx2 v[28:29], v2, s[4:7], s28 offen sc1
    v_smfmac_f32_16x16x64_bf16 v[40:43], v[8:11], v[224:231], v0
    v_smfmac_f32_16x16x64_bf16 v[44:47], v[8:11], v[232:239], v0
    v_add_f32 v32, v32, v33
    v_add_f32 v34, v34, v35
    v_smfmac_f32_16x16x64_bf16 v[40:43], v[12:15], v[96:103], v0
    v_add_f32 v36, v36, v37
    v_add_f32 v38, v38, v39
    v_smfmac_f32_16x16x64_bf16 v[44:47], v[12:15], v[104:111], v0
    v_cvt_pk_bf16_f32 v37, v36, v38
    v_cvt_pk_bf16_f32 v36, v32, v34
    buffer_store_dwordx2 v[36:37], v2, s[4:7], s29 offen sc1
    v_smfmac_f32_16x16x64_bf16 v[48:51], v[8:11], v[240:247], v0
    v_smfmac_f32_16x16x64_bf16 v[52:55], v[8:11], v[248:255], v0
    v_add_f32 v40, v40, v41
    v_add_f32 v42, v42, v43
    v_smfmac_f32_16x16x64_bf16 v[48:51], v[12:15], v[112:119], v0
    v_add_f32 v44, v44, v45
    v_add_f32 v46, v46, v47
    v_smfmac_f32_16x16x64_bf16 v[52:55], v[12:15], v[120:127], v0
    v_cvt_pk_bf16_f32 v45, v44, v46
    v_cvt_pk_bf16_f32 v44, v40, v42
    buffer_store_dwordx2 v[44:45], v2, s[4:7], s30 offen sc1
    s_lshl_b32 s46, s21, 14
    v_add_u32 v58, s46, v5
    v_add_u32 v6, 141312, v5
    ds_read_b128 v[16:19], v6 offset:2048
    v_mov_b32 v61, -1
    v_mov_b32 v62, -1
    v_mov_b32 v63, -1
    v_add_f32 v48, v48, v49
    v_add_f32 v50, v50, v51
    v_add_f32 v52, v52, v53
    v_add_f32 v54, v54, v55
    v_cvt_pk_bf16_f32 v53, v52, v54
    v_cvt_pk_bf16_f32 v52, v48, v50
    buffer_store_dwordx2 v[52:53], v2, s[4:7], s31 offen sc1
    buffer_load_dwordx4 v[8:11], v7, s[4:7], s26 offen sc1
    buffer_load_dwordx4 v[12:15], v7, s[4:7], s27 offen sc1
    ds_read_b128 v[64:67], v58 offset:0
    ds_read_b128 v[68:71], v58 offset:1024
    ds_read_b128 v[72:75], v58 offset:2048
    ds_read_b128 v[76:79], v58 offset:3072
    ds_read_b128 v[80:83], v58 offset:4096
    ds_read_b128 v[84:87], v58 offset:5120
    ds_read_b128 v[88:91], v58 offset:6144
    ds_read_b128 v[92:95], v58 offset:7168
    ds_read_b128 v[96:99], v58 offset:8192
    ds_read_b128 v[100:103], v58 offset:9216
    ds_read_b128 v[104:107], v58 offset:10240
    ds_read_b128 v[108:111], v58 offset:11264
    ds_read_b128 v[112:115], v58 offset:12288
    ds_read_b128 v[116:119], v58 offset:13312
    s_waitcnt lgkmcnt(8)
    ds_read_b128 v[120:123], v58 offset:14336
    ds_read_b128 v[124:127], v58 offset:15360
RCF_PR:
    buffer_load_dwordx4 v[8:11], v7, s[4:7], s26 offen sc1
    buffer_load_dwordx4 v[12:15], v7, s[4:7], s27 offen sc1
    s_waitcnt vmcnt(2)
    v_max3_u32 v6, v8, v9, v10
    v_max3_u32 v6, v6, v11, v12
    v_max3_u32 v6, v6, v13, v14
    v_max_u32 v6, v6, v15
    v_cmp_eq_u32 vcc, -1, v6
    s_cbranch_vccz RCF_PR_D
    s_cmp_eq_u32 s42, 0
    s_cbranch_scc1 RCF_PR_D
    s_sub_u32 s42, s42, 1
    s_branch RCF_PR
RCF_PR_D:
    s_waitcnt lgkmcnt(0)
    v_mfma_f32_16x16x32_bf16 v[20:23], v[8:11], v[16:19], 0
    v_mfma_f32_16x16x32_bf16 v[20:23], v[12:15], v[16:19], v[20:23]
    buffer_store_dwordx4 v[60:63], v7, s[4:7], s26 offen sc1
    buffer_store_dwordx4 v[60:63], v7, s[4:7], s27 offen sc1
    s_nop 5
    v_permlane32_swap_b32 v20, v22
    v_permlane32_swap_b32 v21, v23
    s_nop 0
    v_pk_add_f32 v[20:21], v[20:21], v[22:23]
    s_nop 1
    v_permlane16_swap_b32 v20, v21
    s_nop 0
    v_add_f32 v20, v20, v21
    s_nop 1
    v_mov_b32_dpp v21, v20 row_shl:4 row_mask:0xf bank_mask:0xf
    s_nop 0
    v_cvt_pk_bf16_f32 v20, v20, v21
    buffer_store_dword v20, v3, s[4:7], s25 offen sc1
    buffer_store_dword v60, v3, s[4:7], s24 offen sc1
    s_add_u32 s20, s20, 1
    s_add_u32 s46, s20, 1
    s_lshr_b32 s46, s46, 2
    s_lshl_b32 s46, s46, 11
    s_add_u32 s46, s46, s97
    buffer_load_dwordx2 v[32:33], off, s[4:7], s46 sc1
    buffer_load_dwordx4 v[8:11], v1, s[4:7], s25 offen sc1
    buffer_load_dwordx4 v[12:15], v1, s[4:7], s25 offen offset:1024 sc1
    s_add_u32 s46, s24, 16384
    s_and_b32 s46, s46, 0xffff
    s_and_b32 s24, s24, 0xffff0000
    s_or_b32 s24, s24, s46
    s_add_u32 s46, s25, 16384
    s_and_b32 s46, s46, 0xffff
    s_and_b32 s25, s25, 0xffff0000
    s_or_b32 s25, s25, s46
    s_xor_b32 s26, s26, 0x80000
    s_xor_b32 s27, s27, 0x80000
    s_xor_b32 s28, s28, 0x80000
    s_xor_b32 s29, s29, 0x80000
    s_xor_b32 s30, s30, 0x80000
    s_xor_b32 s31, s31, 0x80000
    s_add_u32 s46, s32, 32768
    s_and_b32 s46, s46, 0x1fffff
    s_add_u32 s32, s46, s60
    s_add_u32 s46, s33, 32768
    s_and_b32 s46, s46, 0x1fffff
    s_add_u32 s33, s46, s60
    s_add_u32 s46, s34, 32768
    s_and_b32 s46, s46, 0x1fffff
    s_add_u32 s34, s46, s60
    s_add_u32 s38, s38, 131072
    s_add_u32 s39, s39, 65536
    v_add_u32 v16, 131072, v1
    v_xor_b32 v20, 0x800, v16
    v_xor_b32 v28, 0x1000, v16
    v_xor_b32 v36, 0x1800, v16
    v_mov_b32 v24, -1
    v_mov_b32 v25, -1
    v_mov_b32 v26, -1
    v_mov_b32 v27, -1
    v_mov_b64 v[40:41], 0
    v_mov_b64 v[42:43], 0
    v_mov_b64 v[44:45], 0
    v_mov_b64 v[46:47], 0
    v_mov_b64 v[48:49], 0
    v_mov_b64 v[50:51], 0
    v_mov_b64 v[52:53], 0
    v_mov_b64 v[54:55], 0
    v_mov_b64 v[56:57], 0
    v_mov_b64 v[58:59], 0
    v_mov_b64 v[60:61], 0
    v_mov_b64 v[62:63], 0
    s_branch RCF_TOP
RCF_KVW:
    s_lshr_b32 s46, s20, 2
    s_lshl_b32 s46, s46, 11
    s_add_u32 s46, s46, s97
RCF_KVP:
    buffer_load_dwordx2 v[36:37], off, s[4:7], s46 sc1
    s_waitcnt vmcnt(0)
    v_and_b32 v36, v36, v37
    v_cmp_ne_u32 vcc, 0x01010101, v36
    s_cbranch_vccz RCF_KVP_D
    s_cmp_eq_u32 s42, 0
    s_cbranch_scc1 RCF_KVP_D
    s_sub_u32 s42, s42, 1
    s_branch RCF_KVP
RCF_KVP_D:
    s_mov_b32 m0, s56
    s_nop 0
    buffer_load_dwordx4 v4, s[8:11], s36 offen lds
    s_add_u32 m0, s56, 896
    s_nop 0
    buffer_load_dwordx4 v4, s[8:11], s36 offen offset:128 lds
    s_add_u32 m0, s56, 2048
    s_nop 0
    buffer_load_dwordx4 v4, s[8:11], s37 offen lds
    s_add_u32 m0, s56, 2944
    s_nop 0
    buffer_load_dwordx4 v4, s[8:11], s37 offen offset:128 lds
    s_add_u32 s36, s36, 262144
    s_add_u32 s37, s37, 262144
    v_xor_b32 v36, 0x1800, v16
    s_branch RCF_KVB
RCF_TAIL:
    v_lshrrev_b32 v6, 1, v5
RCF_TV:
    buffer_load_dwordx2 v[62:63], v6, s[12:15], s33 offen offset:1024 sc1
    s_waitcnt vmcnt(0)
    v_max_u32 v7, v62, v63
    v_cmp_eq_u32 vcc, -1, v7
    s_cbranch_vccz RCF_TV_D
    s_cmp_eq_u32 s42, 0
    s_cbranch_scc1 RCF_TV_D
    s_sub_u32 s42, s42, 1
    s_branch RCF_TV
RCF_TV_D:
    v_swap_b32 v61, v62
    s_cmp_eq_u32 s23, 0
    s_cbranch_scc0 RCF_PUBB1
    v_lshrrev_b32 v62, 8, v5
    v_lshlrev_b32 v62, 7, v62
    v_and_b32 v63, 0x70, v5
    v_add_u32 v62, v62, v63
    s_mov_b64 exec, s[58:59]
    buffer_store_dwordx4 v[56:59], v62, s[4:7], s38 offen sc1
    s_mov_b64 exec, -1
    s_branch RCF_PUBB2
RCF_PUBB1:
    v_lshlrev_b32 v56, 16, v60
    v_and_b32 v57, 0xffff0000, v60
    v_lshlrev_b32 v58, 16, v61
    v_and_b32 v59, 0xffff0000, v61
    v_pk_add_f32 v[56:57], v[56:57], v[58:59]
    v_cvt_pk_bf16_f32 v60, v56, v57
    v_lshlrev_b32 v56, 16, v62
    v_and_b32 v57, 0xffff0000, v62
    v_lshlrev_b32 v58, 16, v63
    v_and_b32 v59, 0xffff0000, v63
    v_pk_add_f32 v[56:57], v[56:57], v[58:59]
    v_cvt_pk_bf16_f32 v61, v56, v57
    v_lshrrev_b32 v62, 9, v5
    v_lshlrev_b32 v62, 8, v62
    v_bfe_u32 v56, v5, 8, 1
    v_lshl_add_u32 v62, v56, 2, v62
    v_bfe_u32 v56, v5, 7, 1
    v_lshl_add_u32 v62, v56, 7, v62
    v_bfe_u32 v56, v5, 4, 3
    v_lshl_add_u32 v62, v56, 3, v62
    buffer_store_dword v60, v62, s[4:7], s39 offen sc1
    buffer_store_dword v61, v62, s[4:7], s39 offen offset:64 sc1
RCF_PUBB2:
    s_waitcnt vmcnt(0)
    s_endpgm
MG_WORK:
    s_sub_u32 s46, s23, 2
    s_lshl_b32 s46, s46, 5
    s_add_u32 s46, s46, s22
    s_sub_u32 s47, s22, 32
    s_lshl_b32 s47, s47, 1
    s_add_u32 s47, s47, s23
    s_cmp_eq_u32 s61, 1
    s_cselect_b32 s90, s46, s47
    s_cmp_eq_u32 s99, 0
    s_cbranch_scc0 WK_NOVER0
    s_waitcnt vmcnt(0)
    s_barrier
    s_cmp_eq_u32 s21, 0
    s_cbranch_scc0 WK_SG
    s_getreg_b32 s70, hwreg(HW_REG_XCC_ID, 0, 4)
    s_and_b32 s70, s70, 7
    s_lshl_b32 s70, s70, 4
    s_mov_b32 s79, s70
    s_add_u32 s71, s70, 4
    v_mov_b32 v8, 1
    v_mov_b32 v10, s71
    s_mov_b64 exec, 1
    buffer_atomic_add v8, v10, s[92:95], 0 offen sc0
    s_waitcnt vmcnt(0)
    v_readfirstlane_b32 s71, v8
    s_cmp_eq_u32 s71, 31
    s_cselect_b32 s78, 1, 0
    s_cbranch_scc0 WK_SGX
    s_add_u32 s70, s70, 128
    v_mov_b32 v8, 32
    v_mov_b32 v10, s70
    buffer_atomic_add v8, v10, s[92:95], 0 offen sc1
WK_SGX:
    s_mov_b64 exec, -1
WK_SG:
WK_NOVER0:
    s_cmp_eq_u32 s99, 0
    s_cbranch_scc0 WK_NOVER
    s_cmp_eq_u32 s21, 0
    s_cbranch_scc0 WK_VW
    v_lshrrev_b32 v9, 4, v5
    v_cmp_gt_u32 vcc, 8, v9
    v_add_u32 v9, 128, v5
    v_mov_b32 v10, 132
    v_cndmask_b32 v9, v10, v9, vcc
    s_mov_b32 s70, 200000
    s_add_u32 s76, s79, 8
    v_mov_b32 v12, s76
    s_cmp_ge_u32 s22, 32
    s_cselect_b32 s76, 1, s78
WK_VP:
    s_cmp_eq_u32 s76, 0
    s_cbranch_scc0 WK_VPG
    buffer_load_dword v10, v12, s[92:95], 0 offen sc1
    s_waitcnt vmcnt(0)
    v_readfirstlane_b32 s69, v10
    s_branch WK_VPE
WK_VPG:
    buffer_load_dword v10, v9, s[92:95], 0 offen sc1
    s_waitcnt vmcnt(0)
    v_readlane_b32 s80, v10, 0
    v_readlane_b32 s81, v10, 1
    v_readlane_b32 s82, v10, 2
    v_readlane_b32 s83, v10, 3
    v_readlane_b32 s84, v10, 4
    v_readlane_b32 s85, v10, 5
    v_readlane_b32 s86, v10, 6
    v_readlane_b32 s87, v10, 7
    v_readlane_b32 s71, v10, 8
    s_add_u32 s80, s80, s81
    s_add_u32 s80, s80, s82
    s_add_u32 s80, s80, s83
    s_add_u32 s80, s80, s84
    s_add_u32 s80, s80, s85
    s_add_u32 s80, s80, s86
    s_add_u32 s80, s80, s87
    v_cmp_ne_u32 vcc, 32, v10
    s_and_b32 vcc_lo, vcc_lo, 0xff
    s_cselect_b32 s77, 2, 1
    s_cmp_eq_u32 s71, 256
    s_cselect_b32 s71, 2, 0
    s_cmp_eq_u32 s80, 256
    s_cselect_b32 s69, s77, s71
WK_VPE:
    s_cmp_lg_u32 s69, 0
    s_cbranch_scc1 WK_VD
    s_cmp_eq_u32 s70, 199900
    s_cbranch_scc0 WK_VPN
    v_mov_b32 v8, 1
    v_mov_b32 v11, 132
    s_mov_b64 exec, 1
    buffer_atomic_add v8, v11, s[92:95], 0 offen sc1
    s_mov_b64 exec, -1
    s_mov_b32 s76, 1
WK_VPN:
    s_sub_u32 s70, s70, 1
    s_cmp_lg_u32 s70, 0
    s_cbranch_scc1 WK_VP
    s_mov_b32 s69, 2
WK_VD:
    v_mov_b32 v8, s69
    v_mov_b32 v9, 144384
    s_mov_b64 exec, 1
    s_cmp_eq_u32 s78, 1
    s_cbranch_scc0 WK_VDL
    buffer_store_dword v8, v12, s[92:95], 0 offen
WK_VDL:
    ds_write_b32 v9, v8
    s_mov_b64 exec, -1
    s_waitcnt lgkmcnt(0)
WK_VW:
    s_barrier
    v_mov_b32 v9, 144384
    ds_read_b32 v8, v9
    s_waitcnt lgkmcnt(0)
    v_readfirstlane_b32 s70, v8
    s_barrier
    s_cmp_eq_u32 s70, 1
    s_cbranch_scc0 MG_FALL
WK_NOVER:
    s_cmp_ge_u32 s90, 192
    s_cbranch_scc1 MG_EXIT
    s_lshr_b32 s70, s90, 6
    s_cmp_eq_u32 s70, 1
    s_cbranch_scc1 K0_LV
    s_cmp_eq_u32 s70, 2
    s_cbranch_scc1 K0_LQ
    s_load_dwordx2 s[64:65], s[0:1], 24
    s_branch K0_LD
K0_LV:
    s_load_dwordx2 s[64:65], s[0:1], 32
    s_branch K0_LD
K0_LQ:
    s_load_dwordx2 s[64:65], s[0:1], 16
K0_LD:
    v_lshrrev_b32 v65, 8, v5
    v_bfe_u32 v64, v5, 4, 4
    v_lshlrev_b32 v8, 2, v65
    v_xor_b32 v64, v64, v8
    v_lshrrev_b32 v8, 3, v64
    v_and_b32 v64, 7, v64
    v_lshlrev_b32 v64, 4, v64
    v_lshl_add_u32 v64, v8, 22, v64
    v_lshl_add_u32 v64, v65, 13, v64
    s_and_b32 s71, s90, 63
    s_lshl_b32 s71, s71, 7
    v_add_u32 v64, s71, v64
    s_lshl_b32 s76, s21, 16
    s_lshl_b32 s77, s21, 11
    s_waitcnt lgkmcnt(0)
    s_mov_b32 s72, s64
    s_mov_b32 s73, s65
    s_and_b32 s73, s73, 0xffff
    s_mov_b32 s74, 0x800000
    s_mov_b32 s75, 0x00020000
    s_add_u32 m0, s77, 0
    s_nop 0
    buffer_load_dwordx4 v64, s[72:75], s76 offen lds
    s_add_u32 m0, s77, 1024
    s_add_u32 s76, s76, 32768
    buffer_load_dwordx4 v64, s[72:75], s76 offen lds
    s_add_u32 m0, s77, 8192
    s_add_u32 s76, s76, 229376
    buffer_load_dwordx4 v64, s[72:75], s76 offen lds
    s_add_u32 m0, s77, 9216
    s_add_u32 s76, s76, 32768
    buffer_load_dwordx4 v64, s[72:75], s76 offen lds
    s_add_u32 m0, s77, 16384
    s_add_u32 s76, s76, 229376
    buffer_load_dwordx4 v64, s[72:75], s76 offen lds
    s_add_u32 m0, s77, 17408
    s_add_u32 s76, s76, 32768
    buffer_load_dwordx4 v64, s[72:75], s76 offen lds
    s_add_u32 m0, s77, 24576
    s_add_u32 s76, s76, 229376
    buffer_load_dwordx4 v64, s[72:75], s76 offen lds
    s_add_u32 m0, s77, 25600
    s_add_u32 s76, s76, 32768
    buffer_load_dwordx4 v64, s[72:75], s76 offen lds
    s_add_u32 m0, s77, 32768
    s_add_u32 s76, s76, 229376
    buffer_load_dwordx4 v64, s[72:75], s76 offen lds
    s_add_u32 m0, s77, 33792
    s_add_u32 s76, s76, 32768
    buffer_load_dwordx4 v64, s[72:75], s76 offen lds
    s_add_u32 m0, s77, 40960
    s_add_u32 s76, s76, 229376
    buffer_load_dwordx4 v64, s[72:75], s76 offen lds
    s_add_u32 m0, s77, 41984
    s_add_u32 s76, s76, 32768
    buffer_load_dwordx4 v64, s[72:75], s76 offen lds
    s_add_u32 m0, s77, 49152
    s_add_u32 s76, s76, 229376
    buffer_load_dwordx4 v64, s[72:75], s76 offen lds
    s_add_u32 m0, s77, 50176
    s_add_u32 s76, s76, 32768
    buffer_load_dwordx4 v64, s[72:75], s76 offen lds
    s_add_u32 m0, s77, 57344
    s_add_u32 s76, s76, 229376
    buffer_load_dwordx4 v64, s[72:75], s76 offen lds
    s_add_u32 m0, s77, 58368
    s_add_u32 s76, s76, 32768
    buffer_load_dwordx4 v64, s[72:75], s76 offen lds
    s_add_u32 m0, s77, 65536
    s_add_u32 s76, s76, 229376
    buffer_load_dwordx4 v64, s[72:75], s76 offen lds
    s_add_u32 m0, s77, 66560
    s_add_u32 s76, s76, 32768
    buffer_load_dwordx4 v64, s[72:75], s76 offen lds
    s_add_u32 m0, s77, 73728
    s_add_u32 s76, s76, 229376
    buffer_load_dwordx4 v64, s[72:75], s76 offen lds
    s_add_u32 m0, s77, 74752
    s_add_u32 s76, s76, 32768
    buffer_load_dwordx4 v64, s[72:75], s76 offen lds
    s_add_u32 m0, s77, 81920
    s_add_u32 s76, s76, 229376
    buffer_load_dwordx4 v64, s[72:75], s76 offen lds
    s_add_u32 m0, s77, 82944
    s_add_u32 s76, s76, 32768
    buffer_load_dwordx4 v64, s[72:75], s76 offen lds
    s_add_u32 m0, s77, 90112
    s_add_u32 s76, s76, 229376
    buffer_load_dwordx4 v64, s[72:75], s76 offen lds
    s_add_u32 m0, s77, 91136
    s_add_u32 s76, s76, 32768
    buffer_load_dwordx4 v64, s[72:75], s76 offen lds
    s_add_u32 m0, s77, 98304
    s_add_u32 s76, s76, 229376
    buffer_load_dwordx4 v64, s[72:75], s76 offen lds
    s_add_u32 m0, s77, 99328
    s_add_u32 s76, s76, 32768
    buffer_load_dwordx4 v64, s[72:75], s76 offen lds
    s_add_u32 m0, s77, 106496
    s_add_u32 s76, s76, 229376
    buffer_load_dwordx4 v64, s[72:75], s76 offen lds
    s_add_u32 m0, s77, 107520
    s_add_u32 s76, s76, 32768
    buffer_load_dwordx4 v64, s[72:75], s76 offen lds
    s_add_u32 m0, s77, 114688
    s_add_u32 s76, s76, 229376
    buffer_load_dwordx4 v64, s[72:75], s76 offen lds
    s_add_u32 m0, s77, 115712
    s_add_u32 s76, s76, 32768
    buffer_load_dwordx4 v64, s[72:75], s76 offen lds
    s_add_u32 m0, s77, 122880
    s_add_u32 s76, s76, 229376
    buffer_load_dwordx4 v64, s[72:75], s76 offen lds
    s_add_u32 m0, s77, 123904
    s_add_u32 s76, s76, 32768
    buffer_load_dwordx4 v64, s[72:75], s76 offen lds
    s_mov_b32 s19, s21
    s_add_u32 s96, s52, 0x4c00000
    s_addc_u32 s97, s53, 0
    s_and_b32 s97, s97, 0xffff
    s_mov_b32 s98, 0x1000000
    s_mov_b32 s99, 0x00020000
    s_mov_b32 s93, 200000
    s_mov_b32 s87, s61
    s_load_dwordx2 s[34:35], s[0:1], 104
    s_lshr_b32 s31, s90, 6
    s_and_b32 s29, s90, 63
    s_lshl_b32 s16, s19, 16
    s_add_u32 s17, s16, 262144
    s_mov_b32 s28, 0
    v_and_b32 v10, 63, v0
    v_bfe_u32 v8, v10, 2, 2
    v_lshrrev_b32 v9, 5, v10
    v_lshl_add_u32 v9, v9, 2, v8
    v_lshlrev_b32 v9, 8, v9
    v_bfe_u32 v11, v10, 4, 1
    v_lshl_add_u32 v9, v11, 5, v9
    v_bfe_u32 v11, v10, 1, 1
    v_lshl_add_u32 v9, v11, 4, v9
    v_and_b32 v11, 1, v10
    v_lshl_add_u32 v9, v11, 3, v9
    v_xor_b32 v66, 0, v8
    v_lshl_add_u32 v66, v66, 6, v9
    v_add_u32 v67, 65536, v66
    v_xor_b32 v68, 1, v8
    v_lshl_add_u32 v68, v68, 6, v9
    v_add_u32 v69, 65536, v68
    v_xor_b32 v70, 2, v8
    v_lshl_add_u32 v70, v70, 6, v9
    v_add_u32 v71, 65536, v70
    v_xor_b32 v72, 3, v8
    v_lshl_add_u32 v72, v72, 6, v9
    v_add_u32 v73, 65536, v72
    s_waitcnt lgkmcnt(0)
    s_mov_b32 s8, s34
    s_mov_b32 s9, s35
    s_and_b32 s9, s9, 0xffff
    s_mov_b32 s10, 0x400000
    s_mov_b32 s11, 0x00020000
    s_mov_b32 s12, s34
    s_mov_b32 s13, s35
    s_and_b32 s13, s13, 0xffff
    s_mov_b32 s14, 0x400000
    s_mov_b32 s15, 0x00020000
    s_add_u32 s18, s16, 0
    buffer_load_dwordx4 a[0:3], v5, s[8:11], s18 offen offset:0
    buffer_load_dwordx4 a[4:7], v5, s[8:11], s18 offen offset:1024
    buffer_load_dwordx4 a[8:11], v5, s[8:11], s18 offen offset:2048
    buffer_load_dwordx4 a[12:15], v5, s[8:11], s18 offen offset:3072
    s_add_u32 s18, s16, 4096
    buffer_load_dwordx4 a[16:19], v5, s[8:11], s18 offen offset:0
    buffer_load_dwordx4 a[20:23], v5, s[8:11], s18 offen offset:1024
    buffer_load_dwordx4 a[24:27], v5, s[8:11], s18 offen offset:2048
    buffer_load_dwordx4 a[28:31], v5, s[8:11], s18 offen offset:3072
    s_add_u32 s18, s16, 8192
    buffer_load_dwordx4 a[32:35], v5, s[8:11], s18 offen offset:0
    buffer_load_dwordx4 a[36:39], v5, s[8:11], s18 offen offset:1024
    buffer_load_dwordx4 a[40:43], v5, s[8:11], s18 offen offset:2048
    buffer_load_dwordx4 a[44:47], v5, s[8:11], s18 offen offset:3072
    s_add_u32 s18, s16, 12288
    buffer_load_dwordx4 a[48:51], v5, s[8:11], s18 offen offset:0
    buffer_load_dwordx4 a[52:55], v5, s[8:11], s18 offen offset:1024
    buffer_load_dwordx4 a[56:59], v5, s[8:11], s18 offen offset:2048
    buffer_load_dwordx4 a[60:63], v5, s[8:11], s18 offen offset:3072
    s_add_u32 s18, s16, 16384
    buffer_load_dwordx4 a[64:67], v5, s[8:11], s18 offen offset:0
    buffer_load_dwordx4 a[68:71], v5, s[8:11], s18 offen offset:1024
    buffer_load_dwordx4 a[72:75], v5, s[8:11], s18 offen offset:2048
    buffer_load_dwordx4 a[76:79], v5, s[8:11], s18 offen offset:3072
    s_add_u32 s18, s16, 20480
    buffer_load_dwordx4 a[80:83], v5, s[8:11], s18 offen offset:0
    buffer_load_dwordx4 a[84:87], v5, s[8:11], s18 offen offset:1024
    buffer_load_dwordx4 a[88:91], v5, s[8:11], s18 offen offset:2048
    buffer_load_dwordx4 a[92:95], v5, s[8:11], s18 offen offset:3072
    s_add_u32 s18, s16, 24576
    buffer_load_dwordx4 a[96:99], v5, s[8:11], s18 offen offset:0
    buffer_load_dwordx4 a[100:103], v5, s[8:11], s18 offen offset:1024
    buffer_load_dwordx4 a[104:107], v5, s[8:11], s18 offen offset:2048
    buffer_load_dwordx4 a[108:111], v5, s[8:11], s18 offen offset:3072
    s_add_u32 s18, s16, 28672
    buffer_load_dwordx4 a[112:115], v5, s[8:11], s18 offen offset:0
    buffer_load_dwordx4 a[116:119], v5, s[8:11], s18 offen offset:1024
    buffer_load_dwordx4 a[120:123], v5, s[8:11], s18 offen offset:2048
    buffer_load_dwordx4 a[124:127], v5, s[8:11], s18 offen offset:3072
    s_add_u32 s18, s16, 32768
    buffer_load_dwordx4 a[128:131], v5, s[8:11], s18 offen offset:0
    buffer_load_dwordx4 a[132:135], v5, s[8:11], s18 offen offset:1024
    buffer_load_dwordx4 a[136:139], v5, s[8:11], s18 offen offset:2048
    buffer_load_dwordx4 a[140:143], v5, s[8:11], s18 offen offset:3072
    s_add_u32 s18, s16, 36864
    buffer_load_dwordx4 a[144:147], v5, s[8:11], s18 offen offset:0
    buffer_load_dwordx4 a[148:151], v5, s[8:11], s18 offen offset:1024
    buffer_load_dwordx4 a[152:155], v5, s[8:11], s18 offen offset:2048
    buffer_load_dwordx4 a[156:159], v5, s[8:11], s18 offen offset:3072
    s_add_u32 s18, s16, 40960
    buffer_load_dwordx4 a[160:163], v5, s[8:11], s18 offen offset:0
    buffer_load_dwordx4 a[164:167], v5, s[8:11], s18 offen offset:1024
    buffer_load_dwordx4 a[168:171], v5, s[8:11], s18 offen offset:2048
    buffer_load_dwordx4 a[172:175], v5, s[8:11], s18 offen offset:3072
    s_add_u32 s18, s16, 45056
    buffer_load_dwordx4 a[176:179], v5, s[8:11], s18 offen offset:0
    buffer_load_dwordx4 a[180:183], v5, s[8:11], s18 offen offset:1024
    buffer_load_dwordx4 a[184:187], v5, s[8:11], s18 offen offset:2048
    buffer_load_dwordx4 a[188:191], v5, s[8:11], s18 offen offset:3072
    s_add_u32 s18, s16, 49152
    buffer_load_dwordx4 a[192:195], v5, s[8:11], s18 offen offset:0
    buffer_load_dwordx4 a[196:199], v5, s[8:11], s18 offen offset:1024
    buffer_load_dwordx4 a[200:203], v5, s[8:11], s18 offen offset:2048
    buffer_load_dwordx4 a[204:207], v5, s[8:11], s18 offen offset:3072
    s_add_u32 s18, s16, 53248
    buffer_load_dwordx4 a[208:211], v5, s[8:11], s18 offen offset:0
    buffer_load_dwordx4 a[212:215], v5, s[8:11], s18 offen offset:1024
    buffer_load_dwordx4 a[216:219], v5, s[8:11], s18 offen offset:2048
    buffer_load_dwordx4 a[220:223], v5, s[8:11], s18 offen offset:3072
    s_add_u32 s18, s16, 57344
    buffer_load_dwordx4 a[224:227], v5, s[8:11], s18 offen offset:0
    buffer_load_dwordx4 a[228:231], v5, s[8:11], s18 offen offset:1024
    buffer_load_dwordx4 a[232:235], v5, s[8:11], s18 offen offset:2048
    buffer_load_dwordx4 a[236:239], v5, s[8:11], s18 offen offset:3072
    s_cmp_eq_u32 s31, 1
    s_mov_b32 s22, 0x400000
    s_cselect_b32 s22, 0x1400000, s22
    s_cmp_eq_u32 s31, 2
    s_cselect_b32 s22, 0x6000000, s22
    s_add_u32 s36, s34, s22
    s_addc_u32 s37, s35, 0
    s_and_b32 s37, s37, 0xffff
    s_mov_b32 s38, 0x1000000
    s_mov_b32 s39, 0x00020000
    s_lshl_b32 s22, s29, 12
    s_lshl_b32 s23, s19, 18
    s_add_u32 s22, s22, s23
    v_add_u32 v74, s22, v5
    s_mov_b32 s20, 0
    s_lshr_b32 s22, s29, 2
    s_lshl_b32 s22, s22, 7
    s_lshl_b32 s23, s31, 2
    s_add_u32 s22, s22, s23
    s_and_b32 s23, s29, 3
    s_add_u32 s22, s22, s23
    s_add_u32 s95, s22, 14688256
    v_mov_b32 v75, 1
    s_waitcnt vmcnt(60)
    s_barrier
    s_cmp_eq_u32 s31, 1
    s_cbranch_scc1 K0_V
    ds_read_b64_tr_b16 v[76:77], v66 offset:0
    ds_read_b64_tr_b16 v[78:79], v66 offset:2048
    ds_read_b64_tr_b16 v[80:81], v68 offset:0
    ds_read_b64_tr_b16 v[82:83], v68 offset:2048
    ds_read_b64_tr_b16 v[84:85], v66 offset:4096
    ds_read_b64_tr_b16 v[86:87], v66 offset:6144
    ds_read_b64_tr_b16 v[88:89], v68 offset:4096
    ds_read_b64_tr_b16 v[90:91], v68 offset:6144
K0A_L:
    s_waitcnt vmcnt(59) lgkmcnt(4)
    v_mfma_f32_32x32x16_bf16 v[108:123], v[76:79], a[0:3], 0
    ds_read_b64_tr_b16 v[92:93], v66 offset:8192
    ds_read_b64_tr_b16 v[94:95], v66 offset:10240
    ds_read_b64_tr_b16 v[96:97], v68 offset:8192
    ds_read_b64_tr_b16 v[98:99], v68 offset:10240
    s_add_u32 s18, s16, 61440
    buffer_load_dwordx4 a[240:243], v5, s[8:11], s18 offen offset:0
    v_mfma_f32_32x32x16_bf16 v[124:139], v[80:83], a[0:3], 0
    s_waitcnt vmcnt(59) lgkmcnt(4)
    v_mfma_f32_32x32x16_bf16 v[108:123], v[84:87], a[4:7], v[108:123]
    ds_read_b64_tr_b16 v[100:101], v66 offset:12288
    ds_read_b64_tr_b16 v[102:103], v66 offset:14336
    ds_read_b64_tr_b16 v[104:105], v68 offset:12288
    ds_read_b64_tr_b16 v[106:107], v68 offset:14336
    buffer_load_dwordx4 a[244:247], v5, s[8:11], s18 offen offset:1024
    v_mfma_f32_32x32x16_bf16 v[124:139], v[88:91], a[4:7], v[124:139]
    s_waitcnt vmcnt(59) lgkmcnt(4)
    v_mfma_f32_32x32x16_bf16 v[108:123], v[92:95], a[8:11], v[108:123]
    ds_read_b64_tr_b16 v[76:77], v66 offset:16384
    ds_read_b64_tr_b16 v[78:79], v66 offset:18432
    ds_read_b64_tr_b16 v[80:81], v68 offset:16384
    ds_read_b64_tr_b16 v[82:83], v68 offset:18432
    buffer_load_dwordx4 a[248:251], v5, s[8:11], s18 offen offset:2048
    v_mfma_f32_32x32x16_bf16 v[124:139], v[96:99], a[8:11], v[124:139]
    s_waitcnt vmcnt(59) lgkmcnt(4)
    v_mfma_f32_32x32x16_bf16 v[108:123], v[100:103], a[12:15], v[108:123]
    ds_read_b64_tr_b16 v[84:85], v66 offset:20480
    ds_read_b64_tr_b16 v[86:87], v66 offset:22528
    ds_read_b64_tr_b16 v[88:89], v68 offset:20480
    ds_read_b64_tr_b16 v[90:91], v68 offset:22528
    buffer_load_dwordx4 a[252:255], v5, s[8:11], s18 offen offset:3072
    v_mfma_f32_32x32x16_bf16 v[124:139], v[104:107], a[12:15], v[124:139]
    s_waitcnt vmcnt(59) lgkmcnt(4)
    v_mfma_f32_32x32x16_bf16 v[108:123], v[76:79], a[16:19], v[108:123]
    ds_read_b64_tr_b16 v[92:93], v66 offset:24576
    ds_read_b64_tr_b16 v[94:95], v66 offset:26624
    ds_read_b64_tr_b16 v[96:97], v68 offset:24576
    ds_read_b64_tr_b16 v[98:99], v68 offset:26624
    s_add_u32 s18, s17, 0
    buffer_load_dwordx4 a[0:3], v5, s[12:15], s18 offen offset:0
    v_mfma_f32_32x32x16_bf16 v[124:139], v[80:83], a[16:19], v[124:139]
    s_waitcnt vmcnt(59) lgkmcnt(4)
    v_mfma_f32_32x32x16_bf16 v[108:123], v[84:87], a[20:23], v[108:123]
    ds_read_b64_tr_b16 v[100:101], v66 offset:28672
    ds_read_b64_tr_b16 v[102:103], v66 offset:30720
    ds_read_b64_tr_b16 v[104:105], v68 offset:28672
    ds_read_b64_tr_b16 v[106:107], v68 offset:30720
    buffer_load_dwordx4 a[4:7], v5, s[12:15], s18 offen offset:1024
    v_mfma_f32_32x32x16_bf16 v[124:139], v[88:91], a[20:23], v[124:139]
    s_waitcnt vmcnt(59) lgkmcnt(4)
    v_mfma_f32_32x32x16_bf16 v[108:123], v[92:95], a[24:27], v[108:123]
    ds_read_b64_tr_b16 v[76:77], v66 offset:32768
    ds_read_b64_tr_b16 v[78:79], v66 offset:34816
    ds_read_b64_tr_b16 v[80:81], v68 offset:32768
    ds_read_b64_tr_b16 v[82:83], v68 offset:34816
    buffer_load_dwordx4 a[8:11], v5, s[12:15], s18 offen offset:2048
    v_mfma_f32_32x32x16_bf16 v[124:139], v[96:99], a[24:27], v[124:139]
    s_waitcnt vmcnt(59) lgkmcnt(4)
    v_mfma_f32_32x32x16_bf16 v[108:123], v[100:103], a[28:31], v[108:123]
    ds_read_b64_tr_b16 v[84:85], v66 offset:36864
    ds_read_b64_tr_b16 v[86:87], v66 offset:38912
    ds_read_b64_tr_b16 v[88:89], v68 offset:36864
    ds_read_b64_tr_b16 v[90:91], v68 offset:38912
    buffer_load_dwordx4 a[12:15], v5, s[12:15], s18 offen offset:3072
    v_mfma_f32_32x32x16_bf16 v[124:139], v[104:107], a[28:31], v[124:139]
    s_waitcnt vmcnt(59) lgkmcnt(4)
    v_mfma_f32_32x32x16_bf16 v[108:123], v[76:79], a[32:35], v[108:123]
    ds_read_b64_tr_b16 v[92:93], v66 offset:40960
    ds_read_b64_tr_b16 v[94:95], v66 offset:43008
    ds_read_b64_tr_b16 v[96:97], v68 offset:40960
    ds_read_b64_tr_b16 v[98:99], v68 offset:43008
    s_add_u32 s18, s17, 4096
    buffer_load_dwordx4 a[16:19], v5, s[12:15], s18 offen offset:0
    v_mfma_f32_32x32x16_bf16 v[124:139], v[80:83], a[32:35], v[124:139]
    s_waitcnt vmcnt(59) lgkmcnt(4)
    v_mfma_f32_32x32x16_bf16 v[108:123], v[84:87], a[36:39], v[108:123]
    ds_read_b64_tr_b16 v[100:101], v66 offset:45056
    ds_read_b64_tr_b16 v[102:103], v66 offset:47104
    ds_read_b64_tr_b16 v[104:105], v68 offset:45056
    ds_read_b64_tr_b16 v[106:107], v68 offset:47104
    buffer_load_dwordx4 a[20:23], v5, s[12:15], s18 offen offset:1024
    v_mfma_f32_32x32x16_bf16 v[124:139], v[88:91], a[36:39], v[124:139]
    s_waitcnt vmcnt(59) lgkmcnt(4)
    v_mfma_f32_32x32x16_bf16 v[108:123], v[92:95], a[40:43], v[108:123]
    ds_read_b64_tr_b16 v[76:77], v66 offset:49152
    ds_read_b64_tr_b16 v[78:79], v66 offset:51200
    ds_read_b64_tr_b16 v[80:81], v68 offset:49152
    ds_read_b64_tr_b16 v[82:83], v68 offset:51200
    buffer_load_dwordx4 a[24:27], v5, s[12:15], s18 offen offset:2048
    v_mfma_f32_32x32x16_bf16 v[124:139], v[96:99], a[40:43], v[124:139]
    s_waitcnt vmcnt(59) lgkmcnt(4)
    v_mfma_f32_32x32x16_bf16 v[108:123], v[100:103], a[44:47], v[108:123]
    ds_read_b64_tr_b16 v[84:85], v66 offset:53248
    ds_read_b64_tr_b16 v[86:87], v66 offset:55296
    ds_read_b64_tr_b16 v[88:89], v68 offset:53248
    ds_read_b64_tr_b16 v[90:91], v68 offset:55296
    buffer_load_dwordx4 a[28:31], v5, s[12:15], s18 offen offset:3072
    v_mfma_f32_32x32x16_bf16 v[124:139], v[104:107], a[44:47], v[124:139]
    s_waitcnt vmcnt(59) lgkmcnt(4)
    v_mfma_f32_32x32x16_bf16 v[108:123], v[76:79], a[48:51], v[108:123]
    ds_read_b64_tr_b16 v[92:93], v66 offset:57344
    ds_read_b64_tr_b16 v[94:95], v66 offset:59392
    ds_read_b64_tr_b16 v[96:97], v68 offset:57344
    ds_read_b64_tr_b16 v[98:99], v68 offset:59392
    s_add_u32 s18, s17, 8192
    buffer_load_dwordx4 a[32:35], v5, s[12:15], s18 offen offset:0
    v_mfma_f32_32x32x16_bf16 v[124:139], v[80:83], a[48:51], v[124:139]
    s_waitcnt vmcnt(59) lgkmcnt(4)
    v_mfma_f32_32x32x16_bf16 v[108:123], v[84:87], a[52:55], v[108:123]
    ds_read_b64_tr_b16 v[100:101], v66 offset:61440
    ds_read_b64_tr_b16 v[102:103], v66 offset:63488
    ds_read_b64_tr_b16 v[104:105], v68 offset:61440
    ds_read_b64_tr_b16 v[106:107], v68 offset:63488
    buffer_load_dwordx4 a[36:39], v5, s[12:15], s18 offen offset:1024
    v_mfma_f32_32x32x16_bf16 v[124:139], v[88:91], a[52:55], v[124:139]
    s_waitcnt vmcnt(59) lgkmcnt(4)
    v_mfma_f32_32x32x16_bf16 v[108:123], v[92:95], a[56:59], v[108:123]
    ds_read_b64_tr_b16 v[76:77], v67 offset:0
    ds_read_b64_tr_b16 v[78:79], v67 offset:2048
    ds_read_b64_tr_b16 v[80:81], v69 offset:0
    ds_read_b64_tr_b16 v[82:83], v69 offset:2048
    buffer_load_dwordx4 a[40:43], v5, s[12:15], s18 offen offset:2048
    v_mfma_f32_32x32x16_bf16 v[124:139], v[96:99], a[56:59], v[124:139]
    s_waitcnt vmcnt(59) lgkmcnt(4)
    v_mfma_f32_32x32x16_bf16 v[108:123], v[100:103], a[60:63], v[108:123]
    ds_read_b64_tr_b16 v[84:85], v67 offset:4096
    ds_read_b64_tr_b16 v[86:87], v67 offset:6144
    ds_read_b64_tr_b16 v[88:89], v69 offset:4096
    ds_read_b64_tr_b16 v[90:91], v69 offset:6144
    buffer_load_dwordx4 a[44:47], v5, s[12:15], s18 offen offset:3072
    v_mfma_f32_32x32x16_bf16 v[124:139], v[104:107], a[60:63], v[124:139]
    s_cmp_eq_u32 s28, 0
    s_cbranch_scc1 K0A_NF
    s_waitcnt vmcnt(16)
    s_barrier
    s_cmp_lg_u32 s19, 0
    s_cbranch_scc1 K0A_F
    s_mov_b64 exec, 1
    buffer_store_byte v75, off, s[96:99], s95 sc1
    s_mov_b64 exec, -1
K0A_F:
    s_add_u32 s95, s95, 2048
K0A_NF:
    s_waitcnt vmcnt(59) lgkmcnt(4)
    v_mfma_f32_32x32x16_bf16 v[108:123], v[76:79], a[64:67], v[108:123]
    ds_read_b64_tr_b16 v[92:93], v67 offset:8192
    ds_read_b64_tr_b16 v[94:95], v67 offset:10240
    ds_read_b64_tr_b16 v[96:97], v69 offset:8192
    ds_read_b64_tr_b16 v[98:99], v69 offset:10240
    s_add_u32 s18, s17, 12288
    buffer_load_dwordx4 a[48:51], v5, s[12:15], s18 offen offset:0
    v_mfma_f32_32x32x16_bf16 v[124:139], v[80:83], a[64:67], v[124:139]
    s_waitcnt vmcnt(59) lgkmcnt(4)
    v_mfma_f32_32x32x16_bf16 v[108:123], v[84:87], a[68:71], v[108:123]
    ds_read_b64_tr_b16 v[100:101], v67 offset:12288
    ds_read_b64_tr_b16 v[102:103], v67 offset:14336
    ds_read_b64_tr_b16 v[104:105], v69 offset:12288
    ds_read_b64_tr_b16 v[106:107], v69 offset:14336
    buffer_load_dwordx4 a[52:55], v5, s[12:15], s18 offen offset:1024
    v_mfma_f32_32x32x16_bf16 v[124:139], v[88:91], a[68:71], v[124:139]
    s_waitcnt vmcnt(59) lgkmcnt(4)
    v_mfma_f32_32x32x16_bf16 v[108:123], v[92:95], a[72:75], v[108:123]
    ds_read_b64_tr_b16 v[76:77], v67 offset:16384
    ds_read_b64_tr_b16 v[78:79], v67 offset:18432
    ds_read_b64_tr_b16 v[80:81], v69 offset:16384
    ds_read_b64_tr_b16 v[82:83], v69 offset:18432
    buffer_load_dwordx4 a[56:59], v5, s[12:15], s18 offen offset:2048
    v_mfma_f32_32x32x16_bf16 v[124:139], v[96:99], a[72:75], v[124:139]
    s_waitcnt vmcnt(59) lgkmcnt(4)
    v_mfma_f32_32x32x16_bf16 v[108:123], v[100:103], a[76:79], v[108:123]
    ds_read_b64_tr_b16 v[84:85], v67 offset:20480
    ds_read_b64_tr_b16 v[86:87], v67 offset:22528
    ds_read_b64_tr_b16 v[88:89], v69 offset:20480
    ds_read_b64_tr_b16 v[90:91], v69 offset:22528
    buffer_load_dwordx4 a[60:63], v5, s[12:15], s18 offen offset:3072
    v_mfma_f32_32x32x16_bf16 v[124:139], v[104:107], a[76:79], v[124:139]
    s_waitcnt vmcnt(59) lgkmcnt(4)
    v_mfma_f32_32x32x16_bf16 v[108:123], v[76:79], a[80:83], v[108:123]
    ds_read_b64_tr_b16 v[92:93], v67 offset:24576
    ds_read_b64_tr_b16 v[94:95], v67 offset:26624
    ds_read_b64_tr_b16 v[96:97], v69 offset:24576
    ds_read_b64_tr_b16 v[98:99], v69 offset:26624
    s_add_u32 s18, s17, 16384
    buffer_load_dwordx4 a[64:67], v5, s[12:15], s18 offen offset:0
    v_mfma_f32_32x32x16_bf16 v[124:139], v[80:83], a[80:83], v[124:139]
    s_waitcnt vmcnt(59) lgkmcnt(4)
    v_mfma_f32_32x32x16_bf16 v[108:123], v[84:87], a[84:87], v[108:123]
    ds_read_b64_tr_b16 v[100:101], v67 offset:28672
    ds_read_b64_tr_b16 v[102:103], v67 offset:30720
    ds_read_b64_tr_b16 v[104:105], v69 offset:28672
    ds_read_b64_tr_b16 v[106:107], v69 offset:30720
    buffer_load_dwordx4 a[68:71], v5, s[12:15], s18 offen offset:1024
    v_mfma_f32_32x32x16_bf16 v[124:139], v[88:91], a[84:87], v[124:139]
    s_waitcnt vmcnt(59) lgkmcnt(4)
    v_mfma_f32_32x32x16_bf16 v[108:123], v[92:95], a[88:91], v[108:123]
    ds_read_b64_tr_b16 v[76:77], v67 offset:32768
    ds_read_b64_tr_b16 v[78:79], v67 offset:34816
    ds_read_b64_tr_b16 v[80:81], v69 offset:32768
    ds_read_b64_tr_b16 v[82:83], v69 offset:34816
    buffer_load_dwordx4 a[72:75], v5, s[12:15], s18 offen offset:2048
    v_mfma_f32_32x32x16_bf16 v[124:139], v[96:99], a[88:91], v[124:139]
    s_waitcnt vmcnt(59) lgkmcnt(4)
    v_mfma_f32_32x32x16_bf16 v[108:123], v[100:103], a[92:95], v[108:123]
    ds_read_b64_tr_b16 v[84:85], v67 offset:36864
    ds_read_b64_tr_b16 v[86:87], v67 offset:38912
    ds_read_b64_tr_b16 v[88:89], v69 offset:36864
    ds_read_b64_tr_b16 v[90:91], v69 offset:38912
    buffer_load_dwordx4 a[76:79], v5, s[12:15], s18 offen offset:3072
    v_mfma_f32_32x32x16_bf16 v[124:139], v[104:107], a[92:95], v[124:139]
    s_waitcnt vmcnt(59) lgkmcnt(4)
    v_mfma_f32_32x32x16_bf16 v[108:123], v[76:79], a[96:99], v[108:123]
    ds_read_b64_tr_b16 v[92:93], v67 offset:40960
    ds_read_b64_tr_b16 v[94:95], v67 offset:43008
    ds_read_b64_tr_b16 v[96:97], v69 offset:40960
    ds_read_b64_tr_b16 v[98:99], v69 offset:43008
    s_add_u32 s18, s17, 20480
    buffer_load_dwordx4 a[80:83], v5, s[12:15], s18 offen offset:0
    v_mfma_f32_32x32x16_bf16 v[124:139], v[80:83], a[96:99], v[124:139]
    s_waitcnt vmcnt(59) lgkmcnt(4)
    v_mfma_f32_32x32x16_bf16 v[108:123], v[84:87], a[100:103], v[108:123]
    ds_read_b64_tr_b16 v[100:101], v67 offset:45056
    ds_read_b64_tr_b16 v[102:103], v67 offset:47104
    ds_read_b64_tr_b16 v[104:105], v69 offset:45056
    ds_read_b64_tr_b16 v[106:107], v69 offset:47104
    buffer_load_dwordx4 a[84:87], v5, s[12:15], s18 offen offset:1024
    v_mfma_f32_32x32x16_bf16 v[124:139], v[88:91], a[100:103], v[124:139]
    s_waitcnt vmcnt(59) lgkmcnt(4)
    v_mfma_f32_32x32x16_bf16 v[108:123], v[92:95], a[104:107], v[108:123]
    ds_read_b64_tr_b16 v[76:77], v67 offset:49152
    ds_read_b64_tr_b16 v[78:79], v67 offset:51200
    ds_read_b64_tr_b16 v[80:81], v69 offset:49152
    ds_read_b64_tr_b16 v[82:83], v69 offset:51200
    buffer_load_dwordx4 a[88:91], v5, s[12:15], s18 offen offset:2048
    v_mfma_f32_32x32x16_bf16 v[124:139], v[96:99], a[104:107], v[124:139]
    s_waitcnt vmcnt(59) lgkmcnt(4)
    v_mfma_f32_32x32x16_bf16 v[108:123], v[100:103], a[108:111], v[108:123]
    ds_read_b64_tr_b16 v[84:85], v67 offset:53248
    ds_read_b64_tr_b16 v[86:87], v67 offset:55296
    ds_read_b64_tr_b16 v[88:89], v69 offset:53248
    ds_read_b64_tr_b16 v[90:91], v69 offset:55296
    buffer_load_dwordx4 a[92:95], v5, s[12:15], s18 offen offset:3072
    v_mfma_f32_32x32x16_bf16 v[124:139], v[104:107], a[108:111], v[124:139]
    s_waitcnt vmcnt(59) lgkmcnt(4)
    v_mfma_f32_32x32x16_bf16 v[108:123], v[76:79], a[112:115], v[108:123]
    ds_read_b64_tr_b16 v[92:93], v67 offset:57344
    ds_read_b64_tr_b16 v[94:95], v67 offset:59392
    ds_read_b64_tr_b16 v[96:97], v69 offset:57344
    ds_read_b64_tr_b16 v[98:99], v69 offset:59392
    s_add_u32 s18, s17, 24576
    buffer_load_dwordx4 a[96:99], v5, s[12:15], s18 offen offset:0
    v_mfma_f32_32x32x16_bf16 v[124:139], v[80:83], a[112:115], v[124:139]
    s_waitcnt vmcnt(59) lgkmcnt(4)
    v_mfma_f32_32x32x16_bf16 v[108:123], v[84:87], a[116:119], v[108:123]
    ds_read_b64_tr_b16 v[100:101], v67 offset:61440
    ds_read_b64_tr_b16 v[102:103], v67 offset:63488
    ds_read_b64_tr_b16 v[104:105], v69 offset:61440
    ds_read_b64_tr_b16 v[106:107], v69 offset:63488
    buffer_load_dwordx4 a[100:103], v5, s[12:15], s18 offen offset:1024
    v_mfma_f32_32x32x16_bf16 v[124:139], v[88:91], a[116:119], v[124:139]
    s_waitcnt vmcnt(59) lgkmcnt(4)
    v_mfma_f32_32x32x16_bf16 v[108:123], v[92:95], a[120:123], v[108:123]
    ds_read_b64_tr_b16 v[76:77], v70 offset:0
    ds_read_b64_tr_b16 v[78:79], v70 offset:2048
    ds_read_b64_tr_b16 v[80:81], v72 offset:0
    ds_read_b64_tr_b16 v[82:83], v72 offset:2048
    buffer_load_dwordx4 a[104:107], v5, s[12:15], s18 offen offset:2048
    v_mfma_f32_32x32x16_bf16 v[124:139], v[96:99], a[120:123], v[124:139]
    s_waitcnt vmcnt(59) lgkmcnt(4)
    v_mfma_f32_32x32x16_bf16 v[108:123], v[100:103], a[124:127], v[108:123]
    ds_read_b64_tr_b16 v[84:85], v70 offset:4096
    ds_read_b64_tr_b16 v[86:87], v70 offset:6144
    ds_read_b64_tr_b16 v[88:89], v72 offset:4096
    ds_read_b64_tr_b16 v[90:91], v72 offset:6144
    buffer_load_dwordx4 a[108:111], v5, s[12:15], s18 offen offset:3072
    v_mfma_f32_32x32x16_bf16 v[124:139], v[104:107], a[124:127], v[124:139]
    s_waitcnt vmcnt(59) lgkmcnt(4)
    v_mfma_f32_32x32x16_bf16 v[108:123], v[76:79], a[128:131], v[108:123]
    ds_read_b64_tr_b16 v[92:93], v70 offset:8192
    ds_read_b64_tr_b16 v[94:95], v70 offset:10240
    ds_read_b64_tr_b16 v[96:97], v72 offset:8192
    ds_read_b64_tr_b16 v[98:99], v72 offset:10240
    s_add_u32 s18, s17, 28672
    buffer_load_dwordx4 a[112:115], v5, s[12:15], s18 offen offset:0
    v_mfma_f32_32x32x16_bf16 v[124:139], v[80:83], a[128:131], v[124:139]
    s_waitcnt vmcnt(59) lgkmcnt(4)
    v_mfma_f32_32x32x16_bf16 v[108:123], v[84:87], a[132:135], v[108:123]
    ds_read_b64_tr_b16 v[100:101], v70 offset:12288
    ds_read_b64_tr_b16 v[102:103], v70 offset:14336
    ds_read_b64_tr_b16 v[104:105], v72 offset:12288
    ds_read_b64_tr_b16 v[106:107], v72 offset:14336
    buffer_load_dwordx4 a[116:119], v5, s[12:15], s18 offen offset:1024
    v_mfma_f32_32x32x16_bf16 v[124:139], v[88:91], a[132:135], v[124:139]
    s_waitcnt vmcnt(59) lgkmcnt(4)
    v_mfma_f32_32x32x16_bf16 v[108:123], v[92:95], a[136:139], v[108:123]
    ds_read_b64_tr_b16 v[76:77], v70 offset:16384
    ds_read_b64_tr_b16 v[78:79], v70 offset:18432
    ds_read_b64_tr_b16 v[80:81], v72 offset:16384
    ds_read_b64_tr_b16 v[82:83], v72 offset:18432
    buffer_load_dwordx4 a[120:123], v5, s[12:15], s18 offen offset:2048
    v_mfma_f32_32x32x16_bf16 v[124:139], v[96:99], a[136:139], v[124:139]
    s_waitcnt vmcnt(59) lgkmcnt(4)
    v_mfma_f32_32x32x16_bf16 v[108:123], v[100:103], a[140:143], v[108:123]
    ds_read_b64_tr_b16 v[84:85], v70 offset:20480
    ds_read_b64_tr_b16 v[86:87], v70 offset:22528
    ds_read_b64_tr_b16 v[88:89], v72 offset:20480
    ds_read_b64_tr_b16 v[90:91], v72 offset:22528
    buffer_load_dwordx4 a[124:127], v5, s[12:15], s18 offen offset:3072
    v_mfma_f32_32x32x16_bf16 v[124:139], v[104:107], a[140:143], v[124:139]
    s_waitcnt vmcnt(59) lgkmcnt(4)
    v_mfma_f32_32x32x16_bf16 v[108:123], v[76:79], a[144:147], v[108:123]
    ds_read_b64_tr_b16 v[92:93], v70 offset:24576
    ds_read_b64_tr_b16 v[94:95], v70 offset:26624
    ds_read_b64_tr_b16 v[96:97], v72 offset:24576
    ds_read_b64_tr_b16 v[98:99], v72 offset:26624
    s_add_u32 s18, s17, 32768
    buffer_load_dwordx4 a[128:131], v5, s[12:15], s18 offen offset:0
    v_mfma_f32_32x32x16_bf16 v[124:139], v[80:83], a[144:147], v[124:139]
    s_waitcnt vmcnt(59) lgkmcnt(4)
    v_mfma_f32_32x32x16_bf16 v[108:123], v[84:87], a[148:151], v[108:123]
    ds_read_b64_tr_b16 v[100:101], v70 offset:28672
    ds_read_b64_tr_b16 v[102:103], v70 offset:30720
    ds_read_b64_tr_b16 v[104:105], v72 offset:28672
    ds_read_b64_tr_b16 v[106:107], v72 offset:30720
    buffer_load_dwordx4 a[132:135], v5, s[12:15], s18 offen offset:1024
    v_mfma_f32_32x32x16_bf16 v[124:139], v[88:91], a[148:151], v[124:139]
    s_waitcnt vmcnt(59) lgkmcnt(4)
    v_mfma_f32_32x32x16_bf16 v[108:123], v[92:95], a[152:155], v[108:123]
    ds_read_b64_tr_b16 v[76:77], v70 offset:32768
    ds_read_b64_tr_b16 v[78:79], v70 offset:34816
    ds_read_b64_tr_b16 v[80:81], v72 offset:32768
    ds_read_b64_tr_b16 v[82:83], v72 offset:34816
    buffer_load_dwordx4 a[136:139], v5, s[12:15], s18 offen offset:2048
    v_mfma_f32_32x32x16_bf16 v[124:139], v[96:99], a[152:155], v[124:139]
    s_waitcnt vmcnt(59) lgkmcnt(4)
    v_mfma_f32_32x32x16_bf16 v[108:123], v[100:103], a[156:159], v[108:123]
    ds_read_b64_tr_b16 v[84:85], v70 offset:36864
    ds_read_b64_tr_b16 v[86:87], v70 offset:38912
    ds_read_b64_tr_b16 v[88:89], v72 offset:36864
    ds_read_b64_tr_b16 v[90:91], v72 offset:38912
    buffer_load_dwordx4 a[140:143], v5, s[12:15], s18 offen offset:3072
    v_mfma_f32_32x32x16_bf16 v[124:139], v[104:107], a[156:159], v[124:139]
    s_waitcnt vmcnt(59) lgkmcnt(4)
    v_mfma_f32_32x32x16_bf16 v[108:123], v[76:79], a[160:163], v[108:123]
    ds_read_b64_tr_b16 v[92:93], v70 offset:40960
    ds_read_b64_tr_b16 v[94:95], v70 offset:43008
    ds_read_b64_tr_b16 v[96:97], v72 offset:40960
    ds_read_b64_tr_b16 v[98:99], v72 offset:43008
    s_add_u32 s18, s17, 36864
    buffer_load_dwordx4 a[144:147], v5, s[12:15], s18 offen offset:0
    v_mfma_f32_32x32x16_bf16 v[124:139], v[80:83], a[160:163], v[124:139]
    s_waitcnt vmcnt(59) lgkmcnt(4)
    v_mfma_f32_32x32x16_bf16 v[108:123], v[84:87], a[164:167], v[108:123]
    ds_read_b64_tr_b16 v[100:101], v70 offset:45056
    ds_read_b64_tr_b16 v[102:103], v70 offset:47104
    ds_read_b64_tr_b16 v[104:105], v72 offset:45056
    ds_read_b64_tr_b16 v[106:107], v72 offset:47104
    buffer_load_dwordx4 a[148:151], v5, s[12:15], s18 offen offset:1024
    v_mfma_f32_32x32x16_bf16 v[124:139], v[88:91], a[164:167], v[124:139]
    s_waitcnt vmcnt(59) lgkmcnt(4)
    v_mfma_f32_32x32x16_bf16 v[108:123], v[92:95], a[168:171], v[108:123]
    ds_read_b64_tr_b16 v[76:77], v70 offset:49152
    ds_read_b64_tr_b16 v[78:79], v70 offset:51200
    ds_read_b64_tr_b16 v[80:81], v72 offset:49152
    ds_read_b64_tr_b16 v[82:83], v72 offset:51200
    buffer_load_dwordx4 a[152:155], v5, s[12:15], s18 offen offset:2048
    v_mfma_f32_32x32x16_bf16 v[124:139], v[96:99], a[168:171], v[124:139]
    s_waitcnt vmcnt(59) lgkmcnt(4)
    v_mfma_f32_32x32x16_bf16 v[108:123], v[100:103], a[172:175], v[108:123]
    ds_read_b64_tr_b16 v[84:85], v70 offset:53248
    ds_read_b64_tr_b16 v[86:87], v70 offset:55296
    ds_read_b64_tr_b16 v[88:89], v72 offset:53248
    ds_read_b64_tr_b16 v[90:91], v72 offset:55296
    buffer_load_dwordx4 a[156:159], v5, s[12:15], s18 offen offset:3072
    v_mfma_f32_32x32x16_bf16 v[124:139], v[104:107], a[172:175], v[124:139]
    s_waitcnt vmcnt(59) lgkmcnt(4)
    v_mfma_f32_32x32x16_bf16 v[108:123], v[76:79], a[176:179], v[108:123]
    ds_read_b64_tr_b16 v[92:93], v70 offset:57344
    ds_read_b64_tr_b16 v[94:95], v70 offset:59392
    ds_read_b64_tr_b16 v[96:97], v72 offset:57344
    ds_read_b64_tr_b16 v[98:99], v72 offset:59392
    s_add_u32 s18, s17, 40960
    buffer_load_dwordx4 a[160:163], v5, s[12:15], s18 offen offset:0
    v_mfma_f32_32x32x16_bf16 v[124:139], v[80:83], a[176:179], v[124:139]
    s_waitcnt vmcnt(59) lgkmcnt(4)
    v_mfma_f32_32x32x16_bf16 v[108:123], v[84:87], a[180:183], v[108:123]
    ds_read_b64_tr_b16 v[100:101], v70 offset:61440
    ds_read_b64_tr_b16 v[102:103], v70 offset:63488
    ds_read_b64_tr_b16 v[104:105], v72 offset:61440
    ds_read_b64_tr_b16 v[106:107], v72 offset:63488
    buffer_load_dwordx4 a[164:167], v5, s[12:15], s18 offen offset:1024
    v_mfma_f32_32x32x16_bf16 v[124:139], v[88:91], a[180:183], v[124:139]
    s_waitcnt vmcnt(59) lgkmcnt(4)
    v_mfma_f32_32x32x16_bf16 v[108:123], v[92:95], a[184:187], v[108:123]
    ds_read_b64_tr_b16 v[76:77], v71 offset:0
    ds_read_b64_tr_b16 v[78:79], v71 offset:2048
    ds_read_b64_tr_b16 v[80:81], v73 offset:0
    ds_read_b64_tr_b16 v[82:83], v73 offset:2048
    buffer_load_dwordx4 a[168:171], v5, s[12:15], s18 offen offset:2048
    v_mfma_f32_32x32x16_bf16 v[124:139], v[96:99], a[184:187], v[124:139]
    s_waitcnt vmcnt(59) lgkmcnt(4)
    v_mfma_f32_32x32x16_bf16 v[108:123], v[100:103], a[188:191], v[108:123]
    ds_read_b64_tr_b16 v[84:85], v71 offset:4096
    ds_read_b64_tr_b16 v[86:87], v71 offset:6144
    ds_read_b64_tr_b16 v[88:89], v73 offset:4096
    ds_read_b64_tr_b16 v[90:91], v73 offset:6144
    buffer_load_dwordx4 a[172:175], v5, s[12:15], s18 offen offset:3072
    v_mfma_f32_32x32x16_bf16 v[124:139], v[104:107], a[188:191], v[124:139]
    s_waitcnt vmcnt(59) lgkmcnt(4)
    v_mfma_f32_32x32x16_bf16 v[108:123], v[76:79], a[192:195], v[108:123]
    ds_read_b64_tr_b16 v[92:93], v71 offset:8192
    ds_read_b64_tr_b16 v[94:95], v71 offset:10240
    ds_read_b64_tr_b16 v[96:97], v73 offset:8192
    ds_read_b64_tr_b16 v[98:99], v73 offset:10240
    s_add_u32 s18, s17, 45056
    buffer_load_dwordx4 a[176:179], v5, s[12:15], s18 offen offset:0
    v_mfma_f32_32x32x16_bf16 v[124:139], v[80:83], a[192:195], v[124:139]
    s_waitcnt vmcnt(59) lgkmcnt(4)
    v_mfma_f32_32x32x16_bf16 v[108:123], v[84:87], a[196:199], v[108:123]
    ds_read_b64_tr_b16 v[100:101], v71 offset:12288
    ds_read_b64_tr_b16 v[102:103], v71 offset:14336
    ds_read_b64_tr_b16 v[104:105], v73 offset:12288
    ds_read_b64_tr_b16 v[106:107], v73 offset:14336
    buffer_load_dwordx4 a[180:183], v5, s[12:15], s18 offen offset:1024
    v_mfma_f32_32x32x16_bf16 v[124:139], v[88:91], a[196:199], v[124:139]
    s_waitcnt vmcnt(59) lgkmcnt(4)
    v_mfma_f32_32x32x16_bf16 v[108:123], v[92:95], a[200:203], v[108:123]
    ds_read_b64_tr_b16 v[76:77], v71 offset:16384
    ds_read_b64_tr_b16 v[78:79], v71 offset:18432
    ds_read_b64_tr_b16 v[80:81], v73 offset:16384
    ds_read_b64_tr_b16 v[82:83], v73 offset:18432
    buffer_load_dwordx4 a[184:187], v5, s[12:15], s18 offen offset:2048
    v_mfma_f32_32x32x16_bf16 v[124:139], v[96:99], a[200:203], v[124:139]
    s_waitcnt vmcnt(59) lgkmcnt(4)
    v_mfma_f32_32x32x16_bf16 v[108:123], v[100:103], a[204:207], v[108:123]
    ds_read_b64_tr_b16 v[84:85], v71 offset:20480
    ds_read_b64_tr_b16 v[86:87], v71 offset:22528
    ds_read_b64_tr_b16 v[88:89], v73 offset:20480
    ds_read_b64_tr_b16 v[90:91], v73 offset:22528
    buffer_load_dwordx4 a[188:191], v5, s[12:15], s18 offen offset:3072
    v_mfma_f32_32x32x16_bf16 v[124:139], v[104:107], a[204:207], v[124:139]
    s_waitcnt vmcnt(59) lgkmcnt(4)
    v_mfma_f32_32x32x16_bf16 v[108:123], v[76:79], a[208:211], v[108:123]
    ds_read_b64_tr_b16 v[92:93], v71 offset:24576
    ds_read_b64_tr_b16 v[94:95], v71 offset:26624
    ds_read_b64_tr_b16 v[96:97], v73 offset:24576
    ds_read_b64_tr_b16 v[98:99], v73 offset:26624
    s_add_u32 s18, s17, 49152
    buffer_load_dwordx4 a[192:195], v5, s[12:15], s18 offen offset:0
    v_mfma_f32_32x32x16_bf16 v[124:139], v[80:83], a[208:211], v[124:139]
    s_waitcnt vmcnt(59) lgkmcnt(4)
    v_mfma_f32_32x32x16_bf16 v[108:123], v[84:87], a[212:215], v[108:123]
    ds_read_b64_tr_b16 v[100:101], v71 offset:28672
    ds_read_b64_tr_b16 v[102:103], v71 offset:30720
    ds_read_b64_tr_b16 v[104:105], v73 offset:28672
    ds_read_b64_tr_b16 v[106:107], v73 offset:30720
    buffer_load_dwordx4 a[196:199], v5, s[12:15], s18 offen offset:1024
    v_mfma_f32_32x32x16_bf16 v[124:139], v[88:91], a[212:215], v[124:139]
    s_waitcnt vmcnt(59) lgkmcnt(4)
    v_mfma_f32_32x32x16_bf16 v[108:123], v[92:95], a[216:219], v[108:123]
    ds_read_b64_tr_b16 v[76:77], v71 offset:32768
    ds_read_b64_tr_b16 v[78:79], v71 offset:34816
    ds_read_b64_tr_b16 v[80:81], v73 offset:32768
    ds_read_b64_tr_b16 v[82:83], v73 offset:34816
    buffer_load_dwordx4 a[200:203], v5, s[12:15], s18 offen offset:2048
    v_mfma_f32_32x32x16_bf16 v[124:139], v[96:99], a[216:219], v[124:139]
    s_waitcnt vmcnt(59) lgkmcnt(4)
    v_mfma_f32_32x32x16_bf16 v[108:123], v[100:103], a[220:223], v[108:123]
    ds_read_b64_tr_b16 v[84:85], v71 offset:36864
    ds_read_b64_tr_b16 v[86:87], v71 offset:38912
    ds_read_b64_tr_b16 v[88:89], v73 offset:36864
    ds_read_b64_tr_b16 v[90:91], v73 offset:38912
    buffer_load_dwordx4 a[204:207], v5, s[12:15], s18 offen offset:3072
    v_mfma_f32_32x32x16_bf16 v[124:139], v[104:107], a[220:223], v[124:139]
    s_waitcnt vmcnt(59) lgkmcnt(4)
    v_mfma_f32_32x32x16_bf16 v[108:123], v[76:79], a[224:227], v[108:123]
    ds_read_b64_tr_b16 v[92:93], v71 offset:40960
    ds_read_b64_tr_b16 v[94:95], v71 offset:43008
    ds_read_b64_tr_b16 v[96:97], v73 offset:40960
    ds_read_b64_tr_b16 v[98:99], v73 offset:43008
    s_add_u32 s18, s17, 53248
    buffer_load_dwordx4 a[208:211], v5, s[12:15], s18 offen offset:0
    v_mfma_f32_32x32x16_bf16 v[124:139], v[80:83], a[224:227], v[124:139]
    s_waitcnt vmcnt(59) lgkmcnt(4)
    v_mfma_f32_32x32x16_bf16 v[108:123], v[84:87], a[228:231], v[108:123]
    ds_read_b64_tr_b16 v[100:101], v71 offset:45056
    ds_read_b64_tr_b16 v[102:103], v71 offset:47104
    ds_read_b64_tr_b16 v[104:105], v73 offset:45056
    ds_read_b64_tr_b16 v[106:107], v73 offset:47104
    buffer_load_dwordx4 a[212:215], v5, s[12:15], s18 offen offset:1024
    v_mfma_f32_32x32x16_bf16 v[124:139], v[88:91], a[228:231], v[124:139]
    s_waitcnt vmcnt(59) lgkmcnt(4)
    v_mfma_f32_32x32x16_bf16 v[108:123], v[92:95], a[232:235], v[108:123]
    ds_read_b64_tr_b16 v[76:77], v71 offset:49152
    ds_read_b64_tr_b16 v[78:79], v71 offset:51200
    ds_read_b64_tr_b16 v[80:81], v73 offset:49152
    ds_read_b64_tr_b16 v[82:83], v73 offset:51200
    buffer_load_dwordx4 a[216:219], v5, s[12:15], s18 offen offset:2048
    v_mfma_f32_32x32x16_bf16 v[124:139], v[96:99], a[232:235], v[124:139]
    s_waitcnt vmcnt(59) lgkmcnt(4)
    v_mfma_f32_32x32x16_bf16 v[108:123], v[100:103], a[236:239], v[108:123]
    ds_read_b64_tr_b16 v[84:85], v71 offset:53248
    ds_read_b64_tr_b16 v[86:87], v71 offset:55296
    ds_read_b64_tr_b16 v[88:89], v73 offset:53248
    ds_read_b64_tr_b16 v[90:91], v73 offset:55296
    buffer_load_dwordx4 a[220:223], v5, s[12:15], s18 offen offset:3072
    v_mfma_f32_32x32x16_bf16 v[124:139], v[104:107], a[236:239], v[124:139]
    s_waitcnt vmcnt(59) lgkmcnt(4)
    v_mfma_f32_32x32x16_bf16 v[108:123], v[76:79], a[240:243], v[108:123]
    ds_read_b64_tr_b16 v[92:93], v71 offset:57344
    ds_read_b64_tr_b16 v[94:95], v71 offset:59392
    ds_read_b64_tr_b16 v[96:97], v73 offset:57344
    ds_read_b64_tr_b16 v[98:99], v73 offset:59392
    s_add_u32 s18, s17, 57344
    buffer_load_dwordx4 a[224:227], v5, s[12:15], s18 offen offset:0
    v_mfma_f32_32x32x16_bf16 v[124:139], v[80:83], a[240:243], v[124:139]
    s_waitcnt vmcnt(59) lgkmcnt(4)
    v_mfma_f32_32x32x16_bf16 v[108:123], v[84:87], a[244:247], v[108:123]
    ds_read_b64_tr_b16 v[100:101], v71 offset:61440
    ds_read_b64_tr_b16 v[102:103], v71 offset:63488
    ds_read_b64_tr_b16 v[104:105], v73 offset:61440
    ds_read_b64_tr_b16 v[106:107], v73 offset:63488
    buffer_load_dwordx4 a[228:231], v5, s[12:15], s18 offen offset:1024
    v_mfma_f32_32x32x16_bf16 v[124:139], v[88:91], a[244:247], v[124:139]
    s_waitcnt vmcnt(59) lgkmcnt(4)
    v_mfma_f32_32x32x16_bf16 v[108:123], v[92:95], a[248:251], v[108:123]
    ds_read_b64_tr_b16 v[76:77], v66 offset:0
    ds_read_b64_tr_b16 v[78:79], v66 offset:2048
    ds_read_b64_tr_b16 v[80:81], v68 offset:0
    ds_read_b64_tr_b16 v[82:83], v68 offset:2048
    buffer_load_dwordx4 a[232:235], v5, s[12:15], s18 offen offset:2048
    v_mfma_f32_32x32x16_bf16 v[124:139], v[96:99], a[248:251], v[124:139]
    s_waitcnt vmcnt(59) lgkmcnt(4)
    v_mfma_f32_32x32x16_bf16 v[108:123], v[100:103], a[252:255], v[108:123]
    ds_read_b64_tr_b16 v[84:85], v66 offset:4096
    ds_read_b64_tr_b16 v[86:87], v66 offset:6144
    ds_read_b64_tr_b16 v[88:89], v68 offset:4096
    ds_read_b64_tr_b16 v[90:91], v68 offset:6144
    buffer_load_dwordx4 a[236:239], v5, s[12:15], s18 offen offset:3072
    v_mfma_f32_32x32x16_bf16 v[124:139], v[104:107], a[252:255], v[124:139]
    s_nop 7
    s_nop 7
    v_cvt_pk_bf16_f32 v140, v108, v109
    v_cvt_pk_bf16_f32 v141, v110, v111
    v_cvt_pk_bf16_f32 v142, v112, v113
    v_cvt_pk_bf16_f32 v143, v114, v115
    v_cvt_pk_bf16_f32 v144, v116, v117
    v_cvt_pk_bf16_f32 v145, v118, v119
    v_cvt_pk_bf16_f32 v146, v120, v121
    v_cvt_pk_bf16_f32 v147, v122, v123
    buffer_store_dwordx4 v[140:143], v74, s[36:39], s20 offen offset:0 sc1
    buffer_store_dwordx4 v[144:147], v74, s[36:39], s20 offen offset:1024 sc1
    v_cvt_pk_bf16_f32 v148, v124, v125
    v_cvt_pk_bf16_f32 v149, v126, v127
    v_cvt_pk_bf16_f32 v150, v128, v129
    v_cvt_pk_bf16_f32 v151, v130, v131
    v_cvt_pk_bf16_f32 v152, v132, v133
    v_cvt_pk_bf16_f32 v153, v134, v135
    v_cvt_pk_bf16_f32 v154, v136, v137
    v_cvt_pk_bf16_f32 v155, v138, v139
    buffer_store_dwordx4 v[148:151], v74, s[36:39], s20 offen offset:2048 sc1
    buffer_store_dwordx4 v[152:155], v74, s[36:39], s20 offen offset:3072 sc1
    s_add_u32 s20, s20, 1048576
    s_add_u32 s16, s16, 262144
    s_add_u32 s17, s17, 262144
    s_add_u32 s28, s28, 1
    s_cmp_eq_u32 s28, 3
    s_cselect_b32 s14, 0, s14
    s_cmp_lt_u32 s28, 4
    s_cbranch_scc1 K0A_L
    s_waitcnt vmcnt(0) lgkmcnt(0)
    s_barrier
    s_cmp_lg_u32 s19, 0
    s_cbranch_scc1 K0A_G
    s_mov_b64 exec, 1
    buffer_store_byte v75, off, s[96:99], s95 sc1
    s_mov_b64 exec, -1
K0A_G:
    s_add_u32 s95, s95, 2048
    s_branch K0_END
K0_V:
    ds_read_b64_tr_b16 v[76:77], v66 offset:0
    ds_read_b64_tr_b16 v[78:79], v66 offset:2048
    ds_read_b64_tr_b16 v[80:81], v68 offset:0
    ds_read_b64_tr_b16 v[82:83], v68 offset:2048
    ds_read_b64_tr_b16 v[84:85], v66 offset:4096
    ds_read_b64_tr_b16 v[86:87], v66 offset:6144
    ds_read_b64_tr_b16 v[88:89], v68 offset:4096
    ds_read_b64_tr_b16 v[90:91], v68 offset:6144
K0B_L:
    s_waitcnt vmcnt(59) lgkmcnt(4)
    v_mfma_f32_32x32x16_bf16 v[108:123], a[0:3], v[76:79], 0
    ds_read_b64_tr_b16 v[92:93], v66 offset:8192
    ds_read_b64_tr_b16 v[94:95], v66 offset:10240
    ds_read_b64_tr_b16 v[96:97], v68 offset:8192
    ds_read_b64_tr_b16 v[98:99], v68 offset:10240
    s_add_u32 s18, s16, 61440
    buffer_load_dwordx4 a[240:243], v5, s[8:11], s18 offen offset:0
    v_mfma_f32_32x32x16_bf16 v[124:139], a[0:3], v[80:83], 0
    s_waitcnt vmcnt(59) lgkmcnt(4)
    v_mfma_f32_32x32x16_bf16 v[108:123], a[4:7], v[84:87], v[108:123]
    ds_read_b64_tr_b16 v[100:101], v66 offset:12288
    ds_read_b64_tr_b16 v[102:103], v66 offset:14336
    ds_read_b64_tr_b16 v[104:105], v68 offset:12288
    ds_read_b64_tr_b16 v[106:107], v68 offset:14336
    buffer_load_dwordx4 a[244:247], v5, s[8:11], s18 offen offset:1024
    v_mfma_f32_32x32x16_bf16 v[124:139], a[4:7], v[88:91], v[124:139]
    s_waitcnt vmcnt(59) lgkmcnt(4)
    v_mfma_f32_32x32x16_bf16 v[108:123], a[8:11], v[92:95], v[108:123]
    ds_read_b64_tr_b16 v[76:77], v66 offset:16384
    ds_read_b64_tr_b16 v[78:79], v66 offset:18432
    ds_read_b64_tr_b16 v[80:81], v68 offset:16384
    ds_read_b64_tr_b16 v[82:83], v68 offset:18432
    buffer_load_dwordx4 a[248:251], v5, s[8:11], s18 offen offset:2048
    v_mfma_f32_32x32x16_bf16 v[124:139], a[8:11], v[96:99], v[124:139]
    s_waitcnt vmcnt(59) lgkmcnt(4)
    v_mfma_f32_32x32x16_bf16 v[108:123], a[12:15], v[100:103], v[108:123]
    ds_read_b64_tr_b16 v[84:85], v66 offset:20480
    ds_read_b64_tr_b16 v[86:87], v66 offset:22528
    ds_read_b64_tr_b16 v[88:89], v68 offset:20480
    ds_read_b64_tr_b16 v[90:91], v68 offset:22528
    buffer_load_dwordx4 a[252:255], v5, s[8:11], s18 offen offset:3072
    v_mfma_f32_32x32x16_bf16 v[124:139], a[12:15], v[104:107], v[124:139]
    s_waitcnt vmcnt(59) lgkmcnt(4)
    v_mfma_f32_32x32x16_bf16 v[108:123], a[16:19], v[76:79], v[108:123]
    ds_read_b64_tr_b16 v[92:93], v66 offset:24576
    ds_read_b64_tr_b16 v[94:95], v66 offset:26624
    ds_read_b64_tr_b16 v[96:97], v68 offset:24576
    ds_read_b64_tr_b16 v[98:99], v68 offset:26624
    s_add_u32 s18, s17, 0
    buffer_load_dwordx4 a[0:3], v5, s[12:15], s18 offen offset:0
    v_mfma_f32_32x32x16_bf16 v[124:139], a[16:19], v[80:83], v[124:139]
    s_waitcnt vmcnt(59) lgkmcnt(4)
    v_mfma_f32_32x32x16_bf16 v[108:123], a[20:23], v[84:87], v[108:123]
    ds_read_b64_tr_b16 v[100:101], v66 offset:28672
    ds_read_b64_tr_b16 v[102:103], v66 offset:30720
    ds_read_b64_tr_b16 v[104:105], v68 offset:28672
    ds_read_b64_tr_b16 v[106:107], v68 offset:30720
    buffer_load_dwordx4 a[4:7], v5, s[12:15], s18 offen offset:1024
    v_mfma_f32_32x32x16_bf16 v[124:139], a[20:23], v[88:91], v[124:139]
    s_waitcnt vmcnt(59) lgkmcnt(4)
    v_mfma_f32_32x32x16_bf16 v[108:123], a[24:27], v[92:95], v[108:123]
    ds_read_b64_tr_b16 v[76:77], v66 offset:32768
    ds_read_b64_tr_b16 v[78:79], v66 offset:34816
    ds_read_b64_tr_b16 v[80:81], v68 offset:32768
    ds_read_b64_tr_b16 v[82:83], v68 offset:34816
    buffer_load_dwordx4 a[8:11], v5, s[12:15], s18 offen offset:2048
    v_mfma_f32_32x32x16_bf16 v[124:139], a[24:27], v[96:99], v[124:139]
    s_waitcnt vmcnt(59) lgkmcnt(4)
    v_mfma_f32_32x32x16_bf16 v[108:123], a[28:31], v[100:103], v[108:123]
    ds_read_b64_tr_b16 v[84:85], v66 offset:36864
    ds_read_b64_tr_b16 v[86:87], v66 offset:38912
    ds_read_b64_tr_b16 v[88:89], v68 offset:36864
    ds_read_b64_tr_b16 v[90:91], v68 offset:38912
    buffer_load_dwordx4 a[12:15], v5, s[12:15], s18 offen offset:3072
    v_mfma_f32_32x32x16_bf16 v[124:139], a[28:31], v[104:107], v[124:139]
    s_waitcnt vmcnt(59) lgkmcnt(4)
    v_mfma_f32_32x32x16_bf16 v[108:123], a[32:35], v[76:79], v[108:123]
    ds_read_b64_tr_b16 v[92:93], v66 offset:40960
    ds_read_b64_tr_b16 v[94:95], v66 offset:43008
    ds_read_b64_tr_b16 v[96:97], v68 offset:40960
    ds_read_b64_tr_b16 v[98:99], v68 offset:43008
    s_add_u32 s18, s17, 4096
    buffer_load_dwordx4 a[16:19], v5, s[12:15], s18 offen offset:0
    v_mfma_f32_32x32x16_bf16 v[124:139], a[32:35], v[80:83], v[124:139]
    s_waitcnt vmcnt(59) lgkmcnt(4)
    v_mfma_f32_32x32x16_bf16 v[108:123], a[36:39], v[84:87], v[108:123]
    ds_read_b64_tr_b16 v[100:101], v66 offset:45056
    ds_read_b64_tr_b16 v[102:103], v66 offset:47104
    ds_read_b64_tr_b16 v[104:105], v68 offset:45056
    ds_read_b64_tr_b16 v[106:107], v68 offset:47104
    buffer_load_dwordx4 a[20:23], v5, s[12:15], s18 offen offset:1024
    v_mfma_f32_32x32x16_bf16 v[124:139], a[36:39], v[88:91], v[124:139]
    s_waitcnt vmcnt(59) lgkmcnt(4)
    v_mfma_f32_32x32x16_bf16 v[108:123], a[40:43], v[92:95], v[108:123]
    ds_read_b64_tr_b16 v[76:77], v66 offset:49152
    ds_read_b64_tr_b16 v[78:79], v66 offset:51200
    ds_read_b64_tr_b16 v[80:81], v68 offset:49152
    ds_read_b64_tr_b16 v[82:83], v68 offset:51200
    buffer_load_dwordx4 a[24:27], v5, s[12:15], s18 offen offset:2048
    v_mfma_f32_32x32x16_bf16 v[124:139], a[40:43], v[96:99], v[124:139]
    s_waitcnt vmcnt(59) lgkmcnt(4)
    v_mfma_f32_32x32x16_bf16 v[108:123], a[44:47], v[100:103], v[108:123]
    ds_read_b64_tr_b16 v[84:85], v66 offset:53248
    ds_read_b64_tr_b16 v[86:87], v66 offset:55296
    ds_read_b64_tr_b16 v[88:89], v68 offset:53248
    ds_read_b64_tr_b16 v[90:91], v68 offset:55296
    buffer_load_dwordx4 a[28:31], v5, s[12:15], s18 offen offset:3072
    v_mfma_f32_32x32x16_bf16 v[124:139], a[44:47], v[104:107], v[124:139]
    s_waitcnt vmcnt(59) lgkmcnt(4)
    v_mfma_f32_32x32x16_bf16 v[108:123], a[48:51], v[76:79], v[108:123]
    ds_read_b64_tr_b16 v[92:93], v66 offset:57344
    ds_read_b64_tr_b16 v[94:95], v66 offset:59392
    ds_read_b64_tr_b16 v[96:97], v68 offset:57344
    ds_read_b64_tr_b16 v[98:99], v68 offset:59392
    s_add_u32 s18, s17, 8192
    buffer_load_dwordx4 a[32:35], v5, s[12:15], s18 offen offset:0
    v_mfma_f32_32x32x16_bf16 v[124:139], a[48:51], v[80:83], v[124:139]
    s_waitcnt vmcnt(59) lgkmcnt(4)
    v_mfma_f32_32x32x16_bf16 v[108:123], a[52:55], v[84:87], v[108:123]
    ds_read_b64_tr_b16 v[100:101], v66 offset:61440
    ds_read_b64_tr_b16 v[102:103], v66 offset:63488
    ds_read_b64_tr_b16 v[104:105], v68 offset:61440
    ds_read_b64_tr_b16 v[106:107], v68 offset:63488
    buffer_load_dwordx4 a[36:39], v5, s[12:15], s18 offen offset:1024
    v_mfma_f32_32x32x16_bf16 v[124:139], a[52:55], v[88:91], v[124:139]
    s_waitcnt vmcnt(59) lgkmcnt(4)
    v_mfma_f32_32x32x16_bf16 v[108:123], a[56:59], v[92:95], v[108:123]
    ds_read_b64_tr_b16 v[76:77], v67 offset:0
    ds_read_b64_tr_b16 v[78:79], v67 offset:2048
    ds_read_b64_tr_b16 v[80:81], v69 offset:0
    ds_read_b64_tr_b16 v[82:83], v69 offset:2048
    buffer_load_dwordx4 a[40:43], v5, s[12:15], s18 offen offset:2048
    v_mfma_f32_32x32x16_bf16 v[124:139], a[56:59], v[96:99], v[124:139]
    s_waitcnt vmcnt(59) lgkmcnt(4)
    v_mfma_f32_32x32x16_bf16 v[108:123], a[60:63], v[100:103], v[108:123]
    ds_read_b64_tr_b16 v[84:85], v67 offset:4096
    ds_read_b64_tr_b16 v[86:87], v67 offset:6144
    ds_read_b64_tr_b16 v[88:89], v69 offset:4096
    ds_read_b64_tr_b16 v[90:91], v69 offset:6144
    buffer_load_dwordx4 a[44:47], v5, s[12:15], s18 offen offset:3072
    v_mfma_f32_32x32x16_bf16 v[124:139], a[60:63], v[104:107], v[124:139]
    s_cmp_eq_u32 s28, 0
    s_cbranch_scc1 K0B_NF
    s_waitcnt vmcnt(16)
    s_barrier
    s_cmp_lg_u32 s19, 0
    s_cbranch_scc1 K0B_F
    s_mov_b64 exec, 1
    buffer_store_byte v75, off, s[96:99], s95 sc1
    s_mov_b64 exec, -1
K0B_F:
    s_add_u32 s95, s95, 2048
K0B_NF:
    s_waitcnt vmcnt(59) lgkmcnt(4)
    v_mfma_f32_32x32x16_bf16 v[108:123], a[64:67], v[76:79], v[108:123]
    ds_read_b64_tr_b16 v[92:93], v67 offset:8192
    ds_read_b64_tr_b16 v[94:95], v67 offset:10240
    ds_read_b64_tr_b16 v[96:97], v69 offset:8192
    ds_read_b64_tr_b16 v[98:99], v69 offset:10240
    s_add_u32 s18, s17, 12288
    buffer_load_dwordx4 a[48:51], v5, s[12:15], s18 offen offset:0
    v_mfma_f32_32x32x16_bf16 v[124:139], a[64:67], v[80:83], v[124:139]
    s_waitcnt vmcnt(59) lgkmcnt(4)
    v_mfma_f32_32x32x16_bf16 v[108:123], a[68:71], v[84:87], v[108:123]
    ds_read_b64_tr_b16 v[100:101], v67 offset:12288
    ds_read_b64_tr_b16 v[102:103], v67 offset:14336
    ds_read_b64_tr_b16 v[104:105], v69 offset:12288
    ds_read_b64_tr_b16 v[106:107], v69 offset:14336
    buffer_load_dwordx4 a[52:55], v5, s[12:15], s18 offen offset:1024
    v_mfma_f32_32x32x16_bf16 v[124:139], a[68:71], v[88:91], v[124:139]
    s_waitcnt vmcnt(59) lgkmcnt(4)
    v_mfma_f32_32x32x16_bf16 v[108:123], a[72:75], v[92:95], v[108:123]
    ds_read_b64_tr_b16 v[76:77], v67 offset:16384
    ds_read_b64_tr_b16 v[78:79], v67 offset:18432
    ds_read_b64_tr_b16 v[80:81], v69 offset:16384
    ds_read_b64_tr_b16 v[82:83], v69 offset:18432
    buffer_load_dwordx4 a[56:59], v5, s[12:15], s18 offen offset:2048
    v_mfma_f32_32x32x16_bf16 v[124:139], a[72:75], v[96:99], v[124:139]
    s_waitcnt vmcnt(59) lgkmcnt(4)
    v_mfma_f32_32x32x16_bf16 v[108:123], a[76:79], v[100:103], v[108:123]
    ds_read_b64_tr_b16 v[84:85], v67 offset:20480
    ds_read_b64_tr_b16 v[86:87], v67 offset:22528
    ds_read_b64_tr_b16 v[88:89], v69 offset:20480
    ds_read_b64_tr_b16 v[90:91], v69 offset:22528
    buffer_load_dwordx4 a[60:63], v5, s[12:15], s18 offen offset:3072
    v_mfma_f32_32x32x16_bf16 v[124:139], a[76:79], v[104:107], v[124:139]
    s_waitcnt vmcnt(59) lgkmcnt(4)
    v_mfma_f32_32x32x16_bf16 v[108:123], a[80:83], v[76:79], v[108:123]
    ds_read_b64_tr_b16 v[92:93], v67 offset:24576
    ds_read_b64_tr_b16 v[94:95], v67 offset:26624
    ds_read_b64_tr_b16 v[96:97], v69 offset:24576
    ds_read_b64_tr_b16 v[98:99], v69 offset:26624
    s_add_u32 s18, s17, 16384
    buffer_load_dwordx4 a[64:67], v5, s[12:15], s18 offen offset:0
    v_mfma_f32_32x32x16_bf16 v[124:139], a[80:83], v[80:83], v[124:139]
    s_waitcnt vmcnt(59) lgkmcnt(4)
    v_mfma_f32_32x32x16_bf16 v[108:123], a[84:87], v[84:87], v[108:123]
    ds_read_b64_tr_b16 v[100:101], v67 offset:28672
    ds_read_b64_tr_b16 v[102:103], v67 offset:30720
    ds_read_b64_tr_b16 v[104:105], v69 offset:28672
    ds_read_b64_tr_b16 v[106:107], v69 offset:30720
    buffer_load_dwordx4 a[68:71], v5, s[12:15], s18 offen offset:1024
    v_mfma_f32_32x32x16_bf16 v[124:139], a[84:87], v[88:91], v[124:139]
    s_waitcnt vmcnt(59) lgkmcnt(4)
    v_mfma_f32_32x32x16_bf16 v[108:123], a[88:91], v[92:95], v[108:123]
    ds_read_b64_tr_b16 v[76:77], v67 offset:32768
    ds_read_b64_tr_b16 v[78:79], v67 offset:34816
    ds_read_b64_tr_b16 v[80:81], v69 offset:32768
    ds_read_b64_tr_b16 v[82:83], v69 offset:34816
    buffer_load_dwordx4 a[72:75], v5, s[12:15], s18 offen offset:2048
    v_mfma_f32_32x32x16_bf16 v[124:139], a[88:91], v[96:99], v[124:139]
    s_waitcnt vmcnt(59) lgkmcnt(4)
    v_mfma_f32_32x32x16_bf16 v[108:123], a[92:95], v[100:103], v[108:123]
    ds_read_b64_tr_b16 v[84:85], v67 offset:36864
    ds_read_b64_tr_b16 v[86:87], v67 offset:38912
    ds_read_b64_tr_b16 v[88:89], v69 offset:36864
    ds_read_b64_tr_b16 v[90:91], v69 offset:38912
    buffer_load_dwordx4 a[76:79], v5, s[12:15], s18 offen offset:3072
    v_mfma_f32_32x32x16_bf16 v[124:139], a[92:95], v[104:107], v[124:139]
    s_waitcnt vmcnt(59) lgkmcnt(4)
    v_mfma_f32_32x32x16_bf16 v[108:123], a[96:99], v[76:79], v[108:123]
    ds_read_b64_tr_b16 v[92:93], v67 offset:40960
    ds_read_b64_tr_b16 v[94:95], v67 offset:43008
    ds_read_b64_tr_b16 v[96:97], v69 offset:40960
    ds_read_b64_tr_b16 v[98:99], v69 offset:43008
    s_add_u32 s18, s17, 20480
    buffer_load_dwordx4 a[80:83], v5, s[12:15], s18 offen offset:0
    v_mfma_f32_32x32x16_bf16 v[124:139], a[96:99], v[80:83], v[124:139]
    s_waitcnt vmcnt(59) lgkmcnt(4)
    v_mfma_f32_32x32x16_bf16 v[108:123], a[100:103], v[84:87], v[108:123]
    ds_read_b64_tr_b16 v[100:101], v67 offset:45056
    ds_read_b64_tr_b16 v[102:103], v67 offset:47104
    ds_read_b64_tr_b16 v[104:105], v69 offset:45056
    ds_read_b64_tr_b16 v[106:107], v69 offset:47104
    buffer_load_dwordx4 a[84:87], v5, s[12:15], s18 offen offset:1024
    v_mfma_f32_32x32x16_bf16 v[124:139], a[100:103], v[88:91], v[124:139]
    s_waitcnt vmcnt(59) lgkmcnt(4)
    v_mfma_f32_32x32x16_bf16 v[108:123], a[104:107], v[92:95], v[108:123]
    ds_read_b64_tr_b16 v[76:77], v67 offset:49152
    ds_read_b64_tr_b16 v[78:79], v67 offset:51200
    ds_read_b64_tr_b16 v[80:81], v69 offset:49152
    ds_read_b64_tr_b16 v[82:83], v69 offset:51200
    buffer_load_dwordx4 a[88:91], v5, s[12:15], s18 offen offset:2048
    v_mfma_f32_32x32x16_bf16 v[124:139], a[104:107], v[96:99], v[124:139]
    s_waitcnt vmcnt(59) lgkmcnt(4)
    v_mfma_f32_32x32x16_bf16 v[108:123], a[108:111], v[100:103], v[108:123]
    ds_read_b64_tr_b16 v[84:85], v67 offset:53248
    ds_read_b64_tr_b16 v[86:87], v67 offset:55296
    ds_read_b64_tr_b16 v[88:89], v69 offset:53248
    ds_read_b64_tr_b16 v[90:91], v69 offset:55296
    buffer_load_dwordx4 a[92:95], v5, s[12:15], s18 offen offset:3072
    v_mfma_f32_32x32x16_bf16 v[124:139], a[108:111], v[104:107], v[124:139]
    s_waitcnt vmcnt(59) lgkmcnt(4)
    v_mfma_f32_32x32x16_bf16 v[108:123], a[112:115], v[76:79], v[108:123]
    ds_read_b64_tr_b16 v[92:93], v67 offset:57344
    ds_read_b64_tr_b16 v[94:95], v67 offset:59392
    ds_read_b64_tr_b16 v[96:97], v69 offset:57344
    ds_read_b64_tr_b16 v[98:99], v69 offset:59392
    s_add_u32 s18, s17, 24576
    buffer_load_dwordx4 a[96:99], v5, s[12:15], s18 offen offset:0
    v_mfma_f32_32x32x16_bf16 v[124:139], a[112:115], v[80:83], v[124:139]
    s_waitcnt vmcnt(59) lgkmcnt(4)
    v_mfma_f32_32x32x16_bf16 v[108:123], a[116:119], v[84:87], v[108:123]
    ds_read_b64_tr_b16 v[100:101], v67 offset:61440
    ds_read_b64_tr_b16 v[102:103], v67 offset:63488
    ds_read_b64_tr_b16 v[104:105], v69 offset:61440
    ds_read_b64_tr_b16 v[106:107], v69 offset:63488
    buffer_load_dwordx4 a[100:103], v5, s[12:15], s18 offen offset:1024
    v_mfma_f32_32x32x16_bf16 v[124:139], a[116:119], v[88:91], v[124:139]
    s_waitcnt vmcnt(59) lgkmcnt(4)
    v_mfma_f32_32x32x16_bf16 v[108:123], a[120:123], v[92:95], v[108:123]
    ds_read_b64_tr_b16 v[76:77], v70 offset:0
    ds_read_b64_tr_b16 v[78:79], v70 offset:2048
    ds_read_b64_tr_b16 v[80:81], v72 offset:0
    ds_read_b64_tr_b16 v[82:83], v72 offset:2048
    buffer_load_dwordx4 a[104:107], v5, s[12:15], s18 offen offset:2048
    v_mfma_f32_32x32x16_bf16 v[124:139], a[120:123], v[96:99], v[124:139]
    s_waitcnt vmcnt(59) lgkmcnt(4)
    v_mfma_f32_32x32x16_bf16 v[108:123], a[124:127], v[100:103], v[108:123]
    ds_read_b64_tr_b16 v[84:85], v70 offset:4096
    ds_read_b64_tr_b16 v[86:87], v70 offset:6144
    ds_read_b64_tr_b16 v[88:89], v72 offset:4096
    ds_read_b64_tr_b16 v[90:91], v72 offset:6144
    buffer_load_dwordx4 a[108:111], v5, s[12:15], s18 offen offset:3072
    v_mfma_f32_32x32x16_bf16 v[124:139], a[124:127], v[104:107], v[124:139]
    s_waitcnt vmcnt(59) lgkmcnt(4)
    v_mfma_f32_32x32x16_bf16 v[108:123], a[128:131], v[76:79], v[108:123]
    ds_read_b64_tr_b16 v[92:93], v70 offset:8192
    ds_read_b64_tr_b16 v[94:95], v70 offset:10240
    ds_read_b64_tr_b16 v[96:97], v72 offset:8192
    ds_read_b64_tr_b16 v[98:99], v72 offset:10240
    s_add_u32 s18, s17, 28672
    buffer_load_dwordx4 a[112:115], v5, s[12:15], s18 offen offset:0
    v_mfma_f32_32x32x16_bf16 v[124:139], a[128:131], v[80:83], v[124:139]
    s_waitcnt vmcnt(59) lgkmcnt(4)
    v_mfma_f32_32x32x16_bf16 v[108:123], a[132:135], v[84:87], v[108:123]
    ds_read_b64_tr_b16 v[100:101], v70 offset:12288
    ds_read_b64_tr_b16 v[102:103], v70 offset:14336
    ds_read_b64_tr_b16 v[104:105], v72 offset:12288
    ds_read_b64_tr_b16 v[106:107], v72 offset:14336
    buffer_load_dwordx4 a[116:119], v5, s[12:15], s18 offen offset:1024
    v_mfma_f32_32x32x16_bf16 v[124:139], a[132:135], v[88:91], v[124:139]
    s_waitcnt vmcnt(59) lgkmcnt(4)
    v_mfma_f32_32x32x16_bf16 v[108:123], a[136:139], v[92:95], v[108:123]
    ds_read_b64_tr_b16 v[76:77], v70 offset:16384
    ds_read_b64_tr_b16 v[78:79], v70 offset:18432
    ds_read_b64_tr_b16 v[80:81], v72 offset:16384
    ds_read_b64_tr_b16 v[82:83], v72 offset:18432
    buffer_load_dwordx4 a[120:123], v5, s[12:15], s18 offen offset:2048
    v_mfma_f32_32x32x16_bf16 v[124:139], a[136:139], v[96:99], v[124:139]
    s_waitcnt vmcnt(59) lgkmcnt(4)
    v_mfma_f32_32x32x16_bf16 v[108:123], a[140:143], v[100:103], v[108:123]
    ds_read_b64_tr_b16 v[84:85], v70 offset:20480
    ds_read_b64_tr_b16 v[86:87], v70 offset:22528
    ds_read_b64_tr_b16 v[88:89], v72 offset:20480
    ds_read_b64_tr_b16 v[90:91], v72 offset:22528
    buffer_load_dwordx4 a[124:127], v5, s[12:15], s18 offen offset:3072
    v_mfma_f32_32x32x16_bf16 v[124:139], a[140:143], v[104:107], v[124:139]
    s_waitcnt vmcnt(59) lgkmcnt(4)
    v_mfma_f32_32x32x16_bf16 v[108:123], a[144:147], v[76:79], v[108:123]
    ds_read_b64_tr_b16 v[92:93], v70 offset:24576
    ds_read_b64_tr_b16 v[94:95], v70 offset:26624
    ds_read_b64_tr_b16 v[96:97], v72 offset:24576
    ds_read_b64_tr_b16 v[98:99], v72 offset:26624
    s_add_u32 s18, s17, 32768
    buffer_load_dwordx4 a[128:131], v5, s[12:15], s18 offen offset:0
    v_mfma_f32_32x32x16_bf16 v[124:139], a[144:147], v[80:83], v[124:139]
    s_waitcnt vmcnt(59) lgkmcnt(4)
    v_mfma_f32_32x32x16_bf16 v[108:123], a[148:151], v[84:87], v[108:123]
    ds_read_b64_tr_b16 v[100:101], v70 offset:28672
    ds_read_b64_tr_b16 v[102:103], v70 offset:30720
    ds_read_b64_tr_b16 v[104:105], v72 offset:28672
    ds_read_b64_tr_b16 v[106:107], v72 offset:30720
    buffer_load_dwordx4 a[132:135], v5, s[12:15], s18 offen offset:1024
    v_mfma_f32_32x32x16_bf16 v[124:139], a[148:151], v[88:91], v[124:139]
    s_waitcnt vmcnt(59) lgkmcnt(4)
    v_mfma_f32_32x32x16_bf16 v[108:123], a[152:155], v[92:95], v[108:123]
    ds_read_b64_tr_b16 v[76:77], v70 offset:32768
    ds_read_b64_tr_b16 v[78:79], v70 offset:34816
    ds_read_b64_tr_b16 v[80:81], v72 offset:32768
    ds_read_b64_tr_b16 v[82:83], v72 offset:34816
    buffer_load_dwordx4 a[136:139], v5, s[12:15], s18 offen offset:2048
    v_mfma_f32_32x32x16_bf16 v[124:139], a[152:155], v[96:99], v[124:139]
    s_waitcnt vmcnt(59) lgkmcnt(4)
    v_mfma_f32_32x32x16_bf16 v[108:123], a[156:159], v[100:103], v[108:123]
    ds_read_b64_tr_b16 v[84:85], v70 offset:36864
    ds_read_b64_tr_b16 v[86:87], v70 offset:38912
    ds_read_b64_tr_b16 v[88:89], v72 offset:36864
    ds_read_b64_tr_b16 v[90:91], v72 offset:38912
    buffer_load_dwordx4 a[140:143], v5, s[12:15], s18 offen offset:3072
    v_mfma_f32_32x32x16_bf16 v[124:139], a[156:159], v[104:107], v[124:139]
    s_waitcnt vmcnt(59) lgkmcnt(4)
    v_mfma_f32_32x32x16_bf16 v[108:123], a[160:163], v[76:79], v[108:123]
    ds_read_b64_tr_b16 v[92:93], v70 offset:40960
    ds_read_b64_tr_b16 v[94:95], v70 offset:43008
    ds_read_b64_tr_b16 v[96:97], v72 offset:40960
    ds_read_b64_tr_b16 v[98:99], v72 offset:43008
    s_add_u32 s18, s17, 36864
    buffer_load_dwordx4 a[144:147], v5, s[12:15], s18 offen offset:0
    v_mfma_f32_32x32x16_bf16 v[124:139], a[160:163], v[80:83], v[124:139]
    s_waitcnt vmcnt(59) lgkmcnt(4)
    v_mfma_f32_32x32x16_bf16 v[108:123], a[164:167], v[84:87], v[108:123]
    ds_read_b64_tr_b16 v[100:101], v70 offset:45056
    ds_read_b64_tr_b16 v[102:103], v70 offset:47104
    ds_read_b64_tr_b16 v[104:105], v72 offset:45056
    ds_read_b64_tr_b16 v[106:107], v72 offset:47104
    buffer_load_dwordx4 a[148:151], v5, s[12:15], s18 offen offset:1024
    v_mfma_f32_32x32x16_bf16 v[124:139], a[164:167], v[88:91], v[124:139]
    s_waitcnt vmcnt(59) lgkmcnt(4)
    v_mfma_f32_32x32x16_bf16 v[108:123], a[168:171], v[92:95], v[108:123]
    ds_read_b64_tr_b16 v[76:77], v70 offset:49152
    ds_read_b64_tr_b16 v[78:79], v70 offset:51200
    ds_read_b64_tr_b16 v[80:81], v72 offset:49152
    ds_read_b64_tr_b16 v[82:83], v72 offset:51200
    buffer_load_dwordx4 a[152:155], v5, s[12:15], s18 offen offset:2048
    v_mfma_f32_32x32x16_bf16 v[124:139], a[168:171], v[96:99], v[124:139]
    s_waitcnt vmcnt(59) lgkmcnt(4)
    v_mfma_f32_32x32x16_bf16 v[108:123], a[172:175], v[100:103], v[108:123]
    ds_read_b64_tr_b16 v[84:85], v70 offset:53248
    ds_read_b64_tr_b16 v[86:87], v70 offset:55296
    ds_read_b64_tr_b16 v[88:89], v72 offset:53248
    ds_read_b64_tr_b16 v[90:91], v72 offset:55296
    buffer_load_dwordx4 a[156:159], v5, s[12:15], s18 offen offset:3072
    v_mfma_f32_32x32x16_bf16 v[124:139], a[172:175], v[104:107], v[124:139]
    s_waitcnt vmcnt(59) lgkmcnt(4)
    v_mfma_f32_32x32x16_bf16 v[108:123], a[176:179], v[76:79], v[108:123]
    ds_read_b64_tr_b16 v[92:93], v70 offset:57344
    ds_read_b64_tr_b16 v[94:95], v70 offset:59392
    ds_read_b64_tr_b16 v[96:97], v72 offset:57344
    ds_read_b64_tr_b16 v[98:99], v72 offset:59392
    s_add_u32 s18, s17, 40960
    buffer_load_dwordx4 a[160:163], v5, s[12:15], s18 offen offset:0
    v_mfma_f32_32x32x16_bf16 v[124:139], a[176:179], v[80:83], v[124:139]
    s_waitcnt vmcnt(59) lgkmcnt(4)
    v_mfma_f32_32x32x16_bf16 v[108:123], a[180:183], v[84:87], v[108:123]
    ds_read_b64_tr_b16 v[100:101], v70 offset:61440
    ds_read_b64_tr_b16 v[102:103], v70 offset:63488
    ds_read_b64_tr_b16 v[104:105], v72 offset:61440
    ds_read_b64_tr_b16 v[106:107], v72 offset:63488
    buffer_load_dwordx4 a[164:167], v5, s[12:15], s18 offen offset:1024
    v_mfma_f32_32x32x16_bf16 v[124:139], a[180:183], v[88:91], v[124:139]
    s_waitcnt vmcnt(59) lgkmcnt(4)
    v_mfma_f32_32x32x16_bf16 v[108:123], a[184:187], v[92:95], v[108:123]
    ds_read_b64_tr_b16 v[76:77], v71 offset:0
    ds_read_b64_tr_b16 v[78:79], v71 offset:2048
    ds_read_b64_tr_b16 v[80:81], v73 offset:0
    ds_read_b64_tr_b16 v[82:83], v73 offset:2048
    buffer_load_dwordx4 a[168:171], v5, s[12:15], s18 offen offset:2048
    v_mfma_f32_32x32x16_bf16 v[124:139], a[184:187], v[96:99], v[124:139]
    s_waitcnt vmcnt(59) lgkmcnt(4)
    v_mfma_f32_32x32x16_bf16 v[108:123], a[188:191], v[100:103], v[108:123]
    ds_read_b64_tr_b16 v[84:85], v71 offset:4096
    ds_read_b64_tr_b16 v[86:87], v71 offset:6144
    ds_read_b64_tr_b16 v[88:89], v73 offset:4096
    ds_read_b64_tr_b16 v[90:91], v73 offset:6144
    buffer_load_dwordx4 a[172:175], v5, s[12:15], s18 offen offset:3072
    v_mfma_f32_32x32x16_bf16 v[124:139], a[188:191], v[104:107], v[124:139]
    s_waitcnt vmcnt(59) lgkmcnt(4)
    v_mfma_f32_32x32x16_bf16 v[108:123], a[192:195], v[76:79], v[108:123]
    ds_read_b64_tr_b16 v[92:93], v71 offset:8192
    ds_read_b64_tr_b16 v[94:95], v71 offset:10240
    ds_read_b64_tr_b16 v[96:97], v73 offset:8192
    ds_read_b64_tr_b16 v[98:99], v73 offset:10240
    s_add_u32 s18, s17, 45056
    buffer_load_dwordx4 a[176:179], v5, s[12:15], s18 offen offset:0
    v_mfma_f32_32x32x16_bf16 v[124:139], a[192:195], v[80:83], v[124:139]
    s_waitcnt vmcnt(59) lgkmcnt(4)
    v_mfma_f32_32x32x16_bf16 v[108:123], a[196:199], v[84:87], v[108:123]
    ds_read_b64_tr_b16 v[100:101], v71 offset:12288
    ds_read_b64_tr_b16 v[102:103], v71 offset:14336
    ds_read_b64_tr_b16 v[104:105], v73 offset:12288
    ds_read_b64_tr_b16 v[106:107], v73 offset:14336
    buffer_load_dwordx4 a[180:183], v5, s[12:15], s18 offen offset:1024
    v_mfma_f32_32x32x16_bf16 v[124:139], a[196:199], v[88:91], v[124:139]
    s_waitcnt vmcnt(59) lgkmcnt(4)
    v_mfma_f32_32x32x16_bf16 v[108:123], a[200:203], v[92:95], v[108:123]
    ds_read_b64_tr_b16 v[76:77], v71 offset:16384
    ds_read_b64_tr_b16 v[78:79], v71 offset:18432
    ds_read_b64_tr_b16 v[80:81], v73 offset:16384
    ds_read_b64_tr_b16 v[82:83], v73 offset:18432
    buffer_load_dwordx4 a[184:187], v5, s[12:15], s18 offen offset:2048
    v_mfma_f32_32x32x16_bf16 v[124:139], a[200:203], v[96:99], v[124:139]
    s_waitcnt vmcnt(59) lgkmcnt(4)
    v_mfma_f32_32x32x16_bf16 v[108:123], a[204:207], v[100:103], v[108:123]
    ds_read_b64_tr_b16 v[84:85], v71 offset:20480
    ds_read_b64_tr_b16 v[86:87], v71 offset:22528
    ds_read_b64_tr_b16 v[88:89], v73 offset:20480
    ds_read_b64_tr_b16 v[90:91], v73 offset:22528
    buffer_load_dwordx4 a[188:191], v5, s[12:15], s18 offen offset:3072
    v_mfma_f32_32x32x16_bf16 v[124:139], a[204:207], v[104:107], v[124:139]
    s_waitcnt vmcnt(59) lgkmcnt(4)
    v_mfma_f32_32x32x16_bf16 v[108:123], a[208:211], v[76:79], v[108:123]
    ds_read_b64_tr_b16 v[92:93], v71 offset:24576
    ds_read_b64_tr_b16 v[94:95], v71 offset:26624
    ds_read_b64_tr_b16 v[96:97], v73 offset:24576
    ds_read_b64_tr_b16 v[98:99], v73 offset:26624
    s_add_u32 s18, s17, 49152
    buffer_load_dwordx4 a[192:195], v5, s[12:15], s18 offen offset:0
    v_mfma_f32_32x32x16_bf16 v[124:139], a[208:211], v[80:83], v[124:139]
    s_waitcnt vmcnt(59) lgkmcnt(4)
    v_mfma_f32_32x32x16_bf16 v[108:123], a[212:215], v[84:87], v[108:123]
    ds_read_b64_tr_b16 v[100:101], v71 offset:28672
    ds_read_b64_tr_b16 v[102:103], v71 offset:30720
    ds_read_b64_tr_b16 v[104:105], v73 offset:28672
    ds_read_b64_tr_b16 v[106:107], v73 offset:30720
    buffer_load_dwordx4 a[196:199], v5, s[12:15], s18 offen offset:1024
    v_mfma_f32_32x32x16_bf16 v[124:139], a[212:215], v[88:91], v[124:139]
    s_waitcnt vmcnt(59) lgkmcnt(4)
    v_mfma_f32_32x32x16_bf16 v[108:123], a[216:219], v[92:95], v[108:123]
    ds_read_b64_tr_b16 v[76:77], v71 offset:32768
    ds_read_b64_tr_b16 v[78:79], v71 offset:34816
    ds_read_b64_tr_b16 v[80:81], v73 offset:32768
    ds_read_b64_tr_b16 v[82:83], v73 offset:34816
    buffer_load_dwordx4 a[200:203], v5, s[12:15], s18 offen offset:2048
    v_mfma_f32_32x32x16_bf16 v[124:139], a[216:219], v[96:99], v[124:139]
    s_waitcnt vmcnt(59) lgkmcnt(4)
    v_mfma_f32_32x32x16_bf16 v[108:123], a[220:223], v[100:103], v[108:123]
    ds_read_b64_tr_b16 v[84:85], v71 offset:36864
    ds_read_b64_tr_b16 v[86:87], v71 offset:38912
    ds_read_b64_tr_b16 v[88:89], v73 offset:36864
    ds_read_b64_tr_b16 v[90:91], v73 offset:38912
    buffer_load_dwordx4 a[204:207], v5, s[12:15], s18 offen offset:3072
    v_mfma_f32_32x32x16_bf16 v[124:139], a[220:223], v[104:107], v[124:139]
    s_waitcnt vmcnt(59) lgkmcnt(4)
    v_mfma_f32_32x32x16_bf16 v[108:123], a[224:227], v[76:79], v[108:123]
    ds_read_b64_tr_b16 v[92:93], v71 offset:40960
    ds_read_b64_tr_b16 v[94:95], v71 offset:43008
    ds_read_b64_tr_b16 v[96:97], v73 offset:40960
    ds_read_b64_tr_b16 v[98:99], v73 offset:43008
    s_add_u32 s18, s17, 53248
    buffer_load_dwordx4 a[208:211], v5, s[12:15], s18 offen offset:0
    v_mfma_f32_32x32x16_bf16 v[124:139], a[224:227], v[80:83], v[124:139]
    s_waitcnt vmcnt(59) lgkmcnt(4)
    v_mfma_f32_32x32x16_bf16 v[108:123], a[228:231], v[84:87], v[108:123]
    ds_read_b64_tr_b16 v[100:101], v71 offset:45056
    ds_read_b64_tr_b16 v[102:103], v71 offset:47104
    ds_read_b64_tr_b16 v[104:105], v73 offset:45056
    ds_read_b64_tr_b16 v[106:107], v73 offset:47104
    buffer_load_dwordx4 a[212:215], v5, s[12:15], s18 offen offset:1024
    v_mfma_f32_32x32x16_bf16 v[124:139], a[228:231], v[88:91], v[124:139]
    s_waitcnt vmcnt(59) lgkmcnt(4)
    v_mfma_f32_32x32x16_bf16 v[108:123], a[232:235], v[92:95], v[108:123]
    ds_read_b64_tr_b16 v[76:77], v71 offset:49152
    ds_read_b64_tr_b16 v[78:79], v71 offset:51200
    ds_read_b64_tr_b16 v[80:81], v73 offset:49152
    ds_read_b64_tr_b16 v[82:83], v73 offset:51200
    buffer_load_dwordx4 a[216:219], v5, s[12:15], s18 offen offset:2048
    v_mfma_f32_32x32x16_bf16 v[124:139], a[232:235], v[96:99], v[124:139]
    s_waitcnt vmcnt(59) lgkmcnt(4)
    v_mfma_f32_32x32x16_bf16 v[108:123], a[236:239], v[100:103], v[108:123]
    ds_read_b64_tr_b16 v[84:85], v71 offset:53248
    ds_read_b64_tr_b16 v[86:87], v71 offset:55296
    ds_read_b64_tr_b16 v[88:89], v73 offset:53248
    ds_read_b64_tr_b16 v[90:91], v73 offset:55296
    buffer_load_dwordx4 a[220:223], v5, s[12:15], s18 offen offset:3072
    v_mfma_f32_32x32x16_bf16 v[124:139], a[236:239], v[104:107], v[124:139]
    s_waitcnt vmcnt(59) lgkmcnt(4)
    v_mfma_f32_32x32x16_bf16 v[108:123], a[240:243], v[76:79], v[108:123]
    ds_read_b64_tr_b16 v[92:93], v71 offset:57344
    ds_read_b64_tr_b16 v[94:95], v71 offset:59392
    ds_read_b64_tr_b16 v[96:97], v73 offset:57344
    ds_read_b64_tr_b16 v[98:99], v73 offset:59392
    s_add_u32 s18, s17, 57344
    buffer_load_dwordx4 a[224:227], v5, s[12:15], s18 offen offset:0
    v_mfma_f32_32x32x16_bf16 v[124:139], a[240:243], v[80:83], v[124:139]
    s_waitcnt vmcnt(59) lgkmcnt(4)
    v_mfma_f32_32x32x16_bf16 v[108:123], a[244:247], v[84:87], v[108:123]
    ds_read_b64_tr_b16 v[100:101], v71 offset:61440
    ds_read_b64_tr_b16 v[102:103], v71 offset:63488
    ds_read_b64_tr_b16 v[104:105], v73 offset:61440
    ds_read_b64_tr_b16 v[106:107], v73 offset:63488
    buffer_load_dwordx4 a[228:231], v5, s[12:15], s18 offen offset:1024
    v_mfma_f32_32x32x16_bf16 v[124:139], a[244:247], v[88:91], v[124:139]
    s_waitcnt vmcnt(59) lgkmcnt(4)
    v_mfma_f32_32x32x16_bf16 v[108:123], a[248:251], v[92:95], v[108:123]
    ds_read_b64_tr_b16 v[76:77], v66 offset:0
    ds_read_b64_tr_b16 v[78:79], v66 offset:2048
    ds_read_b64_tr_b16 v[80:81], v68 offset:0
    ds_read_b64_tr_b16 v[82:83], v68 offset:2048
    buffer_load_dwordx4 a[232:235], v5, s[12:15], s18 offen offset:2048
    v_mfma_f32_32x32x16_bf16 v[124:139], a[248:251], v[96:99], v[124:139]
    s_waitcnt vmcnt(59) lgkmcnt(4)
    v_mfma_f32_32x32x16_bf16 v[108:123], a[252:255], v[100:103], v[108:123]
    ds_read_b64_tr_b16 v[84:85], v66 offset:4096
    ds_read_b64_tr_b16 v[86:87], v66 offset:6144
    ds_read_b64_tr_b16 v[88:89], v68 offset:4096
    ds_read_b64_tr_b16 v[90:91], v68 offset:6144
    buffer_load_dwordx4 a[236:239], v5, s[12:15], s18 offen offset:3072
    v_mfma_f32_32x32x16_bf16 v[124:139], a[252:255], v[104:107], v[124:139]
    s_nop 7
    s_nop 7
    v_cvt_pk_bf16_f32 v140, v108, v109
    v_cvt_pk_bf16_f32 v141, v110, v111
    v_cvt_pk_bf16_f32 v142, v112, v113
    v_cvt_pk_bf16_f32 v143, v114, v115
    v_cvt_pk_bf16_f32 v144, v116, v117
    v_cvt_pk_bf16_f32 v145, v118, v119
    v_cvt_pk_bf16_f32 v146, v120, v121
    v_cvt_pk_bf16_f32 v147, v122, v123
    buffer_store_dwordx4 v[140:143], v74, s[36:39], s20 offen offset:0 sc1
    buffer_store_dwordx4 v[144:147], v74, s[36:39], s20 offen offset:1024 sc1
    v_cvt_pk_bf16_f32 v148, v124, v125
    v_cvt_pk_bf16_f32 v149, v126, v127
    v_cvt_pk_bf16_f32 v150, v128, v129
    v_cvt_pk_bf16_f32 v151, v130, v131
    v_cvt_pk_bf16_f32 v152, v132, v133
    v_cvt_pk_bf16_f32 v153, v134, v135
    v_cvt_pk_bf16_f32 v154, v136, v137
    v_cvt_pk_bf16_f32 v155, v138, v139
    buffer_store_dwordx4 v[148:151], v74, s[36:39], s20 offen offset:2048 sc1
    buffer_store_dwordx4 v[152:155], v74, s[36:39], s20 offen offset:3072 sc1
    s_add_u32 s20, s20, 1048576
    s_add_u32 s16, s16, 262144
    s_add_u32 s17, s17, 262144
    s_add_u32 s28, s28, 1
    s_cmp_eq_u32 s28, 3
    s_cselect_b32 s14, 0, s14
    s_cmp_lt_u32 s28, 4
    s_cbranch_scc1 K0B_L
    s_waitcnt vmcnt(0) lgkmcnt(0)
    s_barrier
    s_cmp_lg_u32 s19, 0
    s_cbranch_scc1 K0B_G
    s_mov_b64 exec, 1
    buffer_store_byte v75, off, s[96:99], s95 sc1
    s_mov_b64 exec, -1
K0B_G:
    s_add_u32 s95, s95, 2048
K0_END:
    s_cmp_lt_u32 s90, 64
    s_cbranch_scc1 KQ_END
    s_and_b32 s22, s90, 16
    s_cmp_eq_u32 s22, 0
    s_cbranch_scc1 KQ_END
    s_mov_b32 s91, 1
KQ_TOP:
    s_cmp_lg_u32 s91, 0
    s_cbranch_scc1 KQ_BG
    s_and_b32 s22, s90, 31
    s_and_b32 s28, s22, 3
    s_lshr_b32 s22, s22, 2
    s_lshr_b32 s23, s90, 5
    s_lshl_b32 s23, s23, 3
    s_add_u32 s31, s22, s23
    s_branch KQ_DEC
KQ_BG:
    s_sub_u32 s22, s90, 64
    s_lshr_b32 s22, s22, 5
    s_lshl_b32 s22, s22, 4
    s_and_b32 s23, s90, 15
    s_add_u32 s22, s22, s23
    s_sub_u32 s23, s91, 1
    s_lshl_b32 s23, s23, 6
    s_add_u32 s22, s22, s23
    s_mul_i32 s23, s22, 683
    s_lshr_b32 s23, s23, 16
    s_mul_i32 s24, s23, 96
    s_sub_u32 s22, s22, s24
    s_lshl_b32 s23, s23, 1
    s_add_u32 s23, s23, 4
    s_and_b32 s24, s22, 1
    s_add_u32 s28, s23, s24
    s_lshr_b32 s31, s22, 1
KQ_DEC:
    s_and_b32 s28, s28, 15
    s_and_b32 s29, s31, 15
    s_mov_b32 s30, 0
    s_lshr_b32 s31, s31, 4
    s_lshl_b32 s22, s28, 11
    s_lshl_b32 s23, s29, 7
    s_add_u32 s22, s22, s23
    s_lshl_b32 s23, s31, 2
    s_add_u32 s22, s22, s23
    s_add_u32 s95, s22, 14688256
    s_cmp_eq_u32 s31, 1
    s_cbranch_scc1 KQ_V
    s_cmp_eq_u32 s31, 2
    s_cbranch_scc1 KQ_Q
    s_load_dwordx2 s[32:33], s[0:1], 24
    s_load_dwordx2 s[34:35], s[0:1], 104
    s_mov_b32 s14, 8192
    s_mov_b32 s15, 65536
    s_mov_b32 s18, 7
    s_mov_b32 s25, 0
    s_mul_i32 s13, s28, 262144
    s_lshr_b32 s22, s19, 1
    s_lshl_b32 s12, s29, 9
    s_lshl_b32 s23, s22, 8
    s_add_u32 s12, s12, s23
    s_mov_b32 s16, 0
    s_mov_b32 s17, 0
    s_waitcnt lgkmcnt(0)
    s_mov_b32 s4, s32
    s_mov_b32 s5, s33
    s_and_b32 s5, s5, 0xffff
    s_mov_b32 s6, 0x800000
    s_mov_b32 s7, 0x00020000
    s_mov_b32 s8, s34
    s_mov_b32 s9, s35
    s_and_b32 s9, s9, 0xffff
    s_mov_b32 s10, 0x400000
    s_mov_b32 s11, 0x00020000
    v_and_b32 v1, 63, v0
    s_lshl_b32 s26, s14, 5
    s_mul_i32 s22, s19, 4
    s_and_b32 s22, s22, 7
    s_lshl_b32 s22, s22, 2
    s_mul_i32 s22, s22, s14
    s_add_u32 s22, s22, s12
    v_lshrrev_b32 v2, 4, v1
    v_lshlrev_b32 v3, 2, v2
    v_and_b32 v8, 15, v1
    v_xor_b32 v8, v8, v3
    v_lshlrev_b32 v8, 4, v8
    v_mul_lo_u32 v2, s14, v2
    v_add3_u32 v8, v8, v2, s22
    s_lshl_b32 s22, s14, 2
    s_sub_u32 s22, s22, 1024
    v_add_u32 v9, s22, v8
    v_add_u32 v10, s22, v9
    v_add_u32 v11, s22, v10
    v_lshlrev_b32 v2, 4, v1
    s_mul_i32 s22, s19, s15
    s_add_u32 s22, s22, s13
    v_add_u32 v12, s22, v2
    s_mul_i32 s20, s19, 4096
    s_mul_i32 s21, s19, 2048
    s_add_u32 s21, s21, 16384
    v_bfe_u32 v2, v1, 2, 2
    v_lshrrev_b32 v3, 5, v1
    v_lshl_add_u32 v3, v3, 2, v2
    v_lshlrev_b32 v3, 8, v3
    v_bfe_u32 v13, v1, 4, 1
    v_lshl_add_u32 v3, v13, 5, v3
    v_bfe_u32 v13, v1, 1, 1
    v_lshl_add_u32 v3, v13, 4, v3
    v_and_b32 v13, 1, v1
    v_lshl_add_u32 v3, v13, 3, v3
    s_and_b32 s22, s19, 1
    s_lshl_b32 s23, s22, 1
    s_add_u32 s23, s23, 0
    s_cmp_lg_u32 s25, 0
    s_cselect_b32 s23, s23, 0
    s_cselect_b32 s24, 0, s22
    s_lshl_b32 s24, s24, 13
    v_xor_b32 v13, s23, v2
    v_lshl_add_u32 v13, v13, 6, v3
    v_add_u32 v13, s24, v13
    v_add_u32 v14, 49152, v13
    s_lshl_b32 s23, s22, 1
    s_add_u32 s23, s23, 1
    s_cmp_lg_u32 s25, 0
    s_cselect_b32 s23, s23, 1
    s_cselect_b32 s24, 0, s22
    s_lshl_b32 s24, s24, 13
    v_xor_b32 v15, s23, v2
    v_lshl_add_u32 v15, v15, 6, v3
    v_add_u32 v15, s24, v15
    v_add_u32 v16, 49152, v15
    s_lshl_b32 s23, s22, 1
    s_add_u32 s23, s23, 0
    s_cmp_lg_u32 s25, 0
    s_cselect_b32 s23, s23, 2
    s_cselect_b32 s24, 1, s22
    s_lshl_b32 s24, s24, 13
    v_xor_b32 v17, s23, v2
    v_lshl_add_u32 v17, v17, 6, v3
    v_add_u32 v17, s24, v17
    v_add_u32 v18, 49152, v17
    s_lshl_b32 s23, s22, 1
    s_add_u32 s23, s23, 1
    s_cmp_lg_u32 s25, 0
    s_cselect_b32 s23, s23, 3
    s_cselect_b32 s24, 1, s22
    s_lshl_b32 s24, s24, 13
    v_xor_b32 v19, s23, v2
    v_lshl_add_u32 v19, v19, 6, v3
    v_add_u32 v19, s24, v19
    v_add_u32 v20, 49152, v19
    s_lshr_b32 s22, s19, 1
    s_mul_i32 s22, s22, 4096
    s_add_u32 s22, s22, 16384
    v_lshlrev_b32 v21, 4, v1
    v_add_u32 v21, s22, v21
    v_add_u32 v22, 49152, v21
    s_mov_b32 m0, s20
    s_nop 0
    buffer_load_dwordx4 v8, s[4:7], s16 offen offset:0 lds
    buffer_load_dwordx4 v9, s[4:7], s16 offen offset:1024 lds
    buffer_load_dwordx4 v10, s[4:7], s16 offen offset:2048 lds
    buffer_load_dwordx4 v11, s[4:7], s16 offen offset:3072 lds
    s_add_u32 s16, s16, s26
    s_add_u32 m0, s21, 0
    s_nop 0
    buffer_load_dwordx4 v12, s[8:11], s17 offen offset:0 lds
    buffer_load_dwordx4 v12, s[8:11], s17 offen offset:1024 lds
    s_add_u32 s17, s17, 2048
    s_add_u32 m0, s20, 24576
    s_nop 0
    buffer_load_dwordx4 v8, s[4:7], s16 offen offset:0 lds
    buffer_load_dwordx4 v9, s[4:7], s16 offen offset:1024 lds
    buffer_load_dwordx4 v10, s[4:7], s16 offen offset:2048 lds
    buffer_load_dwordx4 v11, s[4:7], s16 offen offset:3072 lds
    s_add_u32 s16, s16, s26
    s_add_u32 m0, s21, 24576
    s_nop 0
    buffer_load_dwordx4 v12, s[8:11], s17 offen offset:0 lds
    buffer_load_dwordx4 v12, s[8:11], s17 offen offset:1024 lds
    s_add_u32 s17, s17, 2048
    s_add_u32 m0, s20, 49152
    s_nop 0
    buffer_load_dwordx4 v8, s[4:7], s16 offen offset:0 lds
    buffer_load_dwordx4 v9, s[4:7], s16 offen offset:1024 lds
    buffer_load_dwordx4 v10, s[4:7], s16 offen offset:2048 lds
    buffer_load_dwordx4 v11, s[4:7], s16 offen offset:3072 lds
    s_add_u32 s16, s16, s26
    s_add_u32 m0, s21, 49152
    s_nop 0
    buffer_load_dwordx4 v12, s[8:11], s17 offen offset:0 lds
    buffer_load_dwordx4 v12, s[8:11], s17 offen offset:1024 lds
    s_add_u32 s17, s17, 2048
    s_add_u32 m0, s20, 73728
    s_nop 0
    buffer_load_dwordx4 v8, s[4:7], s16 offen offset:0 lds
    buffer_load_dwordx4 v9, s[4:7], s16 offen offset:1024 lds
    buffer_load_dwordx4 v10, s[4:7], s16 offen offset:2048 lds
    buffer_load_dwordx4 v11, s[4:7], s16 offen offset:3072 lds
    s_add_u32 s16, s16, s26
    v_accvgpr_write_b32 a0, 0
    v_accvgpr_write_b32 a1, 0
    v_accvgpr_write_b32 a2, 0
    v_accvgpr_write_b32 a3, 0
    v_accvgpr_write_b32 a4, 0
    v_accvgpr_write_b32 a5, 0
    v_accvgpr_write_b32 a6, 0
    v_accvgpr_write_b32 a7, 0
    v_accvgpr_write_b32 a8, 0
    v_accvgpr_write_b32 a9, 0
    v_accvgpr_write_b32 a10, 0
    v_accvgpr_write_b32 a11, 0
    v_accvgpr_write_b32 a12, 0
    v_accvgpr_write_b32 a13, 0
    v_accvgpr_write_b32 a14, 0
    v_accvgpr_write_b32 a15, 0
    v_accvgpr_write_b32 a16, 0
    v_accvgpr_write_b32 a17, 0
    v_accvgpr_write_b32 a18, 0
    v_accvgpr_write_b32 a19, 0
    v_accvgpr_write_b32 a20, 0
    v_accvgpr_write_b32 a21, 0
    v_accvgpr_write_b32 a22, 0
    v_accvgpr_write_b32 a23, 0
    v_accvgpr_write_b32 a24, 0
    v_accvgpr_write_b32 a25, 0
    v_accvgpr_write_b32 a26, 0
    v_accvgpr_write_b32 a27, 0
    v_accvgpr_write_b32 a28, 0
    v_accvgpr_write_b32 a29, 0
    v_accvgpr_write_b32 a30, 0
    v_accvgpr_write_b32 a31, 0
    v_accvgpr_write_b32 a32, 0
    v_accvgpr_write_b32 a33, 0
    v_accvgpr_write_b32 a34, 0
    v_accvgpr_write_b32 a35, 0
    v_accvgpr_write_b32 a36, 0
    v_accvgpr_write_b32 a37, 0
    v_accvgpr_write_b32 a38, 0
    v_accvgpr_write_b32 a39, 0
    v_accvgpr_write_b32 a40, 0
    v_accvgpr_write_b32 a41, 0
    v_accvgpr_write_b32 a42, 0
    v_accvgpr_write_b32 a43, 0
    v_accvgpr_write_b32 a44, 0
    v_accvgpr_write_b32 a45, 0
    v_accvgpr_write_b32 a46, 0
    v_accvgpr_write_b32 a47, 0
    v_accvgpr_write_b32 a48, 0
    v_accvgpr_write_b32 a49, 0
    v_accvgpr_write_b32 a50, 0
    v_accvgpr_write_b32 a51, 0
    v_accvgpr_write_b32 a52, 0
    v_accvgpr_write_b32 a53, 0
    v_accvgpr_write_b32 a54, 0
    v_accvgpr_write_b32 a55, 0
    v_accvgpr_write_b32 a56, 0
    v_accvgpr_write_b32 a57, 0
    v_accvgpr_write_b32 a58, 0
    v_accvgpr_write_b32 a59, 0
    v_accvgpr_write_b32 a60, 0
    v_accvgpr_write_b32 a61, 0
    v_accvgpr_write_b32 a62, 0
    v_accvgpr_write_b32 a63, 0
    v_accvgpr_write_b32 a64, 0
    v_accvgpr_write_b32 a65, 0
    v_accvgpr_write_b32 a66, 0
    v_accvgpr_write_b32 a67, 0
    v_accvgpr_write_b32 a68, 0
    v_accvgpr_write_b32 a69, 0
    v_accvgpr_write_b32 a70, 0
    v_accvgpr_write_b32 a71, 0
    v_accvgpr_write_b32 a72, 0
    v_accvgpr_write_b32 a73, 0
    v_accvgpr_write_b32 a74, 0
    v_accvgpr_write_b32 a75, 0
    v_accvgpr_write_b32 a76, 0
    v_accvgpr_write_b32 a77, 0
    v_accvgpr_write_b32 a78, 0
    v_accvgpr_write_b32 a79, 0
    v_accvgpr_write_b32 a80, 0
    v_accvgpr_write_b32 a81, 0
    v_accvgpr_write_b32 a82, 0
    v_accvgpr_write_b32 a83, 0
    v_accvgpr_write_b32 a84, 0
    v_accvgpr_write_b32 a85, 0
    v_accvgpr_write_b32 a86, 0
    v_accvgpr_write_b32 a87, 0
    v_accvgpr_write_b32 a88, 0
    v_accvgpr_write_b32 a89, 0
    v_accvgpr_write_b32 a90, 0
    v_accvgpr_write_b32 a91, 0
    v_accvgpr_write_b32 a92, 0
    v_accvgpr_write_b32 a93, 0
    v_accvgpr_write_b32 a94, 0
    v_accvgpr_write_b32 a95, 0
    v_accvgpr_write_b32 a96, 0
    v_accvgpr_write_b32 a97, 0
    v_accvgpr_write_b32 a98, 0
    v_accvgpr_write_b32 a99, 0
    v_accvgpr_write_b32 a100, 0
    v_accvgpr_write_b32 a101, 0
    v_accvgpr_write_b32 a102, 0
    v_accvgpr_write_b32 a103, 0
    v_accvgpr_write_b32 a104, 0
    v_accvgpr_write_b32 a105, 0
    v_accvgpr_write_b32 a106, 0
    v_accvgpr_write_b32 a107, 0
    v_accvgpr_write_b32 a108, 0
    v_accvgpr_write_b32 a109, 0
    v_accvgpr_write_b32 a110, 0
    v_accvgpr_write_b32 a111, 0
    v_accvgpr_write_b32 a112, 0
    v_accvgpr_write_b32 a113, 0
    v_accvgpr_write_b32 a114, 0
    v_accvgpr_write_b32 a115, 0
    v_accvgpr_write_b32 a116, 0
    v_accvgpr_write_b32 a117, 0
    v_accvgpr_write_b32 a118, 0
    v_accvgpr_write_b32 a119, 0
    v_accvgpr_write_b32 a120, 0
    v_accvgpr_write_b32 a121, 0
    v_accvgpr_write_b32 a122, 0
    v_accvgpr_write_b32 a123, 0
    v_accvgpr_write_b32 a124, 0
    v_accvgpr_write_b32 a125, 0
    v_accvgpr_write_b32 a126, 0
    v_accvgpr_write_b32 a127, 0
    s_waitcnt vmcnt(16)
    s_barrier
    ds_read_b128 v[56:59], v21 offset:0
    ds_read_b64_tr_b16 v[24:25], v13 offset:0
    ds_read_b64_tr_b16 v[26:27], v13 offset:2048
    ds_read_b64_tr_b16 v[28:29], v15 offset:0
    ds_read_b64_tr_b16 v[30:31], v15 offset:2048
    ds_read_b64_tr_b16 v[32:33], v17 offset:0
    ds_read_b64_tr_b16 v[34:35], v17 offset:2048
    ds_read_b64_tr_b16 v[36:37], v19 offset:0
    ds_read_b64_tr_b16 v[38:39], v19 offset:2048
    ds_read_b128 v[60:63], v21 offset:2048
K_loop_1:
    s_waitcnt lgkmcnt(0)
    v_mfma_f32_32x32x16_bf16 a[0:15], v[24:27], v[56:59], a[0:15]
    ds_read_b128 v[64:67], v21 offset:1024
    ds_read_b64_tr_b16 v[40:41], v13 offset:4096
    v_mfma_f32_32x32x16_bf16 a[16:31], v[28:31], v[56:59], a[16:31]
    ds_read_b64_tr_b16 v[42:43], v13 offset:6144
    ds_read_b64_tr_b16 v[44:45], v15 offset:4096
    s_add_u32 m0, s21, 73728
    s_nop 0
    buffer_load_dwordx4 v12, s[8:11], s17 offen offset:0 lds
    v_mfma_f32_32x32x16_bf16 a[32:47], v[32:35], v[56:59], a[32:47]
    ds_read_b64_tr_b16 v[46:47], v15 offset:6144
    ds_read_b64_tr_b16 v[48:49], v17 offset:4096
    v_mfma_f32_32x32x16_bf16 a[48:63], v[36:39], v[56:59], a[48:63]
    ds_read_b64_tr_b16 v[50:51], v17 offset:6144
    ds_read_b64_tr_b16 v[52:53], v19 offset:4096
    v_mfma_f32_32x32x16_bf16 a[64:79], v[24:27], v[60:63], a[64:79]
    ds_read_b64_tr_b16 v[54:55], v19 offset:6144
    ds_read_b128 v[68:71], v21 offset:3072
    v_mfma_f32_32x32x16_bf16 a[80:95], v[28:31], v[60:63], a[80:95]
    buffer_load_dwordx4 v12, s[8:11], s17 offen offset:1024 lds
    s_add_u32 s17, s17, 2048
    v_mfma_f32_32x32x16_bf16 a[96:111], v[32:35], v[60:63], a[96:111]
    v_mfma_f32_32x32x16_bf16 a[112:127], v[36:39], v[60:63], a[112:127]
    s_waitcnt vmcnt(12) lgkmcnt(0)
    s_barrier
    v_mfma_f32_32x32x16_bf16 a[0:15], v[40:43], v[64:67], a[0:15]
    ds_read_b128 v[56:59], v21 offset:24576
    ds_read_b64_tr_b16 v[24:25], v13 offset:24576
    v_mfma_f32_32x32x16_bf16 a[16:31], v[44:47], v[64:67], a[16:31]
    ds_read_b64_tr_b16 v[26:27], v13 offset:26624
    ds_read_b64_tr_b16 v[28:29], v15 offset:24576
    s_mov_b32 m0, s20
    s_nop 0
    buffer_load_dwordx4 v8, s[4:7], s16 offen offset:0 lds
    v_mfma_f32_32x32x16_bf16 a[32:47], v[48:51], v[64:67], a[32:47]
    ds_read_b64_tr_b16 v[30:31], v15 offset:26624
    ds_read_b64_tr_b16 v[32:33], v17 offset:24576
    v_mfma_f32_32x32x16_bf16 a[48:63], v[52:55], v[64:67], a[48:63]
    ds_read_b64_tr_b16 v[34:35], v17 offset:26624
    ds_read_b64_tr_b16 v[36:37], v19 offset:24576
    buffer_load_dwordx4 v9, s[4:7], s16 offen offset:1024 lds
    v_mfma_f32_32x32x16_bf16 a[64:79], v[40:43], v[68:71], a[64:79]
    ds_read_b64_tr_b16 v[38:39], v19 offset:26624
    ds_read_b128 v[60:63], v21 offset:26624
    v_mfma_f32_32x32x16_bf16 a[80:95], v[44:47], v[68:71], a[80:95]
    buffer_load_dwordx4 v10, s[4:7], s16 offen offset:2048 lds
    v_mfma_f32_32x32x16_bf16 a[96:111], v[48:51], v[68:71], a[96:111]
    v_mfma_f32_32x32x16_bf16 a[112:127], v[52:55], v[68:71], a[112:127]
    buffer_load_dwordx4 v11, s[4:7], s16 offen offset:3072 lds
    s_add_u32 s16, s16, s26
    s_waitcnt lgkmcnt(0)
    v_mfma_f32_32x32x16_bf16 a[0:15], v[24:27], v[56:59], a[0:15]
    ds_read_b128 v[64:67], v21 offset:25600
    ds_read_b64_tr_b16 v[40:41], v13 offset:28672
    v_mfma_f32_32x32x16_bf16 a[16:31], v[28:31], v[56:59], a[16:31]
    ds_read_b64_tr_b16 v[42:43], v13 offset:30720
    ds_read_b64_tr_b16 v[44:45], v15 offset:28672
    s_add_u32 m0, s21, 0
    s_nop 0
    buffer_load_dwordx4 v12, s[8:11], s17 offen offset:0 lds
    v_mfma_f32_32x32x16_bf16 a[32:47], v[32:35], v[56:59], a[32:47]
    ds_read_b64_tr_b16 v[46:47], v15 offset:30720
    ds_read_b64_tr_b16 v[48:49], v17 offset:28672
    v_mfma_f32_32x32x16_bf16 a[48:63], v[36:39], v[56:59], a[48:63]
    ds_read_b64_tr_b16 v[50:51], v17 offset:30720
    ds_read_b64_tr_b16 v[52:53], v19 offset:28672
    v_mfma_f32_32x32x16_bf16 a[64:79], v[24:27], v[60:63], a[64:79]
    ds_read_b64_tr_b16 v[54:55], v19 offset:30720
    ds_read_b128 v[68:71], v21 offset:27648
    v_mfma_f32_32x32x16_bf16 a[80:95], v[28:31], v[60:63], a[80:95]
    buffer_load_dwordx4 v12, s[8:11], s17 offen offset:1024 lds
    s_add_u32 s17, s17, 2048
    v_mfma_f32_32x32x16_bf16 a[96:111], v[32:35], v[60:63], a[96:111]
    v_mfma_f32_32x32x16_bf16 a[112:127], v[36:39], v[60:63], a[112:127]
    s_waitcnt vmcnt(12) lgkmcnt(0)
    s_barrier
    v_mfma_f32_32x32x16_bf16 a[0:15], v[40:43], v[64:67], a[0:15]
    ds_read_b128 v[56:59], v22 offset:0
    ds_read_b64_tr_b16 v[24:25], v14 offset:0
    v_mfma_f32_32x32x16_bf16 a[16:31], v[44:47], v[64:67], a[16:31]
    ds_read_b64_tr_b16 v[26:27], v14 offset:2048
    ds_read_b64_tr_b16 v[28:29], v16 offset:0
    s_add_u32 m0, s20, 24576
    s_nop 0
    buffer_load_dwordx4 v8, s[4:7], s16 offen offset:0 lds
    v_mfma_f32_32x32x16_bf16 a[32:47], v[48:51], v[64:67], a[32:47]
    ds_read_b64_tr_b16 v[30:31], v16 offset:2048
    ds_read_b64_tr_b16 v[32:33], v18 offset:0
    v_mfma_f32_32x32x16_bf16 a[48:63], v[52:55], v[64:67], a[48:63]
    ds_read_b64_tr_b16 v[34:35], v18 offset:2048
    ds_read_b64_tr_b16 v[36:37], v20 offset:0
    buffer_load_dwordx4 v9, s[4:7], s16 offen offset:1024 lds
    v_mfma_f32_32x32x16_bf16 a[64:79], v[40:43], v[68:71], a[64:79]
    ds_read_b64_tr_b16 v[38:39], v20 offset:2048
    ds_read_b128 v[60:63], v22 offset:2048
    v_mfma_f32_32x32x16_bf16 a[80:95], v[44:47], v[68:71], a[80:95]
    buffer_load_dwordx4 v10, s[4:7], s16 offen offset:2048 lds
    v_mfma_f32_32x32x16_bf16 a[96:111], v[48:51], v[68:71], a[96:111]
    v_mfma_f32_32x32x16_bf16 a[112:127], v[52:55], v[68:71], a[112:127]
    buffer_load_dwordx4 v11, s[4:7], s16 offen offset:3072 lds
    s_add_u32 s16, s16, s26
    s_waitcnt lgkmcnt(0)
    v_mfma_f32_32x32x16_bf16 a[0:15], v[24:27], v[56:59], a[0:15]
    ds_read_b128 v[64:67], v22 offset:1024
    ds_read_b64_tr_b16 v[40:41], v14 offset:4096
    v_mfma_f32_32x32x16_bf16 a[16:31], v[28:31], v[56:59], a[16:31]
    ds_read_b64_tr_b16 v[42:43], v14 offset:6144
    ds_read_b64_tr_b16 v[44:45], v16 offset:4096
    s_add_u32 m0, s21, 24576
    s_nop 0
    buffer_load_dwordx4 v12, s[8:11], s17 offen offset:0 lds
    v_mfma_f32_32x32x16_bf16 a[32:47], v[32:35], v[56:59], a[32:47]
    ds_read_b64_tr_b16 v[46:47], v16 offset:6144
    ds_read_b64_tr_b16 v[48:49], v18 offset:4096
    v_mfma_f32_32x32x16_bf16 a[48:63], v[36:39], v[56:59], a[48:63]
    ds_read_b64_tr_b16 v[50:51], v18 offset:6144
    ds_read_b64_tr_b16 v[52:53], v20 offset:4096
    v_mfma_f32_32x32x16_bf16 a[64:79], v[24:27], v[60:63], a[64:79]
    ds_read_b64_tr_b16 v[54:55], v20 offset:6144
    ds_read_b128 v[68:71], v22 offset:3072
    v_mfma_f32_32x32x16_bf16 a[80:95], v[28:31], v[60:63], a[80:95]
    buffer_load_dwordx4 v12, s[8:11], s17 offen offset:1024 lds
    s_add_u32 s17, s17, 2048
    v_mfma_f32_32x32x16_bf16 a[96:111], v[32:35], v[60:63], a[96:111]
    v_mfma_f32_32x32x16_bf16 a[112:127], v[36:39], v[60:63], a[112:127]
    s_waitcnt vmcnt(12) lgkmcnt(0)
    s_barrier
    v_mfma_f32_32x32x16_bf16 a[0:15], v[40:43], v[64:67], a[0:15]
    ds_read_b128 v[56:59], v22 offset:24576
    ds_read_b64_tr_b16 v[24:25], v14 offset:24576
    v_mfma_f32_32x32x16_bf16 a[16:31], v[44:47], v[64:67], a[16:31]
    ds_read_b64_tr_b16 v[26:27], v14 offset:26624
    ds_read_b64_tr_b16 v[28:29], v16 offset:24576
    s_add_u32 m0, s20, 49152
    s_nop 0
    buffer_load_dwordx4 v8, s[4:7], s16 offen offset:0 lds
    v_mfma_f32_32x32x16_bf16 a[32:47], v[48:51], v[64:67], a[32:47]
    ds_read_b64_tr_b16 v[30:31], v16 offset:26624
    ds_read_b64_tr_b16 v[32:33], v18 offset:24576
    v_mfma_f32_32x32x16_bf16 a[48:63], v[52:55], v[64:67], a[48:63]
    ds_read_b64_tr_b16 v[34:35], v18 offset:26624
    ds_read_b64_tr_b16 v[36:37], v20 offset:24576
    buffer_load_dwordx4 v9, s[4:7], s16 offen offset:1024 lds
    v_mfma_f32_32x32x16_bf16 a[64:79], v[40:43], v[68:71], a[64:79]
    ds_read_b64_tr_b16 v[38:39], v20 offset:26624
    ds_read_b128 v[60:63], v22 offset:26624
    v_mfma_f32_32x32x16_bf16 a[80:95], v[44:47], v[68:71], a[80:95]
    buffer_load_dwordx4 v10, s[4:7], s16 offen offset:2048 lds
    v_mfma_f32_32x32x16_bf16 a[96:111], v[48:51], v[68:71], a[96:111]
    v_mfma_f32_32x32x16_bf16 a[112:127], v[52:55], v[68:71], a[112:127]
    buffer_load_dwordx4 v11, s[4:7], s16 offen offset:3072 lds
    s_add_u32 s16, s16, s26
    s_waitcnt lgkmcnt(0)
    v_mfma_f32_32x32x16_bf16 a[0:15], v[24:27], v[56:59], a[0:15]
    ds_read_b128 v[64:67], v22 offset:25600
    ds_read_b64_tr_b16 v[40:41], v14 offset:28672
    v_mfma_f32_32x32x16_bf16 a[16:31], v[28:31], v[56:59], a[16:31]
    ds_read_b64_tr_b16 v[42:43], v14 offset:30720
    ds_read_b64_tr_b16 v[44:45], v16 offset:28672
    s_add_u32 m0, s21, 49152
    s_nop 0
    buffer_load_dwordx4 v12, s[8:11], s17 offen offset:0 lds
    v_mfma_f32_32x32x16_bf16 a[32:47], v[32:35], v[56:59], a[32:47]
    ds_read_b64_tr_b16 v[46:47], v16 offset:30720
    ds_read_b64_tr_b16 v[48:49], v18 offset:28672
    v_mfma_f32_32x32x16_bf16 a[48:63], v[36:39], v[56:59], a[48:63]
    ds_read_b64_tr_b16 v[50:51], v18 offset:30720
    ds_read_b64_tr_b16 v[52:53], v20 offset:28672
    v_mfma_f32_32x32x16_bf16 a[64:79], v[24:27], v[60:63], a[64:79]
    ds_read_b64_tr_b16 v[54:55], v20 offset:30720
    ds_read_b128 v[68:71], v22 offset:27648
    v_mfma_f32_32x32x16_bf16 a[80:95], v[28:31], v[60:63], a[80:95]
    buffer_load_dwordx4 v12, s[8:11], s17 offen offset:1024 lds
    s_add_u32 s17, s17, 2048
    v_mfma_f32_32x32x16_bf16 a[96:111], v[32:35], v[60:63], a[96:111]
    v_mfma_f32_32x32x16_bf16 a[112:127], v[36:39], v[60:63], a[112:127]
    s_waitcnt vmcnt(12) lgkmcnt(0)
    s_barrier
    v_mfma_f32_32x32x16_bf16 a[0:15], v[40:43], v[64:67], a[0:15]
    ds_read_b128 v[56:59], v21 offset:0
    ds_read_b64_tr_b16 v[24:25], v13 offset:0
    v_mfma_f32_32x32x16_bf16 a[16:31], v[44:47], v[64:67], a[16:31]
    ds_read_b64_tr_b16 v[26:27], v13 offset:2048
    ds_read_b64_tr_b16 v[28:29], v15 offset:0
    s_add_u32 m0, s20, 73728
    s_nop 0
    buffer_load_dwordx4 v8, s[4:7], s16 offen offset:0 lds
    v_mfma_f32_32x32x16_bf16 a[32:47], v[48:51], v[64:67], a[32:47]
    ds_read_b64_tr_b16 v[30:31], v15 offset:2048
    ds_read_b64_tr_b16 v[32:33], v17 offset:0
    v_mfma_f32_32x32x16_bf16 a[48:63], v[52:55], v[64:67], a[48:63]
    ds_read_b64_tr_b16 v[34:35], v17 offset:2048
    ds_read_b64_tr_b16 v[36:37], v19 offset:0
    buffer_load_dwordx4 v9, s[4:7], s16 offen offset:1024 lds
    v_mfma_f32_32x32x16_bf16 a[64:79], v[40:43], v[68:71], a[64:79]
    ds_read_b64_tr_b16 v[38:39], v19 offset:2048
    ds_read_b128 v[60:63], v21 offset:2048
    v_mfma_f32_32x32x16_bf16 a[80:95], v[44:47], v[68:71], a[80:95]
    buffer_load_dwordx4 v10, s[4:7], s16 offen offset:2048 lds
    v_mfma_f32_32x32x16_bf16 a[96:111], v[48:51], v[68:71], a[96:111]
    v_mfma_f32_32x32x16_bf16 a[112:127], v[52:55], v[68:71], a[112:127]
    buffer_load_dwordx4 v11, s[4:7], s16 offen offset:3072 lds
    s_add_u32 s16, s16, s26
    s_sub_u32 s18, s18, 1
    s_cmp_lg_u32 s18, 0
    s_cbranch_scc1 K_loop_1
    s_waitcnt lgkmcnt(0)
    v_mfma_f32_32x32x16_bf16 a[0:15], v[24:27], v[56:59], a[0:15]
    ds_read_b128 v[64:67], v21 offset:1024
    ds_read_b64_tr_b16 v[40:41], v13 offset:4096
    v_mfma_f32_32x32x16_bf16 a[16:31], v[28:31], v[56:59], a[16:31]
    ds_read_b64_tr_b16 v[42:43], v13 offset:6144
    ds_read_b64_tr_b16 v[44:45], v15 offset:4096
    s_add_u32 m0, s21, 73728
    s_nop 0
    buffer_load_dwordx4 v12, s[8:11], s17 offen offset:0 lds
    v_mfma_f32_32x32x16_bf16 a[32:47], v[32:35], v[56:59], a[32:47]
    ds_read_b64_tr_b16 v[46:47], v15 offset:6144
    ds_read_b64_tr_b16 v[48:49], v17 offset:4096
    v_mfma_f32_32x32x16_bf16 a[48:63], v[36:39], v[56:59], a[48:63]
    ds_read_b64_tr_b16 v[50:51], v17 offset:6144
    ds_read_b64_tr_b16 v[52:53], v19 offset:4096
    v_mfma_f32_32x32x16_bf16 a[64:79], v[24:27], v[60:63], a[64:79]
    ds_read_b64_tr_b16 v[54:55], v19 offset:6144
    ds_read_b128 v[68:71], v21 offset:3072
    v_mfma_f32_32x32x16_bf16 a[80:95], v[28:31], v[60:63], a[80:95]
    buffer_load_dwordx4 v12, s[8:11], s17 offen offset:1024 lds
    s_add_u32 s17, s17, 2048
    v_mfma_f32_32x32x16_bf16 a[96:111], v[32:35], v[60:63], a[96:111]
    v_mfma_f32_32x32x16_bf16 a[112:127], v[36:39], v[60:63], a[112:127]
    s_waitcnt vmcnt(12) lgkmcnt(0)
    s_barrier
    v_mfma_f32_32x32x16_bf16 a[0:15], v[40:43], v[64:67], a[0:15]
    ds_read_b128 v[56:59], v21 offset:24576
    ds_read_b64_tr_b16 v[24:25], v13 offset:24576
    v_mfma_f32_32x32x16_bf16 a[16:31], v[44:47], v[64:67], a[16:31]
    ds_read_b64_tr_b16 v[26:27], v13 offset:26624
    ds_read_b64_tr_b16 v[28:29], v15 offset:24576
    v_mfma_f32_32x32x16_bf16 a[32:47], v[48:51], v[64:67], a[32:47]
    ds_read_b64_tr_b16 v[30:31], v15 offset:26624
    ds_read_b64_tr_b16 v[32:33], v17 offset:24576
    v_mfma_f32_32x32x16_bf16 a[48:63], v[52:55], v[64:67], a[48:63]
    ds_read_b64_tr_b16 v[34:35], v17 offset:26624
    ds_read_b64_tr_b16 v[36:37], v19 offset:24576
    v_mfma_f32_32x32x16_bf16 a[64:79], v[40:43], v[68:71], a[64:79]
    ds_read_b64_tr_b16 v[38:39], v19 offset:26624
    ds_read_b128 v[60:63], v21 offset:26624
    v_mfma_f32_32x32x16_bf16 a[80:95], v[44:47], v[68:71], a[80:95]
    v_mfma_f32_32x32x16_bf16 a[96:111], v[48:51], v[68:71], a[96:111]
    v_mfma_f32_32x32x16_bf16 a[112:127], v[52:55], v[68:71], a[112:127]
    s_waitcnt lgkmcnt(0)
    v_mfma_f32_32x32x16_bf16 a[0:15], v[24:27], v[56:59], a[0:15]
    ds_read_b128 v[64:67], v21 offset:25600
    ds_read_b64_tr_b16 v[40:41], v13 offset:28672
    v_mfma_f32_32x32x16_bf16 a[16:31], v[28:31], v[56:59], a[16:31]
    ds_read_b64_tr_b16 v[42:43], v13 offset:30720
    ds_read_b64_tr_b16 v[44:45], v15 offset:28672
    v_mfma_f32_32x32x16_bf16 a[32:47], v[32:35], v[56:59], a[32:47]
    ds_read_b64_tr_b16 v[46:47], v15 offset:30720
    ds_read_b64_tr_b16 v[48:49], v17 offset:28672
    v_mfma_f32_32x32x16_bf16 a[48:63], v[36:39], v[56:59], a[48:63]
    ds_read_b64_tr_b16 v[50:51], v17 offset:30720
    ds_read_b64_tr_b16 v[52:53], v19 offset:28672
    v_mfma_f32_32x32x16_bf16 a[64:79], v[24:27], v[60:63], a[64:79]
    ds_read_b64_tr_b16 v[54:55], v19 offset:30720
    ds_read_b128 v[68:71], v21 offset:27648
    v_mfma_f32_32x32x16_bf16 a[80:95], v[28:31], v[60:63], a[80:95]
    v_mfma_f32_32x32x16_bf16 a[96:111], v[32:35], v[60:63], a[96:111]
    v_mfma_f32_32x32x16_bf16 a[112:127], v[36:39], v[60:63], a[112:127]
    s_waitcnt vmcnt(6) lgkmcnt(0)
    s_barrier
    v_mfma_f32_32x32x16_bf16 a[0:15], v[40:43], v[64:67], a[0:15]
    ds_read_b128 v[56:59], v22 offset:0
    ds_read_b64_tr_b16 v[24:25], v14 offset:0
    v_mfma_f32_32x32x16_bf16 a[16:31], v[44:47], v[64:67], a[16:31]
    ds_read_b64_tr_b16 v[26:27], v14 offset:2048
    ds_read_b64_tr_b16 v[28:29], v16 offset:0
    v_mfma_f32_32x32x16_bf16 a[32:47], v[48:51], v[64:67], a[32:47]
    ds_read_b64_tr_b16 v[30:31], v16 offset:2048
    ds_read_b64_tr_b16 v[32:33], v18 offset:0
    v_mfma_f32_32x32x16_bf16 a[48:63], v[52:55], v[64:67], a[48:63]
    ds_read_b64_tr_b16 v[34:35], v18 offset:2048
    ds_read_b64_tr_b16 v[36:37], v20 offset:0
    v_mfma_f32_32x32x16_bf16 a[64:79], v[40:43], v[68:71], a[64:79]
    ds_read_b64_tr_b16 v[38:39], v20 offset:2048
    ds_read_b128 v[60:63], v22 offset:2048
    v_mfma_f32_32x32x16_bf16 a[80:95], v[44:47], v[68:71], a[80:95]
    v_mfma_f32_32x32x16_bf16 a[96:111], v[48:51], v[68:71], a[96:111]
    v_mfma_f32_32x32x16_bf16 a[112:127], v[52:55], v[68:71], a[112:127]
    s_waitcnt lgkmcnt(0)
    v_mfma_f32_32x32x16_bf16 a[0:15], v[24:27], v[56:59], a[0:15]
    ds_read_b128 v[64:67], v22 offset:1024
    ds_read_b64_tr_b16 v[40:41], v14 offset:4096
    v_mfma_f32_32x32x16_bf16 a[16:31], v[28:31], v[56:59], a[16:31]
    ds_read_b64_tr_b16 v[42:43], v14 offset:6144
    ds_read_b64_tr_b16 v[44:45], v16 offset:4096
    v_mfma_f32_32x32x16_bf16 a[32:47], v[32:35], v[56:59], a[32:47]
    ds_read_b64_tr_b16 v[46:47], v16 offset:6144
    ds_read_b64_tr_b16 v[48:49], v18 offset:4096
    v_mfma_f32_32x32x16_bf16 a[48:63], v[36:39], v[56:59], a[48:63]
    ds_read_b64_tr_b16 v[50:51], v18 offset:6144
    ds_read_b64_tr_b16 v[52:53], v20 offset:4096
    v_mfma_f32_32x32x16_bf16 a[64:79], v[24:27], v[60:63], a[64:79]
    ds_read_b64_tr_b16 v[54:55], v20 offset:6144
    ds_read_b128 v[68:71], v22 offset:3072
    v_mfma_f32_32x32x16_bf16 a[80:95], v[28:31], v[60:63], a[80:95]
    v_mfma_f32_32x32x16_bf16 a[96:111], v[32:35], v[60:63], a[96:111]
    v_mfma_f32_32x32x16_bf16 a[112:127], v[36:39], v[60:63], a[112:127]
    s_waitcnt vmcnt(0) lgkmcnt(0)
    s_barrier
    v_mfma_f32_32x32x16_bf16 a[0:15], v[40:43], v[64:67], a[0:15]
    ds_read_b128 v[56:59], v22 offset:24576
    ds_read_b64_tr_b16 v[24:25], v14 offset:24576
    v_mfma_f32_32x32x16_bf16 a[16:31], v[44:47], v[64:67], a[16:31]
    ds_read_b64_tr_b16 v[26:27], v14 offset:26624
    ds_read_b64_tr_b16 v[28:29], v16 offset:24576
    v_mfma_f32_32x32x16_bf16 a[32:47], v[48:51], v[64:67], a[32:47]
    ds_read_b64_tr_b16 v[30:31], v16 offset:26624
    ds_read_b64_tr_b16 v[32:33], v18 offset:24576
    v_mfma_f32_32x32x16_bf16 a[48:63], v[52:55], v[64:67], a[48:63]
    ds_read_b64_tr_b16 v[34:35], v18 offset:26624
    ds_read_b64_tr_b16 v[36:37], v20 offset:24576
    v_mfma_f32_32x32x16_bf16 a[64:79], v[40:43], v[68:71], a[64:79]
    ds_read_b64_tr_b16 v[38:39], v20 offset:26624
    ds_read_b128 v[60:63], v22 offset:26624
    v_mfma_f32_32x32x16_bf16 a[80:95], v[44:47], v[68:71], a[80:95]
    v_mfma_f32_32x32x16_bf16 a[96:111], v[48:51], v[68:71], a[96:111]
    v_mfma_f32_32x32x16_bf16 a[112:127], v[52:55], v[68:71], a[112:127]
    s_waitcnt lgkmcnt(0)
    v_mfma_f32_32x32x16_bf16 a[0:15], v[24:27], v[56:59], a[0:15]
    ds_read_b128 v[64:67], v22 offset:25600
    ds_read_b64_tr_b16 v[40:41], v14 offset:28672
    v_mfma_f32_32x32x16_bf16 a[16:31], v[28:31], v[56:59], a[16:31]
    ds_read_b64_tr_b16 v[42:43], v14 offset:30720
    ds_read_b64_tr_b16 v[44:45], v16 offset:28672
    v_mfma_f32_32x32x16_bf16 a[32:47], v[32:35], v[56:59], a[32:47]
    ds_read_b64_tr_b16 v[46:47], v16 offset:30720
    ds_read_b64_tr_b16 v[48:49], v18 offset:28672
    v_mfma_f32_32x32x16_bf16 a[48:63], v[36:39], v[56:59], a[48:63]
    ds_read_b64_tr_b16 v[50:51], v18 offset:30720
    ds_read_b64_tr_b16 v[52:53], v20 offset:28672
    v_mfma_f32_32x32x16_bf16 a[64:79], v[24:27], v[60:63], a[64:79]
    ds_read_b64_tr_b16 v[54:55], v20 offset:30720
    ds_read_b128 v[68:71], v22 offset:27648
    v_mfma_f32_32x32x16_bf16 a[80:95], v[28:31], v[60:63], a[80:95]
    v_mfma_f32_32x32x16_bf16 a[96:111], v[32:35], v[60:63], a[96:111]
    v_mfma_f32_32x32x16_bf16 a[112:127], v[36:39], v[60:63], a[112:127]
    s_waitcnt lgkmcnt(0)
    v_mfma_f32_32x32x16_bf16 a[0:15], v[40:43], v[64:67], a[0:15]
    v_mfma_f32_32x32x16_bf16 a[16:31], v[44:47], v[64:67], a[16:31]
    v_mfma_f32_32x32x16_bf16 a[32:47], v[48:51], v[64:67], a[32:47]
    v_mfma_f32_32x32x16_bf16 a[48:63], v[52:55], v[64:67], a[48:63]
    v_mfma_f32_32x32x16_bf16 a[64:79], v[40:43], v[68:71], a[64:79]
    v_mfma_f32_32x32x16_bf16 a[80:95], v[44:47], v[68:71], a[80:95]
    v_mfma_f32_32x32x16_bf16 a[96:111], v[48:51], v[68:71], a[96:111]
    v_mfma_f32_32x32x16_bf16 a[112:127], v[52:55], v[68:71], a[112:127]
    s_add_u32 s36, s34, 0x400000
    s_addc_u32 s37, s35, 0
    s_and_b32 s37, s37, 0xffff
    s_mov_b32 s38, 0x1000000
    s_mov_b32 s39, 0x00020000
    v_and_b32 v1, 63, v0
    v_lshlrev_b32 v1, 4, v1
    s_lshr_b32 s22, s19, 1
    s_lshl_b32 s22, s22, 1
    s_lshl_b32 s23, s28, 2
    s_add_u32 s22, s22, s23
    s_lshl_b32 s22, s22, 8
    s_and_b32 s23, s19, 1
    s_lshl_b32 s23, s23, 3
    s_add_u32 s22, s22, s23
    s_lshl_b32 s23, s29, 4
    s_add_u32 s22, s22, s23
    s_lshl_b32 s22, s22, 10
    v_add_u32 v1, s22, v1
    s_nop 7
    s_nop 7
    v_accvgpr_read_b32 v72, a0
    v_accvgpr_read_b32 v73, a1
    v_accvgpr_read_b32 v74, a2
    v_accvgpr_read_b32 v75, a3
    v_accvgpr_read_b32 v76, a4
    v_accvgpr_read_b32 v77, a5
    v_accvgpr_read_b32 v78, a6
    v_accvgpr_read_b32 v79, a7
    v_accvgpr_read_b32 v80, a8
    v_accvgpr_read_b32 v81, a9
    v_accvgpr_read_b32 v82, a10
    v_accvgpr_read_b32 v83, a11
    v_accvgpr_read_b32 v84, a12
    v_accvgpr_read_b32 v85, a13
    v_accvgpr_read_b32 v86, a14
    v_accvgpr_read_b32 v87, a15
    v_cvt_pk_bf16_f32 v88, v72, v73
    v_cvt_pk_bf16_f32 v89, v74, v75
    v_cvt_pk_bf16_f32 v90, v76, v77
    v_cvt_pk_bf16_f32 v91, v78, v79
    v_cvt_pk_bf16_f32 v92, v80, v81
    v_cvt_pk_bf16_f32 v93, v82, v83
    v_cvt_pk_bf16_f32 v94, v84, v85
    v_cvt_pk_bf16_f32 v95, v86, v87
    s_mov_b32 s24, 0
    buffer_store_dwordx4 v[88:91], v1, s[36:39], s24 offen offset:0 sc1
    buffer_store_dwordx4 v[92:95], v1, s[36:39], s24 offen offset:1024 sc1
    v_accvgpr_read_b32 v96, a16
    v_accvgpr_read_b32 v97, a17
    v_accvgpr_read_b32 v98, a18
    v_accvgpr_read_b32 v99, a19
    v_accvgpr_read_b32 v100, a20
    v_accvgpr_read_b32 v101, a21
    v_accvgpr_read_b32 v102, a22
    v_accvgpr_read_b32 v103, a23
    v_accvgpr_read_b32 v104, a24
    v_accvgpr_read_b32 v105, a25
    v_accvgpr_read_b32 v106, a26
    v_accvgpr_read_b32 v107, a27
    v_accvgpr_read_b32 v108, a28
    v_accvgpr_read_b32 v109, a29
    v_accvgpr_read_b32 v110, a30
    v_accvgpr_read_b32 v111, a31
    v_cvt_pk_bf16_f32 v112, v96, v97
    v_cvt_pk_bf16_f32 v113, v98, v99
    v_cvt_pk_bf16_f32 v114, v100, v101
    v_cvt_pk_bf16_f32 v115, v102, v103
    v_cvt_pk_bf16_f32 v116, v104, v105
    v_cvt_pk_bf16_f32 v117, v106, v107
    v_cvt_pk_bf16_f32 v118, v108, v109
    v_cvt_pk_bf16_f32 v119, v110, v111
    s_mov_b32 s24, 0
    buffer_store_dwordx4 v[112:115], v1, s[36:39], s24 offen offset:2048 sc1
    buffer_store_dwordx4 v[116:119], v1, s[36:39], s24 offen offset:3072 sc1
    v_accvgpr_read_b32 v120, a32
    v_accvgpr_read_b32 v121, a33
    v_accvgpr_read_b32 v122, a34
    v_accvgpr_read_b32 v123, a35
    v_accvgpr_read_b32 v124, a36
    v_accvgpr_read_b32 v125, a37
    v_accvgpr_read_b32 v126, a38
    v_accvgpr_read_b32 v127, a39
    v_accvgpr_read_b32 v128, a40
    v_accvgpr_read_b32 v129, a41
    v_accvgpr_read_b32 v130, a42
    v_accvgpr_read_b32 v131, a43
    v_accvgpr_read_b32 v132, a44
    v_accvgpr_read_b32 v133, a45
    v_accvgpr_read_b32 v134, a46
    v_accvgpr_read_b32 v135, a47
    v_cvt_pk_bf16_f32 v136, v120, v121
    v_cvt_pk_bf16_f32 v137, v122, v123
    v_cvt_pk_bf16_f32 v138, v124, v125
    v_cvt_pk_bf16_f32 v139, v126, v127
    v_cvt_pk_bf16_f32 v140, v128, v129
    v_cvt_pk_bf16_f32 v141, v130, v131
    v_cvt_pk_bf16_f32 v142, v132, v133
    v_cvt_pk_bf16_f32 v143, v134, v135
    s_mov_b32 s24, 4096
    buffer_store_dwordx4 v[136:139], v1, s[36:39], s24 offen offset:0 sc1
    buffer_store_dwordx4 v[140:143], v1, s[36:39], s24 offen offset:1024 sc1
    v_accvgpr_read_b32 v144, a48
    v_accvgpr_read_b32 v145, a49
    v_accvgpr_read_b32 v146, a50
    v_accvgpr_read_b32 v147, a51
    v_accvgpr_read_b32 v148, a52
    v_accvgpr_read_b32 v149, a53
    v_accvgpr_read_b32 v150, a54
    v_accvgpr_read_b32 v151, a55
    v_accvgpr_read_b32 v152, a56
    v_accvgpr_read_b32 v153, a57
    v_accvgpr_read_b32 v154, a58
    v_accvgpr_read_b32 v155, a59
    v_accvgpr_read_b32 v156, a60
    v_accvgpr_read_b32 v157, a61
    v_accvgpr_read_b32 v158, a62
    v_accvgpr_read_b32 v159, a63
    v_cvt_pk_bf16_f32 v160, v144, v145
    v_cvt_pk_bf16_f32 v161, v146, v147
    v_cvt_pk_bf16_f32 v162, v148, v149
    v_cvt_pk_bf16_f32 v163, v150, v151
    v_cvt_pk_bf16_f32 v164, v152, v153
    v_cvt_pk_bf16_f32 v165, v154, v155
    v_cvt_pk_bf16_f32 v166, v156, v157
    v_cvt_pk_bf16_f32 v167, v158, v159
    s_mov_b32 s24, 4096
    buffer_store_dwordx4 v[160:163], v1, s[36:39], s24 offen offset:2048 sc1
    buffer_store_dwordx4 v[164:167], v1, s[36:39], s24 offen offset:3072 sc1
    s_waitcnt vmcnt(6)
    v_accvgpr_read_b32 v72, a64
    v_accvgpr_read_b32 v73, a65
    v_accvgpr_read_b32 v74, a66
    v_accvgpr_read_b32 v75, a67
    v_accvgpr_read_b32 v76, a68
    v_accvgpr_read_b32 v77, a69
    v_accvgpr_read_b32 v78, a70
    v_accvgpr_read_b32 v79, a71
    v_accvgpr_read_b32 v80, a72
    v_accvgpr_read_b32 v81, a73
    v_accvgpr_read_b32 v82, a74
    v_accvgpr_read_b32 v83, a75
    v_accvgpr_read_b32 v84, a76
    v_accvgpr_read_b32 v85, a77
    v_accvgpr_read_b32 v86, a78
    v_accvgpr_read_b32 v87, a79
    v_cvt_pk_bf16_f32 v88, v72, v73
    v_cvt_pk_bf16_f32 v89, v74, v75
    v_cvt_pk_bf16_f32 v90, v76, v77
    v_cvt_pk_bf16_f32 v91, v78, v79
    v_cvt_pk_bf16_f32 v92, v80, v81
    v_cvt_pk_bf16_f32 v93, v82, v83
    v_cvt_pk_bf16_f32 v94, v84, v85
    v_cvt_pk_bf16_f32 v95, v86, v87
    s_mov_b32 s24, 262144
    buffer_store_dwordx4 v[88:91], v1, s[36:39], s24 offen offset:0 sc1
    buffer_store_dwordx4 v[92:95], v1, s[36:39], s24 offen offset:1024 sc1
    s_waitcnt vmcnt(6)
    v_accvgpr_read_b32 v96, a80
    v_accvgpr_read_b32 v97, a81
    v_accvgpr_read_b32 v98, a82
    v_accvgpr_read_b32 v99, a83
    v_accvgpr_read_b32 v100, a84
    v_accvgpr_read_b32 v101, a85
    v_accvgpr_read_b32 v102, a86
    v_accvgpr_read_b32 v103, a87
    v_accvgpr_read_b32 v104, a88
    v_accvgpr_read_b32 v105, a89
    v_accvgpr_read_b32 v106, a90
    v_accvgpr_read_b32 v107, a91
    v_accvgpr_read_b32 v108, a92
    v_accvgpr_read_b32 v109, a93
    v_accvgpr_read_b32 v110, a94
    v_accvgpr_read_b32 v111, a95
    v_cvt_pk_bf16_f32 v112, v96, v97
    v_cvt_pk_bf16_f32 v113, v98, v99
    v_cvt_pk_bf16_f32 v114, v100, v101
    v_cvt_pk_bf16_f32 v115, v102, v103
    v_cvt_pk_bf16_f32 v116, v104, v105
    v_cvt_pk_bf16_f32 v117, v106, v107
    v_cvt_pk_bf16_f32 v118, v108, v109
    v_cvt_pk_bf16_f32 v119, v110, v111
    s_mov_b32 s24, 262144
    buffer_store_dwordx4 v[112:115], v1, s[36:39], s24 offen offset:2048 sc1
    buffer_store_dwordx4 v[116:119], v1, s[36:39], s24 offen offset:3072 sc1
    s_waitcnt vmcnt(6)
    v_accvgpr_read_b32 v120, a96
    v_accvgpr_read_b32 v121, a97
    v_accvgpr_read_b32 v122, a98
    v_accvgpr_read_b32 v123, a99
    v_accvgpr_read_b32 v124, a100
    v_accvgpr_read_b32 v125, a101
    v_accvgpr_read_b32 v126, a102
    v_accvgpr_read_b32 v127, a103
    v_accvgpr_read_b32 v128, a104
    v_accvgpr_read_b32 v129, a105
    v_accvgpr_read_b32 v130, a106
    v_accvgpr_read_b32 v131, a107
    v_accvgpr_read_b32 v132, a108
    v_accvgpr_read_b32 v133, a109
    v_accvgpr_read_b32 v134, a110
    v_accvgpr_read_b32 v135, a111
    v_cvt_pk_bf16_f32 v136, v120, v121
    v_cvt_pk_bf16_f32 v137, v122, v123
    v_cvt_pk_bf16_f32 v138, v124, v125
    v_cvt_pk_bf16_f32 v139, v126, v127
    v_cvt_pk_bf16_f32 v140, v128, v129
    v_cvt_pk_bf16_f32 v141, v130, v131
    v_cvt_pk_bf16_f32 v142, v132, v133
    v_cvt_pk_bf16_f32 v143, v134, v135
    s_mov_b32 s24, 266240
    buffer_store_dwordx4 v[136:139], v1, s[36:39], s24 offen offset:0 sc1
    buffer_store_dwordx4 v[140:143], v1, s[36:39], s24 offen offset:1024 sc1
    s_waitcnt vmcnt(6)
    v_accvgpr_read_b32 v144, a112
    v_accvgpr_read_b32 v145, a113
    v_accvgpr_read_b32 v146, a114
    v_accvgpr_read_b32 v147, a115
    v_accvgpr_read_b32 v148, a116
    v_accvgpr_read_b32 v149, a117
    v_accvgpr_read_b32 v150, a118
    v_accvgpr_read_b32 v151, a119
    v_accvgpr_read_b32 v152, a120
    v_accvgpr_read_b32 v153, a121
    v_accvgpr_read_b32 v154, a122
    v_accvgpr_read_b32 v155, a123
    v_accvgpr_read_b32 v156, a124
    v_accvgpr_read_b32 v157, a125
    v_accvgpr_read_b32 v158, a126
    v_accvgpr_read_b32 v159, a127
    v_cvt_pk_bf16_f32 v160, v144, v145
    v_cvt_pk_bf16_f32 v161, v146, v147
    v_cvt_pk_bf16_f32 v162, v148, v149
    v_cvt_pk_bf16_f32 v163, v150, v151
    v_cvt_pk_bf16_f32 v164, v152, v153
    v_cvt_pk_bf16_f32 v165, v154, v155
    v_cvt_pk_bf16_f32 v166, v156, v157
    v_cvt_pk_bf16_f32 v167, v158, v159
    s_mov_b32 s24, 266240
    buffer_store_dwordx4 v[160:163], v1, s[36:39], s24 offen offset:2048 sc1
    buffer_store_dwordx4 v[164:167], v1, s[36:39], s24 offen offset:3072 sc1
    s_branch KQ_FIN
KQ_V:
    s_load_dwordx2 s[32:33], s[0:1], 32
    s_load_dwordx2 s[34:35], s[0:1], 104
    s_mov_b32 s14, 8192
    s_mov_b32 s15, 65536
    s_mov_b32 s18, 7
    s_mov_b32 s25, 0
    s_mul_i32 s13, s28, 262144
    s_lshr_b32 s22, s19, 1
    s_lshl_b32 s12, s29, 9
    s_lshl_b32 s23, s22, 8
    s_add_u32 s12, s12, s23
    s_mov_b32 s16, 0
    s_mov_b32 s17, 0
    s_waitcnt lgkmcnt(0)
    s_mov_b32 s4, s32
    s_mov_b32 s5, s33
    s_and_b32 s5, s5, 0xffff
    s_mov_b32 s6, 0x800000
    s_mov_b32 s7, 0x00020000
    s_mov_b32 s8, s34
    s_mov_b32 s9, s35
    s_and_b32 s9, s9, 0xffff
    s_mov_b32 s10, 0x400000
    s_mov_b32 s11, 0x00020000
    v_and_b32 v1, 63, v0
    s_lshl_b32 s26, s14, 5
    s_mul_i32 s22, s19, 4
    s_and_b32 s22, s22, 7
    s_lshl_b32 s22, s22, 2
    s_mul_i32 s22, s22, s14
    s_add_u32 s22, s22, s12
    v_lshrrev_b32 v2, 4, v1
    v_lshlrev_b32 v3, 2, v2
    v_and_b32 v8, 15, v1
    v_xor_b32 v8, v8, v3
    v_lshlrev_b32 v8, 4, v8
    v_mul_lo_u32 v2, s14, v2
    v_add3_u32 v8, v8, v2, s22
    s_lshl_b32 s22, s14, 2
    s_sub_u32 s22, s22, 1024
    v_add_u32 v9, s22, v8
    v_add_u32 v10, s22, v9
    v_add_u32 v11, s22, v10
    v_lshlrev_b32 v2, 4, v1
    s_mul_i32 s22, s19, s15
    s_add_u32 s22, s22, s13
    v_add_u32 v12, s22, v2
    s_mul_i32 s20, s19, 4096
    s_mul_i32 s21, s19, 2048
    s_add_u32 s21, s21, 16384
    v_bfe_u32 v2, v1, 2, 2
    v_lshrrev_b32 v3, 5, v1
    v_lshl_add_u32 v3, v3, 2, v2
    v_lshlrev_b32 v3, 8, v3
    v_bfe_u32 v13, v1, 4, 1
    v_lshl_add_u32 v3, v13, 5, v3
    v_bfe_u32 v13, v1, 1, 1
    v_lshl_add_u32 v3, v13, 4, v3
    v_and_b32 v13, 1, v1
    v_lshl_add_u32 v3, v13, 3, v3
    s_and_b32 s22, s19, 1
    s_lshl_b32 s23, s22, 1
    s_add_u32 s23, s23, 0
    s_cmp_lg_u32 s25, 0
    s_cselect_b32 s23, s23, 0
    s_cselect_b32 s24, 0, s22
    s_lshl_b32 s24, s24, 13
    v_xor_b32 v13, s23, v2
    v_lshl_add_u32 v13, v13, 6, v3
    v_add_u32 v13, s24, v13
    v_add_u32 v14, 49152, v13
    s_lshl_b32 s23, s22, 1
    s_add_u32 s23, s23, 1
    s_cmp_lg_u32 s25, 0
    s_cselect_b32 s23, s23, 1
    s_cselect_b32 s24, 0, s22
    s_lshl_b32 s24, s24, 13
    v_xor_b32 v15, s23, v2
    v_lshl_add_u32 v15, v15, 6, v3
    v_add_u32 v15, s24, v15
    v_add_u32 v16, 49152, v15
    s_lshl_b32 s23, s22, 1
    s_add_u32 s23, s23, 0
    s_cmp_lg_u32 s25, 0
    s_cselect_b32 s23, s23, 2
    s_cselect_b32 s24, 1, s22
    s_lshl_b32 s24, s24, 13
    v_xor_b32 v17, s23, v2
    v_lshl_add_u32 v17, v17, 6, v3
    v_add_u32 v17, s24, v17
    v_add_u32 v18, 49152, v17
    s_lshl_b32 s23, s22, 1
    s_add_u32 s23, s23, 1
    s_cmp_lg_u32 s25, 0
    s_cselect_b32 s23, s23, 3
    s_cselect_b32 s24, 1, s22
    s_lshl_b32 s24, s24, 13
    v_xor_b32 v19, s23, v2
    v_lshl_add_u32 v19, v19, 6, v3
    v_add_u32 v19, s24, v19
    v_add_u32 v20, 49152, v19
    s_lshr_b32 s22, s19, 1
    s_mul_i32 s22, s22, 4096
    s_add_u32 s22, s22, 16384
    v_lshlrev_b32 v21, 4, v1
    v_add_u32 v21, s22, v21
    v_add_u32 v22, 49152, v21
    s_mov_b32 m0, s20
    s_nop 0
    buffer_load_dwordx4 v8, s[4:7], s16 offen offset:0 lds
    buffer_load_dwordx4 v9, s[4:7], s16 offen offset:1024 lds
    buffer_load_dwordx4 v10, s[4:7], s16 offen offset:2048 lds
    buffer_load_dwordx4 v11, s[4:7], s16 offen offset:3072 lds
    s_add_u32 s16, s16, s26
    s_add_u32 m0, s21, 0
    s_nop 0
    buffer_load_dwordx4 v12, s[8:11], s17 offen offset:0 lds
    buffer_load_dwordx4 v12, s[8:11], s17 offen offset:1024 lds
    s_add_u32 s17, s17, 2048
    s_add_u32 m0, s20, 24576
    s_nop 0
    buffer_load_dwordx4 v8, s[4:7], s16 offen offset:0 lds
    buffer_load_dwordx4 v9, s[4:7], s16 offen offset:1024 lds
    buffer_load_dwordx4 v10, s[4:7], s16 offen offset:2048 lds
    buffer_load_dwordx4 v11, s[4:7], s16 offen offset:3072 lds
    s_add_u32 s16, s16, s26
    s_add_u32 m0, s21, 24576
    s_nop 0
    buffer_load_dwordx4 v12, s[8:11], s17 offen offset:0 lds
    buffer_load_dwordx4 v12, s[8:11], s17 offen offset:1024 lds
    s_add_u32 s17, s17, 2048
    s_add_u32 m0, s20, 49152
    s_nop 0
    buffer_load_dwordx4 v8, s[4:7], s16 offen offset:0 lds
    buffer_load_dwordx4 v9, s[4:7], s16 offen offset:1024 lds
    buffer_load_dwordx4 v10, s[4:7], s16 offen offset:2048 lds
    buffer_load_dwordx4 v11, s[4:7], s16 offen offset:3072 lds
    s_add_u32 s16, s16, s26
    s_add_u32 m0, s21, 49152
    s_nop 0
    buffer_load_dwordx4 v12, s[8:11], s17 offen offset:0 lds
    buffer_load_dwordx4 v12, s[8:11], s17 offen offset:1024 lds
    s_add_u32 s17, s17, 2048
    s_add_u32 m0, s20, 73728
    s_nop 0
    buffer_load_dwordx4 v8, s[4:7], s16 offen offset:0 lds
    buffer_load_dwordx4 v9, s[4:7], s16 offen offset:1024 lds
    buffer_load_dwordx4 v10, s[4:7], s16 offen offset:2048 lds
    buffer_load_dwordx4 v11, s[4:7], s16 offen offset:3072 lds
    s_add_u32 s16, s16, s26
    v_accvgpr_write_b32 a0, 0
    v_accvgpr_write_b32 a1, 0
    v_accvgpr_write_b32 a2, 0
    v_accvgpr_write_b32 a3, 0
    v_accvgpr_write_b32 a4, 0
    v_accvgpr_write_b32 a5, 0
    v_accvgpr_write_b32 a6, 0
    v_accvgpr_write_b32 a7, 0
    v_accvgpr_write_b32 a8, 0
    v_accvgpr_write_b32 a9, 0
    v_accvgpr_write_b32 a10, 0
    v_accvgpr_write_b32 a11, 0
    v_accvgpr_write_b32 a12, 0
    v_accvgpr_write_b32 a13, 0
    v_accvgpr_write_b32 a14, 0
    v_accvgpr_write_b32 a15, 0
    v_accvgpr_write_b32 a16, 0
    v_accvgpr_write_b32 a17, 0
    v_accvgpr_write_b32 a18, 0
    v_accvgpr_write_b32 a19, 0
    v_accvgpr_write_b32 a20, 0
    v_accvgpr_write_b32 a21, 0
    v_accvgpr_write_b32 a22, 0
    v_accvgpr_write_b32 a23, 0
    v_accvgpr_write_b32 a24, 0
    v_accvgpr_write_b32 a25, 0
    v_accvgpr_write_b32 a26, 0
    v_accvgpr_write_b32 a27, 0
    v_accvgpr_write_b32 a28, 0
    v_accvgpr_write_b32 a29, 0
    v_accvgpr_write_b32 a30, 0
    v_accvgpr_write_b32 a31, 0
    v_accvgpr_write_b32 a32, 0
    v_accvgpr_write_b32 a33, 0
    v_accvgpr_write_b32 a34, 0
    v_accvgpr_write_b32 a35, 0
    v_accvgpr_write_b32 a36, 0
    v_accvgpr_write_b32 a37, 0
    v_accvgpr_write_b32 a38, 0
    v_accvgpr_write_b32 a39, 0
    v_accvgpr_write_b32 a40, 0
    v_accvgpr_write_b32 a41, 0
    v_accvgpr_write_b32 a42, 0
    v_accvgpr_write_b32 a43, 0
    v_accvgpr_write_b32 a44, 0
    v_accvgpr_write_b32 a45, 0
    v_accvgpr_write_b32 a46, 0
    v_accvgpr_write_b32 a47, 0
    v_accvgpr_write_b32 a48, 0
    v_accvgpr_write_b32 a49, 0
    v_accvgpr_write_b32 a50, 0
    v_accvgpr_write_b32 a51, 0
    v_accvgpr_write_b32 a52, 0
    v_accvgpr_write_b32 a53, 0
    v_accvgpr_write_b32 a54, 0
    v_accvgpr_write_b32 a55, 0
    v_accvgpr_write_b32 a56, 0
    v_accvgpr_write_b32 a57, 0
    v_accvgpr_write_b32 a58, 0
    v_accvgpr_write_b32 a59, 0
    v_accvgpr_write_b32 a60, 0
    v_accvgpr_write_b32 a61, 0
    v_accvgpr_write_b32 a62, 0
    v_accvgpr_write_b32 a63, 0
    v_accvgpr_write_b32 a64, 0
    v_accvgpr_write_b32 a65, 0
    v_accvgpr_write_b32 a66, 0
    v_accvgpr_write_b32 a67, 0
    v_accvgpr_write_b32 a68, 0
    v_accvgpr_write_b32 a69, 0
    v_accvgpr_write_b32 a70, 0
    v_accvgpr_write_b32 a71, 0
    v_accvgpr_write_b32 a72, 0
    v_accvgpr_write_b32 a73, 0
    v_accvgpr_write_b32 a74, 0
    v_accvgpr_write_b32 a75, 0
    v_accvgpr_write_b32 a76, 0
    v_accvgpr_write_b32 a77, 0
    v_accvgpr_write_b32 a78, 0
    v_accvgpr_write_b32 a79, 0
    v_accvgpr_write_b32 a80, 0
    v_accvgpr_write_b32 a81, 0
    v_accvgpr_write_b32 a82, 0
    v_accvgpr_write_b32 a83, 0
    v_accvgpr_write_b32 a84, 0
    v_accvgpr_write_b32 a85, 0
    v_accvgpr_write_b32 a86, 0
    v_accvgpr_write_b32 a87, 0
    v_accvgpr_write_b32 a88, 0
    v_accvgpr_write_b32 a89, 0
    v_accvgpr_write_b32 a90, 0
    v_accvgpr_write_b32 a91, 0
    v_accvgpr_write_b32 a92, 0
    v_accvgpr_write_b32 a93, 0
    v_accvgpr_write_b32 a94, 0
    v_accvgpr_write_b32 a95, 0
    v_accvgpr_write_b32 a96, 0
    v_accvgpr_write_b32 a97, 0
    v_accvgpr_write_b32 a98, 0
    v_accvgpr_write_b32 a99, 0
    v_accvgpr_write_b32 a100, 0
    v_accvgpr_write_b32 a101, 0
    v_accvgpr_write_b32 a102, 0
    v_accvgpr_write_b32 a103, 0
    v_accvgpr_write_b32 a104, 0
    v_accvgpr_write_b32 a105, 0
    v_accvgpr_write_b32 a106, 0
    v_accvgpr_write_b32 a107, 0
    v_accvgpr_write_b32 a108, 0
    v_accvgpr_write_b32 a109, 0
    v_accvgpr_write_b32 a110, 0
    v_accvgpr_write_b32 a111, 0
    v_accvgpr_write_b32 a112, 0
    v_accvgpr_write_b32 a113, 0
    v_accvgpr_write_b32 a114, 0
    v_accvgpr_write_b32 a115, 0
    v_accvgpr_write_b32 a116, 0
    v_accvgpr_write_b32 a117, 0
    v_accvgpr_write_b32 a118, 0
    v_accvgpr_write_b32 a119, 0
    v_accvgpr_write_b32 a120, 0
    v_accvgpr_write_b32 a121, 0
    v_accvgpr_write_b32 a122, 0
    v_accvgpr_write_b32 a123, 0
    v_accvgpr_write_b32 a124, 0
    v_accvgpr_write_b32 a125, 0
    v_accvgpr_write_b32 a126, 0
    v_accvgpr_write_b32 a127, 0
    s_waitcnt vmcnt(16)
    s_barrier
    ds_read_b128 v[56:59], v21 offset:0
    ds_read_b64_tr_b16 v[24:25], v13 offset:0
    ds_read_b64_tr_b16 v[26:27], v13 offset:2048
    ds_read_b64_tr_b16 v[28:29], v15 offset:0
    ds_read_b64_tr_b16 v[30:31], v15 offset:2048
    ds_read_b64_tr_b16 v[32:33], v17 offset:0
    ds_read_b64_tr_b16 v[34:35], v17 offset:2048
    ds_read_b64_tr_b16 v[36:37], v19 offset:0
    ds_read_b64_tr_b16 v[38:39], v19 offset:2048
    ds_read_b128 v[60:63], v21 offset:2048
V_loop_2:
    s_waitcnt lgkmcnt(0)
    v_mfma_f32_32x32x16_bf16 a[0:15], v[56:59], v[24:27], a[0:15]
    ds_read_b128 v[64:67], v21 offset:1024
    ds_read_b64_tr_b16 v[40:41], v13 offset:4096
    v_mfma_f32_32x32x16_bf16 a[16:31], v[56:59], v[28:31], a[16:31]
    ds_read_b64_tr_b16 v[42:43], v13 offset:6144
    ds_read_b64_tr_b16 v[44:45], v15 offset:4096
    s_add_u32 m0, s21, 73728
    s_nop 0
    buffer_load_dwordx4 v12, s[8:11], s17 offen offset:0 lds
    v_mfma_f32_32x32x16_bf16 a[32:47], v[56:59], v[32:35], a[32:47]
    ds_read_b64_tr_b16 v[46:47], v15 offset:6144
    ds_read_b64_tr_b16 v[48:49], v17 offset:4096
    v_mfma_f32_32x32x16_bf16 a[48:63], v[56:59], v[36:39], a[48:63]
    ds_read_b64_tr_b16 v[50:51], v17 offset:6144
    ds_read_b64_tr_b16 v[52:53], v19 offset:4096
    v_mfma_f32_32x32x16_bf16 a[64:79], v[60:63], v[24:27], a[64:79]
    ds_read_b64_tr_b16 v[54:55], v19 offset:6144
    ds_read_b128 v[68:71], v21 offset:3072
    v_mfma_f32_32x32x16_bf16 a[80:95], v[60:63], v[28:31], a[80:95]
    buffer_load_dwordx4 v12, s[8:11], s17 offen offset:1024 lds
    s_add_u32 s17, s17, 2048
    v_mfma_f32_32x32x16_bf16 a[96:111], v[60:63], v[32:35], a[96:111]
    v_mfma_f32_32x32x16_bf16 a[112:127], v[60:63], v[36:39], a[112:127]
    s_waitcnt vmcnt(12) lgkmcnt(0)
    s_barrier
    v_mfma_f32_32x32x16_bf16 a[0:15], v[64:67], v[40:43], a[0:15]
    ds_read_b128 v[56:59], v21 offset:24576
    ds_read_b64_tr_b16 v[24:25], v13 offset:24576
    v_mfma_f32_32x32x16_bf16 a[16:31], v[64:67], v[44:47], a[16:31]
    ds_read_b64_tr_b16 v[26:27], v13 offset:26624
    ds_read_b64_tr_b16 v[28:29], v15 offset:24576
    s_mov_b32 m0, s20
    s_nop 0
    buffer_load_dwordx4 v8, s[4:7], s16 offen offset:0 lds
    v_mfma_f32_32x32x16_bf16 a[32:47], v[64:67], v[48:51], a[32:47]
    ds_read_b64_tr_b16 v[30:31], v15 offset:26624
    ds_read_b64_tr_b16 v[32:33], v17 offset:24576
    v_mfma_f32_32x32x16_bf16 a[48:63], v[64:67], v[52:55], a[48:63]
    ds_read_b64_tr_b16 v[34:35], v17 offset:26624
    ds_read_b64_tr_b16 v[36:37], v19 offset:24576
    buffer_load_dwordx4 v9, s[4:7], s16 offen offset:1024 lds
    v_mfma_f32_32x32x16_bf16 a[64:79], v[68:71], v[40:43], a[64:79]
    ds_read_b64_tr_b16 v[38:39], v19 offset:26624
    ds_read_b128 v[60:63], v21 offset:26624
    v_mfma_f32_32x32x16_bf16 a[80:95], v[68:71], v[44:47], a[80:95]
    buffer_load_dwordx4 v10, s[4:7], s16 offen offset:2048 lds
    v_mfma_f32_32x32x16_bf16 a[96:111], v[68:71], v[48:51], a[96:111]
    v_mfma_f32_32x32x16_bf16 a[112:127], v[68:71], v[52:55], a[112:127]
    buffer_load_dwordx4 v11, s[4:7], s16 offen offset:3072 lds
    s_add_u32 s16, s16, s26
    s_waitcnt lgkmcnt(0)
    v_mfma_f32_32x32x16_bf16 a[0:15], v[56:59], v[24:27], a[0:15]
    ds_read_b128 v[64:67], v21 offset:25600
    ds_read_b64_tr_b16 v[40:41], v13 offset:28672
    v_mfma_f32_32x32x16_bf16 a[16:31], v[56:59], v[28:31], a[16:31]
    ds_read_b64_tr_b16 v[42:43], v13 offset:30720
    ds_read_b64_tr_b16 v[44:45], v15 offset:28672
    s_add_u32 m0, s21, 0
    s_nop 0
    buffer_load_dwordx4 v12, s[8:11], s17 offen offset:0 lds
    v_mfma_f32_32x32x16_bf16 a[32:47], v[56:59], v[32:35], a[32:47]
    ds_read_b64_tr_b16 v[46:47], v15 offset:30720
    ds_read_b64_tr_b16 v[48:49], v17 offset:28672
    v_mfma_f32_32x32x16_bf16 a[48:63], v[56:59], v[36:39], a[48:63]
    ds_read_b64_tr_b16 v[50:51], v17 offset:30720
    ds_read_b64_tr_b16 v[52:53], v19 offset:28672
    v_mfma_f32_32x32x16_bf16 a[64:79], v[60:63], v[24:27], a[64:79]
    ds_read_b64_tr_b16 v[54:55], v19 offset:30720
    ds_read_b128 v[68:71], v21 offset:27648
    v_mfma_f32_32x32x16_bf16 a[80:95], v[60:63], v[28:31], a[80:95]
    buffer_load_dwordx4 v12, s[8:11], s17 offen offset:1024 lds
    s_add_u32 s17, s17, 2048
    v_mfma_f32_32x32x16_bf16 a[96:111], v[60:63], v[32:35], a[96:111]
    v_mfma_f32_32x32x16_bf16 a[112:127], v[60:63], v[36:39], a[112:127]
    s_waitcnt vmcnt(12) lgkmcnt(0)
    s_barrier
    v_mfma_f32_32x32x16_bf16 a[0:15], v[64:67], v[40:43], a[0:15]
    ds_read_b128 v[56:59], v22 offset:0
    ds_read_b64_tr_b16 v[24:25], v14 offset:0
    v_mfma_f32_32x32x16_bf16 a[16:31], v[64:67], v[44:47], a[16:31]
    ds_read_b64_tr_b16 v[26:27], v14 offset:2048
    ds_read_b64_tr_b16 v[28:29], v16 offset:0
    s_add_u32 m0, s20, 24576
    s_nop 0
    buffer_load_dwordx4 v8, s[4:7], s16 offen offset:0 lds
    v_mfma_f32_32x32x16_bf16 a[32:47], v[64:67], v[48:51], a[32:47]
    ds_read_b64_tr_b16 v[30:31], v16 offset:2048
    ds_read_b64_tr_b16 v[32:33], v18 offset:0
    v_mfma_f32_32x32x16_bf16 a[48:63], v[64:67], v[52:55], a[48:63]
    ds_read_b64_tr_b16 v[34:35], v18 offset:2048
    ds_read_b64_tr_b16 v[36:37], v20 offset:0
    buffer_load_dwordx4 v9, s[4:7], s16 offen offset:1024 lds
    v_mfma_f32_32x32x16_bf16 a[64:79], v[68:71], v[40:43], a[64:79]
    ds_read_b64_tr_b16 v[38:39], v20 offset:2048
    ds_read_b128 v[60:63], v22 offset:2048
    v_mfma_f32_32x32x16_bf16 a[80:95], v[68:71], v[44:47], a[80:95]
    buffer_load_dwordx4 v10, s[4:7], s16 offen offset:2048 lds
    v_mfma_f32_32x32x16_bf16 a[96:111], v[68:71], v[48:51], a[96:111]
    v_mfma_f32_32x32x16_bf16 a[112:127], v[68:71], v[52:55], a[112:127]
    buffer_load_dwordx4 v11, s[4:7], s16 offen offset:3072 lds
    s_add_u32 s16, s16, s26
    s_waitcnt lgkmcnt(0)
    v_mfma_f32_32x32x16_bf16 a[0:15], v[56:59], v[24:27], a[0:15]
    ds_read_b128 v[64:67], v22 offset:1024
    ds_read_b64_tr_b16 v[40:41], v14 offset:4096
    v_mfma_f32_32x32x16_bf16 a[16:31], v[56:59], v[28:31], a[16:31]
    ds_read_b64_tr_b16 v[42:43], v14 offset:6144
    ds_read_b64_tr_b16 v[44:45], v16 offset:4096
    s_add_u32 m0, s21, 24576
    s_nop 0
    buffer_load_dwordx4 v12, s[8:11], s17 offen offset:0 lds
    v_mfma_f32_32x32x16_bf16 a[32:47], v[56:59], v[32:35], a[32:47]
    ds_read_b64_tr_b16 v[46:47], v16 offset:6144
    ds_read_b64_tr_b16 v[48:49], v18 offset:4096
    v_mfma_f32_32x32x16_bf16 a[48:63], v[56:59], v[36:39], a[48:63]
    ds_read_b64_tr_b16 v[50:51], v18 offset:6144
    ds_read_b64_tr_b16 v[52:53], v20 offset:4096
    v_mfma_f32_32x32x16_bf16 a[64:79], v[60:63], v[24:27], a[64:79]
    ds_read_b64_tr_b16 v[54:55], v20 offset:6144
    ds_read_b128 v[68:71], v22 offset:3072
    v_mfma_f32_32x32x16_bf16 a[80:95], v[60:63], v[28:31], a[80:95]
    buffer_load_dwordx4 v12, s[8:11], s17 offen offset:1024 lds
    s_add_u32 s17, s17, 2048
    v_mfma_f32_32x32x16_bf16 a[96:111], v[60:63], v[32:35], a[96:111]
    v_mfma_f32_32x32x16_bf16 a[112:127], v[60:63], v[36:39], a[112:127]
    s_waitcnt vmcnt(12) lgkmcnt(0)
    s_barrier
    v_mfma_f32_32x32x16_bf16 a[0:15], v[64:67], v[40:43], a[0:15]
    ds_read_b128 v[56:59], v22 offset:24576
    ds_read_b64_tr_b16 v[24:25], v14 offset:24576
    v_mfma_f32_32x32x16_bf16 a[16:31], v[64:67], v[44:47], a[16:31]
    ds_read_b64_tr_b16 v[26:27], v14 offset:26624
    ds_read_b64_tr_b16 v[28:29], v16 offset:24576
    s_add_u32 m0, s20, 49152
    s_nop 0
    buffer_load_dwordx4 v8, s[4:7], s16 offen offset:0 lds
    v_mfma_f32_32x32x16_bf16 a[32:47], v[64:67], v[48:51], a[32:47]
    ds_read_b64_tr_b16 v[30:31], v16 offset:26624
    ds_read_b64_tr_b16 v[32:33], v18 offset:24576
    v_mfma_f32_32x32x16_bf16 a[48:63], v[64:67], v[52:55], a[48:63]
    ds_read_b64_tr_b16 v[34:35], v18 offset:26624
    ds_read_b64_tr_b16 v[36:37], v20 offset:24576
    buffer_load_dwordx4 v9, s[4:7], s16 offen offset:1024 lds
    v_mfma_f32_32x32x16_bf16 a[64:79], v[68:71], v[40:43], a[64:79]
    ds_read_b64_tr_b16 v[38:39], v20 offset:26624
    ds_read_b128 v[60:63], v22 offset:26624
    v_mfma_f32_32x32x16_bf16 a[80:95], v[68:71], v[44:47], a[80:95]
    buffer_load_dwordx4 v10, s[4:7], s16 offen offset:2048 lds
    v_mfma_f32_32x32x16_bf16 a[96:111], v[68:71], v[48:51], a[96:111]
    v_mfma_f32_32x32x16_bf16 a[112:127], v[68:71], v[52:55], a[112:127]
    buffer_load_dwordx4 v11, s[4:7], s16 offen offset:3072 lds
    s_add_u32 s16, s16, s26
    s_waitcnt lgkmcnt(0)
    v_mfma_f32_32x32x16_bf16 a[0:15], v[56:59], v[24:27], a[0:15]
    ds_read_b128 v[64:67], v22 offset:25600
    ds_read_b64_tr_b16 v[40:41], v14 offset:28672
    v_mfma_f32_32x32x16_bf16 a[16:31], v[56:59], v[28:31], a[16:31]
    ds_read_b64_tr_b16 v[42:43], v14 offset:30720
    ds_read_b64_tr_b16 v[44:45], v16 offset:28672
    s_add_u32 m0, s21, 49152
    s_nop 0
    buffer_load_dwordx4 v12, s[8:11], s17 offen offset:0 lds
    v_mfma_f32_32x32x16_bf16 a[32:47], v[56:59], v[32:35], a[32:47]
    ds_read_b64_tr_b16 v[46:47], v16 offset:30720
    ds_read_b64_tr_b16 v[48:49], v18 offset:28672
    v_mfma_f32_32x32x16_bf16 a[48:63], v[56:59], v[36:39], a[48:63]
    ds_read_b64_tr_b16 v[50:51], v18 offset:30720
    ds_read_b64_tr_b16 v[52:53], v20 offset:28672
    v_mfma_f32_32x32x16_bf16 a[64:79], v[60:63], v[24:27], a[64:79]
    ds_read_b64_tr_b16 v[54:55], v20 offset:30720
    ds_read_b128 v[68:71], v22 offset:27648
    v_mfma_f32_32x32x16_bf16 a[80:95], v[60:63], v[28:31], a[80:95]
    buffer_load_dwordx4 v12, s[8:11], s17 offen offset:1024 lds
    s_add_u32 s17, s17, 2048
    v_mfma_f32_32x32x16_bf16 a[96:111], v[60:63], v[32:35], a[96:111]
    v_mfma_f32_32x32x16_bf16 a[112:127], v[60:63], v[36:39], a[112:127]
    s_waitcnt vmcnt(12) lgkmcnt(0)
    s_barrier
    v_mfma_f32_32x32x16_bf16 a[0:15], v[64:67], v[40:43], a[0:15]
    ds_read_b128 v[56:59], v21 offset:0
    ds_read_b64_tr_b16 v[24:25], v13 offset:0
    v_mfma_f32_32x32x16_bf16 a[16:31], v[64:67], v[44:47], a[16:31]
    ds_read_b64_tr_b16 v[26:27], v13 offset:2048
    ds_read_b64_tr_b16 v[28:29], v15 offset:0
    s_add_u32 m0, s20, 73728
    s_nop 0
    buffer_load_dwordx4 v8, s[4:7], s16 offen offset:0 lds
    v_mfma_f32_32x32x16_bf16 a[32:47], v[64:67], v[48:51], a[32:47]
    ds_read_b64_tr_b16 v[30:31], v15 offset:2048
    ds_read_b64_tr_b16 v[32:33], v17 offset:0
    v_mfma_f32_32x32x16_bf16 a[48:63], v[64:67], v[52:55], a[48:63]
    ds_read_b64_tr_b16 v[34:35], v17 offset:2048
    ds_read_b64_tr_b16 v[36:37], v19 offset:0
    buffer_load_dwordx4 v9, s[4:7], s16 offen offset:1024 lds
    v_mfma_f32_32x32x16_bf16 a[64:79], v[68:71], v[40:43], a[64:79]
    ds_read_b64_tr_b16 v[38:39], v19 offset:2048
    ds_read_b128 v[60:63], v21 offset:2048
    v_mfma_f32_32x32x16_bf16 a[80:95], v[68:71], v[44:47], a[80:95]
    buffer_load_dwordx4 v10, s[4:7], s16 offen offset:2048 lds
    v_mfma_f32_32x32x16_bf16 a[96:111], v[68:71], v[48:51], a[96:111]
    v_mfma_f32_32x32x16_bf16 a[112:127], v[68:71], v[52:55], a[112:127]
    buffer_load_dwordx4 v11, s[4:7], s16 offen offset:3072 lds
    s_add_u32 s16, s16, s26
    s_sub_u32 s18, s18, 1
    s_cmp_lg_u32 s18, 0
    s_cbranch_scc1 V_loop_2
    s_waitcnt lgkmcnt(0)
    v_mfma_f32_32x32x16_bf16 a[0:15], v[56:59], v[24:27], a[0:15]
    ds_read_b128 v[64:67], v21 offset:1024
    ds_read_b64_tr_b16 v[40:41], v13 offset:4096
    v_mfma_f32_32x32x16_bf16 a[16:31], v[56:59], v[28:31], a[16:31]
    ds_read_b64_tr_b16 v[42:43], v13 offset:6144
    ds_read_b64_tr_b16 v[44:45], v15 offset:4096
    s_add_u32 m0, s21, 73728
    s_nop 0
    buffer_load_dwordx4 v12, s[8:11], s17 offen offset:0 lds
    v_mfma_f32_32x32x16_bf16 a[32:47], v[56:59], v[32:35], a[32:47]
    ds_read_b64_tr_b16 v[46:47], v15 offset:6144
    ds_read_b64_tr_b16 v[48:49], v17 offset:4096
    v_mfma_f32_32x32x16_bf16 a[48:63], v[56:59], v[36:39], a[48:63]
    ds_read_b64_tr_b16 v[50:51], v17 offset:6144
    ds_read_b64_tr_b16 v[52:53], v19 offset:4096
    v_mfma_f32_32x32x16_bf16 a[64:79], v[60:63], v[24:27], a[64:79]
    ds_read_b64_tr_b16 v[54:55], v19 offset:6144
    ds_read_b128 v[68:71], v21 offset:3072
    v_mfma_f32_32x32x16_bf16 a[80:95], v[60:63], v[28:31], a[80:95]
    buffer_load_dwordx4 v12, s[8:11], s17 offen offset:1024 lds
    s_add_u32 s17, s17, 2048
    v_mfma_f32_32x32x16_bf16 a[96:111], v[60:63], v[32:35], a[96:111]
    v_mfma_f32_32x32x16_bf16 a[112:127], v[60:63], v[36:39], a[112:127]
    s_waitcnt vmcnt(12) lgkmcnt(0)
    s_barrier
    v_mfma_f32_32x32x16_bf16 a[0:15], v[64:67], v[40:43], a[0:15]
    ds_read_b128 v[56:59], v21 offset:24576
    ds_read_b64_tr_b16 v[24:25], v13 offset:24576
    v_mfma_f32_32x32x16_bf16 a[16:31], v[64:67], v[44:47], a[16:31]
    ds_read_b64_tr_b16 v[26:27], v13 offset:26624
    ds_read_b64_tr_b16 v[28:29], v15 offset:24576
    v_mfma_f32_32x32x16_bf16 a[32:47], v[64:67], v[48:51], a[32:47]
    ds_read_b64_tr_b16 v[30:31], v15 offset:26624
    ds_read_b64_tr_b16 v[32:33], v17 offset:24576
    v_mfma_f32_32x32x16_bf16 a[48:63], v[64:67], v[52:55], a[48:63]
    ds_read_b64_tr_b16 v[34:35], v17 offset:26624
    ds_read_b64_tr_b16 v[36:37], v19 offset:24576
    v_mfma_f32_32x32x16_bf16 a[64:79], v[68:71], v[40:43], a[64:79]
    ds_read_b64_tr_b16 v[38:39], v19 offset:26624
    ds_read_b128 v[60:63], v21 offset:26624
    v_mfma_f32_32x32x16_bf16 a[80:95], v[68:71], v[44:47], a[80:95]
    v_mfma_f32_32x32x16_bf16 a[96:111], v[68:71], v[48:51], a[96:111]
    v_mfma_f32_32x32x16_bf16 a[112:127], v[68:71], v[52:55], a[112:127]
    s_waitcnt lgkmcnt(0)
    v_mfma_f32_32x32x16_bf16 a[0:15], v[56:59], v[24:27], a[0:15]
    ds_read_b128 v[64:67], v21 offset:25600
    ds_read_b64_tr_b16 v[40:41], v13 offset:28672
    v_mfma_f32_32x32x16_bf16 a[16:31], v[56:59], v[28:31], a[16:31]
    ds_read_b64_tr_b16 v[42:43], v13 offset:30720
    ds_read_b64_tr_b16 v[44:45], v15 offset:28672
    v_mfma_f32_32x32x16_bf16 a[32:47], v[56:59], v[32:35], a[32:47]
    ds_read_b64_tr_b16 v[46:47], v15 offset:30720
    ds_read_b64_tr_b16 v[48:49], v17 offset:28672
    v_mfma_f32_32x32x16_bf16 a[48:63], v[56:59], v[36:39], a[48:63]
    ds_read_b64_tr_b16 v[50:51], v17 offset:30720
    ds_read_b64_tr_b16 v[52:53], v19 offset:28672
    v_mfma_f32_32x32x16_bf16 a[64:79], v[60:63], v[24:27], a[64:79]
    ds_read_b64_tr_b16 v[54:55], v19 offset:30720
    ds_read_b128 v[68:71], v21 offset:27648
    v_mfma_f32_32x32x16_bf16 a[80:95], v[60:63], v[28:31], a[80:95]
    v_mfma_f32_32x32x16_bf16 a[96:111], v[60:63], v[32:35], a[96:111]
    v_mfma_f32_32x32x16_bf16 a[112:127], v[60:63], v[36:39], a[112:127]
    s_waitcnt vmcnt(6) lgkmcnt(0)
    s_barrier
    v_mfma_f32_32x32x16_bf16 a[0:15], v[64:67], v[40:43], a[0:15]
    ds_read_b128 v[56:59], v22 offset:0
    ds_read_b64_tr_b16 v[24:25], v14 offset:0
    v_mfma_f32_32x32x16_bf16 a[16:31], v[64:67], v[44:47], a[16:31]
    ds_read_b64_tr_b16 v[26:27], v14 offset:2048
    ds_read_b64_tr_b16 v[28:29], v16 offset:0
    v_mfma_f32_32x32x16_bf16 a[32:47], v[64:67], v[48:51], a[32:47]
    ds_read_b64_tr_b16 v[30:31], v16 offset:2048
    ds_read_b64_tr_b16 v[32:33], v18 offset:0
    v_mfma_f32_32x32x16_bf16 a[48:63], v[64:67], v[52:55], a[48:63]
    ds_read_b64_tr_b16 v[34:35], v18 offset:2048
    ds_read_b64_tr_b16 v[36:37], v20 offset:0
    v_mfma_f32_32x32x16_bf16 a[64:79], v[68:71], v[40:43], a[64:79]
    ds_read_b64_tr_b16 v[38:39], v20 offset:2048
    ds_read_b128 v[60:63], v22 offset:2048
    v_mfma_f32_32x32x16_bf16 a[80:95], v[68:71], v[44:47], a[80:95]
    v_mfma_f32_32x32x16_bf16 a[96:111], v[68:71], v[48:51], a[96:111]
    v_mfma_f32_32x32x16_bf16 a[112:127], v[68:71], v[52:55], a[112:127]
    s_waitcnt lgkmcnt(0)
    v_mfma_f32_32x32x16_bf16 a[0:15], v[56:59], v[24:27], a[0:15]
    ds_read_b128 v[64:67], v22 offset:1024
    ds_read_b64_tr_b16 v[40:41], v14 offset:4096
    v_mfma_f32_32x32x16_bf16 a[16:31], v[56:59], v[28:31], a[16:31]
    ds_read_b64_tr_b16 v[42:43], v14 offset:6144
    ds_read_b64_tr_b16 v[44:45], v16 offset:4096
    v_mfma_f32_32x32x16_bf16 a[32:47], v[56:59], v[32:35], a[32:47]
    ds_read_b64_tr_b16 v[46:47], v16 offset:6144
    ds_read_b64_tr_b16 v[48:49], v18 offset:4096
    v_mfma_f32_32x32x16_bf16 a[48:63], v[56:59], v[36:39], a[48:63]
    ds_read_b64_tr_b16 v[50:51], v18 offset:6144
    ds_read_b64_tr_b16 v[52:53], v20 offset:4096
    v_mfma_f32_32x32x16_bf16 a[64:79], v[60:63], v[24:27], a[64:79]
    ds_read_b64_tr_b16 v[54:55], v20 offset:6144
    ds_read_b128 v[68:71], v22 offset:3072
    v_mfma_f32_32x32x16_bf16 a[80:95], v[60:63], v[28:31], a[80:95]
    v_mfma_f32_32x32x16_bf16 a[96:111], v[60:63], v[32:35], a[96:111]
    v_mfma_f32_32x32x16_bf16 a[112:127], v[60:63], v[36:39], a[112:127]
    s_waitcnt vmcnt(0) lgkmcnt(0)
    s_barrier
    v_mfma_f32_32x32x16_bf16 a[0:15], v[64:67], v[40:43], a[0:15]
    ds_read_b128 v[56:59], v22 offset:24576
    ds_read_b64_tr_b16 v[24:25], v14 offset:24576
    v_mfma_f32_32x32x16_bf16 a[16:31], v[64:67], v[44:47], a[16:31]
    ds_read_b64_tr_b16 v[26:27], v14 offset:26624
    ds_read_b64_tr_b16 v[28:29], v16 offset:24576
    v_mfma_f32_32x32x16_bf16 a[32:47], v[64:67], v[48:51], a[32:47]
    ds_read_b64_tr_b16 v[30:31], v16 offset:26624
    ds_read_b64_tr_b16 v[32:33], v18 offset:24576
    v_mfma_f32_32x32x16_bf16 a[48:63], v[64:67], v[52:55], a[48:63]
    ds_read_b64_tr_b16 v[34:35], v18 offset:26624
    ds_read_b64_tr_b16 v[36:37], v20 offset:24576
    v_mfma_f32_32x32x16_bf16 a[64:79], v[68:71], v[40:43], a[64:79]
    ds_read_b64_tr_b16 v[38:39], v20 offset:26624
    ds_read_b128 v[60:63], v22 offset:26624
    v_mfma_f32_32x32x16_bf16 a[80:95], v[68:71], v[44:47], a[80:95]
    v_mfma_f32_32x32x16_bf16 a[96:111], v[68:71], v[48:51], a[96:111]
    v_mfma_f32_32x32x16_bf16 a[112:127], v[68:71], v[52:55], a[112:127]
    s_waitcnt lgkmcnt(0)
    v_mfma_f32_32x32x16_bf16 a[0:15], v[56:59], v[24:27], a[0:15]
    ds_read_b128 v[64:67], v22 offset:25600
    ds_read_b64_tr_b16 v[40:41], v14 offset:28672
    v_mfma_f32_32x32x16_bf16 a[16:31], v[56:59], v[28:31], a[16:31]
    ds_read_b64_tr_b16 v[42:43], v14 offset:30720
    ds_read_b64_tr_b16 v[44:45], v16 offset:28672
    v_mfma_f32_32x32x16_bf16 a[32:47], v[56:59], v[32:35], a[32:47]
    ds_read_b64_tr_b16 v[46:47], v16 offset:30720
    ds_read_b64_tr_b16 v[48:49], v18 offset:28672
    v_mfma_f32_32x32x16_bf16 a[48:63], v[56:59], v[36:39], a[48:63]
    ds_read_b64_tr_b16 v[50:51], v18 offset:30720
    ds_read_b64_tr_b16 v[52:53], v20 offset:28672
    v_mfma_f32_32x32x16_bf16 a[64:79], v[60:63], v[24:27], a[64:79]
    ds_read_b64_tr_b16 v[54:55], v20 offset:30720
    ds_read_b128 v[68:71], v22 offset:27648
    v_mfma_f32_32x32x16_bf16 a[80:95], v[60:63], v[28:31], a[80:95]
    v_mfma_f32_32x32x16_bf16 a[96:111], v[60:63], v[32:35], a[96:111]
    v_mfma_f32_32x32x16_bf16 a[112:127], v[60:63], v[36:39], a[112:127]
    s_waitcnt lgkmcnt(0)
    v_mfma_f32_32x32x16_bf16 a[0:15], v[64:67], v[40:43], a[0:15]
    v_mfma_f32_32x32x16_bf16 a[16:31], v[64:67], v[44:47], a[16:31]
    v_mfma_f32_32x32x16_bf16 a[32:47], v[64:67], v[48:51], a[32:47]
    v_mfma_f32_32x32x16_bf16 a[48:63], v[64:67], v[52:55], a[48:63]
    v_mfma_f32_32x32x16_bf16 a[64:79], v[68:71], v[40:43], a[64:79]
    v_mfma_f32_32x32x16_bf16 a[80:95], v[68:71], v[44:47], a[80:95]
    v_mfma_f32_32x32x16_bf16 a[96:111], v[68:71], v[48:51], a[96:111]
    v_mfma_f32_32x32x16_bf16 a[112:127], v[68:71], v[52:55], a[112:127]
    s_add_u32 s36, s34, 0x1400000
    s_addc_u32 s37, s35, 0
    s_and_b32 s37, s37, 0xffff
    s_mov_b32 s38, 0x1000000
    s_mov_b32 s39, 0x00020000
    v_and_b32 v1, 63, v0
    v_lshlrev_b32 v1, 4, v1
    s_lshr_b32 s22, s19, 1
    s_lshl_b32 s22, s22, 1
    s_lshl_b32 s23, s28, 2
    s_add_u32 s22, s22, s23
    s_lshl_b32 s22, s22, 5
    s_and_b32 s23, s19, 1
    s_add_u32 s22, s22, s23
    s_lshl_b32 s23, s29, 1
    s_add_u32 s22, s22, s23
    s_lshl_b32 s22, s22, 13
    v_add_u32 v1, s22, v1
    s_nop 7
    s_nop 7
    v_accvgpr_read_b32 v72, a0
    v_accvgpr_read_b32 v73, a1
    v_accvgpr_read_b32 v74, a2
    v_accvgpr_read_b32 v75, a3
    v_accvgpr_read_b32 v76, a4
    v_accvgpr_read_b32 v77, a5
    v_accvgpr_read_b32 v78, a6
    v_accvgpr_read_b32 v79, a7
    v_accvgpr_read_b32 v80, a8
    v_accvgpr_read_b32 v81, a9
    v_accvgpr_read_b32 v82, a10
    v_accvgpr_read_b32 v83, a11
    v_accvgpr_read_b32 v84, a12
    v_accvgpr_read_b32 v85, a13
    v_accvgpr_read_b32 v86, a14
    v_accvgpr_read_b32 v87, a15
    v_cvt_pk_bf16_f32 v88, v72, v73
    v_cvt_pk_bf16_f32 v89, v74, v75
    v_cvt_pk_bf16_f32 v90, v76, v77
    v_cvt_pk_bf16_f32 v91, v78, v79
    v_cvt_pk_bf16_f32 v92, v80, v81
    v_cvt_pk_bf16_f32 v93, v82, v83
    v_cvt_pk_bf16_f32 v94, v84, v85
    v_cvt_pk_bf16_f32 v95, v86, v87
    s_mov_b32 s24, 0
    buffer_store_dwordx4 v[88:91], v1, s[36:39], s24 offen offset:0 sc1
    buffer_store_dwordx4 v[92:95], v1, s[36:39], s24 offen offset:1024 sc1
    v_accvgpr_read_b32 v96, a16
    v_accvgpr_read_b32 v97, a17
    v_accvgpr_read_b32 v98, a18
    v_accvgpr_read_b32 v99, a19
    v_accvgpr_read_b32 v100, a20
    v_accvgpr_read_b32 v101, a21
    v_accvgpr_read_b32 v102, a22
    v_accvgpr_read_b32 v103, a23
    v_accvgpr_read_b32 v104, a24
    v_accvgpr_read_b32 v105, a25
    v_accvgpr_read_b32 v106, a26
    v_accvgpr_read_b32 v107, a27
    v_accvgpr_read_b32 v108, a28
    v_accvgpr_read_b32 v109, a29
    v_accvgpr_read_b32 v110, a30
    v_accvgpr_read_b32 v111, a31
    v_cvt_pk_bf16_f32 v112, v96, v97
    v_cvt_pk_bf16_f32 v113, v98, v99
    v_cvt_pk_bf16_f32 v114, v100, v101
    v_cvt_pk_bf16_f32 v115, v102, v103
    v_cvt_pk_bf16_f32 v116, v104, v105
    v_cvt_pk_bf16_f32 v117, v106, v107
    v_cvt_pk_bf16_f32 v118, v108, v109
    v_cvt_pk_bf16_f32 v119, v110, v111
    s_mov_b32 s24, 0
    buffer_store_dwordx4 v[112:115], v1, s[36:39], s24 offen offset:2048 sc1
    buffer_store_dwordx4 v[116:119], v1, s[36:39], s24 offen offset:3072 sc1
    v_accvgpr_read_b32 v120, a32
    v_accvgpr_read_b32 v121, a33
    v_accvgpr_read_b32 v122, a34
    v_accvgpr_read_b32 v123, a35
    v_accvgpr_read_b32 v124, a36
    v_accvgpr_read_b32 v125, a37
    v_accvgpr_read_b32 v126, a38
    v_accvgpr_read_b32 v127, a39
    v_accvgpr_read_b32 v128, a40
    v_accvgpr_read_b32 v129, a41
    v_accvgpr_read_b32 v130, a42
    v_accvgpr_read_b32 v131, a43
    v_accvgpr_read_b32 v132, a44
    v_accvgpr_read_b32 v133, a45
    v_accvgpr_read_b32 v134, a46
    v_accvgpr_read_b32 v135, a47
    v_cvt_pk_bf16_f32 v136, v120, v121
    v_cvt_pk_bf16_f32 v137, v122, v123
    v_cvt_pk_bf16_f32 v138, v124, v125
    v_cvt_pk_bf16_f32 v139, v126, v127
    v_cvt_pk_bf16_f32 v140, v128, v129
    v_cvt_pk_bf16_f32 v141, v130, v131
    v_cvt_pk_bf16_f32 v142, v132, v133
    v_cvt_pk_bf16_f32 v143, v134, v135
    s_mov_b32 s24, 4096
    buffer_store_dwordx4 v[136:139], v1, s[36:39], s24 offen offset:0 sc1
    buffer_store_dwordx4 v[140:143], v1, s[36:39], s24 offen offset:1024 sc1
    v_accvgpr_read_b32 v144, a48
    v_accvgpr_read_b32 v145, a49
    v_accvgpr_read_b32 v146, a50
    v_accvgpr_read_b32 v147, a51
    v_accvgpr_read_b32 v148, a52
    v_accvgpr_read_b32 v149, a53
    v_accvgpr_read_b32 v150, a54
    v_accvgpr_read_b32 v151, a55
    v_accvgpr_read_b32 v152, a56
    v_accvgpr_read_b32 v153, a57
    v_accvgpr_read_b32 v154, a58
    v_accvgpr_read_b32 v155, a59
    v_accvgpr_read_b32 v156, a60
    v_accvgpr_read_b32 v157, a61
    v_accvgpr_read_b32 v158, a62
    v_accvgpr_read_b32 v159, a63
    v_cvt_pk_bf16_f32 v160, v144, v145
    v_cvt_pk_bf16_f32 v161, v146, v147
    v_cvt_pk_bf16_f32 v162, v148, v149
    v_cvt_pk_bf16_f32 v163, v150, v151
    v_cvt_pk_bf16_f32 v164, v152, v153
    v_cvt_pk_bf16_f32 v165, v154, v155
    v_cvt_pk_bf16_f32 v166, v156, v157
    v_cvt_pk_bf16_f32 v167, v158, v159
    s_mov_b32 s24, 4096
    buffer_store_dwordx4 v[160:163], v1, s[36:39], s24 offen offset:2048 sc1
    buffer_store_dwordx4 v[164:167], v1, s[36:39], s24 offen offset:3072 sc1
    s_waitcnt vmcnt(6)
    v_accvgpr_read_b32 v72, a64
    v_accvgpr_read_b32 v73, a65
    v_accvgpr_read_b32 v74, a66
    v_accvgpr_read_b32 v75, a67
    v_accvgpr_read_b32 v76, a68
    v_accvgpr_read_b32 v77, a69
    v_accvgpr_read_b32 v78, a70
    v_accvgpr_read_b32 v79, a71
    v_accvgpr_read_b32 v80, a72
    v_accvgpr_read_b32 v81, a73
    v_accvgpr_read_b32 v82, a74
    v_accvgpr_read_b32 v83, a75
    v_accvgpr_read_b32 v84, a76
    v_accvgpr_read_b32 v85, a77
    v_accvgpr_read_b32 v86, a78
    v_accvgpr_read_b32 v87, a79
    v_cvt_pk_bf16_f32 v88, v72, v73
    v_cvt_pk_bf16_f32 v89, v74, v75
    v_cvt_pk_bf16_f32 v90, v76, v77
    v_cvt_pk_bf16_f32 v91, v78, v79
    v_cvt_pk_bf16_f32 v92, v80, v81
    v_cvt_pk_bf16_f32 v93, v82, v83
    v_cvt_pk_bf16_f32 v94, v84, v85
    v_cvt_pk_bf16_f32 v95, v86, v87
    s_mov_b32 s24, 262144
    buffer_store_dwordx4 v[88:91], v1, s[36:39], s24 offen offset:0 sc1
    buffer_store_dwordx4 v[92:95], v1, s[36:39], s24 offen offset:1024 sc1
    s_waitcnt vmcnt(6)
    v_accvgpr_read_b32 v96, a80
    v_accvgpr_read_b32 v97, a81
    v_accvgpr_read_b32 v98, a82
    v_accvgpr_read_b32 v99, a83
    v_accvgpr_read_b32 v100, a84
    v_accvgpr_read_b32 v101, a85
    v_accvgpr_read_b32 v102, a86
    v_accvgpr_read_b32 v103, a87
    v_accvgpr_read_b32 v104, a88
    v_accvgpr_read_b32 v105, a89
    v_accvgpr_read_b32 v106, a90
    v_accvgpr_read_b32 v107, a91
    v_accvgpr_read_b32 v108, a92
    v_accvgpr_read_b32 v109, a93
    v_accvgpr_read_b32 v110, a94
    v_accvgpr_read_b32 v111, a95
    v_cvt_pk_bf16_f32 v112, v96, v97
    v_cvt_pk_bf16_f32 v113, v98, v99
    v_cvt_pk_bf16_f32 v114, v100, v101
    v_cvt_pk_bf16_f32 v115, v102, v103
    v_cvt_pk_bf16_f32 v116, v104, v105
    v_cvt_pk_bf16_f32 v117, v106, v107
    v_cvt_pk_bf16_f32 v118, v108, v109
    v_cvt_pk_bf16_f32 v119, v110, v111
    s_mov_b32 s24, 262144
    buffer_store_dwordx4 v[112:115], v1, s[36:39], s24 offen offset:2048 sc1
    buffer_store_dwordx4 v[116:119], v1, s[36:39], s24 offen offset:3072 sc1
    s_waitcnt vmcnt(6)
    v_accvgpr_read_b32 v120, a96
    v_accvgpr_read_b32 v121, a97
    v_accvgpr_read_b32 v122, a98
    v_accvgpr_read_b32 v123, a99
    v_accvgpr_read_b32 v124, a100
    v_accvgpr_read_b32 v125, a101
    v_accvgpr_read_b32 v126, a102
    v_accvgpr_read_b32 v127, a103
    v_accvgpr_read_b32 v128, a104
    v_accvgpr_read_b32 v129, a105
    v_accvgpr_read_b32 v130, a106
    v_accvgpr_read_b32 v131, a107
    v_accvgpr_read_b32 v132, a108
    v_accvgpr_read_b32 v133, a109
    v_accvgpr_read_b32 v134, a110
    v_accvgpr_read_b32 v135, a111
    v_cvt_pk_bf16_f32 v136, v120, v121
    v_cvt_pk_bf16_f32 v137, v122, v123
    v_cvt_pk_bf16_f32 v138, v124, v125
    v_cvt_pk_bf16_f32 v139, v126, v127
    v_cvt_pk_bf16_f32 v140, v128, v129
    v_cvt_pk_bf16_f32 v141, v130, v131
    v_cvt_pk_bf16_f32 v142, v132, v133
    v_cvt_pk_bf16_f32 v143, v134, v135
    s_mov_b32 s24, 266240
    buffer_store_dwordx4 v[136:139], v1, s[36:39], s24 offen offset:0 sc1
    buffer_store_dwordx4 v[140:143], v1, s[36:39], s24 offen offset:1024 sc1
    s_waitcnt vmcnt(6)
    v_accvgpr_read_b32 v144, a112
    v_accvgpr_read_b32 v145, a113
    v_accvgpr_read_b32 v146, a114
    v_accvgpr_read_b32 v147, a115
    v_accvgpr_read_b32 v148, a116
    v_accvgpr_read_b32 v149, a117
    v_accvgpr_read_b32 v150, a118
    v_accvgpr_read_b32 v151, a119
    v_accvgpr_read_b32 v152, a120
    v_accvgpr_read_b32 v153, a121
    v_accvgpr_read_b32 v154, a122
    v_accvgpr_read_b32 v155, a123
    v_accvgpr_read_b32 v156, a124
    v_accvgpr_read_b32 v157, a125
    v_accvgpr_read_b32 v158, a126
    v_accvgpr_read_b32 v159, a127
    v_cvt_pk_bf16_f32 v160, v144, v145
    v_cvt_pk_bf16_f32 v161, v146, v147
    v_cvt_pk_bf16_f32 v162, v148, v149
    v_cvt_pk_bf16_f32 v163, v150, v151
    v_cvt_pk_bf16_f32 v164, v152, v153
    v_cvt_pk_bf16_f32 v165, v154, v155
    v_cvt_pk_bf16_f32 v166, v156, v157
    v_cvt_pk_bf16_f32 v167, v158, v159
    s_mov_b32 s24, 266240
    buffer_store_dwordx4 v[160:163], v1, s[36:39], s24 offen offset:2048 sc1
    buffer_store_dwordx4 v[164:167], v1, s[36:39], s24 offen offset:3072 sc1
    s_branch KQ_FIN
KQ_Q:
    s_load_dwordx2 s[32:33], s[0:1], 16
    s_load_dwordx2 s[34:35], s[0:1], 104
    s_mov_b32 s14, 8192
    s_mov_b32 s15, 65536
    s_mov_b32 s18, 7
    s_mov_b32 s25, 0
    s_mul_i32 s13, s28, 262144
    s_lshr_b32 s22, s19, 1
    s_lshl_b32 s12, s29, 9
    s_lshl_b32 s23, s22, 8
    s_add_u32 s12, s12, s23
    s_mov_b32 s16, 0
    s_mov_b32 s17, 0
    s_waitcnt lgkmcnt(0)
    s_mov_b32 s4, s32
    s_mov_b32 s5, s33
    s_and_b32 s5, s5, 0xffff
    s_mov_b32 s6, 0x800000
    s_mov_b32 s7, 0x00020000
    s_mov_b32 s8, s34
    s_mov_b32 s9, s35
    s_and_b32 s9, s9, 0xffff
    s_mov_b32 s10, 0x400000
    s_mov_b32 s11, 0x00020000
    v_and_b32 v1, 63, v0
    s_lshl_b32 s26, s14, 5
    s_mul_i32 s22, s19, 4
    s_and_b32 s22, s22, 7
    s_lshl_b32 s22, s22, 2
    s_mul_i32 s22, s22, s14
    s_add_u32 s22, s22, s12
    v_lshrrev_b32 v2, 4, v1
    v_lshlrev_b32 v3, 2, v2
    v_and_b32 v8, 15, v1
    v_xor_b32 v8, v8, v3
    v_lshlrev_b32 v8, 4, v8
    v_mul_lo_u32 v2, s14, v2
    v_add3_u32 v8, v8, v2, s22
    s_lshl_b32 s22, s14, 2
    s_sub_u32 s22, s22, 1024
    v_add_u32 v9, s22, v8
    v_add_u32 v10, s22, v9
    v_add_u32 v11, s22, v10
    v_lshlrev_b32 v2, 4, v1
    s_mul_i32 s22, s19, s15
    s_add_u32 s22, s22, s13
    v_add_u32 v12, s22, v2
    s_mul_i32 s20, s19, 4096
    s_mul_i32 s21, s19, 2048
    s_add_u32 s21, s21, 16384
    v_bfe_u32 v2, v1, 2, 2
    v_lshrrev_b32 v3, 5, v1
    v_lshl_add_u32 v3, v3, 2, v2
    v_lshlrev_b32 v3, 8, v3
    v_bfe_u32 v13, v1, 4, 1
    v_lshl_add_u32 v3, v13, 5, v3
    v_bfe_u32 v13, v1, 1, 1
    v_lshl_add_u32 v3, v13, 4, v3
    v_and_b32 v13, 1, v1
    v_lshl_add_u32 v3, v13, 3, v3
    s_and_b32 s22, s19, 1
    s_lshl_b32 s23, s22, 1
    s_add_u32 s23, s23, 0
    s_cmp_lg_u32 s25, 0
    s_cselect_b32 s23, s23, 0
    s_cselect_b32 s24, 0, s22
    s_lshl_b32 s24, s24, 13
    v_xor_b32 v13, s23, v2
    v_lshl_add_u32 v13, v13, 6, v3
    v_add_u32 v13, s24, v13
    v_add_u32 v14, 49152, v13
    s_lshl_b32 s23, s22, 1
    s_add_u32 s23, s23, 1
    s_cmp_lg_u32 s25, 0
    s_cselect_b32 s23, s23, 1
    s_cselect_b32 s24, 0, s22
    s_lshl_b32 s24, s24, 13
    v_xor_b32 v15, s23, v2
    v_lshl_add_u32 v15, v15, 6, v3
    v_add_u32 v15, s24, v15
    v_add_u32 v16, 49152, v15
    s_lshl_b32 s23, s22, 1
    s_add_u32 s23, s23, 0
    s_cmp_lg_u32 s25, 0
    s_cselect_b32 s23, s23, 2
    s_cselect_b32 s24, 1, s22
    s_lshl_b32 s24, s24, 13
    v_xor_b32 v17, s23, v2
    v_lshl_add_u32 v17, v17, 6, v3
    v_add_u32 v17, s24, v17
    v_add_u32 v18, 49152, v17
    s_lshl_b32 s23, s22, 1
    s_add_u32 s23, s23, 1
    s_cmp_lg_u32 s25, 0
    s_cselect_b32 s23, s23, 3
    s_cselect_b32 s24, 1, s22
    s_lshl_b32 s24, s24, 13
    v_xor_b32 v19, s23, v2
    v_lshl_add_u32 v19, v19, 6, v3
    v_add_u32 v19, s24, v19
    v_add_u32 v20, 49152, v19
    s_lshr_b32 s22, s19, 1
    s_mul_i32 s22, s22, 4096
    s_add_u32 s22, s22, 16384
    v_lshlrev_b32 v21, 4, v1
    v_add_u32 v21, s22, v21
    v_add_u32 v22, 49152, v21
    s_mov_b32 m0, s20
    s_nop 0
    buffer_load_dwordx4 v8, s[4:7], s16 offen offset:0 lds
    buffer_load_dwordx4 v9, s[4:7], s16 offen offset:1024 lds
    buffer_load_dwordx4 v10, s[4:7], s16 offen offset:2048 lds
    buffer_load_dwordx4 v11, s[4:7], s16 offen offset:3072 lds
    s_add_u32 s16, s16, s26
    s_add_u32 m0, s21, 0
    s_nop 0
    buffer_load_dwordx4 v12, s[8:11], s17 offen offset:0 lds
    buffer_load_dwordx4 v12, s[8:11], s17 offen offset:1024 lds
    s_add_u32 s17, s17, 2048
    s_add_u32 m0, s20, 24576
    s_nop 0
    buffer_load_dwordx4 v8, s[4:7], s16 offen offset:0 lds
    buffer_load_dwordx4 v9, s[4:7], s16 offen offset:1024 lds
    buffer_load_dwordx4 v10, s[4:7], s16 offen offset:2048 lds
    buffer_load_dwordx4 v11, s[4:7], s16 offen offset:3072 lds
    s_add_u32 s16, s16, s26
    s_add_u32 m0, s21, 24576
    s_nop 0
    buffer_load_dwordx4 v12, s[8:11], s17 offen offset:0 lds
    buffer_load_dwordx4 v12, s[8:11], s17 offen offset:1024 lds
    s_add_u32 s17, s17, 2048
    s_add_u32 m0, s20, 49152
    s_nop 0
    buffer_load_dwordx4 v8, s[4:7], s16 offen offset:0 lds
    buffer_load_dwordx4 v9, s[4:7], s16 offen offset:1024 lds
    buffer_load_dwordx4 v10, s[4:7], s16 offen offset:2048 lds
    buffer_load_dwordx4 v11, s[4:7], s16 offen offset:3072 lds
    s_add_u32 s16, s16, s26
    s_add_u32 m0, s21, 49152
    s_nop 0
    buffer_load_dwordx4 v12, s[8:11], s17 offen offset:0 lds
    buffer_load_dwordx4 v12, s[8:11], s17 offen offset:1024 lds
    s_add_u32 s17, s17, 2048
    s_add_u32 m0, s20, 73728
    s_nop 0
    buffer_load_dwordx4 v8, s[4:7], s16 offen offset:0 lds
    buffer_load_dwordx4 v9, s[4:7], s16 offen offset:1024 lds
    buffer_load_dwordx4 v10, s[4:7], s16 offen offset:2048 lds
    buffer_load_dwordx4 v11, s[4:7], s16 offen offset:3072 lds
    s_add_u32 s16, s16, s26
    v_accvgpr_write_b32 a0, 0
    v_accvgpr_write_b32 a1, 0
    v_accvgpr_write_b32 a2, 0
    v_accvgpr_write_b32 a3, 0
    v_accvgpr_write_b32 a4, 0
    v_accvgpr_write_b32 a5, 0
    v_accvgpr_write_b32 a6, 0
    v_accvgpr_write_b32 a7, 0
    v_accvgpr_write_b32 a8, 0
    v_accvgpr_write_b32 a9, 0
    v_accvgpr_write_b32 a10, 0
    v_accvgpr_write_b32 a11, 0
    v_accvgpr_write_b32 a12, 0
    v_accvgpr_write_b32 a13, 0
    v_accvgpr_write_b32 a14, 0
    v_accvgpr_write_b32 a15, 0
    v_accvgpr_write_b32 a16, 0
    v_accvgpr_write_b32 a17, 0
    v_accvgpr_write_b32 a18, 0
    v_accvgpr_write_b32 a19, 0
    v_accvgpr_write_b32 a20, 0
    v_accvgpr_write_b32 a21, 0
    v_accvgpr_write_b32 a22, 0
    v_accvgpr_write_b32 a23, 0
    v_accvgpr_write_b32 a24, 0
    v_accvgpr_write_b32 a25, 0
    v_accvgpr_write_b32 a26, 0
    v_accvgpr_write_b32 a27, 0
    v_accvgpr_write_b32 a28, 0
    v_accvgpr_write_b32 a29, 0
    v_accvgpr_write_b32 a30, 0
    v_accvgpr_write_b32 a31, 0
    v_accvgpr_write_b32 a32, 0
    v_accvgpr_write_b32 a33, 0
    v_accvgpr_write_b32 a34, 0
    v_accvgpr_write_b32 a35, 0
    v_accvgpr_write_b32 a36, 0
    v_accvgpr_write_b32 a37, 0
    v_accvgpr_write_b32 a38, 0
    v_accvgpr_write_b32 a39, 0
    v_accvgpr_write_b32 a40, 0
    v_accvgpr_write_b32 a41, 0
    v_accvgpr_write_b32 a42, 0
    v_accvgpr_write_b32 a43, 0
    v_accvgpr_write_b32 a44, 0
    v_accvgpr_write_b32 a45, 0
    v_accvgpr_write_b32 a46, 0
    v_accvgpr_write_b32 a47, 0
    v_accvgpr_write_b32 a48, 0
    v_accvgpr_write_b32 a49, 0
    v_accvgpr_write_b32 a50, 0
    v_accvgpr_write_b32 a51, 0
    v_accvgpr_write_b32 a52, 0
    v_accvgpr_write_b32 a53, 0
    v_accvgpr_write_b32 a54, 0
    v_accvgpr_write_b32 a55, 0
    v_accvgpr_write_b32 a56, 0
    v_accvgpr_write_b32 a57, 0
    v_accvgpr_write_b32 a58, 0
    v_accvgpr_write_b32 a59, 0
    v_accvgpr_write_b32 a60, 0
    v_accvgpr_write_b32 a61, 0
    v_accvgpr_write_b32 a62, 0
    v_accvgpr_write_b32 a63, 0
    v_accvgpr_write_b32 a64, 0
    v_accvgpr_write_b32 a65, 0
    v_accvgpr_write_b32 a66, 0
    v_accvgpr_write_b32 a67, 0
    v_accvgpr_write_b32 a68, 0
    v_accvgpr_write_b32 a69, 0
    v_accvgpr_write_b32 a70, 0
    v_accvgpr_write_b32 a71, 0
    v_accvgpr_write_b32 a72, 0
    v_accvgpr_write_b32 a73, 0
    v_accvgpr_write_b32 a74, 0
    v_accvgpr_write_b32 a75, 0
    v_accvgpr_write_b32 a76, 0
    v_accvgpr_write_b32 a77, 0
    v_accvgpr_write_b32 a78, 0
    v_accvgpr_write_b32 a79, 0
    v_accvgpr_write_b32 a80, 0
    v_accvgpr_write_b32 a81, 0
    v_accvgpr_write_b32 a82, 0
    v_accvgpr_write_b32 a83, 0
    v_accvgpr_write_b32 a84, 0
    v_accvgpr_write_b32 a85, 0
    v_accvgpr_write_b32 a86, 0
    v_accvgpr_write_b32 a87, 0
    v_accvgpr_write_b32 a88, 0
    v_accvgpr_write_b32 a89, 0
    v_accvgpr_write_b32 a90, 0
    v_accvgpr_write_b32 a91, 0
    v_accvgpr_write_b32 a92, 0
    v_accvgpr_write_b32 a93, 0
    v_accvgpr_write_b32 a94, 0
    v_accvgpr_write_b32 a95, 0
    v_accvgpr_write_b32 a96, 0
    v_accvgpr_write_b32 a97, 0
    v_accvgpr_write_b32 a98, 0
    v_accvgpr_write_b32 a99, 0
    v_accvgpr_write_b32 a100, 0
    v_accvgpr_write_b32 a101, 0
    v_accvgpr_write_b32 a102, 0
    v_accvgpr_write_b32 a103, 0
    v_accvgpr_write_b32 a104, 0
    v_accvgpr_write_b32 a105, 0
    v_accvgpr_write_b32 a106, 0
    v_accvgpr_write_b32 a107, 0
    v_accvgpr_write_b32 a108, 0
    v_accvgpr_write_b32 a109, 0
    v_accvgpr_write_b32 a110, 0
    v_accvgpr_write_b32 a111, 0
    v_accvgpr_write_b32 a112, 0
    v_accvgpr_write_b32 a113, 0
    v_accvgpr_write_b32 a114, 0
    v_accvgpr_write_b32 a115, 0
    v_accvgpr_write_b32 a116, 0
    v_accvgpr_write_b32 a117, 0
    v_accvgpr_write_b32 a118, 0
    v_accvgpr_write_b32 a119, 0
    v_accvgpr_write_b32 a120, 0
    v_accvgpr_write_b32 a121, 0
    v_accvgpr_write_b32 a122, 0
    v_accvgpr_write_b32 a123, 0
    v_accvgpr_write_b32 a124, 0
    v_accvgpr_write_b32 a125, 0
    v_accvgpr_write_b32 a126, 0
    v_accvgpr_write_b32 a127, 0
    s_waitcnt vmcnt(16)
    s_barrier
    ds_read_b128 v[56:59], v21 offset:0
    ds_read_b64_tr_b16 v[24:25], v13 offset:0
    ds_read_b64_tr_b16 v[26:27], v13 offset:2048
    ds_read_b64_tr_b16 v[28:29], v15 offset:0
    ds_read_b64_tr_b16 v[30:31], v15 offset:2048
    ds_read_b64_tr_b16 v[32:33], v17 offset:0
    ds_read_b64_tr_b16 v[34:35], v17 offset:2048
    ds_read_b64_tr_b16 v[36:37], v19 offset:0
    ds_read_b64_tr_b16 v[38:39], v19 offset:2048
    ds_read_b128 v[60:63], v21 offset:2048
Q_loop_3:
    s_waitcnt lgkmcnt(0)
    v_mfma_f32_32x32x16_bf16 a[0:15], v[24:27], v[56:59], a[0:15]
    ds_read_b128 v[64:67], v21 offset:1024
    ds_read_b64_tr_b16 v[40:41], v13 offset:4096
    v_mfma_f32_32x32x16_bf16 a[16:31], v[28:31], v[56:59], a[16:31]
    ds_read_b64_tr_b16 v[42:43], v13 offset:6144
    ds_read_b64_tr_b16 v[44:45], v15 offset:4096
    s_add_u32 m0, s21, 73728
    s_nop 0
    buffer_load_dwordx4 v12, s[8:11], s17 offen offset:0 lds
    v_mfma_f32_32x32x16_bf16 a[32:47], v[32:35], v[56:59], a[32:47]
    ds_read_b64_tr_b16 v[46:47], v15 offset:6144
    ds_read_b64_tr_b16 v[48:49], v17 offset:4096
    v_mfma_f32_32x32x16_bf16 a[48:63], v[36:39], v[56:59], a[48:63]
    ds_read_b64_tr_b16 v[50:51], v17 offset:6144
    ds_read_b64_tr_b16 v[52:53], v19 offset:4096
    v_mfma_f32_32x32x16_bf16 a[64:79], v[24:27], v[60:63], a[64:79]
    ds_read_b64_tr_b16 v[54:55], v19 offset:6144
    ds_read_b128 v[68:71], v21 offset:3072
    v_mfma_f32_32x32x16_bf16 a[80:95], v[28:31], v[60:63], a[80:95]
    buffer_load_dwordx4 v12, s[8:11], s17 offen offset:1024 lds
    s_add_u32 s17, s17, 2048
    v_mfma_f32_32x32x16_bf16 a[96:111], v[32:35], v[60:63], a[96:111]
    v_mfma_f32_32x32x16_bf16 a[112:127], v[36:39], v[60:63], a[112:127]
    s_waitcnt vmcnt(12) lgkmcnt(0)
    s_barrier
    v_mfma_f32_32x32x16_bf16 a[0:15], v[40:43], v[64:67], a[0:15]
    ds_read_b128 v[56:59], v21 offset:24576
    ds_read_b64_tr_b16 v[24:25], v13 offset:24576
    v_mfma_f32_32x32x16_bf16 a[16:31], v[44:47], v[64:67], a[16:31]
    ds_read_b64_tr_b16 v[26:27], v13 offset:26624
    ds_read_b64_tr_b16 v[28:29], v15 offset:24576
    s_mov_b32 m0, s20
    s_nop 0
    buffer_load_dwordx4 v8, s[4:7], s16 offen offset:0 lds
    v_mfma_f32_32x32x16_bf16 a[32:47], v[48:51], v[64:67], a[32:47]
    ds_read_b64_tr_b16 v[30:31], v15 offset:26624
    ds_read_b64_tr_b16 v[32:33], v17 offset:24576
    v_mfma_f32_32x32x16_bf16 a[48:63], v[52:55], v[64:67], a[48:63]
    ds_read_b64_tr_b16 v[34:35], v17 offset:26624
    ds_read_b64_tr_b16 v[36:37], v19 offset:24576
    buffer_load_dwordx4 v9, s[4:7], s16 offen offset:1024 lds
    v_mfma_f32_32x32x16_bf16 a[64:79], v[40:43], v[68:71], a[64:79]
    ds_read_b64_tr_b16 v[38:39], v19 offset:26624
    ds_read_b128 v[60:63], v21 offset:26624
    v_mfma_f32_32x32x16_bf16 a[80:95], v[44:47], v[68:71], a[80:95]
    buffer_load_dwordx4 v10, s[4:7], s16 offen offset:2048 lds
    v_mfma_f32_32x32x16_bf16 a[96:111], v[48:51], v[68:71], a[96:111]
    v_mfma_f32_32x32x16_bf16 a[112:127], v[52:55], v[68:71], a[112:127]
    buffer_load_dwordx4 v11, s[4:7], s16 offen offset:3072 lds
    s_add_u32 s16, s16, s26
    s_waitcnt lgkmcnt(0)
    v_mfma_f32_32x32x16_bf16 a[0:15], v[24:27], v[56:59], a[0:15]
    ds_read_b128 v[64:67], v21 offset:25600
    ds_read_b64_tr_b16 v[40:41], v13 offset:28672
    v_mfma_f32_32x32x16_bf16 a[16:31], v[28:31], v[56:59], a[16:31]
    ds_read_b64_tr_b16 v[42:43], v13 offset:30720
    ds_read_b64_tr_b16 v[44:45], v15 offset:28672
    s_add_u32 m0, s21, 0
    s_nop 0
    buffer_load_dwordx4 v12, s[8:11], s17 offen offset:0 lds
    v_mfma_f32_32x32x16_bf16 a[32:47], v[32:35], v[56:59], a[32:47]
    ds_read_b64_tr_b16 v[46:47], v15 offset:30720
    ds_read_b64_tr_b16 v[48:49], v17 offset:28672
    v_mfma_f32_32x32x16_bf16 a[48:63], v[36:39], v[56:59], a[48:63]
    ds_read_b64_tr_b16 v[50:51], v17 offset:30720
    ds_read_b64_tr_b16 v[52:53], v19 offset:28672
    v_mfma_f32_32x32x16_bf16 a[64:79], v[24:27], v[60:63], a[64:79]
    ds_read_b64_tr_b16 v[54:55], v19 offset:30720
    ds_read_b128 v[68:71], v21 offset:27648
    v_mfma_f32_32x32x16_bf16 a[80:95], v[28:31], v[60:63], a[80:95]
    buffer_load_dwordx4 v12, s[8:11], s17 offen offset:1024 lds
    s_add_u32 s17, s17, 2048
    v_mfma_f32_32x32x16_bf16 a[96:111], v[32:35], v[60:63], a[96:111]
    v_mfma_f32_32x32x16_bf16 a[112:127], v[36:39], v[60:63], a[112:127]
    s_waitcnt vmcnt(12) lgkmcnt(0)
    s_barrier
    v_mfma_f32_32x32x16_bf16 a[0:15], v[40:43], v[64:67], a[0:15]
    ds_read_b128 v[56:59], v22 offset:0
    ds_read_b64_tr_b16 v[24:25], v14 offset:0
    v_mfma_f32_32x32x16_bf16 a[16:31], v[44:47], v[64:67], a[16:31]
    ds_read_b64_tr_b16 v[26:27], v14 offset:2048
    ds_read_b64_tr_b16 v[28:29], v16 offset:0
    s_add_u32 m0, s20, 24576
    s_nop 0
    buffer_load_dwordx4 v8, s[4:7], s16 offen offset:0 lds
    v_mfma_f32_32x32x16_bf16 a[32:47], v[48:51], v[64:67], a[32:47]
    ds_read_b64_tr_b16 v[30:31], v16 offset:2048
    ds_read_b64_tr_b16 v[32:33], v18 offset:0
    v_mfma_f32_32x32x16_bf16 a[48:63], v[52:55], v[64:67], a[48:63]
    ds_read_b64_tr_b16 v[34:35], v18 offset:2048
    ds_read_b64_tr_b16 v[36:37], v20 offset:0
    buffer_load_dwordx4 v9, s[4:7], s16 offen offset:1024 lds
    v_mfma_f32_32x32x16_bf16 a[64:79], v[40:43], v[68:71], a[64:79]
    ds_read_b64_tr_b16 v[38:39], v20 offset:2048
    ds_read_b128 v[60:63], v22 offset:2048
    v_mfma_f32_32x32x16_bf16 a[80:95], v[44:47], v[68:71], a[80:95]
    buffer_load_dwordx4 v10, s[4:7], s16 offen offset:2048 lds
    v_mfma_f32_32x32x16_bf16 a[96:111], v[48:51], v[68:71], a[96:111]
    v_mfma_f32_32x32x16_bf16 a[112:127], v[52:55], v[68:71], a[112:127]
    buffer_load_dwordx4 v11, s[4:7], s16 offen offset:3072 lds
    s_add_u32 s16, s16, s26
    s_waitcnt lgkmcnt(0)
    v_mfma_f32_32x32x16_bf16 a[0:15], v[24:27], v[56:59], a[0:15]
    ds_read_b128 v[64:67], v22 offset:1024
    ds_read_b64_tr_b16 v[40:41], v14 offset:4096
    v_mfma_f32_32x32x16_bf16 a[16:31], v[28:31], v[56:59], a[16:31]
    ds_read_b64_tr_b16 v[42:43], v14 offset:6144
    ds_read_b64_tr_b16 v[44:45], v16 offset:4096
    s_add_u32 m0, s21, 24576
    s_nop 0
    buffer_load_dwordx4 v12, s[8:11], s17 offen offset:0 lds
    v_mfma_f32_32x32x16_bf16 a[32:47], v[32:35], v[56:59], a[32:47]
    ds_read_b64_tr_b16 v[46:47], v16 offset:6144
    ds_read_b64_tr_b16 v[48:49], v18 offset:4096
    v_mfma_f32_32x32x16_bf16 a[48:63], v[36:39], v[56:59], a[48:63]
    ds_read_b64_tr_b16 v[50:51], v18 offset:6144
    ds_read_b64_tr_b16 v[52:53], v20 offset:4096
    v_mfma_f32_32x32x16_bf16 a[64:79], v[24:27], v[60:63], a[64:79]
    ds_read_b64_tr_b16 v[54:55], v20 offset:6144
    ds_read_b128 v[68:71], v22 offset:3072
    v_mfma_f32_32x32x16_bf16 a[80:95], v[28:31], v[60:63], a[80:95]
    buffer_load_dwordx4 v12, s[8:11], s17 offen offset:1024 lds
    s_add_u32 s17, s17, 2048
    v_mfma_f32_32x32x16_bf16 a[96:111], v[32:35], v[60:63], a[96:111]
    v_mfma_f32_32x32x16_bf16 a[112:127], v[36:39], v[60:63], a[112:127]
    s_waitcnt vmcnt(12) lgkmcnt(0)
    s_barrier
    v_mfma_f32_32x32x16_bf16 a[0:15], v[40:43], v[64:67], a[0:15]
    ds_read_b128 v[56:59], v22 offset:24576
    ds_read_b64_tr_b16 v[24:25], v14 offset:24576
    v_mfma_f32_32x32x16_bf16 a[16:31], v[44:47], v[64:67], a[16:31]
    ds_read_b64_tr_b16 v[26:27], v14 offset:26624
    ds_read_b64_tr_b16 v[28:29], v16 offset:24576
    s_add_u32 m0, s20, 49152
    s_nop 0
    buffer_load_dwordx4 v8, s[4:7], s16 offen offset:0 lds
    v_mfma_f32_32x32x16_bf16 a[32:47], v[48:51], v[64:67], a[32:47]
    ds_read_b64_tr_b16 v[30:31], v16 offset:26624
    ds_read_b64_tr_b16 v[32:33], v18 offset:24576
    v_mfma_f32_32x32x16_bf16 a[48:63], v[52:55], v[64:67], a[48:63]
    ds_read_b64_tr_b16 v[34:35], v18 offset:26624
    ds_read_b64_tr_b16 v[36:37], v20 offset:24576
    buffer_load_dwordx4 v9, s[4:7], s16 offen offset:1024 lds
    v_mfma_f32_32x32x16_bf16 a[64:79], v[40:43], v[68:71], a[64:79]
    ds_read_b64_tr_b16 v[38:39], v20 offset:26624
    ds_read_b128 v[60:63], v22 offset:26624
    v_mfma_f32_32x32x16_bf16 a[80:95], v[44:47], v[68:71], a[80:95]
    buffer_load_dwordx4 v10, s[4:7], s16 offen offset:2048 lds
    v_mfma_f32_32x32x16_bf16 a[96:111], v[48:51], v[68:71], a[96:111]
    v_mfma_f32_32x32x16_bf16 a[112:127], v[52:55], v[68:71], a[112:127]
    buffer_load_dwordx4 v11, s[4:7], s16 offen offset:3072 lds
    s_add_u32 s16, s16, s26
    s_waitcnt lgkmcnt(0)
    v_mfma_f32_32x32x16_bf16 a[0:15], v[24:27], v[56:59], a[0:15]
    ds_read_b128 v[64:67], v22 offset:25600
    ds_read_b64_tr_b16 v[40:41], v14 offset:28672
    v_mfma_f32_32x32x16_bf16 a[16:31], v[28:31], v[56:59], a[16:31]
    ds_read_b64_tr_b16 v[42:43], v14 offset:30720
    ds_read_b64_tr_b16 v[44:45], v16 offset:28672
    s_add_u32 m0, s21, 49152
    s_nop 0
    buffer_load_dwordx4 v12, s[8:11], s17 offen offset:0 lds
    v_mfma_f32_32x32x16_bf16 a[32:47], v[32:35], v[56:59], a[32:47]
    ds_read_b64_tr_b16 v[46:47], v16 offset:30720
    ds_read_b64_tr_b16 v[48:49], v18 offset:28672
    v_mfma_f32_32x32x16_bf16 a[48:63], v[36:39], v[56:59], a[48:63]
    ds_read_b64_tr_b16 v[50:51], v18 offset:30720
    ds_read_b64_tr_b16 v[52:53], v20 offset:28672
    v_mfma_f32_32x32x16_bf16 a[64:79], v[24:27], v[60:63], a[64:79]
    ds_read_b64_tr_b16 v[54:55], v20 offset:30720
    ds_read_b128 v[68:71], v22 offset:27648
    v_mfma_f32_32x32x16_bf16 a[80:95], v[28:31], v[60:63], a[80:95]
    buffer_load_dwordx4 v12, s[8:11], s17 offen offset:1024 lds
    s_add_u32 s17, s17, 2048
    v_mfma_f32_32x32x16_bf16 a[96:111], v[32:35], v[60:63], a[96:111]
    v_mfma_f32_32x32x16_bf16 a[112:127], v[36:39], v[60:63], a[112:127]
    s_waitcnt vmcnt(12) lgkmcnt(0)
    s_barrier
    v_mfma_f32_32x32x16_bf16 a[0:15], v[40:43], v[64:67], a[0:15]
    ds_read_b128 v[56:59], v21 offset:0
    ds_read_b64_tr_b16 v[24:25], v13 offset:0
    v_mfma_f32_32x32x16_bf16 a[16:31], v[44:47], v[64:67], a[16:31]
    ds_read_b64_tr_b16 v[26:27], v13 offset:2048
    ds_read_b64_tr_b16 v[28:29], v15 offset:0
    s_add_u32 m0, s20, 73728
    s_nop 0
    buffer_load_dwordx4 v8, s[4:7], s16 offen offset:0 lds
    v_mfma_f32_32x32x16_bf16 a[32:47], v[48:51], v[64:67], a[32:47]
    ds_read_b64_tr_b16 v[30:31], v15 offset:2048
    ds_read_b64_tr_b16 v[32:33], v17 offset:0
    v_mfma_f32_32x32x16_bf16 a[48:63], v[52:55], v[64:67], a[48:63]
    ds_read_b64_tr_b16 v[34:35], v17 offset:2048
    ds_read_b64_tr_b16 v[36:37], v19 offset:0
    buffer_load_dwordx4 v9, s[4:7], s16 offen offset:1024 lds
    v_mfma_f32_32x32x16_bf16 a[64:79], v[40:43], v[68:71], a[64:79]
    ds_read_b64_tr_b16 v[38:39], v19 offset:2048
    ds_read_b128 v[60:63], v21 offset:2048
    v_mfma_f32_32x32x16_bf16 a[80:95], v[44:47], v[68:71], a[80:95]
    buffer_load_dwordx4 v10, s[4:7], s16 offen offset:2048 lds
    v_mfma_f32_32x32x16_bf16 a[96:111], v[48:51], v[68:71], a[96:111]
    v_mfma_f32_32x32x16_bf16 a[112:127], v[52:55], v[68:71], a[112:127]
    buffer_load_dwordx4 v11, s[4:7], s16 offen offset:3072 lds
    s_add_u32 s16, s16, s26
    s_sub_u32 s18, s18, 1
    s_cmp_lg_u32 s18, 0
    s_cbranch_scc1 Q_loop_3
    s_waitcnt lgkmcnt(0)
    v_mfma_f32_32x32x16_bf16 a[0:15], v[24:27], v[56:59], a[0:15]
    ds_read_b128 v[64:67], v21 offset:1024
    ds_read_b64_tr_b16 v[40:41], v13 offset:4096
    v_mfma_f32_32x32x16_bf16 a[16:31], v[28:31], v[56:59], a[16:31]
    ds_read_b64_tr_b16 v[42:43], v13 offset:6144
    ds_read_b64_tr_b16 v[44:45], v15 offset:4096
    s_add_u32 m0, s21, 73728
    s_nop 0
    buffer_load_dwordx4 v12, s[8:11], s17 offen offset:0 lds
    v_mfma_f32_32x32x16_bf16 a[32:47], v[32:35], v[56:59], a[32:47]
    ds_read_b64_tr_b16 v[46:47], v15 offset:6144
    ds_read_b64_tr_b16 v[48:49], v17 offset:4096
    v_mfma_f32_32x32x16_bf16 a[48:63], v[36:39], v[56:59], a[48:63]
    ds_read_b64_tr_b16 v[50:51], v17 offset:6144
    ds_read_b64_tr_b16 v[52:53], v19 offset:4096
    v_mfma_f32_32x32x16_bf16 a[64:79], v[24:27], v[60:63], a[64:79]
    ds_read_b64_tr_b16 v[54:55], v19 offset:6144
    ds_read_b128 v[68:71], v21 offset:3072
    v_mfma_f32_32x32x16_bf16 a[80:95], v[28:31], v[60:63], a[80:95]
    buffer_load_dwordx4 v12, s[8:11], s17 offen offset:1024 lds
    s_add_u32 s17, s17, 2048
    v_mfma_f32_32x32x16_bf16 a[96:111], v[32:35], v[60:63], a[96:111]
    v_mfma_f32_32x32x16_bf16 a[112:127], v[36:39], v[60:63], a[112:127]
    s_waitcnt vmcnt(12) lgkmcnt(0)
    s_barrier
    v_mfma_f32_32x32x16_bf16 a[0:15], v[40:43], v[64:67], a[0:15]
    ds_read_b128 v[56:59], v21 offset:24576
    ds_read_b64_tr_b16 v[24:25], v13 offset:24576
    v_mfma_f32_32x32x16_bf16 a[16:31], v[44:47], v[64:67], a[16:31]
    ds_read_b64_tr_b16 v[26:27], v13 offset:26624
    ds_read_b64_tr_b16 v[28:29], v15 offset:24576
    v_mfma_f32_32x32x16_bf16 a[32:47], v[48:51], v[64:67], a[32:47]
    ds_read_b64_tr_b16 v[30:31], v15 offset:26624
    ds_read_b64_tr_b16 v[32:33], v17 offset:24576
    v_mfma_f32_32x32x16_bf16 a[48:63], v[52:55], v[64:67], a[48:63]
    ds_read_b64_tr_b16 v[34:35], v17 offset:26624
    ds_read_b64_tr_b16 v[36:37], v19 offset:24576
    v_mfma_f32_32x32x16_bf16 a[64:79], v[40:43], v[68:71], a[64:79]
    ds_read_b64_tr_b16 v[38:39], v19 offset:26624
    ds_read_b128 v[60:63], v21 offset:26624
    v_mfma_f32_32x32x16_bf16 a[80:95], v[44:47], v[68:71], a[80:95]
    v_mfma_f32_32x32x16_bf16 a[96:111], v[48:51], v[68:71], a[96:111]
    v_mfma_f32_32x32x16_bf16 a[112:127], v[52:55], v[68:71], a[112:127]
    s_waitcnt lgkmcnt(0)
    v_mfma_f32_32x32x16_bf16 a[0:15], v[24:27], v[56:59], a[0:15]
    ds_read_b128 v[64:67], v21 offset:25600
    ds_read_b64_tr_b16 v[40:41], v13 offset:28672
    v_mfma_f32_32x32x16_bf16 a[16:31], v[28:31], v[56:59], a[16:31]
    ds_read_b64_tr_b16 v[42:43], v13 offset:30720
    ds_read_b64_tr_b16 v[44:45], v15 offset:28672
    v_mfma_f32_32x32x16_bf16 a[32:47], v[32:35], v[56:59], a[32:47]
    ds_read_b64_tr_b16 v[46:47], v15 offset:30720
    ds_read_b64_tr_b16 v[48:49], v17 offset:28672
    v_mfma_f32_32x32x16_bf16 a[48:63], v[36:39], v[56:59], a[48:63]
    ds_read_b64_tr_b16 v[50:51], v17 offset:30720
    ds_read_b64_tr_b16 v[52:53], v19 offset:28672
    v_mfma_f32_32x32x16_bf16 a[64:79], v[24:27], v[60:63], a[64:79]
    ds_read_b64_tr_b16 v[54:55], v19 offset:30720
    ds_read_b128 v[68:71], v21 offset:27648
    v_mfma_f32_32x32x16_bf16 a[80:95], v[28:31], v[60:63], a[80:95]
    v_mfma_f32_32x32x16_bf16 a[96:111], v[32:35], v[60:63], a[96:111]
    v_mfma_f32_32x32x16_bf16 a[112:127], v[36:39], v[60:63], a[112:127]
    s_waitcnt vmcnt(6) lgkmcnt(0)
    s_barrier
    v_mfma_f32_32x32x16_bf16 a[0:15], v[40:43], v[64:67], a[0:15]
    ds_read_b128 v[56:59], v22 offset:0
    ds_read_b64_tr_b16 v[24:25], v14 offset:0
    v_mfma_f32_32x32x16_bf16 a[16:31], v[44:47], v[64:67], a[16:31]
    ds_read_b64_tr_b16 v[26:27], v14 offset:2048
    ds_read_b64_tr_b16 v[28:29], v16 offset:0
    v_mfma_f32_32x32x16_bf16 a[32:47], v[48:51], v[64:67], a[32:47]
    ds_read_b64_tr_b16 v[30:31], v16 offset:2048
    ds_read_b64_tr_b16 v[32:33], v18 offset:0
    v_mfma_f32_32x32x16_bf16 a[48:63], v[52:55], v[64:67], a[48:63]
    ds_read_b64_tr_b16 v[34:35], v18 offset:2048
    ds_read_b64_tr_b16 v[36:37], v20 offset:0
    v_mfma_f32_32x32x16_bf16 a[64:79], v[40:43], v[68:71], a[64:79]
    ds_read_b64_tr_b16 v[38:39], v20 offset:2048
    ds_read_b128 v[60:63], v22 offset:2048
    v_mfma_f32_32x32x16_bf16 a[80:95], v[44:47], v[68:71], a[80:95]
    v_mfma_f32_32x32x16_bf16 a[96:111], v[48:51], v[68:71], a[96:111]
    v_mfma_f32_32x32x16_bf16 a[112:127], v[52:55], v[68:71], a[112:127]
    s_waitcnt lgkmcnt(0)
    v_mfma_f32_32x32x16_bf16 a[0:15], v[24:27], v[56:59], a[0:15]
    ds_read_b128 v[64:67], v22 offset:1024
    ds_read_b64_tr_b16 v[40:41], v14 offset:4096
    v_mfma_f32_32x32x16_bf16 a[16:31], v[28:31], v[56:59], a[16:31]
    ds_read_b64_tr_b16 v[42:43], v14 offset:6144
    ds_read_b64_tr_b16 v[44:45], v16 offset:4096
    v_mfma_f32_32x32x16_bf16 a[32:47], v[32:35], v[56:59], a[32:47]
    ds_read_b64_tr_b16 v[46:47], v16 offset:6144
    ds_read_b64_tr_b16 v[48:49], v18 offset:4096
    v_mfma_f32_32x32x16_bf16 a[48:63], v[36:39], v[56:59], a[48:63]
    ds_read_b64_tr_b16 v[50:51], v18 offset:6144
    ds_read_b64_tr_b16 v[52:53], v20 offset:4096
    v_mfma_f32_32x32x16_bf16 a[64:79], v[24:27], v[60:63], a[64:79]
    ds_read_b64_tr_b16 v[54:55], v20 offset:6144
    ds_read_b128 v[68:71], v22 offset:3072
    v_mfma_f32_32x32x16_bf16 a[80:95], v[28:31], v[60:63], a[80:95]
    v_mfma_f32_32x32x16_bf16 a[96:111], v[32:35], v[60:63], a[96:111]
    v_mfma_f32_32x32x16_bf16 a[112:127], v[36:39], v[60:63], a[112:127]
    s_waitcnt vmcnt(0) lgkmcnt(0)
    s_barrier
    v_mfma_f32_32x32x16_bf16 a[0:15], v[40:43], v[64:67], a[0:15]
    ds_read_b128 v[56:59], v22 offset:24576
    ds_read_b64_tr_b16 v[24:25], v14 offset:24576
    v_mfma_f32_32x32x16_bf16 a[16:31], v[44:47], v[64:67], a[16:31]
    ds_read_b64_tr_b16 v[26:27], v14 offset:26624
    ds_read_b64_tr_b16 v[28:29], v16 offset:24576
    v_mfma_f32_32x32x16_bf16 a[32:47], v[48:51], v[64:67], a[32:47]
    ds_read_b64_tr_b16 v[30:31], v16 offset:26624
    ds_read_b64_tr_b16 v[32:33], v18 offset:24576
    v_mfma_f32_32x32x16_bf16 a[48:63], v[52:55], v[64:67], a[48:63]
    ds_read_b64_tr_b16 v[34:35], v18 offset:26624
    ds_read_b64_tr_b16 v[36:37], v20 offset:24576
    v_mfma_f32_32x32x16_bf16 a[64:79], v[40:43], v[68:71], a[64:79]
    ds_read_b64_tr_b16 v[38:39], v20 offset:26624
    ds_read_b128 v[60:63], v22 offset:26624
    v_mfma_f32_32x32x16_bf16 a[80:95], v[44:47], v[68:71], a[80:95]
    v_mfma_f32_32x32x16_bf16 a[96:111], v[48:51], v[68:71], a[96:111]
    v_mfma_f32_32x32x16_bf16 a[112:127], v[52:55], v[68:71], a[112:127]
    s_waitcnt lgkmcnt(0)
    v_mfma_f32_32x32x16_bf16 a[0:15], v[24:27], v[56:59], a[0:15]
    ds_read_b128 v[64:67], v22 offset:25600
    ds_read_b64_tr_b16 v[40:41], v14 offset:28672
    v_mfma_f32_32x32x16_bf16 a[16:31], v[28:31], v[56:59], a[16:31]
    ds_read_b64_tr_b16 v[42:43], v14 offset:30720
    ds_read_b64_tr_b16 v[44:45], v16 offset:28672
    v_mfma_f32_32x32x16_bf16 a[32:47], v[32:35], v[56:59], a[32:47]
    ds_read_b64_tr_b16 v[46:47], v16 offset:30720
    ds_read_b64_tr_b16 v[48:49], v18 offset:28672
    v_mfma_f32_32x32x16_bf16 a[48:63], v[36:39], v[56:59], a[48:63]
    ds_read_b64_tr_b16 v[50:51], v18 offset:30720
    ds_read_b64_tr_b16 v[52:53], v20 offset:28672
    v_mfma_f32_32x32x16_bf16 a[64:79], v[24:27], v[60:63], a[64:79]
    ds_read_b64_tr_b16 v[54:55], v20 offset:30720
    ds_read_b128 v[68:71], v22 offset:27648
    v_mfma_f32_32x32x16_bf16 a[80:95], v[28:31], v[60:63], a[80:95]
    v_mfma_f32_32x32x16_bf16 a[96:111], v[32:35], v[60:63], a[96:111]
    v_mfma_f32_32x32x16_bf16 a[112:127], v[36:39], v[60:63], a[112:127]
    s_waitcnt lgkmcnt(0)
    v_mfma_f32_32x32x16_bf16 a[0:15], v[40:43], v[64:67], a[0:15]
    v_mfma_f32_32x32x16_bf16 a[16:31], v[44:47], v[64:67], a[16:31]
    v_mfma_f32_32x32x16_bf16 a[32:47], v[48:51], v[64:67], a[32:47]
    v_mfma_f32_32x32x16_bf16 a[48:63], v[52:55], v[64:67], a[48:63]
    v_mfma_f32_32x32x16_bf16 a[64:79], v[40:43], v[68:71], a[64:79]
    v_mfma_f32_32x32x16_bf16 a[80:95], v[44:47], v[68:71], a[80:95]
    v_mfma_f32_32x32x16_bf16 a[96:111], v[48:51], v[68:71], a[96:111]
    v_mfma_f32_32x32x16_bf16 a[112:127], v[52:55], v[68:71], a[112:127]
    s_add_u32 s36, s34, 0x6000000
    s_addc_u32 s37, s35, 0
    s_and_b32 s37, s37, 0xffff
    s_mov_b32 s38, 0x1000000
    s_mov_b32 s39, 0x00020000
    v_and_b32 v1, 63, v0
    v_lshlrev_b32 v1, 4, v1
    s_lshr_b32 s22, s19, 1
    s_lshl_b32 s22, s22, 1
    s_lshl_b32 s23, s28, 2
    s_add_u32 s22, s22, s23
    s_lshl_b32 s22, s22, 8
    s_and_b32 s23, s19, 1
    s_lshl_b32 s23, s23, 3
    s_add_u32 s22, s22, s23
    s_lshl_b32 s23, s29, 4
    s_add_u32 s22, s22, s23
    s_lshl_b32 s22, s22, 10
    v_add_u32 v1, s22, v1
    s_nop 7
    s_nop 7
    v_accvgpr_read_b32 v72, a0
    v_accvgpr_read_b32 v73, a1
    v_accvgpr_read_b32 v74, a2
    v_accvgpr_read_b32 v75, a3
    v_accvgpr_read_b32 v76, a4
    v_accvgpr_read_b32 v77, a5
    v_accvgpr_read_b32 v78, a6
    v_accvgpr_read_b32 v79, a7
    v_accvgpr_read_b32 v80, a8
    v_accvgpr_read_b32 v81, a9
    v_accvgpr_read_b32 v82, a10
    v_accvgpr_read_b32 v83, a11
    v_accvgpr_read_b32 v84, a12
    v_accvgpr_read_b32 v85, a13
    v_accvgpr_read_b32 v86, a14
    v_accvgpr_read_b32 v87, a15
    v_cvt_pk_bf16_f32 v88, v72, v73
    v_cvt_pk_bf16_f32 v89, v74, v75
    v_cvt_pk_bf16_f32 v90, v76, v77
    v_cvt_pk_bf16_f32 v91, v78, v79
    v_cvt_pk_bf16_f32 v92, v80, v81
    v_cvt_pk_bf16_f32 v93, v82, v83
    v_cvt_pk_bf16_f32 v94, v84, v85
    v_cvt_pk_bf16_f32 v95, v86, v87
    s_mov_b32 s24, 0
    buffer_store_dwordx4 v[88:91], v1, s[36:39], s24 offen offset:0 sc1
    buffer_store_dwordx4 v[92:95], v1, s[36:39], s24 offen offset:1024 sc1
    v_accvgpr_read_b32 v96, a16
    v_accvgpr_read_b32 v97, a17
    v_accvgpr_read_b32 v98, a18
    v_accvgpr_read_b32 v99, a19
    v_accvgpr_read_b32 v100, a20
    v_accvgpr_read_b32 v101, a21
    v_accvgpr_read_b32 v102, a22
    v_accvgpr_read_b32 v103, a23
    v_accvgpr_read_b32 v104, a24
    v_accvgpr_read_b32 v105, a25
    v_accvgpr_read_b32 v106, a26
    v_accvgpr_read_b32 v107, a27
    v_accvgpr_read_b32 v108, a28
    v_accvgpr_read_b32 v109, a29
    v_accvgpr_read_b32 v110, a30
    v_accvgpr_read_b32 v111, a31
    v_cvt_pk_bf16_f32 v112, v96, v97
    v_cvt_pk_bf16_f32 v113, v98, v99
    v_cvt_pk_bf16_f32 v114, v100, v101
    v_cvt_pk_bf16_f32 v115, v102, v103
    v_cvt_pk_bf16_f32 v116, v104, v105
    v_cvt_pk_bf16_f32 v117, v106, v107
    v_cvt_pk_bf16_f32 v118, v108, v109
    v_cvt_pk_bf16_f32 v119, v110, v111
    s_mov_b32 s24, 0
    buffer_store_dwordx4 v[112:115], v1, s[36:39], s24 offen offset:2048 sc1
    buffer_store_dwordx4 v[116:119], v1, s[36:39], s24 offen offset:3072 sc1
    v_accvgpr_read_b32 v120, a32
    v_accvgpr_read_b32 v121, a33
    v_accvgpr_read_b32 v122, a34
    v_accvgpr_read_b32 v123, a35
    v_accvgpr_read_b32 v124, a36
    v_accvgpr_read_b32 v125, a37
    v_accvgpr_read_b32 v126, a38
    v_accvgpr_read_b32 v127, a39
    v_accvgpr_read_b32 v128, a40
    v_accvgpr_read_b32 v129, a41
    v_accvgpr_read_b32 v130, a42
    v_accvgpr_read_b32 v131, a43
    v_accvgpr_read_b32 v132, a44
    v_accvgpr_read_b32 v133, a45
    v_accvgpr_read_b32 v134, a46
    v_accvgpr_read_b32 v135, a47
    v_cvt_pk_bf16_f32 v136, v120, v121
    v_cvt_pk_bf16_f32 v137, v122, v123
    v_cvt_pk_bf16_f32 v138, v124, v125
    v_cvt_pk_bf16_f32 v139, v126, v127
    v_cvt_pk_bf16_f32 v140, v128, v129
    v_cvt_pk_bf16_f32 v141, v130, v131
    v_cvt_pk_bf16_f32 v142, v132, v133
    v_cvt_pk_bf16_f32 v143, v134, v135
    s_mov_b32 s24, 4096
    buffer_store_dwordx4 v[136:139], v1, s[36:39], s24 offen offset:0 sc1
    buffer_store_dwordx4 v[140:143], v1, s[36:39], s24 offen offset:1024 sc1
    v_accvgpr_read_b32 v144, a48
    v_accvgpr_read_b32 v145, a49
    v_accvgpr_read_b32 v146, a50
    v_accvgpr_read_b32 v147, a51
    v_accvgpr_read_b32 v148, a52
    v_accvgpr_read_b32 v149, a53
    v_accvgpr_read_b32 v150, a54
    v_accvgpr_read_b32 v151, a55
    v_accvgpr_read_b32 v152, a56
    v_accvgpr_read_b32 v153, a57
    v_accvgpr_read_b32 v154, a58
    v_accvgpr_read_b32 v155, a59
    v_accvgpr_read_b32 v156, a60
    v_accvgpr_read_b32 v157, a61
    v_accvgpr_read_b32 v158, a62
    v_accvgpr_read_b32 v159, a63
    v_cvt_pk_bf16_f32 v160, v144, v145
    v_cvt_pk_bf16_f32 v161, v146, v147
    v_cvt_pk_bf16_f32 v162, v148, v149
    v_cvt_pk_bf16_f32 v163, v150, v151
    v_cvt_pk_bf16_f32 v164, v152, v153
    v_cvt_pk_bf16_f32 v165, v154, v155
    v_cvt_pk_bf16_f32 v166, v156, v157
    v_cvt_pk_bf16_f32 v167, v158, v159
    s_mov_b32 s24, 4096
    buffer_store_dwordx4 v[160:163], v1, s[36:39], s24 offen offset:2048 sc1
    buffer_store_dwordx4 v[164:167], v1, s[36:39], s24 offen offset:3072 sc1
    s_waitcnt vmcnt(6)
    v_accvgpr_read_b32 v72, a64
    v_accvgpr_read_b32 v73, a65
    v_accvgpr_read_b32 v74, a66
    v_accvgpr_read_b32 v75, a67
    v_accvgpr_read_b32 v76, a68
    v_accvgpr_read_b32 v77, a69
    v_accvgpr_read_b32 v78, a70
    v_accvgpr_read_b32 v79, a71
    v_accvgpr_read_b32 v80, a72
    v_accvgpr_read_b32 v81, a73
    v_accvgpr_read_b32 v82, a74
    v_accvgpr_read_b32 v83, a75
    v_accvgpr_read_b32 v84, a76
    v_accvgpr_read_b32 v85, a77
    v_accvgpr_read_b32 v86, a78
    v_accvgpr_read_b32 v87, a79
    v_cvt_pk_bf16_f32 v88, v72, v73
    v_cvt_pk_bf16_f32 v89, v74, v75
    v_cvt_pk_bf16_f32 v90, v76, v77
    v_cvt_pk_bf16_f32 v91, v78, v79
    v_cvt_pk_bf16_f32 v92, v80, v81
    v_cvt_pk_bf16_f32 v93, v82, v83
    v_cvt_pk_bf16_f32 v94, v84, v85
    v_cvt_pk_bf16_f32 v95, v86, v87
    s_mov_b32 s24, 262144
    buffer_store_dwordx4 v[88:91], v1, s[36:39], s24 offen offset:0 sc1
    buffer_store_dwordx4 v[92:95], v1, s[36:39], s24 offen offset:1024 sc1
    s_waitcnt vmcnt(6)
    v_accvgpr_read_b32 v96, a80
    v_accvgpr_read_b32 v97, a81
    v_accvgpr_read_b32 v98, a82
    v_accvgpr_read_b32 v99, a83
    v_accvgpr_read_b32 v100, a84
    v_accvgpr_read_b32 v101, a85
    v_accvgpr_read_b32 v102, a86
    v_accvgpr_read_b32 v103, a87
    v_accvgpr_read_b32 v104, a88
    v_accvgpr_read_b32 v105, a89
    v_accvgpr_read_b32 v106, a90
    v_accvgpr_read_b32 v107, a91
    v_accvgpr_read_b32 v108, a92
    v_accvgpr_read_b32 v109, a93
    v_accvgpr_read_b32 v110, a94
    v_accvgpr_read_b32 v111, a95
    v_cvt_pk_bf16_f32 v112, v96, v97
    v_cvt_pk_bf16_f32 v113, v98, v99
    v_cvt_pk_bf16_f32 v114, v100, v101
    v_cvt_pk_bf16_f32 v115, v102, v103
    v_cvt_pk_bf16_f32 v116, v104, v105
    v_cvt_pk_bf16_f32 v117, v106, v107
    v_cvt_pk_bf16_f32 v118, v108, v109
    v_cvt_pk_bf16_f32 v119, v110, v111
    s_mov_b32 s24, 262144
    buffer_store_dwordx4 v[112:115], v1, s[36:39], s24 offen offset:2048 sc1
    buffer_store_dwordx4 v[116:119], v1, s[36:39], s24 offen offset:3072 sc1
    s_waitcnt vmcnt(6)
    v_accvgpr_read_b32 v120, a96
    v_accvgpr_read_b32 v121, a97
    v_accvgpr_read_b32 v122, a98
    v_accvgpr_read_b32 v123, a99
    v_accvgpr_read_b32 v124, a100
    v_accvgpr_read_b32 v125, a101
    v_accvgpr_read_b32 v126, a102
    v_accvgpr_read_b32 v127, a103
    v_accvgpr_read_b32 v128, a104
    v_accvgpr_read_b32 v129, a105
    v_accvgpr_read_b32 v130, a106
    v_accvgpr_read_b32 v131, a107
    v_accvgpr_read_b32 v132, a108
    v_accvgpr_read_b32 v133, a109
    v_accvgpr_read_b32 v134, a110
    v_accvgpr_read_b32 v135, a111
    v_cvt_pk_bf16_f32 v136, v120, v121
    v_cvt_pk_bf16_f32 v137, v122, v123
    v_cvt_pk_bf16_f32 v138, v124, v125
    v_cvt_pk_bf16_f32 v139, v126, v127
    v_cvt_pk_bf16_f32 v140, v128, v129
    v_cvt_pk_bf16_f32 v141, v130, v131
    v_cvt_pk_bf16_f32 v142, v132, v133
    v_cvt_pk_bf16_f32 v143, v134, v135
    s_mov_b32 s24, 266240
    buffer_store_dwordx4 v[136:139], v1, s[36:39], s24 offen offset:0 sc1
    buffer_store_dwordx4 v[140:143], v1, s[36:39], s24 offen offset:1024 sc1
    s_waitcnt vmcnt(6)
    v_accvgpr_read_b32 v144, a112
    v_accvgpr_read_b32 v145, a113
    v_accvgpr_read_b32 v146, a114
    v_accvgpr_read_b32 v147, a115
    v_accvgpr_read_b32 v148, a116
    v_accvgpr_read_b32 v149, a117
    v_accvgpr_read_b32 v150, a118
    v_accvgpr_read_b32 v151, a119
    v_accvgpr_read_b32 v152, a120
    v_accvgpr_read_b32 v153, a121
    v_accvgpr_read_b32 v154, a122
    v_accvgpr_read_b32 v155, a123
    v_accvgpr_read_b32 v156, a124
    v_accvgpr_read_b32 v157, a125
    v_accvgpr_read_b32 v158, a126
    v_accvgpr_read_b32 v159, a127
    v_cvt_pk_bf16_f32 v160, v144, v145
    v_cvt_pk_bf16_f32 v161, v146, v147
    v_cvt_pk_bf16_f32 v162, v148, v149
    v_cvt_pk_bf16_f32 v163, v150, v151
    v_cvt_pk_bf16_f32 v164, v152, v153
    v_cvt_pk_bf16_f32 v165, v154, v155
    v_cvt_pk_bf16_f32 v166, v156, v157
    v_cvt_pk_bf16_f32 v167, v158, v159
    s_mov_b32 s24, 266240
    buffer_store_dwordx4 v[160:163], v1, s[36:39], s24 offen offset:2048 sc1
    buffer_store_dwordx4 v[164:167], v1, s[36:39], s24 offen offset:3072 sc1
KQ_FIN:
    s_sub_u32 s22, s95, 14688256
    s_lshr_b32 s23, s22, 11
    s_cmp_lt_u32 s23, 4
    s_cbranch_scc1 KQ_NC
    s_and_b32 s24, s22, 12
    s_cmp_ge_u32 s24, 8
    s_cbranch_scc1 KQ_NC
    s_lshl_b32 s23, s23, 7
    s_bfe_u32 s22, s22, 0x40007
    s_lshl_b32 s22, s22, 1
    s_add_u32 s23, s23, s22
    v_mov_b32 v4, -1
    v_mov_b32 v5, -1
    v_mov_b32 v6, -1
    v_mov_b32 v7, -1
    s_cmp_eq_u32 s24, 0
    s_cbranch_scc0 KQ_CV
    v_lshrrev_b32 v1, 7, v0
    v_lshlrev_b32 v1, 12, v1
    v_and_b32 v2, 127, v0
    v_lshl_add_u32 v1, v2, 4, v1
    s_lshl_b32 s23, s23, 12
    s_add_u32 s23, s23, 2048
    buffer_store_dwordx4 v[4:7], v1, s[96:99], s23 offen sc1
    s_add_u32 s23, s23, 131072
    buffer_store_dwordx4 v[4:7], v1, s[96:99], s23 offen sc1
    s_add_u32 s23, s23, 131072
    buffer_store_dwordx4 v[4:7], v1, s[96:99], s23 offen sc1
    s_add_u32 s23, s23, 131072
    buffer_store_dwordx4 v[4:7], v1, s[96:99], s23 offen sc1
    s_add_u32 s23, s23, 131072
    s_branch KQ_NC
KQ_CV:
    v_lshlrev_b32 v1, 4, v0
    s_lshl_b32 s23, s23, 11
    s_add_u32 s23, s23, 8388608
    buffer_store_dwordx4 v[4:7], v1, s[96:99], s23 offen sc1
    s_add_u32 s23, s23, 65536
    buffer_store_dwordx4 v[4:7], v1, s[96:99], s23 offen sc1
    s_add_u32 s23, s23, 65536
    buffer_store_dwordx4 v[4:7], v1, s[96:99], s23 offen sc1
    s_add_u32 s23, s23, 65536
    buffer_store_dwordx4 v[4:7], v1, s[96:99], s23 offen sc1
    s_add_u32 s23, s23, 65536
KQ_NC:
    s_waitcnt vmcnt(0)
    s_barrier
    s_cmp_lg_u32 s19, 0
    s_cbranch_scc1 KQ_NF
    v_mov_b32 v1, 0x1010101
    s_mov_b64 exec, 1
    buffer_store_dword v1, off, s[96:99], s95 sc1
    s_mov_b64 exec, -1
KQ_NF:
    s_add_u32 s91, s91, 1
    s_cmp_lt_u32 s90, 64
    s_cbranch_scc1 KQ_END
    s_and_b32 s22, s90, 16
    s_cmp_eq_u32 s22, 0
    s_cbranch_scc1 KQ_END
    s_cmp_le_u32 s91, 9
    s_cbranch_scc1 KQ_TOP
    s_endpgm
KQ_END:
    s_cmp_lt_u32 s90, 32
    s_cbranch_scc1 MG_WO
    s_cmp_lt_u32 s90, 64
    s_cbranch_scc1 MG_DN
    s_sub_u32 s46, s90, 64
    s_lshr_b32 s46, s46, 5
    s_and_b32 s47, s90, 31
    s_cmp_ge_u32 s47, 14
    s_cbranch_scc1 MG_AT
    s_mul_i32 s29, s46, 14
    s_add_u32 s29, s29, s47
    s_mov_b32 s28, s46
    s_load_dwordx2 s[34:35], s[0:1], 104
    s_load_dwordx2 s[32:33], s[0:1], 64
    s_load_dwordx2 s[40:41], s[0:1], 72
    v_and_b32 v1, 63, v0
    v_lshlrev_b32 v2, 4, v1
    s_waitcnt lgkmcnt(0)
    s_cmp_ge_u32 s19, 2
    s_cselect_b32 s32, s40, s32
    s_cselect_b32 s33, s41, s33
    s_mov_b32 s4, s32
    s_mov_b32 s5, s33
    s_and_b32 s5, s5, 0xffff
    s_mov_b32 s6, 0x700000
    s_mov_b32 s7, 0x00020000
    s_add_u32 s8, s34, 0x3400000
    s_addc_u32 s9, s35, 0
    s_and_b32 s9, s9, 0xffff
    s_mov_b32 s10, 0x400000
    s_mov_b32 s11, 0x00020000
    s_add_u32 s12, s34, 0x3c00000
    s_addc_u32 s13, s35, 0
    s_and_b32 s13, s13, 0xffff
    s_mov_b32 s14, 0xe00000
    s_mov_b32 s15, 0x00020000
    v_lshrrev_b32 v5, 3, v1
    v_mul_u32_u24 v3, 7168, v5
    v_and_b32 v5, 7, v1
    v_lshl_add_u32 v3, v5, 4, v3
    s_lshl_b32 s22, s29, 7
    s_and_b32 s23, s19, 1
    s_mul_i32 s23, s23, 458752
    s_add_u32 s42, s22, s23
    s_lshl_b32 s43, s19, 13
    v_bfe_u32 v5, v1, 2, 2
    v_lshrrev_b32 v6, 5, v1
    v_lshl_add_u32 v5, v6, 2, v5
    v_lshlrev_b32 v4, 7, v5
    v_bfe_u32 v5, v1, 4, 1
    v_lshl_add_u32 v4, v5, 14, v4
    v_and_b32 v5, 3, v1
    v_lshl_add_u32 v4, v5, 3, v4
    s_lshl_b32 s22, s19, 5
    v_add_u32 v4, s22, v4
    s_xor_b32 s22, s19, 0
    s_lshl_b32 s22, s22, 11
    v_add_u32 v84, s22, v4
    s_xor_b32 s22, s19, 1
    s_lshl_b32 s22, s22, 11
    v_add_u32 v85, s22, v4
    s_xor_b32 s22, s19, 2
    s_lshl_b32 s22, s22, 11
    v_add_u32 v86, s22, v4
    s_xor_b32 s22, s19, 3
    s_lshl_b32 s22, s22, 11
    v_add_u32 v87, s22, v4
    s_add_u32 s22, s42, 0
    s_add_u32 m0, s43, 0
    s_nop 0
    buffer_load_dwordx4 v3, s[4:7], s22 offen lds
    s_add_u32 s22, s22, 57344
    s_add_u32 m0, m0, 1024
    s_nop 0
    buffer_load_dwordx4 v3, s[4:7], s22 offen lds
    s_add_u32 s22, s22, 57344
    s_add_u32 m0, m0, 1024
    s_nop 0
    buffer_load_dwordx4 v3, s[4:7], s22 offen lds
    s_add_u32 s22, s22, 57344
    s_add_u32 m0, m0, 1024
    s_nop 0
    buffer_load_dwordx4 v3, s[4:7], s22 offen lds
    s_add_u32 s22, s22, 57344
    s_add_u32 m0, m0, 1024
    s_nop 0
    buffer_load_dwordx4 v3, s[4:7], s22 offen lds
    s_add_u32 s22, s22, 57344
    s_add_u32 m0, m0, 1024
    s_nop 0
    buffer_load_dwordx4 v3, s[4:7], s22 offen lds
    s_add_u32 s22, s22, 57344
    s_add_u32 m0, m0, 1024
    s_nop 0
    buffer_load_dwordx4 v3, s[4:7], s22 offen lds
    s_add_u32 s22, s22, 57344
    s_add_u32 m0, m0, 1024
    s_nop 0
    buffer_load_dwordx4 v3, s[4:7], s22 offen lds
    s_add_u32 s22, s42, 917504
    s_add_u32 m0, s43, 32768
    s_nop 0
    buffer_load_dwordx4 v3, s[4:7], s22 offen lds
    s_add_u32 s22, s22, 57344
    s_add_u32 m0, m0, 1024
    s_nop 0
    buffer_load_dwordx4 v3, s[4:7], s22 offen lds
    s_add_u32 s22, s22, 57344
    s_add_u32 m0, m0, 1024
    s_nop 0
    buffer_load_dwordx4 v3, s[4:7], s22 offen lds
    s_add_u32 s22, s22, 57344
    s_add_u32 m0, m0, 1024
    s_nop 0
    buffer_load_dwordx4 v3, s[4:7], s22 offen lds
    s_add_u32 s22, s22, 57344
    s_add_u32 m0, m0, 1024
    s_nop 0
    buffer_load_dwordx4 v3, s[4:7], s22 offen lds
    s_add_u32 s22, s22, 57344
    s_add_u32 m0, m0, 1024
    s_nop 0
    buffer_load_dwordx4 v3, s[4:7], s22 offen lds
    s_add_u32 s22, s22, 57344
    s_add_u32 m0, m0, 1024
    s_nop 0
    buffer_load_dwordx4 v3, s[4:7], s22 offen lds
    s_add_u32 s22, s22, 57344
    s_add_u32 m0, m0, 1024
    s_nop 0
    buffer_load_dwordx4 v3, s[4:7], s22 offen lds
    s_add_u32 s22, s42, 1835008
    s_add_u32 m0, s43, 65536
    s_nop 0
    buffer_load_dwordx4 v3, s[4:7], s22 offen lds
    s_add_u32 s22, s22, 57344
    s_add_u32 m0, m0, 1024
    s_nop 0
    buffer_load_dwordx4 v3, s[4:7], s22 offen lds
    s_add_u32 s22, s22, 57344
    s_add_u32 m0, m0, 1024
    s_nop 0
    buffer_load_dwordx4 v3, s[4:7], s22 offen lds
    s_add_u32 s22, s22, 57344
    s_add_u32 m0, m0, 1024
    s_nop 0
    buffer_load_dwordx4 v3, s[4:7], s22 offen lds
    s_add_u32 s22, s22, 57344
    s_add_u32 m0, m0, 1024
    s_nop 0
    buffer_load_dwordx4 v3, s[4:7], s22 offen lds
    s_add_u32 s22, s22, 57344
    s_add_u32 m0, m0, 1024
    s_nop 0
    buffer_load_dwordx4 v3, s[4:7], s22 offen lds
    s_add_u32 s22, s22, 57344
    s_add_u32 m0, m0, 1024
    s_nop 0
    buffer_load_dwordx4 v3, s[4:7], s22 offen lds
    s_add_u32 s22, s22, 57344
    s_add_u32 m0, m0, 1024
    s_nop 0
    buffer_load_dwordx4 v3, s[4:7], s22 offen lds
    s_add_u32 s22, s42, 2752512
    s_add_u32 m0, s43, 98304
    s_nop 0
    buffer_load_dwordx4 v3, s[4:7], s22 offen lds
    s_add_u32 s22, s22, 57344
    s_add_u32 m0, m0, 1024
    s_nop 0
    buffer_load_dwordx4 v3, s[4:7], s22 offen lds
    s_add_u32 s22, s22, 57344
    s_add_u32 m0, m0, 1024
    s_nop 0
    buffer_load_dwordx4 v3, s[4:7], s22 offen lds
    s_add_u32 s22, s22, 57344
    s_add_u32 m0, m0, 1024
    s_nop 0
    buffer_load_dwordx4 v3, s[4:7], s22 offen lds
    s_add_u32 s22, s22, 57344
    s_add_u32 m0, m0, 1024
    s_nop 0
    buffer_load_dwordx4 v3, s[4:7], s22 offen lds
    s_add_u32 s22, s22, 57344
    s_add_u32 m0, m0, 1024
    s_nop 0
    buffer_load_dwordx4 v3, s[4:7], s22 offen lds
    s_add_u32 s22, s22, 57344
    s_add_u32 m0, m0, 1024
    s_nop 0
    buffer_load_dwordx4 v3, s[4:7], s22 offen lds
    s_add_u32 s22, s22, 57344
    s_add_u32 m0, m0, 1024
    s_nop 0
    buffer_load_dwordx4 v3, s[4:7], s22 offen lds
    s_waitcnt vmcnt(24)
    s_barrier
    v_add_u32 v88, 0, v84
    v_add_u32 v89, 0, v85
    v_add_u32 v90, 0, v86
    v_add_u32 v91, 0, v87
    ds_read_b64_tr_b16 a[0:1], v88 offset:0
    ds_read_b64_tr_b16 a[2:3], v88 offset:1024
    ds_read_b64_tr_b16 a[4:5], v89 offset:0
    ds_read_b64_tr_b16 a[6:7], v89 offset:1024
    ds_read_b64_tr_b16 a[8:9], v90 offset:0
    ds_read_b64_tr_b16 a[10:11], v90 offset:1024
    ds_read_b64_tr_b16 a[12:13], v91 offset:0
    ds_read_b64_tr_b16 a[14:15], v91 offset:1024
    s_waitcnt lgkmcnt(0)
    ds_read_b64_tr_b16 a[16:17], v88 offset:8192
    ds_read_b64_tr_b16 a[18:19], v88 offset:9216
    ds_read_b64_tr_b16 a[20:21], v89 offset:8192
    ds_read_b64_tr_b16 a[22:23], v89 offset:9216
    ds_read_b64_tr_b16 a[24:25], v90 offset:8192
    ds_read_b64_tr_b16 a[26:27], v90 offset:9216
    ds_read_b64_tr_b16 a[28:29], v91 offset:8192
    ds_read_b64_tr_b16 a[30:31], v91 offset:9216
    s_waitcnt lgkmcnt(0)
    s_barrier
    s_add_u32 s22, s42, 3670016
    s_add_u32 m0, s43, 0
    s_nop 0
    buffer_load_dwordx4 v3, s[4:7], s22 offen lds
    s_add_u32 s22, s22, 57344
    s_add_u32 m0, m0, 1024
    s_nop 0
    buffer_load_dwordx4 v3, s[4:7], s22 offen lds
    s_add_u32 s22, s22, 57344
    s_add_u32 m0, m0, 1024
    s_nop 0
    buffer_load_dwordx4 v3, s[4:7], s22 offen lds
    s_add_u32 s22, s22, 57344
    s_add_u32 m0, m0, 1024
    s_nop 0
    buffer_load_dwordx4 v3, s[4:7], s22 offen lds
    s_add_u32 s22, s22, 57344
    s_add_u32 m0, m0, 1024
    s_nop 0
    buffer_load_dwordx4 v3, s[4:7], s22 offen lds
    s_add_u32 s22, s22, 57344
    s_add_u32 m0, m0, 1024
    s_nop 0
    buffer_load_dwordx4 v3, s[4:7], s22 offen lds
    s_add_u32 s22, s22, 57344
    s_add_u32 m0, m0, 1024
    s_nop 0
    buffer_load_dwordx4 v3, s[4:7], s22 offen lds
    s_add_u32 s22, s22, 57344
    s_add_u32 m0, m0, 1024
    s_nop 0
    buffer_load_dwordx4 v3, s[4:7], s22 offen lds
    s_waitcnt vmcnt(24)
    s_barrier
    v_add_u32 v88, 32768, v84
    v_add_u32 v89, 32768, v85
    v_add_u32 v90, 32768, v86
    v_add_u32 v91, 32768, v87
    ds_read_b64_tr_b16 a[32:33], v88 offset:0
    ds_read_b64_tr_b16 a[34:35], v88 offset:1024
    ds_read_b64_tr_b16 a[36:37], v89 offset:0
    ds_read_b64_tr_b16 a[38:39], v89 offset:1024
    ds_read_b64_tr_b16 a[40:41], v90 offset:0
    ds_read_b64_tr_b16 a[42:43], v90 offset:1024
    ds_read_b64_tr_b16 a[44:45], v91 offset:0
    ds_read_b64_tr_b16 a[46:47], v91 offset:1024
    s_waitcnt lgkmcnt(0)
    ds_read_b64_tr_b16 a[48:49], v88 offset:8192
    ds_read_b64_tr_b16 a[50:51], v88 offset:9216
    ds_read_b64_tr_b16 a[52:53], v89 offset:8192
    ds_read_b64_tr_b16 a[54:55], v89 offset:9216
    ds_read_b64_tr_b16 a[56:57], v90 offset:8192
    ds_read_b64_tr_b16 a[58:59], v90 offset:9216
    ds_read_b64_tr_b16 a[60:61], v91 offset:8192
    ds_read_b64_tr_b16 a[62:63], v91 offset:9216
    s_waitcnt lgkmcnt(0)
    s_barrier
    s_add_u32 s22, s42, 4587520
    s_add_u32 m0, s43, 32768
    s_nop 0
    buffer_load_dwordx4 v3, s[4:7], s22 offen lds
    s_add_u32 s22, s22, 57344
    s_add_u32 m0, m0, 1024
    s_nop 0
    buffer_load_dwordx4 v3, s[4:7], s22 offen lds
    s_add_u32 s22, s22, 57344
    s_add_u32 m0, m0, 1024
    s_nop 0
    buffer_load_dwordx4 v3, s[4:7], s22 offen lds
    s_add_u32 s22, s22, 57344
    s_add_u32 m0, m0, 1024
    s_nop 0
    buffer_load_dwordx4 v3, s[4:7], s22 offen lds
    s_add_u32 s22, s22, 57344
    s_add_u32 m0, m0, 1024
    s_nop 0
    buffer_load_dwordx4 v3, s[4:7], s22 offen lds
    s_add_u32 s22, s22, 57344
    s_add_u32 m0, m0, 1024
    s_nop 0
    buffer_load_dwordx4 v3, s[4:7], s22 offen lds
    s_add_u32 s22, s22, 57344
    s_add_u32 m0, m0, 1024
    s_nop 0
    buffer_load_dwordx4 v3, s[4:7], s22 offen lds
    s_add_u32 s22, s22, 57344
    s_add_u32 m0, m0, 1024
    s_nop 0
    buffer_load_dwordx4 v3, s[4:7], s22 offen lds
    s_waitcnt vmcnt(24)
    s_barrier
    v_add_u32 v88, 65536, v84
    v_add_u32 v89, 65536, v85
    v_add_u32 v90, 65536, v86
    v_add_u32 v91, 65536, v87
    ds_read_b64_tr_b16 a[64:65], v88 offset:0
    ds_read_b64_tr_b16 a[66:67], v88 offset:1024
    ds_read_b64_tr_b16 a[68:69], v89 offset:0
    ds_read_b64_tr_b16 a[70:71], v89 offset:1024
    ds_read_b64_tr_b16 a[72:73], v90 offset:0
    ds_read_b64_tr_b16 a[74:75], v90 offset:1024
    ds_read_b64_tr_b16 a[76:77], v91 offset:0
    ds_read_b64_tr_b16 a[78:79], v91 offset:1024
    s_waitcnt lgkmcnt(0)
    ds_read_b64_tr_b16 a[80:81], v88 offset:8192
    ds_read_b64_tr_b16 a[82:83], v88 offset:9216
    ds_read_b64_tr_b16 a[84:85], v89 offset:8192
    ds_read_b64_tr_b16 a[86:87], v89 offset:9216
    ds_read_b64_tr_b16 a[88:89], v90 offset:8192
    ds_read_b64_tr_b16 a[90:91], v90 offset:9216
    ds_read_b64_tr_b16 a[92:93], v91 offset:8192
    ds_read_b64_tr_b16 a[94:95], v91 offset:9216
    s_waitcnt lgkmcnt(0)
    s_barrier
    s_add_u32 s22, s42, 5505024
    s_add_u32 m0, s43, 65536
    s_nop 0
    buffer_load_dwordx4 v3, s[4:7], s22 offen lds
    s_add_u32 s22, s22, 57344
    s_add_u32 m0, m0, 1024
    s_nop 0
    buffer_load_dwordx4 v3, s[4:7], s22 offen lds
    s_add_u32 s22, s22, 57344
    s_add_u32 m0, m0, 1024
    s_nop 0
    buffer_load_dwordx4 v3, s[4:7], s22 offen lds
    s_add_u32 s22, s22, 57344
    s_add_u32 m0, m0, 1024
    s_nop 0
    buffer_load_dwordx4 v3, s[4:7], s22 offen lds
    s_add_u32 s22, s22, 57344
    s_add_u32 m0, m0, 1024
    s_nop 0
    buffer_load_dwordx4 v3, s[4:7], s22 offen lds
    s_add_u32 s22, s22, 57344
    s_add_u32 m0, m0, 1024
    s_nop 0
    buffer_load_dwordx4 v3, s[4:7], s22 offen lds
    s_add_u32 s22, s22, 57344
    s_add_u32 m0, m0, 1024
    s_nop 0
    buffer_load_dwordx4 v3, s[4:7], s22 offen lds
    s_add_u32 s22, s22, 57344
    s_add_u32 m0, m0, 1024
    s_nop 0
    buffer_load_dwordx4 v3, s[4:7], s22 offen lds
    s_waitcnt vmcnt(24)
    s_barrier
    v_add_u32 v88, 98304, v84
    v_add_u32 v89, 98304, v85
    v_add_u32 v90, 98304, v86
    v_add_u32 v91, 98304, v87
    ds_read_b64_tr_b16 a[96:97], v88 offset:0
    ds_read_b64_tr_b16 a[98:99], v88 offset:1024
    ds_read_b64_tr_b16 a[100:101], v89 offset:0
    ds_read_b64_tr_b16 a[102:103], v89 offset:1024
    ds_read_b64_tr_b16 a[104:105], v90 offset:0
    ds_read_b64_tr_b16 a[106:107], v90 offset:1024
    ds_read_b64_tr_b16 a[108:109], v91 offset:0
    ds_read_b64_tr_b16 a[110:111], v91 offset:1024
    s_waitcnt lgkmcnt(0)
    ds_read_b64_tr_b16 a[112:113], v88 offset:8192
    ds_read_b64_tr_b16 a[114:115], v88 offset:9216
    ds_read_b64_tr_b16 a[116:117], v89 offset:8192
    ds_read_b64_tr_b16 a[118:119], v89 offset:9216
    ds_read_b64_tr_b16 a[120:121], v90 offset:8192
    ds_read_b64_tr_b16 a[122:123], v90 offset:9216
    ds_read_b64_tr_b16 a[124:125], v91 offset:8192
    ds_read_b64_tr_b16 a[126:127], v91 offset:9216
    s_waitcnt lgkmcnt(0)
    s_barrier
    s_add_u32 s22, s42, 6422528
    s_add_u32 m0, s43, 98304
    s_nop 0
    buffer_load_dwordx4 v3, s[4:7], s22 offen lds
    s_add_u32 s22, s22, 57344
    s_add_u32 m0, m0, 1024
    s_nop 0
    buffer_load_dwordx4 v3, s[4:7], s22 offen lds
    s_add_u32 s22, s22, 57344
    s_add_u32 m0, m0, 1024
    s_nop 0
    buffer_load_dwordx4 v3, s[4:7], s22 offen lds
    s_add_u32 s22, s22, 57344
    s_add_u32 m0, m0, 1024
    s_nop 0
    buffer_load_dwordx4 v3, s[4:7], s22 offen lds
    s_add_u32 s22, s22, 57344
    s_add_u32 m0, m0, 1024
    s_nop 0
    buffer_load_dwordx4 v3, s[4:7], s22 offen lds
    s_add_u32 s22, s22, 57344
    s_add_u32 m0, m0, 1024
    s_nop 0
    buffer_load_dwordx4 v3, s[4:7], s22 offen lds
    s_add_u32 s22, s22, 57344
    s_add_u32 m0, m0, 1024
    s_nop 0
    buffer_load_dwordx4 v3, s[4:7], s22 offen lds
    s_add_u32 s22, s22, 57344
    s_add_u32 m0, m0, 1024
    s_nop 0
    buffer_load_dwordx4 v3, s[4:7], s22 offen lds
    s_waitcnt vmcnt(24)
    s_barrier
    v_add_u32 v88, 0, v84
    v_add_u32 v89, 0, v85
    v_add_u32 v90, 0, v86
    v_add_u32 v91, 0, v87
    ds_read_b64_tr_b16 a[128:129], v88 offset:0
    ds_read_b64_tr_b16 a[130:131], v88 offset:1024
    ds_read_b64_tr_b16 a[132:133], v89 offset:0
    ds_read_b64_tr_b16 a[134:135], v89 offset:1024
    ds_read_b64_tr_b16 a[136:137], v90 offset:0
    ds_read_b64_tr_b16 a[138:139], v90 offset:1024
    ds_read_b64_tr_b16 a[140:141], v91 offset:0
    ds_read_b64_tr_b16 a[142:143], v91 offset:1024
    s_waitcnt lgkmcnt(0)
    ds_read_b64_tr_b16 a[144:145], v88 offset:8192
    ds_read_b64_tr_b16 a[146:147], v88 offset:9216
    ds_read_b64_tr_b16 a[148:149], v89 offset:8192
    ds_read_b64_tr_b16 a[150:151], v89 offset:9216
    ds_read_b64_tr_b16 a[152:153], v90 offset:8192
    ds_read_b64_tr_b16 a[154:155], v90 offset:9216
    ds_read_b64_tr_b16 a[156:157], v91 offset:8192
    ds_read_b64_tr_b16 a[158:159], v91 offset:9216
    s_waitcnt lgkmcnt(0)
    s_barrier
    s_waitcnt vmcnt(16)
    s_barrier
    v_add_u32 v88, 32768, v84
    v_add_u32 v89, 32768, v85
    v_add_u32 v90, 32768, v86
    v_add_u32 v91, 32768, v87
    ds_read_b64_tr_b16 a[160:161], v88 offset:0
    ds_read_b64_tr_b16 a[162:163], v88 offset:1024
    ds_read_b64_tr_b16 a[164:165], v89 offset:0
    ds_read_b64_tr_b16 a[166:167], v89 offset:1024
    ds_read_b64_tr_b16 a[168:169], v90 offset:0
    ds_read_b64_tr_b16 a[170:171], v90 offset:1024
    ds_read_b64_tr_b16 a[172:173], v91 offset:0
    ds_read_b64_tr_b16 a[174:175], v91 offset:1024
    s_waitcnt lgkmcnt(0)
    ds_read_b64_tr_b16 a[176:177], v88 offset:8192
    ds_read_b64_tr_b16 a[178:179], v88 offset:9216
    ds_read_b64_tr_b16 a[180:181], v89 offset:8192
    ds_read_b64_tr_b16 a[182:183], v89 offset:9216
    ds_read_b64_tr_b16 a[184:185], v90 offset:8192
    ds_read_b64_tr_b16 a[186:187], v90 offset:9216
    ds_read_b64_tr_b16 a[188:189], v91 offset:8192
    ds_read_b64_tr_b16 a[190:191], v91 offset:9216
    s_waitcnt lgkmcnt(0)
    s_barrier
    s_waitcnt vmcnt(8)
    s_barrier
    v_add_u32 v88, 65536, v84
    v_add_u32 v89, 65536, v85
    v_add_u32 v90, 65536, v86
    v_add_u32 v91, 65536, v87
    ds_read_b64_tr_b16 a[192:193], v88 offset:0
    ds_read_b64_tr_b16 a[194:195], v88 offset:1024
    ds_read_b64_tr_b16 a[196:197], v89 offset:0
    ds_read_b64_tr_b16 a[198:199], v89 offset:1024
    ds_read_b64_tr_b16 a[200:201], v90 offset:0
    ds_read_b64_tr_b16 a[202:203], v90 offset:1024
    ds_read_b64_tr_b16 a[204:205], v91 offset:0
    ds_read_b64_tr_b16 a[206:207], v91 offset:1024
    s_waitcnt lgkmcnt(0)
    ds_read_b64_tr_b16 a[208:209], v88 offset:8192
    ds_read_b64_tr_b16 a[210:211], v88 offset:9216
    ds_read_b64_tr_b16 a[212:213], v89 offset:8192
    ds_read_b64_tr_b16 a[214:215], v89 offset:9216
    ds_read_b64_tr_b16 a[216:217], v90 offset:8192
    ds_read_b64_tr_b16 a[218:219], v90 offset:9216
    ds_read_b64_tr_b16 a[220:221], v91 offset:8192
    ds_read_b64_tr_b16 a[222:223], v91 offset:9216
    s_waitcnt lgkmcnt(0)
    s_barrier
    s_waitcnt vmcnt(0)
    s_barrier
    v_add_u32 v88, 98304, v84
    v_add_u32 v89, 98304, v85
    v_add_u32 v90, 98304, v86
    v_add_u32 v91, 98304, v87
    ds_read_b64_tr_b16 a[224:225], v88 offset:0
    ds_read_b64_tr_b16 a[226:227], v88 offset:1024
    ds_read_b64_tr_b16 a[228:229], v89 offset:0
    ds_read_b64_tr_b16 a[230:231], v89 offset:1024
    ds_read_b64_tr_b16 a[232:233], v90 offset:0
    ds_read_b64_tr_b16 a[234:235], v90 offset:1024
    ds_read_b64_tr_b16 a[236:237], v91 offset:0
    ds_read_b64_tr_b16 a[238:239], v91 offset:1024
    s_waitcnt lgkmcnt(0)
    ds_read_b64_tr_b16 a[240:241], v88 offset:8192
    ds_read_b64_tr_b16 a[242:243], v88 offset:9216
    ds_read_b64_tr_b16 a[244:245], v89 offset:8192
    ds_read_b64_tr_b16 a[246:247], v89 offset:9216
    ds_read_b64_tr_b16 a[248:249], v90 offset:8192
    ds_read_b64_tr_b16 a[250:251], v90 offset:9216
    ds_read_b64_tr_b16 a[252:253], v91 offset:8192
    ds_read_b64_tr_b16 a[254:255], v91 offset:9216
    s_waitcnt lgkmcnt(0)
    s_barrier
    s_mov_b32 s44, 0
    s_lshl_b32 s22, s19, 10
    s_add_u32 s44, s44, s22
    s_lshl_b32 s45, s19, 10
    s_lshl_b32 s22, s29, 2
    s_add_u32 s22, s22, s19
    s_lshl_b32 s46, s22, 10
    v_mov_b32 v120, 0x3f803f80
    v_mov_b32 v160, 0x3f803f80
    v_mov_b32 v161, 0x3f803f80
    v_mov_b32 v162, 0x3f803f80
    v_mov_b32 v163, 0x3f803f80
    s_nop 1
    v_mfma_f32_32x32x16_bf16 v[100:115], a[0:3], v[160:163], 0
    v_mfma_f32_32x32x16_bf16 v[100:115], a[4:7], v[160:163], v[100:115]
    v_mfma_f32_32x32x16_bf16 v[100:115], a[8:11], v[160:163], v[100:115]
    v_mfma_f32_32x32x16_bf16 v[100:115], a[12:15], v[160:163], v[100:115]
    v_mfma_f32_32x32x16_bf16 v[100:115], a[16:19], v[160:163], v[100:115]
    v_mfma_f32_32x32x16_bf16 v[100:115], a[20:23], v[160:163], v[100:115]
    v_mfma_f32_32x32x16_bf16 v[100:115], a[24:27], v[160:163], v[100:115]
    v_mfma_f32_32x32x16_bf16 v[100:115], a[28:31], v[160:163], v[100:115]
    v_mfma_f32_32x32x16_bf16 v[100:115], a[32:35], v[160:163], v[100:115]
    v_mfma_f32_32x32x16_bf16 v[100:115], a[36:39], v[160:163], v[100:115]
    v_mfma_f32_32x32x16_bf16 v[100:115], a[40:43], v[160:163], v[100:115]
    v_mfma_f32_32x32x16_bf16 v[100:115], a[44:47], v[160:163], v[100:115]
    v_mfma_f32_32x32x16_bf16 v[100:115], a[48:51], v[160:163], v[100:115]
    v_mfma_f32_32x32x16_bf16 v[100:115], a[52:55], v[160:163], v[100:115]
    v_mfma_f32_32x32x16_bf16 v[100:115], a[56:59], v[160:163], v[100:115]
    v_mfma_f32_32x32x16_bf16 v[100:115], a[60:63], v[160:163], v[100:115]
    v_mfma_f32_32x32x16_bf16 v[100:115], a[64:67], v[160:163], v[100:115]
    v_mfma_f32_32x32x16_bf16 v[100:115], a[68:71], v[160:163], v[100:115]
    v_mfma_f32_32x32x16_bf16 v[100:115], a[72:75], v[160:163], v[100:115]
    v_mfma_f32_32x32x16_bf16 v[100:115], a[76:79], v[160:163], v[100:115]
    v_mfma_f32_32x32x16_bf16 v[100:115], a[80:83], v[160:163], v[100:115]
    v_mfma_f32_32x32x16_bf16 v[100:115], a[84:87], v[160:163], v[100:115]
    v_mfma_f32_32x32x16_bf16 v[100:115], a[88:91], v[160:163], v[100:115]
    v_mfma_f32_32x32x16_bf16 v[100:115], a[92:95], v[160:163], v[100:115]
    v_mfma_f32_32x32x16_bf16 v[100:115], a[96:99], v[160:163], v[100:115]
    v_mfma_f32_32x32x16_bf16 v[100:115], a[100:103], v[160:163], v[100:115]
    v_mfma_f32_32x32x16_bf16 v[100:115], a[104:107], v[160:163], v[100:115]
    v_mfma_f32_32x32x16_bf16 v[100:115], a[108:111], v[160:163], v[100:115]
    v_mfma_f32_32x32x16_bf16 v[100:115], a[112:115], v[160:163], v[100:115]
    v_mfma_f32_32x32x16_bf16 v[100:115], a[116:119], v[160:163], v[100:115]
    v_mfma_f32_32x32x16_bf16 v[100:115], a[120:123], v[160:163], v[100:115]
    v_mfma_f32_32x32x16_bf16 v[100:115], a[124:127], v[160:163], v[100:115]
    v_mfma_f32_32x32x16_bf16 v[100:115], a[128:131], v[160:163], v[100:115]
    v_mfma_f32_32x32x16_bf16 v[100:115], a[132:135], v[160:163], v[100:115]
    v_mfma_f32_32x32x16_bf16 v[100:115], a[136:139], v[160:163], v[100:115]
    v_mfma_f32_32x32x16_bf16 v[100:115], a[140:143], v[160:163], v[100:115]
    v_mfma_f32_32x32x16_bf16 v[100:115], a[144:147], v[160:163], v[100:115]
    v_mfma_f32_32x32x16_bf16 v[100:115], a[148:151], v[160:163], v[100:115]
    v_mfma_f32_32x32x16_bf16 v[100:115], a[152:155], v[160:163], v[100:115]
    v_mfma_f32_32x32x16_bf16 v[100:115], a[156:159], v[160:163], v[100:115]
    v_mfma_f32_32x32x16_bf16 v[100:115], a[160:163], v[160:163], v[100:115]
    v_mfma_f32_32x32x16_bf16 v[100:115], a[164:167], v[160:163], v[100:115]
    v_mfma_f32_32x32x16_bf16 v[100:115], a[168:171], v[160:163], v[100:115]
    v_mfma_f32_32x32x16_bf16 v[100:115], a[172:175], v[160:163], v[100:115]
    v_mfma_f32_32x32x16_bf16 v[100:115], a[176:179], v[160:163], v[100:115]
    v_mfma_f32_32x32x16_bf16 v[100:115], a[180:183], v[160:163], v[100:115]
    v_mfma_f32_32x32x16_bf16 v[100:115], a[184:187], v[160:163], v[100:115]
    v_mfma_f32_32x32x16_bf16 v[100:115], a[188:191], v[160:163], v[100:115]
    v_mfma_f32_32x32x16_bf16 v[100:115], a[192:195], v[160:163], v[100:115]
    v_mfma_f32_32x32x16_bf16 v[100:115], a[196:199], v[160:163], v[100:115]
    v_mfma_f32_32x32x16_bf16 v[100:115], a[200:203], v[160:163], v[100:115]
    v_mfma_f32_32x32x16_bf16 v[100:115], a[204:207], v[160:163], v[100:115]
    v_mfma_f32_32x32x16_bf16 v[100:115], a[208:211], v[160:163], v[100:115]
    v_mfma_f32_32x32x16_bf16 v[100:115], a[212:215], v[160:163], v[100:115]
    v_mfma_f32_32x32x16_bf16 v[100:115], a[216:219], v[160:163], v[100:115]
    v_mfma_f32_32x32x16_bf16 v[100:115], a[220:223], v[160:163], v[100:115]
    v_mfma_f32_32x32x16_bf16 v[100:115], a[224:227], v[160:163], v[100:115]
    v_mfma_f32_32x32x16_bf16 v[100:115], a[228:231], v[160:163], v[100:115]
    v_mfma_f32_32x32x16_bf16 v[100:115], a[232:235], v[160:163], v[100:115]
    v_mfma_f32_32x32x16_bf16 v[100:115], a[236:239], v[160:163], v[100:115]
    v_mfma_f32_32x32x16_bf16 v[100:115], a[240:243], v[160:163], v[100:115]
    v_mfma_f32_32x32x16_bf16 v[100:115], a[244:247], v[160:163], v[100:115]
    v_mfma_f32_32x32x16_bf16 v[100:115], a[248:251], v[160:163], v[100:115]
    v_mfma_f32_32x32x16_bf16 v[100:115], a[252:255], v[160:163], v[100:115]
    v_lshrrev_b32 v121, 2, v2
    v_and_b32 v122, 31, v1
    v_lshlrev_b32 v122, 2, v122
    v_add_u32 v122, 131072, v122
    s_lshl_b32 s22, s19, 8
    s_add_u32 s22, s22, 131072
    v_add_u32 v121, s22, v121
    v_and_b32 v8, 31, v1
    v_lshlrev_b32 v8, 4, v8
    v_add_u32 v8, 512, v8
    s_lshl_b32 s22, s29, 4
    s_lshl_b32 s23, s19, 2
    s_add_u32 s22, s22, s23
    v_mov_b32 v16, s22
    v_mov_b32 v17, 1
    v_mov_b32 v18, 163584
    s_mov_b32 s92, 0
    s_mov_b32 s94, 0
    s_xor_b32 s22, s19, 0
    s_lshl_b32 s22, s22, 10
    v_add_u32 v7, s22, v2
    s_xor_b32 s22, s19, 1
    s_lshl_b32 s22, s22, 10
    v_add_u32 v9, s22, v2
    s_xor_b32 s22, s19, 2
    s_lshl_b32 s22, s22, 10
    v_add_u32 v10, s22, v2
    s_xor_b32 s22, s19, 3
    s_lshl_b32 s22, s22, 10
    v_add_u32 v11, s22, v2
    v_lshlrev_b32 v19, 5, v1
    s_and_b32 s22, s29, 7
    s_lshl_b32 s22, s22, 13
    s_lshl_b32 s23, s19, 10
    s_add_u32 s22, s22, s23
    v_add_u32 v19, s22, v19
    v_mov_b32 v12, 0
    v_mov_b32 v13, 0
    v_mov_b32 v14, 0
    v_mov_b32 v15, 0
GU_TOP:
    s_cmp_eq_u32 s94, 1
    s_cbranch_scc1 GU_HAVE
    s_lshl_b32 s95, s92, 12
    s_add_u32 s95, s95, 14721024
GU_PL:
    v_min3_u32 v5, v12, v13, v14
    v_min_u32 v5, v5, v15
    v_cmp_eq_u32 vcc, 0, v5
    s_cbranch_vccz GU_ISS
    s_cmp_eq_u32 s93, 0
    s_cbranch_scc1 GU_ISS
    s_sub_u32 s93, s93, 1
    buffer_load_dwordx4 v[12:15], v8, s[96:99], s95 offen sc1
    s_waitcnt vmcnt(0)
    s_branch GU_PL
GU_ISS:
    s_add_u32 s23, s92, 0
    s_mul_i32 s22, s23, 65536
    s_add_u32 s22, s22, s44
    s_and_b32 s23, s23, 1
    s_lshl_b32 s23, s23, 16
    s_add_u32 m0, s23, s45
    buffer_load_dword v18, v19, s[8:11], s22 offen
    s_nop 0
    buffer_load_dwordx4 v2, s[8:11], s22 offen lds
    s_add_u32 s22, s22, 4096
    s_add_u32 m0, m0, 4096
    s_nop 0
    buffer_load_dwordx4 v2, s[8:11], s22 offen lds
    s_add_u32 s22, s22, 4096
    s_add_u32 m0, m0, 4096
    s_nop 0
    buffer_load_dwordx4 v2, s[8:11], s22 offen lds
    s_add_u32 s22, s22, 4096
    s_add_u32 m0, m0, 4096
    s_nop 0
    buffer_load_dwordx4 v2, s[8:11], s22 offen lds
    s_add_u32 s22, s22, 4096
    s_add_u32 m0, m0, 4096
    s_nop 0
    buffer_load_dwordx4 v2, s[8:11], s22 offen lds
    s_add_u32 s22, s22, 4096
    s_add_u32 m0, m0, 4096
    s_nop 0
    buffer_load_dwordx4 v2, s[8:11], s22 offen lds
    s_add_u32 s22, s22, 4096
    s_add_u32 m0, m0, 4096
    s_nop 0
    buffer_load_dwordx4 v2, s[8:11], s22 offen lds
    s_add_u32 s22, s22, 4096
    s_add_u32 m0, m0, 4096
    s_nop 0
    buffer_load_dwordx4 v2, s[8:11], s22 offen lds
    s_cmp_eq_u32 s94, 3
    s_cbranch_scc0 GU_HAVE
    s_waitcnt vmcnt(9)
    s_lshl_b32 s95, s92, 12
    s_add_u32 s95, s95, 14716928
    s_mov_b64 exec, 1
    buffer_store_dword v17, v16, s[96:99], s95 offen offset:1536 sc1
    s_mov_b64 exec, -1
GU_HAVE:
    v_mov_b32 v116, 0
    v_mov_b32 v117, 0
    v_mov_b32 v118, 0
    v_mov_b32 v119, 0
    s_cmp_eq_u32 s94, 1
    s_cbranch_scc1 GU_C1_5
    s_cmp_eq_u32 s94, 3
    s_cbranch_scc1 GU_C3_6
    s_waitcnt vmcnt(4)
    s_branch GU_CJ_4
GU_C3_6:
    s_waitcnt vmcnt(5)
    s_branch GU_CJ_4
GU_C1_5:
    s_waitcnt vmcnt(5)
GU_CJ_4:
    s_barrier
    ds_read_b128 v[160:163], v7 offset:0
    ds_read_b128 v[164:167], v9 offset:0
    ds_read_b128 v[168:171], v10 offset:0
    ds_read_b128 v[172:175], v11 offset:0
    ds_read_b128 v[176:179], v7 offset:4096
    ds_read_b128 v[180:183], v9 offset:4096
    s_waitcnt lgkmcnt(2)
    v_mfma_f32_32x32x16_bf16 v[52:67], a[0:3], v[160:163], 0
    ds_read_b128 v[184:187], v10 offset:4096
    s_add_u32 s54, s92, 0
    s_mul_i32 s53, s54, 65536
    s_add_u32 s53, s53, s44
    s_and_b32 s54, s54, 1
    s_lshl_b32 s54, s54, 16
    s_add_u32 m0, s54, s45
    s_add_u32 s53, s53, 32768
    s_add_u32 m0, m0, 32768
    s_nop 0
    buffer_load_dwordx4 v2, s[8:11], s53 offen lds
    s_add_u32 s53, s53, 4096
    s_add_u32 m0, m0, 4096
    v_lshlrev_b32 v20, 16, v160
    v_and_b32 v21, 0xffff0000, v160
    v_fmac_f32 v118, v20, v20
    v_add_f32 v116, v116, v20
    v_fmac_f32 v119, v21, v21
    v_add_f32 v117, v117, v21
    v_mfma_f32_32x32x16_bf16 v[68:83], a[4:7], v[164:167], 0
    ds_read_b128 v[188:191], v11 offset:4096
    s_nop 0
    buffer_load_dwordx4 v2, s[8:11], s53 offen lds
    s_add_u32 s53, s53, 4096
    s_add_u32 m0, m0, 4096
    v_lshlrev_b32 v22, 16, v161
    v_and_b32 v23, 0xffff0000, v161
    v_fmac_f32 v118, v22, v22
    v_add_f32 v116, v116, v22
    v_fmac_f32 v119, v23, v23
    v_add_f32 v117, v117, v23
    v_mfma_f32_32x32x16_bf16 v[52:67], a[8:11], v[168:171], v[52:67]
    ds_read_b128 v[192:195], v7 offset:8192
    s_nop 0
    buffer_load_dwordx4 v2, s[8:11], s53 offen lds
    s_add_u32 s53, s53, 4096
    s_add_u32 m0, m0, 4096
    v_lshlrev_b32 v20, 16, v162
    v_and_b32 v21, 0xffff0000, v162
    v_fmac_f32 v118, v20, v20
    v_add_f32 v116, v116, v20
    v_fmac_f32 v119, v21, v21
    v_add_f32 v117, v117, v21
    v_mfma_f32_32x32x16_bf16 v[68:83], a[12:15], v[172:175], v[68:83]
    ds_read_b128 v[196:199], v9 offset:8192
    s_nop 0
    buffer_load_dwordx4 v2, s[8:11], s53 offen lds
    s_add_u32 s53, s53, 4096
    s_add_u32 m0, m0, 4096
    v_lshlrev_b32 v22, 16, v163
    v_and_b32 v23, 0xffff0000, v163
    v_fmac_f32 v118, v22, v22
    v_add_f32 v116, v116, v22
    v_fmac_f32 v119, v23, v23
    v_add_f32 v117, v117, v23
    s_waitcnt lgkmcnt(2)
    v_mfma_f32_32x32x16_bf16 v[52:67], a[16:19], v[176:179], v[52:67]
    ds_read_b128 v[200:203], v10 offset:8192
    s_nop 0
    buffer_load_dwordx4 v2, s[8:11], s53 offen lds
    s_add_u32 s53, s53, 4096
    s_add_u32 m0, m0, 4096
    v_lshlrev_b32 v20, 16, v176
    v_and_b32 v21, 0xffff0000, v176
    v_fmac_f32 v118, v20, v20
    v_add_f32 v116, v116, v20
    v_fmac_f32 v119, v21, v21
    v_add_f32 v117, v117, v21
    v_mfma_f32_32x32x16_bf16 v[68:83], a[20:23], v[180:183], v[68:83]
    ds_read_b128 v[204:207], v11 offset:8192
    s_nop 0
    buffer_load_dwordx4 v2, s[8:11], s53 offen lds
    s_add_u32 s53, s53, 4096
    s_add_u32 m0, m0, 4096
    v_lshlrev_b32 v22, 16, v177
    v_and_b32 v23, 0xffff0000, v177
    v_fmac_f32 v118, v22, v22
    v_add_f32 v116, v116, v22
    v_fmac_f32 v119, v23, v23
    v_add_f32 v117, v117, v23
    v_mfma_f32_32x32x16_bf16 v[52:67], a[24:27], v[184:187], v[52:67]
    ds_read_b128 v[160:163], v7 offset:12288
    s_nop 0
    buffer_load_dwordx4 v2, s[8:11], s53 offen lds
    s_add_u32 s53, s53, 4096
    s_add_u32 m0, m0, 4096
    v_lshlrev_b32 v20, 16, v178
    v_and_b32 v21, 0xffff0000, v178
    v_fmac_f32 v118, v20, v20
    v_add_f32 v116, v116, v20
    v_fmac_f32 v119, v21, v21
    v_add_f32 v117, v117, v21
    v_mfma_f32_32x32x16_bf16 v[68:83], a[28:31], v[188:191], v[68:83]
    ds_read_b128 v[164:167], v9 offset:12288
    s_nop 0
    buffer_load_dwordx4 v2, s[8:11], s53 offen lds
    v_lshlrev_b32 v22, 16, v179
    v_and_b32 v23, 0xffff0000, v179
    v_fmac_f32 v118, v22, v22
    v_add_f32 v116, v116, v22
    v_fmac_f32 v119, v23, v23
    v_add_f32 v117, v117, v23
    s_waitcnt lgkmcnt(2)
    v_mfma_f32_32x32x16_bf16 v[52:67], a[32:35], v[192:195], v[52:67]
    ds_read_b128 v[168:171], v10 offset:12288
    v_lshlrev_b32 v20, 16, v192
    v_and_b32 v21, 0xffff0000, v192
    v_fmac_f32 v118, v20, v20
    v_add_f32 v116, v116, v20
    v_fmac_f32 v119, v21, v21
    v_add_f32 v117, v117, v21
    v_mfma_f32_32x32x16_bf16 v[68:83], a[36:39], v[196:199], v[68:83]
    ds_read_b128 v[172:175], v11 offset:12288
    v_lshlrev_b32 v22, 16, v193
    v_and_b32 v23, 0xffff0000, v193
    v_fmac_f32 v118, v22, v22
    v_add_f32 v116, v116, v22
    v_fmac_f32 v119, v23, v23
    v_add_f32 v117, v117, v23
    s_cmp_eq_u32 s94, 1
    s_cbranch_scc1 GU_C1_9
    s_cmp_eq_u32 s94, 3
    s_cbranch_scc1 GU_C3_10
    s_waitcnt vmcnt(8)
    s_branch GU_CJ_8
GU_C3_10:
    s_waitcnt vmcnt(9)
    s_branch GU_CJ_8
GU_C1_9:
    s_waitcnt vmcnt(8)
    s_lshl_b32 s95, s92, 12
    s_add_u32 s95, s95, 14716928
    s_mov_b64 exec, 1
    buffer_store_dword v17, v16, s[96:99], s95 offen offset:1536 sc1
    s_mov_b64 exec, -1
GU_CJ_8:
    s_lshl_b32 s95, s92, 12
    s_add_u32 s95, s95, 14725120
    buffer_load_dwordx4 v[12:15], v8, s[96:99], s95 offen sc1
    s_barrier
    v_mfma_f32_32x32x16_bf16 v[52:67], a[40:43], v[200:203], v[52:67]
    ds_read_b128 v[176:179], v7 offset:16384
    v_lshlrev_b32 v20, 16, v194
    v_and_b32 v21, 0xffff0000, v194
    v_fmac_f32 v118, v20, v20
    v_add_f32 v116, v116, v20
    v_fmac_f32 v119, v21, v21
    v_add_f32 v117, v117, v21
    v_mfma_f32_32x32x16_bf16 v[68:83], a[44:47], v[204:207], v[68:83]
    ds_read_b128 v[180:183], v9 offset:16384
    v_lshlrev_b32 v22, 16, v195
    v_and_b32 v23, 0xffff0000, v195
    v_fmac_f32 v118, v22, v22
    v_add_f32 v116, v116, v22
    v_fmac_f32 v119, v23, v23
    v_add_f32 v117, v117, v23
    s_waitcnt lgkmcnt(2)
    v_mfma_f32_32x32x16_bf16 v[52:67], a[48:51], v[160:163], v[52:67]
    ds_read_b128 v[184:187], v10 offset:16384
    v_lshlrev_b32 v20, 16, v160
    v_and_b32 v21, 0xffff0000, v160
    v_fmac_f32 v118, v20, v20
    v_add_f32 v116, v116, v20
    v_fmac_f32 v119, v21, v21
    v_add_f32 v117, v117, v21
    v_mfma_f32_32x32x16_bf16 v[68:83], a[52:55], v[164:167], v[68:83]
    ds_read_b128 v[188:191], v11 offset:16384
    v_lshlrev_b32 v22, 16, v161
    v_and_b32 v23, 0xffff0000, v161
    v_fmac_f32 v118, v22, v22
    v_add_f32 v116, v116, v22
    v_fmac_f32 v119, v23, v23
    v_add_f32 v117, v117, v23
    v_mfma_f32_32x32x16_bf16 v[52:67], a[56:59], v[168:171], v[52:67]
    ds_read_b128 v[192:195], v7 offset:20480
    v_lshlrev_b32 v20, 16, v162
    v_and_b32 v21, 0xffff0000, v162
    v_fmac_f32 v118, v20, v20
    v_add_f32 v116, v116, v20
    v_fmac_f32 v119, v21, v21
    v_add_f32 v117, v117, v21
    v_mfma_f32_32x32x16_bf16 v[68:83], a[60:63], v[172:175], v[68:83]
    ds_read_b128 v[196:199], v9 offset:20480
    v_lshlrev_b32 v22, 16, v163
    v_and_b32 v23, 0xffff0000, v163
    v_fmac_f32 v118, v22, v22
    v_add_f32 v116, v116, v22
    v_fmac_f32 v119, v23, v23
    v_add_f32 v117, v117, v23
    s_waitcnt lgkmcnt(2)
    v_mfma_f32_32x32x16_bf16 v[52:67], a[64:67], v[176:179], v[52:67]
    ds_read_b128 v[200:203], v10 offset:20480
    v_lshlrev_b32 v20, 16, v176
    v_and_b32 v21, 0xffff0000, v176
    v_fmac_f32 v118, v20, v20
    v_add_f32 v116, v116, v20
    v_fmac_f32 v119, v21, v21
    v_add_f32 v117, v117, v21
    v_mfma_f32_32x32x16_bf16 v[68:83], a[68:71], v[180:183], v[68:83]
    ds_read_b128 v[204:207], v11 offset:20480
    v_lshlrev_b32 v22, 16, v177
    v_and_b32 v23, 0xffff0000, v177
    v_fmac_f32 v118, v22, v22
    v_add_f32 v116, v116, v22
    v_fmac_f32 v119, v23, v23
    v_add_f32 v117, v117, v23
    v_mfma_f32_32x32x16_bf16 v[52:67], a[72:75], v[184:187], v[52:67]
    ds_read_b128 v[160:163], v7 offset:24576
    v_lshlrev_b32 v20, 16, v178
    v_and_b32 v21, 0xffff0000, v178
    v_fmac_f32 v118, v20, v20
    v_add_f32 v116, v116, v20
    v_fmac_f32 v119, v21, v21
    v_add_f32 v117, v117, v21
    v_mfma_f32_32x32x16_bf16 v[68:83], a[76:79], v[188:191], v[68:83]
    ds_read_b128 v[164:167], v9 offset:24576
    v_lshlrev_b32 v22, 16, v179
    v_and_b32 v23, 0xffff0000, v179
    v_fmac_f32 v118, v22, v22
    v_add_f32 v116, v116, v22
    v_fmac_f32 v119, v23, v23
    v_add_f32 v117, v117, v23
    s_waitcnt lgkmcnt(2)
    v_mfma_f32_32x32x16_bf16 v[52:67], a[80:83], v[192:195], v[52:67]
    ds_read_b128 v[168:171], v10 offset:24576
    v_lshlrev_b32 v20, 16, v192
    v_and_b32 v21, 0xffff0000, v192
    v_fmac_f32 v118, v20, v20
    v_add_f32 v116, v116, v20
    v_fmac_f32 v119, v21, v21
    v_add_f32 v117, v117, v21
    v_mfma_f32_32x32x16_bf16 v[68:83], a[84:87], v[196:199], v[68:83]
    ds_read_b128 v[172:175], v11 offset:24576
    v_lshlrev_b32 v22, 16, v193
    v_and_b32 v23, 0xffff0000, v193
    v_fmac_f32 v118, v22, v22
    v_add_f32 v116, v116, v22
    v_fmac_f32 v119, v23, v23
    v_add_f32 v117, v117, v23
    v_mfma_f32_32x32x16_bf16 v[52:67], a[88:91], v[200:203], v[52:67]
    ds_read_b128 v[176:179], v7 offset:28672
    v_lshlrev_b32 v20, 16, v194
    v_and_b32 v21, 0xffff0000, v194
    v_fmac_f32 v118, v20, v20
    v_add_f32 v116, v116, v20
    v_fmac_f32 v119, v21, v21
    v_add_f32 v117, v117, v21
    v_mfma_f32_32x32x16_bf16 v[68:83], a[92:95], v[204:207], v[68:83]
    ds_read_b128 v[180:183], v9 offset:28672
    v_lshlrev_b32 v22, 16, v195
    v_and_b32 v23, 0xffff0000, v195
    v_fmac_f32 v118, v22, v22
    v_add_f32 v116, v116, v22
    v_fmac_f32 v119, v23, v23
    v_add_f32 v117, v117, v23
    s_waitcnt lgkmcnt(2)
    v_mfma_f32_32x32x16_bf16 v[52:67], a[96:99], v[160:163], v[52:67]
    ds_read_b128 v[184:187], v10 offset:28672
    v_lshlrev_b32 v20, 16, v160
    v_and_b32 v21, 0xffff0000, v160
    v_fmac_f32 v118, v20, v20
    v_add_f32 v116, v116, v20
    v_fmac_f32 v119, v21, v21
    v_add_f32 v117, v117, v21
    v_mfma_f32_32x32x16_bf16 v[68:83], a[100:103], v[164:167], v[68:83]
    ds_read_b128 v[188:191], v11 offset:28672
    v_lshlrev_b32 v22, 16, v161
    v_and_b32 v23, 0xffff0000, v161
    v_fmac_f32 v118, v22, v22
    v_add_f32 v116, v116, v22
    v_fmac_f32 v119, v23, v23
    v_add_f32 v117, v117, v23
    s_cmp_eq_u32 s94, 1
    s_cbranch_scc1 GU_C2_13
    s_waitcnt vmcnt(5)
    s_branch GU_CJ_12
GU_C2_13:
    s_waitcnt vmcnt(6)
GU_CJ_12:
    s_barrier
    v_mfma_f32_32x32x16_bf16 v[52:67], a[104:107], v[168:171], v[52:67]
    ds_read_b128 v[192:195], v7 offset:32768
    v_lshlrev_b32 v20, 16, v162
    v_and_b32 v21, 0xffff0000, v162
    v_fmac_f32 v118, v20, v20
    v_add_f32 v116, v116, v20
    v_fmac_f32 v119, v21, v21
    v_add_f32 v117, v117, v21
    v_mfma_f32_32x32x16_bf16 v[68:83], a[108:111], v[172:175], v[68:83]
    ds_read_b128 v[196:199], v9 offset:32768
    v_lshlrev_b32 v22, 16, v163
    v_and_b32 v23, 0xffff0000, v163
    v_fmac_f32 v118, v22, v22
    v_add_f32 v116, v116, v22
    v_fmac_f32 v119, v23, v23
    v_add_f32 v117, v117, v23
    s_waitcnt lgkmcnt(2)
    v_mfma_f32_32x32x16_bf16 v[52:67], a[112:115], v[176:179], v[52:67]
    ds_read_b128 v[200:203], v10 offset:32768
    v_lshlrev_b32 v20, 16, v176
    v_and_b32 v21, 0xffff0000, v176
    v_fmac_f32 v118, v20, v20
    v_add_f32 v116, v116, v20
    v_fmac_f32 v119, v21, v21
    v_add_f32 v117, v117, v21
    v_mfma_f32_32x32x16_bf16 v[68:83], a[116:119], v[180:183], v[68:83]
    ds_read_b128 v[204:207], v11 offset:32768
    v_lshlrev_b32 v22, 16, v177
    v_and_b32 v23, 0xffff0000, v177
    v_fmac_f32 v118, v22, v22
    v_add_f32 v116, v116, v22
    v_fmac_f32 v119, v23, v23
    v_add_f32 v117, v117, v23
    v_mfma_f32_32x32x16_bf16 v[52:67], a[120:123], v[184:187], v[52:67]
    ds_read_b128 v[160:163], v7 offset:36864
    v_lshlrev_b32 v20, 16, v178
    v_and_b32 v21, 0xffff0000, v178
    v_fmac_f32 v118, v20, v20
    v_add_f32 v116, v116, v20
    v_fmac_f32 v119, v21, v21
    v_add_f32 v117, v117, v21
    v_mfma_f32_32x32x16_bf16 v[68:83], a[124:127], v[188:191], v[68:83]
    ds_read_b128 v[164:167], v9 offset:36864
    v_lshlrev_b32 v22, 16, v179
    v_and_b32 v23, 0xffff0000, v179
    v_fmac_f32 v118, v22, v22
    v_add_f32 v116, v116, v22
    v_fmac_f32 v119, v23, v23
    v_add_f32 v117, v117, v23
    s_waitcnt lgkmcnt(2)
    v_mfma_f32_32x32x16_bf16 v[52:67], a[128:131], v[192:195], v[52:67]
    ds_read_b128 v[168:171], v10 offset:36864
    v_lshlrev_b32 v20, 16, v192
    v_and_b32 v21, 0xffff0000, v192
    v_fmac_f32 v118, v20, v20
    v_add_f32 v116, v116, v20
    v_fmac_f32 v119, v21, v21
    v_add_f32 v117, v117, v21
    v_mfma_f32_32x32x16_bf16 v[68:83], a[132:135], v[196:199], v[68:83]
    ds_read_b128 v[172:175], v11 offset:36864
    v_lshlrev_b32 v22, 16, v193
    v_and_b32 v23, 0xffff0000, v193
    v_fmac_f32 v118, v22, v22
    v_add_f32 v116, v116, v22
    v_fmac_f32 v119, v23, v23
    v_add_f32 v117, v117, v23
    v_mfma_f32_32x32x16_bf16 v[52:67], a[136:139], v[200:203], v[52:67]
    ds_read_b128 v[176:179], v7 offset:40960
    v_lshlrev_b32 v20, 16, v194
    v_and_b32 v21, 0xffff0000, v194
    v_fmac_f32 v118, v20, v20
    v_add_f32 v116, v116, v20
    v_fmac_f32 v119, v21, v21
    v_add_f32 v117, v117, v21
    v_mfma_f32_32x32x16_bf16 v[68:83], a[140:143], v[204:207], v[68:83]
    ds_read_b128 v[180:183], v9 offset:40960
    v_lshlrev_b32 v22, 16, v195
    v_and_b32 v23, 0xffff0000, v195
    v_fmac_f32 v118, v22, v22
    v_add_f32 v116, v116, v22
    v_fmac_f32 v119, v23, v23
    v_add_f32 v117, v117, v23
    s_waitcnt lgkmcnt(2)
    v_mfma_f32_32x32x16_bf16 v[52:67], a[144:147], v[160:163], v[52:67]
    ds_read_b128 v[184:187], v10 offset:40960
    v_lshlrev_b32 v20, 16, v160
    v_and_b32 v21, 0xffff0000, v160
    v_fmac_f32 v118, v20, v20
    v_add_f32 v116, v116, v20
    v_fmac_f32 v119, v21, v21
    v_add_f32 v117, v117, v21
    v_mfma_f32_32x32x16_bf16 v[68:83], a[148:151], v[164:167], v[68:83]
    ds_read_b128 v[188:191], v11 offset:40960
    v_lshlrev_b32 v22, 16, v161
    v_and_b32 v23, 0xffff0000, v161
    v_fmac_f32 v118, v22, v22
    v_add_f32 v116, v116, v22
    v_fmac_f32 v119, v23, v23
    v_add_f32 v117, v117, v23
    v_mfma_f32_32x32x16_bf16 v[52:67], a[152:155], v[168:171], v[52:67]
    ds_read_b128 v[192:195], v7 offset:45056
    v_lshlrev_b32 v20, 16, v162
    v_and_b32 v21, 0xffff0000, v162
    v_fmac_f32 v118, v20, v20
    v_add_f32 v116, v116, v20
    v_fmac_f32 v119, v21, v21
    v_add_f32 v117, v117, v21
    v_mfma_f32_32x32x16_bf16 v[68:83], a[156:159], v[172:175], v[68:83]
    ds_read_b128 v[196:199], v9 offset:45056
    v_lshlrev_b32 v22, 16, v163
    v_and_b32 v23, 0xffff0000, v163
    v_fmac_f32 v118, v22, v22
    v_add_f32 v116, v116, v22
    v_fmac_f32 v119, v23, v23
    v_add_f32 v117, v117, v23
    s_waitcnt lgkmcnt(2)
    v_mfma_f32_32x32x16_bf16 v[52:67], a[160:163], v[176:179], v[52:67]
    ds_read_b128 v[200:203], v10 offset:45056
    v_lshlrev_b32 v20, 16, v176
    v_and_b32 v21, 0xffff0000, v176
    v_fmac_f32 v118, v20, v20
    v_add_f32 v116, v116, v20
    v_fmac_f32 v119, v21, v21
    v_add_f32 v117, v117, v21
    v_mfma_f32_32x32x16_bf16 v[68:83], a[164:167], v[180:183], v[68:83]
    ds_read_b128 v[204:207], v11 offset:45056
    v_lshlrev_b32 v22, 16, v177
    v_and_b32 v23, 0xffff0000, v177
    v_fmac_f32 v118, v22, v22
    v_add_f32 v116, v116, v22
    v_fmac_f32 v119, v23, v23
    v_add_f32 v117, v117, v23
    s_waitcnt vmcnt(0)
    v_min3_u32 v5, v12, v13, v14
    v_min_u32 v5, v5, v15
    v_cmp_eq_u32 vcc, 0, v5
    s_cmp_eq_u64 vcc, 0
    s_cselect_b32 s94, 1, 0
    s_cmp_ge_u32 s92, 63
    s_cselect_b32 s94, 0, s94
    s_barrier
    s_cmp_eq_u32 s94, 0
    s_cbranch_scc1 GU_LB
    v_mfma_f32_32x32x16_bf16 v[52:67], a[168:171], v[184:187], v[52:67]
    ds_read_b128 v[160:163], v7 offset:49152
    s_add_u32 s54, s92, 1
    s_mul_i32 s53, s54, 65536
    s_add_u32 s53, s53, s44
    s_and_b32 s54, s54, 1
    s_lshl_b32 s54, s54, 16
    s_add_u32 m0, s54, s45
    buffer_load_dword v18, v19, s[8:11], s53 offen
    s_nop 0
    buffer_load_dwordx4 v2, s[8:11], s53 offen lds
    s_add_u32 s53, s53, 4096
    s_add_u32 m0, m0, 4096
    v_lshlrev_b32 v20, 16, v178
    v_and_b32 v21, 0xffff0000, v178
    v_fmac_f32 v118, v20, v20
    v_add_f32 v116, v116, v20
    v_fmac_f32 v119, v21, v21
    v_add_f32 v117, v117, v21
    v_mfma_f32_32x32x16_bf16 v[68:83], a[172:175], v[188:191], v[68:83]
    ds_read_b128 v[164:167], v7 offset:53248
    s_nop 0
    buffer_load_dwordx4 v2, s[8:11], s53 offen lds
    s_add_u32 s53, s53, 4096
    s_add_u32 m0, m0, 4096
    v_lshlrev_b32 v22, 16, v179
    v_and_b32 v23, 0xffff0000, v179
    v_fmac_f32 v118, v22, v22
    v_add_f32 v116, v116, v22
    v_fmac_f32 v119, v23, v23
    v_add_f32 v117, v117, v23
    s_waitcnt lgkmcnt(2)
    v_mfma_f32_32x32x16_bf16 v[52:67], a[176:179], v[192:195], v[52:67]
    ds_read_b128 v[168:171], v7 offset:57344
    s_nop 0
    buffer_load_dwordx4 v2, s[8:11], s53 offen lds
    s_add_u32 s53, s53, 4096
    s_add_u32 m0, m0, 4096
    v_lshlrev_b32 v20, 16, v192
    v_and_b32 v21, 0xffff0000, v192
    v_fmac_f32 v118, v20, v20
    v_add_f32 v116, v116, v20
    v_fmac_f32 v119, v21, v21
    v_add_f32 v117, v117, v21
    v_mfma_f32_32x32x16_bf16 v[68:83], a[180:183], v[196:199], v[68:83]
    ds_read_b128 v[172:175], v7 offset:61440
    s_nop 0
    buffer_load_dwordx4 v2, s[8:11], s53 offen lds
    s_add_u32 s53, s53, 4096
    s_add_u32 m0, m0, 4096
    v_lshlrev_b32 v22, 16, v193
    v_and_b32 v23, 0xffff0000, v193
    v_fmac_f32 v118, v22, v22
    v_add_f32 v116, v116, v22
    v_fmac_f32 v119, v23, v23
    v_add_f32 v117, v117, v23
    v_mfma_f32_32x32x16_bf16 v[52:67], a[184:187], v[200:203], v[52:67]
    ds_read_b128 v[176:179], v9 offset:49152
    s_nop 0
    buffer_load_dwordx4 v2, s[8:11], s53 offen lds
    s_add_u32 s53, s53, 4096
    s_add_u32 m0, m0, 4096
    v_lshlrev_b32 v20, 16, v194
    v_and_b32 v21, 0xffff0000, v194
    v_fmac_f32 v118, v20, v20
    v_add_f32 v116, v116, v20
    v_fmac_f32 v119, v21, v21
    v_add_f32 v117, v117, v21
    v_mfma_f32_32x32x16_bf16 v[68:83], a[188:191], v[204:207], v[68:83]
    ds_read_b128 v[180:183], v10 offset:49152
    s_nop 0
    buffer_load_dwordx4 v2, s[8:11], s53 offen lds
    s_add_u32 s53, s53, 4096
    s_add_u32 m0, m0, 4096
    v_lshlrev_b32 v22, 16, v195
    v_and_b32 v23, 0xffff0000, v195
    v_fmac_f32 v118, v22, v22
    v_add_f32 v116, v116, v22
    v_fmac_f32 v119, v23, v23
    v_add_f32 v117, v117, v23
    s_waitcnt lgkmcnt(2)
    v_mfma_f32_32x32x16_bf16 v[52:67], a[192:195], v[160:163], v[52:67]
    ds_read_b128 v[184:187], v11 offset:49152
    s_nop 0
    buffer_load_dwordx4 v2, s[8:11], s53 offen lds
    s_add_u32 s53, s53, 4096
    s_add_u32 m0, m0, 4096
    v_lshlrev_b32 v20, 16, v160
    v_and_b32 v21, 0xffff0000, v160
    v_fmac_f32 v118, v20, v20
    v_add_f32 v116, v116, v20
    v_fmac_f32 v119, v21, v21
    v_add_f32 v117, v117, v21
    v_lshlrev_b32 v22, 16, v161
    v_and_b32 v23, 0xffff0000, v161
    v_fmac_f32 v118, v22, v22
    v_add_f32 v116, v116, v22
    v_fmac_f32 v119, v23, v23
    v_add_f32 v117, v117, v23
    v_mfma_f32_32x32x16_bf16 v[68:83], a[208:211], v[164:167], v[68:83]
    ds_read_b128 v[188:191], v9 offset:53248
    s_nop 0
    buffer_load_dwordx4 v2, s[8:11], s53 offen lds
    v_lshlrev_b32 v20, 16, v162
    v_and_b32 v21, 0xffff0000, v162
    v_fmac_f32 v118, v20, v20
    v_add_f32 v116, v116, v20
    v_fmac_f32 v119, v21, v21
    v_add_f32 v117, v117, v21
    v_lshlrev_b32 v22, 16, v163
    v_and_b32 v23, 0xffff0000, v163
    v_fmac_f32 v118, v22, v22
    v_add_f32 v116, v116, v22
    v_fmac_f32 v119, v23, v23
    v_add_f32 v117, v117, v23
    v_mfma_f32_32x32x16_bf16 v[52:67], a[224:227], v[168:171], v[52:67]
    ds_read_b128 v[192:195], v10 offset:53248
    v_lshlrev_b32 v20, 16, v164
    v_and_b32 v21, 0xffff0000, v164
    v_fmac_f32 v118, v20, v20
    v_add_f32 v116, v116, v20
    v_fmac_f32 v119, v21, v21
    v_add_f32 v117, v117, v21
    v_lshlrev_b32 v22, 16, v165
    v_and_b32 v23, 0xffff0000, v165
    v_fmac_f32 v118, v22, v22
    v_add_f32 v116, v116, v22
    v_fmac_f32 v119, v23, v23
    v_add_f32 v117, v117, v23
    v_mfma_f32_32x32x16_bf16 v[68:83], a[240:243], v[172:175], v[68:83]
    ds_read_b128 v[196:199], v11 offset:53248
    v_lshlrev_b32 v20, 16, v166
    v_and_b32 v21, 0xffff0000, v166
    v_fmac_f32 v118, v20, v20
    v_add_f32 v116, v116, v20
    v_fmac_f32 v119, v21, v21
    v_add_f32 v117, v117, v21
    v_lshlrev_b32 v22, 16, v167
    v_and_b32 v23, 0xffff0000, v167
    v_fmac_f32 v118, v22, v22
    v_add_f32 v116, v116, v22
    v_fmac_f32 v119, v23, v23
    v_add_f32 v117, v117, v23
    s_waitcnt lgkmcnt(2)
    v_mfma_f32_32x32x16_bf16 v[52:67], a[196:199], v[176:179], v[52:67]
    ds_read_b128 v[200:203], v9 offset:57344
    v_lshlrev_b32 v20, 16, v168
    v_and_b32 v21, 0xffff0000, v168
    v_fmac_f32 v118, v20, v20
    v_add_f32 v116, v116, v20
    v_fmac_f32 v119, v21, v21
    v_add_f32 v117, v117, v21
    v_lshlrev_b32 v22, 16, v169
    v_and_b32 v23, 0xffff0000, v169
    v_fmac_f32 v118, v22, v22
    v_add_f32 v116, v116, v22
    v_fmac_f32 v119, v23, v23
    v_add_f32 v117, v117, v23
    v_mfma_f32_32x32x16_bf16 v[68:83], a[200:203], v[180:183], v[68:83]
    ds_read_b128 v[204:207], v10 offset:57344
    v_lshlrev_b32 v20, 16, v170
    v_and_b32 v21, 0xffff0000, v170
    v_fmac_f32 v118, v20, v20
    v_add_f32 v116, v116, v20
    v_fmac_f32 v119, v21, v21
    v_add_f32 v117, v117, v21
    v_lshlrev_b32 v22, 16, v171
    v_and_b32 v23, 0xffff0000, v171
    v_fmac_f32 v118, v22, v22
    v_add_f32 v116, v116, v22
    v_fmac_f32 v119, v23, v23
    v_add_f32 v117, v117, v23
    v_mfma_f32_32x32x16_bf16 v[52:67], a[204:207], v[184:187], v[52:67]
    ds_read_b128 v[160:163], v11 offset:57344
    v_lshlrev_b32 v20, 16, v172
    v_and_b32 v21, 0xffff0000, v172
    v_fmac_f32 v118, v20, v20
    v_add_f32 v116, v116, v20
    v_fmac_f32 v119, v21, v21
    v_add_f32 v117, v117, v21
    v_lshlrev_b32 v22, 16, v173
    v_and_b32 v23, 0xffff0000, v173
    v_fmac_f32 v118, v22, v22
    v_add_f32 v116, v116, v22
    v_fmac_f32 v119, v23, v23
    v_add_f32 v117, v117, v23
    v_mfma_f32_32x32x16_bf16 v[68:83], a[212:215], v[188:191], v[68:83]
    ds_read_b128 v[164:167], v9 offset:61440
    v_lshlrev_b32 v20, 16, v174
    v_and_b32 v21, 0xffff0000, v174
    v_fmac_f32 v118, v20, v20
    v_add_f32 v116, v116, v20
    v_fmac_f32 v119, v21, v21
    v_add_f32 v117, v117, v21
    v_lshlrev_b32 v22, 16, v175
    v_and_b32 v23, 0xffff0000, v175
    v_fmac_f32 v118, v22, v22
    v_add_f32 v116, v116, v22
    v_fmac_f32 v119, v23, v23
    v_add_f32 v117, v117, v23
    s_waitcnt lgkmcnt(2)
    v_mfma_f32_32x32x16_bf16 v[52:67], a[216:219], v[192:195], v[52:67]
    ds_read_b128 v[168:171], v10 offset:61440
    v_add_f32 v116, v116, v117
    v_add_f32 v118, v118, v119
    s_nop 1
    v_permlane32_swap_b32 v116, v118
    s_nop 1
    v_add_f32 v116, v116, v118
    ds_write_b32 v121, v116
    v_mfma_f32_32x32x16_bf16 v[68:83], a[220:223], v[196:199], v[68:83]
    ds_read_b128 v[172:175], v11 offset:61440
    s_waitcnt lgkmcnt(1)
    s_barrier
    ds_read2_b32 v[128:129], v122 offset0:0 offset1:32
    ds_read2_b32 v[130:131], v122 offset0:64 offset1:96
    ds_read2_b32 v[132:133], v122 offset0:128 offset1:160
    ds_read2_b32 v[134:135], v122 offset0:192 offset1:224
    v_mfma_f32_32x32x16_bf16 v[52:67], a[228:231], v[200:203], v[52:67]
    v_mfma_f32_32x32x16_bf16 v[68:83], a[232:235], v[204:207], v[68:83]
    s_waitcnt lgkmcnt(4)
    v_mfma_f32_32x32x16_bf16 v[52:67], a[236:239], v[160:163], v[52:67]
    s_waitcnt lgkmcnt(0)
    v_add_f32 v128, v128, v130
    v_add_f32 v129, v129, v131
    v_add_f32 v132, v132, v134
    v_add_f32 v133, v133, v135
    v_add_f32 v128, v128, v132
    v_add_f32 v129, v129, v133
    v_mul_f32 v124, 0x3a800000, v128
    v_mul_f32 v126, 0x3a800000, v129
    v_mfma_f32_32x32x16_bf16 v[68:83], a[244:247], v[164:167], v[68:83]
    v_fma_f32 v126, -v124, v124, v126
    v_max_f32 v126, 0, v126
    v_cvt_pk_bf16_f32 v126, v126, v126
    v_and_b32 v126, 0xffff0000, v126
    v_add_f32 v126, 0x3727c5ac, v126
    v_cvt_pk_bf16_f32 v126, v126, v126
    v_and_b32 v126, 0xffff0000, v126
    v_mfma_f32_32x32x16_bf16 v[52:67], a[248:251], v[168:171], v[52:67]
    v_sqrt_f32 v126, v126
    v_cvt_pk_bf16_f32 v124, v124, v124
    v_and_b32 v124, 0xffff0000, v124
    v_cvt_pk_bf16_f32 v126, v126, v126
    v_and_b32 v126, 0xffff0000, v126
    v_rcp_f32 v126, v126
    v_mfma_f32_32x32x16_bf16 v[68:83], a[252:255], v[172:175], v[68:83]
    s_branch GU_LJ
GU_LB:
    s_lshl_b32 s95, s92, 12
    s_add_u32 s95, s95, 14725120
    buffer_load_dwordx4 v[12:15], v8, s[96:99], s95 offen sc1
    v_mfma_f32_32x32x16_bf16 v[52:67], a[168:171], v[184:187], v[52:67]
    ds_read_b128 v[160:163], v7 offset:49152
    v_lshlrev_b32 v20, 16, v178
    v_and_b32 v21, 0xffff0000, v178
    v_fmac_f32 v118, v20, v20
    v_add_f32 v116, v116, v20
    v_fmac_f32 v119, v21, v21
    v_add_f32 v117, v117, v21
    v_mfma_f32_32x32x16_bf16 v[68:83], a[172:175], v[188:191], v[68:83]
    ds_read_b128 v[164:167], v7 offset:53248
    v_lshlrev_b32 v22, 16, v179
    v_and_b32 v23, 0xffff0000, v179
    v_fmac_f32 v118, v22, v22
    v_add_f32 v116, v116, v22
    v_fmac_f32 v119, v23, v23
    v_add_f32 v117, v117, v23
    s_waitcnt lgkmcnt(2)
    v_mfma_f32_32x32x16_bf16 v[52:67], a[176:179], v[192:195], v[52:67]
    ds_read_b128 v[168:171], v7 offset:57344
    v_lshlrev_b32 v20, 16, v192
    v_and_b32 v21, 0xffff0000, v192
    v_fmac_f32 v118, v20, v20
    v_add_f32 v116, v116, v20
    v_fmac_f32 v119, v21, v21
    v_add_f32 v117, v117, v21
    v_mfma_f32_32x32x16_bf16 v[68:83], a[180:183], v[196:199], v[68:83]
    ds_read_b128 v[172:175], v7 offset:61440
    v_lshlrev_b32 v22, 16, v193
    v_and_b32 v23, 0xffff0000, v193
    v_fmac_f32 v118, v22, v22
    v_add_f32 v116, v116, v22
    v_fmac_f32 v119, v23, v23
    v_add_f32 v117, v117, v23
    v_mfma_f32_32x32x16_bf16 v[52:67], a[184:187], v[200:203], v[52:67]
    ds_read_b128 v[176:179], v9 offset:49152
    v_lshlrev_b32 v20, 16, v194
    v_and_b32 v21, 0xffff0000, v194
    v_fmac_f32 v118, v20, v20
    v_add_f32 v116, v116, v20
    v_fmac_f32 v119, v21, v21
    v_add_f32 v117, v117, v21
    v_mfma_f32_32x32x16_bf16 v[68:83], a[188:191], v[204:207], v[68:83]
    ds_read_b128 v[180:183], v10 offset:49152
    v_lshlrev_b32 v22, 16, v195
    v_and_b32 v23, 0xffff0000, v195
    v_fmac_f32 v118, v22, v22
    v_add_f32 v116, v116, v22
    v_fmac_f32 v119, v23, v23
    v_add_f32 v117, v117, v23
    s_waitcnt lgkmcnt(2)
    v_mfma_f32_32x32x16_bf16 v[52:67], a[192:195], v[160:163], v[52:67]
    ds_read_b128 v[184:187], v11 offset:49152
    v_lshlrev_b32 v20, 16, v160
    v_and_b32 v21, 0xffff0000, v160
    v_fmac_f32 v118, v20, v20
    v_add_f32 v116, v116, v20
    v_fmac_f32 v119, v21, v21
    v_add_f32 v117, v117, v21
    v_lshlrev_b32 v22, 16, v161
    v_and_b32 v23, 0xffff0000, v161
    v_fmac_f32 v118, v22, v22
    v_add_f32 v116, v116, v22
    v_fmac_f32 v119, v23, v23
    v_add_f32 v117, v117, v23
    v_mfma_f32_32x32x16_bf16 v[68:83], a[208:211], v[164:167], v[68:83]
    ds_read_b128 v[188:191], v9 offset:53248
    v_lshlrev_b32 v20, 16, v162
    v_and_b32 v21, 0xffff0000, v162
    v_fmac_f32 v118, v20, v20
    v_add_f32 v116, v116, v20
    v_fmac_f32 v119, v21, v21
    v_add_f32 v117, v117, v21
    v_lshlrev_b32 v22, 16, v163
    v_and_b32 v23, 0xffff0000, v163
    v_fmac_f32 v118, v22, v22
    v_add_f32 v116, v116, v22
    v_fmac_f32 v119, v23, v23
    v_add_f32 v117, v117, v23
    v_mfma_f32_32x32x16_bf16 v[52:67], a[224:227], v[168:171], v[52:67]
    ds_read_b128 v[192:195], v10 offset:53248
    v_lshlrev_b32 v20, 16, v164
    v_and_b32 v21, 0xffff0000, v164
    v_fmac_f32 v118, v20, v20
    v_add_f32 v116, v116, v20
    v_fmac_f32 v119, v21, v21
    v_add_f32 v117, v117, v21
    v_lshlrev_b32 v22, 16, v165
    v_and_b32 v23, 0xffff0000, v165
    v_fmac_f32 v118, v22, v22
    v_add_f32 v116, v116, v22
    v_fmac_f32 v119, v23, v23
    v_add_f32 v117, v117, v23
    v_mfma_f32_32x32x16_bf16 v[68:83], a[240:243], v[172:175], v[68:83]
    ds_read_b128 v[196:199], v11 offset:53248
    v_lshlrev_b32 v20, 16, v166
    v_and_b32 v21, 0xffff0000, v166
    v_fmac_f32 v118, v20, v20
    v_add_f32 v116, v116, v20
    v_fmac_f32 v119, v21, v21
    v_add_f32 v117, v117, v21
    v_lshlrev_b32 v22, 16, v167
    v_and_b32 v23, 0xffff0000, v167
    v_fmac_f32 v118, v22, v22
    v_add_f32 v116, v116, v22
    v_fmac_f32 v119, v23, v23
    v_add_f32 v117, v117, v23
    s_waitcnt lgkmcnt(2)
    v_mfma_f32_32x32x16_bf16 v[52:67], a[196:199], v[176:179], v[52:67]
    ds_read_b128 v[200:203], v9 offset:57344
    v_lshlrev_b32 v20, 16, v168
    v_and_b32 v21, 0xffff0000, v168
    v_fmac_f32 v118, v20, v20
    v_add_f32 v116, v116, v20
    v_fmac_f32 v119, v21, v21
    v_add_f32 v117, v117, v21
    v_lshlrev_b32 v22, 16, v169
    v_and_b32 v23, 0xffff0000, v169
    v_fmac_f32 v118, v22, v22
    v_add_f32 v116, v116, v22
    v_fmac_f32 v119, v23, v23
    v_add_f32 v117, v117, v23
    v_mfma_f32_32x32x16_bf16 v[68:83], a[200:203], v[180:183], v[68:83]
    ds_read_b128 v[204:207], v10 offset:57344
    v_lshlrev_b32 v20, 16, v170
    v_and_b32 v21, 0xffff0000, v170
    v_fmac_f32 v118, v20, v20
    v_add_f32 v116, v116, v20
    v_fmac_f32 v119, v21, v21
    v_add_f32 v117, v117, v21
    v_lshlrev_b32 v22, 16, v171
    v_and_b32 v23, 0xffff0000, v171
    v_fmac_f32 v118, v22, v22
    v_add_f32 v116, v116, v22
    v_fmac_f32 v119, v23, v23
    v_add_f32 v117, v117, v23
    v_mfma_f32_32x32x16_bf16 v[52:67], a[204:207], v[184:187], v[52:67]
    ds_read_b128 v[160:163], v11 offset:57344
    v_lshlrev_b32 v20, 16, v172
    v_and_b32 v21, 0xffff0000, v172
    v_fmac_f32 v118, v20, v20
    v_add_f32 v116, v116, v20
    v_fmac_f32 v119, v21, v21
    v_add_f32 v117, v117, v21
    v_lshlrev_b32 v22, 16, v173
    v_and_b32 v23, 0xffff0000, v173
    v_fmac_f32 v118, v22, v22
    v_add_f32 v116, v116, v22
    v_fmac_f32 v119, v23, v23
    v_add_f32 v117, v117, v23
    v_mfma_f32_32x32x16_bf16 v[68:83], a[212:215], v[188:191], v[68:83]
    ds_read_b128 v[164:167], v9 offset:61440
    v_lshlrev_b32 v20, 16, v174
    v_and_b32 v21, 0xffff0000, v174
    v_fmac_f32 v118, v20, v20
    v_add_f32 v116, v116, v20
    v_fmac_f32 v119, v21, v21
    v_add_f32 v117, v117, v21
    v_lshlrev_b32 v22, 16, v175
    v_and_b32 v23, 0xffff0000, v175
    v_fmac_f32 v118, v22, v22
    v_add_f32 v116, v116, v22
    v_fmac_f32 v119, v23, v23
    v_add_f32 v117, v117, v23
    s_waitcnt lgkmcnt(2)
    v_mfma_f32_32x32x16_bf16 v[52:67], a[216:219], v[192:195], v[52:67]
    ds_read_b128 v[168:171], v10 offset:61440
    v_add_f32 v116, v116, v117
    v_add_f32 v118, v118, v119
    s_nop 1
    v_permlane32_swap_b32 v116, v118
    s_nop 1
    v_add_f32 v116, v116, v118
    ds_write_b32 v121, v116
    v_mfma_f32_32x32x16_bf16 v[68:83], a[220:223], v[196:199], v[68:83]
    ds_read_b128 v[172:175], v11 offset:61440
    s_waitcnt lgkmcnt(1)
    s_barrier
    ds_read2_b32 v[128:129], v122 offset0:0 offset1:32
    ds_read2_b32 v[130:131], v122 offset0:64 offset1:96
    ds_read2_b32 v[132:133], v122 offset0:128 offset1:160
    ds_read2_b32 v[134:135], v122 offset0:192 offset1:224
    v_mfma_f32_32x32x16_bf16 v[52:67], a[228:231], v[200:203], v[52:67]
    v_mfma_f32_32x32x16_bf16 v[68:83], a[232:235], v[204:207], v[68:83]
    s_waitcnt lgkmcnt(4)
    v_mfma_f32_32x32x16_bf16 v[52:67], a[236:239], v[160:163], v[52:67]
    s_waitcnt lgkmcnt(0)
    v_add_f32 v128, v128, v130
    v_add_f32 v129, v129, v131
    v_add_f32 v132, v132, v134
    v_add_f32 v133, v133, v135
    v_add_f32 v128, v128, v132
    v_add_f32 v129, v129, v133
    v_mul_f32 v124, 0x3a800000, v128
    v_mul_f32 v126, 0x3a800000, v129
    v_mfma_f32_32x32x16_bf16 v[68:83], a[244:247], v[164:167], v[68:83]
    v_fma_f32 v126, -v124, v124, v126
    v_max_f32 v126, 0, v126
    v_cvt_pk_bf16_f32 v126, v126, v126
    v_and_b32 v126, 0xffff0000, v126
    v_add_f32 v126, 0x3727c5ac, v126
    v_cvt_pk_bf16_f32 v126, v126, v126
    v_and_b32 v126, 0xffff0000, v126
    v_mfma_f32_32x32x16_bf16 v[52:67], a[248:251], v[168:171], v[52:67]
    v_sqrt_f32 v126, v126
    v_cvt_pk_bf16_f32 v124, v124, v124
    v_and_b32 v124, 0xffff0000, v124
    v_cvt_pk_bf16_f32 v126, v126, v126
    v_and_b32 v126, 0xffff0000, v126
    v_rcp_f32 v126, v126
    v_mfma_f32_32x32x16_bf16 v[68:83], a[252:255], v[172:175], v[68:83]
GU_LJ:
    s_mul_i32 s24, s92, 229376
    s_add_u32 s24, s24, s46
    v_xor_b32 v7, 0x10000, v7
    v_xor_b32 v9, 0x10000, v9
    v_xor_b32 v10, 0x10000, v10
    v_xor_b32 v11, 0x10000, v11
    s_nop 7
    s_nop 4
    v_pk_add_f32 v[52:53], v[52:53], v[68:69]
    v_pk_add_f32 v[54:55], v[54:55], v[70:71]
    v_pk_add_f32 v[56:57], v[56:57], v[72:73]
    v_pk_add_f32 v[58:59], v[58:59], v[74:75]
    v_pk_add_f32 v[60:61], v[60:61], v[76:77]
    v_pk_add_f32 v[62:63], v[62:63], v[78:79]
    v_pk_add_f32 v[64:65], v[64:65], v[80:81]
    v_pk_add_f32 v[66:67], v[66:67], v[82:83]
    v_pk_fma_f32 v[52:53], v[100:101], v[124:125], v[52:53] op_sel_hi:[1,0,1] neg_lo:[0,1,0] neg_hi:[0,1,0]
    v_pk_fma_f32 v[54:55], v[102:103], v[124:125], v[54:55] op_sel_hi:[1,0,1] neg_lo:[0,1,0] neg_hi:[0,1,0]
    v_pk_fma_f32 v[56:57], v[104:105], v[124:125], v[56:57] op_sel_hi:[1,0,1] neg_lo:[0,1,0] neg_hi:[0,1,0]
    v_pk_fma_f32 v[58:59], v[106:107], v[124:125], v[58:59] op_sel_hi:[1,0,1] neg_lo:[0,1,0] neg_hi:[0,1,0]
    v_pk_fma_f32 v[60:61], v[108:109], v[124:125], v[60:61] op_sel_hi:[1,0,1] neg_lo:[0,1,0] neg_hi:[0,1,0]
    v_pk_fma_f32 v[62:63], v[110:111], v[124:125], v[62:63] op_sel_hi:[1,0,1] neg_lo:[0,1,0] neg_hi:[0,1,0]
    v_pk_fma_f32 v[64:65], v[112:113], v[124:125], v[64:65] op_sel_hi:[1,0,1] neg_lo:[0,1,0] neg_hi:[0,1,0]
    v_pk_fma_f32 v[66:67], v[114:115], v[124:125], v[66:67] op_sel_hi:[1,0,1] neg_lo:[0,1,0] neg_hi:[0,1,0]
    v_pk_mul_f32 v[52:53], v[52:53], v[126:127] op_sel_hi:[1,0]
    v_pk_mul_f32 v[54:55], v[54:55], v[126:127] op_sel_hi:[1,0]
    v_pk_mul_f32 v[56:57], v[56:57], v[126:127] op_sel_hi:[1,0]
    v_pk_mul_f32 v[58:59], v[58:59], v[126:127] op_sel_hi:[1,0]
    v_pk_mul_f32 v[60:61], v[60:61], v[126:127] op_sel_hi:[1,0]
    v_pk_mul_f32 v[62:63], v[62:63], v[126:127] op_sel_hi:[1,0]
    v_pk_mul_f32 v[64:65], v[64:65], v[126:127] op_sel_hi:[1,0]
    v_pk_mul_f32 v[66:67], v[66:67], v[126:127] op_sel_hi:[1,0]
    v_cvt_pk_bf16_f32 v84, v52, v53
    v_cvt_pk_bf16_f32 v85, v54, v55
    v_cvt_pk_bf16_f32 v86, v56, v57
    v_cvt_pk_bf16_f32 v87, v58, v59
    v_cvt_pk_bf16_f32 v88, v60, v61
    v_cvt_pk_bf16_f32 v89, v62, v63
    v_cvt_pk_bf16_f32 v90, v64, v65
    v_cvt_pk_bf16_f32 v91, v66, v67
    v_lshlrev_b32 v52, 16, v84
    v_and_b32 v53, 0xffff0000, v84
    v_lshlrev_b32 v54, 16, v85
    v_and_b32 v55, 0xffff0000, v85
    v_lshlrev_b32 v56, 16, v86
    v_and_b32 v57, 0xffff0000, v86
    v_lshlrev_b32 v58, 16, v87
    v_and_b32 v59, 0xffff0000, v87
    v_mul_f32 v52, 0xbfb8aa3b, v52
    v_mul_f32 v53, 0xbfb8aa3b, v53
    v_mul_f32 v54, 0xbfb8aa3b, v54
    v_mul_f32 v55, 0xbfb8aa3b, v55
    v_mul_f32 v56, 0xbfb8aa3b, v56
    v_mul_f32 v57, 0xbfb8aa3b, v57
    v_mul_f32 v58, 0xbfb8aa3b, v58
    v_mul_f32 v59, 0xbfb8aa3b, v59
    v_lshlrev_b32 v60, 16, v88
    v_and_b32 v61, 0xffff0000, v88
    v_lshlrev_b32 v62, 16, v89
    v_and_b32 v63, 0xffff0000, v89
    v_lshlrev_b32 v64, 16, v90
    v_and_b32 v65, 0xffff0000, v90
    v_lshlrev_b32 v66, 16, v91
    v_and_b32 v67, 0xffff0000, v91
    v_exp_f32 v52, v52
    v_exp_f32 v53, v53
    v_exp_f32 v54, v54
    v_exp_f32 v55, v55
    v_exp_f32 v56, v56
    v_exp_f32 v57, v57
    v_exp_f32 v58, v58
    v_exp_f32 v59, v59
    v_add_f32 v52, 1.0, v52
    v_add_f32 v53, 1.0, v53
    v_add_f32 v54, 1.0, v54
    v_add_f32 v55, 1.0, v55
    v_add_f32 v56, 1.0, v56
    v_add_f32 v57, 1.0, v57
    v_add_f32 v58, 1.0, v58
    v_add_f32 v59, 1.0, v59
    v_rcp_f32 v52, v52
    v_rcp_f32 v53, v53
    v_rcp_f32 v54, v54
    v_rcp_f32 v55, v55
    v_rcp_f32 v56, v56
    v_rcp_f32 v57, v57
    v_rcp_f32 v58, v58
    v_rcp_f32 v59, v59
    s_nop 0
    v_cvt_pk_bf16_f32 v84, v52, v53
    v_cvt_pk_bf16_f32 v85, v54, v55
    v_cvt_pk_bf16_f32 v86, v56, v57
    v_cvt_pk_bf16_f32 v87, v58, v59
    v_lshlrev_b32 v52, 16, v84
    v_and_b32 v53, 0xffff0000, v84
    v_lshlrev_b32 v54, 16, v85
    v_and_b32 v55, 0xffff0000, v85
    v_lshlrev_b32 v56, 16, v86
    v_and_b32 v57, 0xffff0000, v86
    v_lshlrev_b32 v58, 16, v87
    v_and_b32 v59, 0xffff0000, v87
    v_mul_f32 v52, v52, v60
    v_mul_f32 v53, v53, v61
    v_mul_f32 v54, v54, v62
    v_mul_f32 v55, v55, v63
    v_mul_f32 v56, v56, v64
    v_mul_f32 v57, v57, v65
    v_mul_f32 v58, v58, v66
    v_mul_f32 v59, v59, v67
    v_cvt_pk_bf16_f32 v84, v52, v53
    v_cvt_pk_bf16_f32 v85, v54, v55
    v_cvt_pk_bf16_f32 v86, v56, v57
    v_cvt_pk_bf16_f32 v87, v58, v59
    buffer_store_dwordx4 v[84:87], v2, s[12:15], s24 offen sc1
    s_cmp_lg_u32 s94, 0
    s_cbranch_scc1 GU_FIN
    s_waitcnt vmcnt(1)
    v_min3_u32 v5, v12, v13, v14
    v_min_u32 v5, v5, v15
    v_cmp_eq_u32 vcc, 0, v5
    s_cmp_eq_u64 vcc, 0
    s_cselect_b32 s94, 3, 0
    s_cmp_ge_u32 s92, 63
    s_cselect_b32 s94, 0, s94
    s_cmp_lg_u32 s94, 0
    s_cbranch_scc1 GU_FIN
    s_lshl_b32 s95, s92, 12
    s_add_u32 s95, s95, 14725120
    buffer_load_dwordx4 v[12:15], v8, s[96:99], s95 offen sc1
    s_waitcnt vmcnt(0)
    s_lshl_b32 s95, s92, 12
    s_add_u32 s95, s95, 14721024
    s_mov_b64 exec, 1
    buffer_store_dword v17, v16, s[96:99], s95 offen offset:1536 sc1
    s_mov_b64 exec, -1
GU_FIN:
    s_add_u32 s92, s92, 1
    s_cmp_lt_u32 s92, 64
    s_cbranch_scc1 GU_TOP
    s_endpgm
MG_WO:
    s_lshr_b32 s28, s90, 3
    s_and_b32 s29, s90, 7
    s_load_dwordx2 s[34:35], s[0:1], 104
    s_load_dwordx2 s[32:33], s[0:1], 40
    s_load_dwordx2 s[40:41], s[0:1], 0
    v_and_b32 v1, 63, v0
    v_lshlrev_b32 v2, 4, v1
    s_waitcnt lgkmcnt(0)
    s_mov_b32 s4, s32
    s_mov_b32 s5, s33
    s_and_b32 s5, s5, 0xffff
    s_mov_b32 s6, 0x800000
    s_mov_b32 s7, 0x00020000
    s_add_u32 s8, s34, 0x2400000
    s_addc_u32 s9, s35, 0
    s_and_b32 s9, s9, 0xffff
    s_mov_b32 s10, 0x1000000
    s_mov_b32 s11, 0x00020000
    s_add_u32 s12, s34, 0x7000000
    s_addc_u32 s13, s35, 0
    s_and_b32 s13, s13, 0xffff
    s_mov_b32 s14, 0x100000
    s_mov_b32 s15, 0x00020000
    s_add_u32 s36, s34, 0x3400000
    s_addc_u32 s37, s35, 0
    s_and_b32 s37, s37, 0xffff
    s_mov_b32 s38, 0x400000
    s_mov_b32 s39, 0x00020000
    v_lshrrev_b32 v5, 4, v1
    v_lshlrev_b32 v6, 2, v5
    v_and_b32 v3, 15, v1
    v_xor_b32 v3, v3, v6
    v_lshlrev_b32 v3, 4, v3
    v_lshl_add_u32 v3, v5, 11, v3
    s_mul_i32 s22, s28, 2097152
    s_lshl_b32 s23, s29, 8
    s_add_u32 s22, s22, s23
    s_lshl_b32 s23, s19, 16
    s_add_u32 s42, s22, s23
    s_lshl_b32 s43, s19, 13
    v_bfe_u32 v5, v1, 2, 2
    v_lshrrev_b32 v6, 5, v1
    v_lshl_add_u32 v6, v6, 2, v5
    v_lshlrev_b32 v4, 8, v6
    v_xor_b32 v5, s19, v5
    v_lshl_add_u32 v4, v5, 6, v4
    v_bfe_u32 v5, v1, 4, 1
    v_lshl_add_u32 v4, v5, 5, v4
    v_and_b32 v5, 3, v1
    v_lshl_add_u32 v4, v5, 3, v4
    s_add_u32 s22, s42, 0
    s_add_u32 m0, s43, 0
    s_nop 0
    buffer_load_dwordx4 v3, s[4:7], s22 offen lds
    s_add_u32 s22, s22, 8192
    s_add_u32 m0, m0, 1024
    s_nop 0
    buffer_load_dwordx4 v3, s[4:7], s22 offen lds
    s_add_u32 s22, s22, 8192
    s_add_u32 m0, m0, 1024
    s_nop 0
    buffer_load_dwordx4 v3, s[4:7], s22 offen lds
    s_add_u32 s22, s22, 8192
    s_add_u32 m0, m0, 1024
    s_nop 0
    buffer_load_dwordx4 v3, s[4:7], s22 offen lds
    s_add_u32 s22, s22, 8192
    s_add_u32 m0, m0, 1024
    s_nop 0
    buffer_load_dwordx4 v3, s[4:7], s22 offen lds
    s_add_u32 s22, s22, 8192
    s_add_u32 m0, m0, 1024
    s_nop 0
    buffer_load_dwordx4 v3, s[4:7], s22 offen lds
    s_add_u32 s22, s22, 8192
    s_add_u32 m0, m0, 1024
    s_nop 0
    buffer_load_dwordx4 v3, s[4:7], s22 offen lds
    s_add_u32 s22, s22, 8192
    s_add_u32 m0, m0, 1024
    s_nop 0
    buffer_load_dwordx4 v3, s[4:7], s22 offen lds
    s_add_u32 s22, s42, 262144
    s_add_u32 m0, s43, 32768
    s_nop 0
    buffer_load_dwordx4 v3, s[4:7], s22 offen lds
    s_add_u32 s22, s22, 8192
    s_add_u32 m0, m0, 1024
    s_nop 0
    buffer_load_dwordx4 v3, s[4:7], s22 offen lds
    s_add_u32 s22, s22, 8192
    s_add_u32 m0, m0, 1024
    s_nop 0
    buffer_load_dwordx4 v3, s[4:7], s22 offen lds
    s_add_u32 s22, s22, 8192
    s_add_u32 m0, m0, 1024
    s_nop 0
    buffer_load_dwordx4 v3, s[4:7], s22 offen lds
    s_add_u32 s22, s22, 8192
    s_add_u32 m0, m0, 1024
    s_nop 0
    buffer_load_dwordx4 v3, s[4:7], s22 offen lds
    s_add_u32 s22, s22, 8192
    s_add_u32 m0, m0, 1024
    s_nop 0
    buffer_load_dwordx4 v3, s[4:7], s22 offen lds
    s_add_u32 s22, s22, 8192
    s_add_u32 m0, m0, 1024
    s_nop 0
    buffer_load_dwordx4 v3, s[4:7], s22 offen lds
    s_add_u32 s22, s22, 8192
    s_add_u32 m0, m0, 1024
    s_nop 0
    buffer_load_dwordx4 v3, s[4:7], s22 offen lds
    s_add_u32 s22, s42, 524288
    s_add_u32 m0, s43, 65536
    s_nop 0
    buffer_load_dwordx4 v3, s[4:7], s22 offen lds
    s_add_u32 s22, s22, 8192
    s_add_u32 m0, m0, 1024
    s_nop 0
    buffer_load_dwordx4 v3, s[4:7], s22 offen lds
    s_add_u32 s22, s22, 8192
    s_add_u32 m0, m0, 1024
    s_nop 0
    buffer_load_dwordx4 v3, s[4:7], s22 offen lds
    s_add_u32 s22, s22, 8192
    s_add_u32 m0, m0, 1024
    s_nop 0
    buffer_load_dwordx4 v3, s[4:7], s22 offen lds
    s_add_u32 s22, s22, 8192
    s_add_u32 m0, m0, 1024
    s_nop 0
    buffer_load_dwordx4 v3, s[4:7], s22 offen lds
    s_add_u32 s22, s22, 8192
    s_add_u32 m0, m0, 1024
    s_nop 0
    buffer_load_dwordx4 v3, s[4:7], s22 offen lds
    s_add_u32 s22, s22, 8192
    s_add_u32 m0, m0, 1024
    s_nop 0
    buffer_load_dwordx4 v3, s[4:7], s22 offen lds
    s_add_u32 s22, s22, 8192
    s_add_u32 m0, m0, 1024
    s_nop 0
    buffer_load_dwordx4 v3, s[4:7], s22 offen lds
    s_add_u32 s22, s42, 786432
    s_add_u32 m0, s43, 98304
    s_nop 0
    buffer_load_dwordx4 v3, s[4:7], s22 offen lds
    s_add_u32 s22, s22, 8192
    s_add_u32 m0, m0, 1024
    s_nop 0
    buffer_load_dwordx4 v3, s[4:7], s22 offen lds
    s_add_u32 s22, s22, 8192
    s_add_u32 m0, m0, 1024
    s_nop 0
    buffer_load_dwordx4 v3, s[4:7], s22 offen lds
    s_add_u32 s22, s22, 8192
    s_add_u32 m0, m0, 1024
    s_nop 0
    buffer_load_dwordx4 v3, s[4:7], s22 offen lds
    s_add_u32 s22, s22, 8192
    s_add_u32 m0, m0, 1024
    s_nop 0
    buffer_load_dwordx4 v3, s[4:7], s22 offen lds
    s_add_u32 s22, s22, 8192
    s_add_u32 m0, m0, 1024
    s_nop 0
    buffer_load_dwordx4 v3, s[4:7], s22 offen lds
    s_add_u32 s22, s22, 8192
    s_add_u32 m0, m0, 1024
    s_nop 0
    buffer_load_dwordx4 v3, s[4:7], s22 offen lds
    s_add_u32 s22, s22, 8192
    s_add_u32 m0, m0, 1024
    s_nop 0
    buffer_load_dwordx4 v3, s[4:7], s22 offen lds
    s_waitcnt vmcnt(24)
    s_barrier
    v_add_u32 v5, 0, v4
    ds_read_b64_tr_b16 a[0:1], v5 offset:0
    ds_read_b64_tr_b16 a[2:3], v5 offset:2048
    ds_read_b64_tr_b16 a[4:5], v5 offset:4096
    ds_read_b64_tr_b16 a[6:7], v5 offset:6144
    ds_read_b64_tr_b16 a[8:9], v5 offset:8192
    ds_read_b64_tr_b16 a[10:11], v5 offset:10240
    ds_read_b64_tr_b16 a[12:13], v5 offset:12288
    ds_read_b64_tr_b16 a[14:15], v5 offset:14336
    s_waitcnt lgkmcnt(0)
    ds_read_b64_tr_b16 a[16:17], v5 offset:16384
    ds_read_b64_tr_b16 a[18:19], v5 offset:18432
    ds_read_b64_tr_b16 a[20:21], v5 offset:20480
    ds_read_b64_tr_b16 a[22:23], v5 offset:22528
    ds_read_b64_tr_b16 a[24:25], v5 offset:24576
    ds_read_b64_tr_b16 a[26:27], v5 offset:26624
    ds_read_b64_tr_b16 a[28:29], v5 offset:28672
    ds_read_b64_tr_b16 a[30:31], v5 offset:30720
    s_waitcnt lgkmcnt(0)
    s_barrier
    s_add_u32 s22, s42, 1048576
    s_add_u32 m0, s43, 0
    s_nop 0
    buffer_load_dwordx4 v3, s[4:7], s22 offen lds
    s_add_u32 s22, s22, 8192
    s_add_u32 m0, m0, 1024
    s_nop 0
    buffer_load_dwordx4 v3, s[4:7], s22 offen lds
    s_add_u32 s22, s22, 8192
    s_add_u32 m0, m0, 1024
    s_nop 0
    buffer_load_dwordx4 v3, s[4:7], s22 offen lds
    s_add_u32 s22, s22, 8192
    s_add_u32 m0, m0, 1024
    s_nop 0
    buffer_load_dwordx4 v3, s[4:7], s22 offen lds
    s_add_u32 s22, s22, 8192
    s_add_u32 m0, m0, 1024
    s_nop 0
    buffer_load_dwordx4 v3, s[4:7], s22 offen lds
    s_add_u32 s22, s22, 8192
    s_add_u32 m0, m0, 1024
    s_nop 0
    buffer_load_dwordx4 v3, s[4:7], s22 offen lds
    s_add_u32 s22, s22, 8192
    s_add_u32 m0, m0, 1024
    s_nop 0
    buffer_load_dwordx4 v3, s[4:7], s22 offen lds
    s_add_u32 s22, s22, 8192
    s_add_u32 m0, m0, 1024
    s_nop 0
    buffer_load_dwordx4 v3, s[4:7], s22 offen lds
    s_waitcnt vmcnt(24)
    s_barrier
    v_add_u32 v5, 32768, v4
    ds_read_b64_tr_b16 a[32:33], v5 offset:0
    ds_read_b64_tr_b16 a[34:35], v5 offset:2048
    ds_read_b64_tr_b16 a[36:37], v5 offset:4096
    ds_read_b64_tr_b16 a[38:39], v5 offset:6144
    ds_read_b64_tr_b16 a[40:41], v5 offset:8192
    ds_read_b64_tr_b16 a[42:43], v5 offset:10240
    ds_read_b64_tr_b16 a[44:45], v5 offset:12288
    ds_read_b64_tr_b16 a[46:47], v5 offset:14336
    s_waitcnt lgkmcnt(0)
    ds_read_b64_tr_b16 a[48:49], v5 offset:16384
    ds_read_b64_tr_b16 a[50:51], v5 offset:18432
    ds_read_b64_tr_b16 a[52:53], v5 offset:20480
    ds_read_b64_tr_b16 a[54:55], v5 offset:22528
    ds_read_b64_tr_b16 a[56:57], v5 offset:24576
    ds_read_b64_tr_b16 a[58:59], v5 offset:26624
    ds_read_b64_tr_b16 a[60:61], v5 offset:28672
    ds_read_b64_tr_b16 a[62:63], v5 offset:30720
    s_waitcnt lgkmcnt(0)
    s_barrier
    s_add_u32 s22, s42, 1310720
    s_add_u32 m0, s43, 32768
    s_nop 0
    buffer_load_dwordx4 v3, s[4:7], s22 offen lds
    s_add_u32 s22, s22, 8192
    s_add_u32 m0, m0, 1024
    s_nop 0
    buffer_load_dwordx4 v3, s[4:7], s22 offen lds
    s_add_u32 s22, s22, 8192
    s_add_u32 m0, m0, 1024
    s_nop 0
    buffer_load_dwordx4 v3, s[4:7], s22 offen lds
    s_add_u32 s22, s22, 8192
    s_add_u32 m0, m0, 1024
    s_nop 0
    buffer_load_dwordx4 v3, s[4:7], s22 offen lds
    s_add_u32 s22, s22, 8192
    s_add_u32 m0, m0, 1024
    s_nop 0
    buffer_load_dwordx4 v3, s[4:7], s22 offen lds
    s_add_u32 s22, s22, 8192
    s_add_u32 m0, m0, 1024
    s_nop 0
    buffer_load_dwordx4 v3, s[4:7], s22 offen lds
    s_add_u32 s22, s22, 8192
    s_add_u32 m0, m0, 1024
    s_nop 0
    buffer_load_dwordx4 v3, s[4:7], s22 offen lds
    s_add_u32 s22, s22, 8192
    s_add_u32 m0, m0, 1024
    s_nop 0
    buffer_load_dwordx4 v3, s[4:7], s22 offen lds
    s_waitcnt vmcnt(24)
    s_barrier
    v_add_u32 v5, 65536, v4
    ds_read_b64_tr_b16 a[64:65], v5 offset:0
    ds_read_b64_tr_b16 a[66:67], v5 offset:2048
    ds_read_b64_tr_b16 a[68:69], v5 offset:4096
    ds_read_b64_tr_b16 a[70:71], v5 offset:6144
    ds_read_b64_tr_b16 a[72:73], v5 offset:8192
    ds_read_b64_tr_b16 a[74:75], v5 offset:10240
    ds_read_b64_tr_b16 a[76:77], v5 offset:12288
    ds_read_b64_tr_b16 a[78:79], v5 offset:14336
    s_waitcnt lgkmcnt(0)
    ds_read_b64_tr_b16 a[80:81], v5 offset:16384
    ds_read_b64_tr_b16 a[82:83], v5 offset:18432
    ds_read_b64_tr_b16 a[84:85], v5 offset:20480
    ds_read_b64_tr_b16 a[86:87], v5 offset:22528
    ds_read_b64_tr_b16 a[88:89], v5 offset:24576
    ds_read_b64_tr_b16 a[90:91], v5 offset:26624
    ds_read_b64_tr_b16 a[92:93], v5 offset:28672
    ds_read_b64_tr_b16 a[94:95], v5 offset:30720
    s_waitcnt lgkmcnt(0)
    s_barrier
    s_add_u32 s22, s42, 1572864
    s_add_u32 m0, s43, 65536
    s_nop 0
    buffer_load_dwordx4 v3, s[4:7], s22 offen lds
    s_add_u32 s22, s22, 8192
    s_add_u32 m0, m0, 1024
    s_nop 0
    buffer_load_dwordx4 v3, s[4:7], s22 offen lds
    s_add_u32 s22, s22, 8192
    s_add_u32 m0, m0, 1024
    s_nop 0
    buffer_load_dwordx4 v3, s[4:7], s22 offen lds
    s_add_u32 s22, s22, 8192
    s_add_u32 m0, m0, 1024
    s_nop 0
    buffer_load_dwordx4 v3, s[4:7], s22 offen lds
    s_add_u32 s22, s22, 8192
    s_add_u32 m0, m0, 1024
    s_nop 0
    buffer_load_dwordx4 v3, s[4:7], s22 offen lds
    s_add_u32 s22, s22, 8192
    s_add_u32 m0, m0, 1024
    s_nop 0
    buffer_load_dwordx4 v3, s[4:7], s22 offen lds
    s_add_u32 s22, s22, 8192
    s_add_u32 m0, m0, 1024
    s_nop 0
    buffer_load_dwordx4 v3, s[4:7], s22 offen lds
    s_add_u32 s22, s22, 8192
    s_add_u32 m0, m0, 1024
    s_nop 0
    buffer_load_dwordx4 v3, s[4:7], s22 offen lds
    s_waitcnt vmcnt(24)
    s_barrier
    v_add_u32 v5, 98304, v4
    ds_read_b64_tr_b16 a[96:97], v5 offset:0
    ds_read_b64_tr_b16 a[98:99], v5 offset:2048
    ds_read_b64_tr_b16 a[100:101], v5 offset:4096
    ds_read_b64_tr_b16 a[102:103], v5 offset:6144
    ds_read_b64_tr_b16 a[104:105], v5 offset:8192
    ds_read_b64_tr_b16 a[106:107], v5 offset:10240
    ds_read_b64_tr_b16 a[108:109], v5 offset:12288
    ds_read_b64_tr_b16 a[110:111], v5 offset:14336
    s_waitcnt lgkmcnt(0)
    ds_read_b64_tr_b16 a[112:113], v5 offset:16384
    ds_read_b64_tr_b16 a[114:115], v5 offset:18432
    ds_read_b64_tr_b16 a[116:117], v5 offset:20480
    ds_read_b64_tr_b16 a[118:119], v5 offset:22528
    ds_read_b64_tr_b16 a[120:121], v5 offset:24576
    ds_read_b64_tr_b16 a[122:123], v5 offset:26624
    ds_read_b64_tr_b16 a[124:125], v5 offset:28672
    ds_read_b64_tr_b16 a[126:127], v5 offset:30720
    s_waitcnt lgkmcnt(0)
    s_barrier
    s_add_u32 s22, s42, 1835008
    s_add_u32 m0, s43, 98304
    s_nop 0
    buffer_load_dwordx4 v3, s[4:7], s22 offen lds
    s_add_u32 s22, s22, 8192
    s_add_u32 m0, m0, 1024
    s_nop 0
    buffer_load_dwordx4 v3, s[4:7], s22 offen lds
    s_add_u32 s22, s22, 8192
    s_add_u32 m0, m0, 1024
    s_nop 0
    buffer_load_dwordx4 v3, s[4:7], s22 offen lds
    s_add_u32 s22, s22, 8192
    s_add_u32 m0, m0, 1024
    s_nop 0
    buffer_load_dwordx4 v3, s[4:7], s22 offen lds
    s_add_u32 s22, s22, 8192
    s_add_u32 m0, m0, 1024
    s_nop 0
    buffer_load_dwordx4 v3, s[4:7], s22 offen lds
    s_add_u32 s22, s22, 8192
    s_add_u32 m0, m0, 1024
    s_nop 0
    buffer_load_dwordx4 v3, s[4:7], s22 offen lds
    s_add_u32 s22, s22, 8192
    s_add_u32 m0, m0, 1024
    s_nop 0
    buffer_load_dwordx4 v3, s[4:7], s22 offen lds
    s_add_u32 s22, s22, 8192
    s_add_u32 m0, m0, 1024
    s_nop 0
    buffer_load_dwordx4 v3, s[4:7], s22 offen lds
    s_waitcnt vmcnt(24)
    s_barrier
    v_add_u32 v5, 0, v4
    ds_read_b64_tr_b16 a[128:129], v5 offset:0
    ds_read_b64_tr_b16 a[130:131], v5 offset:2048
    ds_read_b64_tr_b16 a[132:133], v5 offset:4096
    ds_read_b64_tr_b16 a[134:135], v5 offset:6144
    ds_read_b64_tr_b16 a[136:137], v5 offset:8192
    ds_read_b64_tr_b16 a[138:139], v5 offset:10240
    ds_read_b64_tr_b16 a[140:141], v5 offset:12288
    ds_read_b64_tr_b16 a[142:143], v5 offset:14336
    s_waitcnt lgkmcnt(0)
    ds_read_b64_tr_b16 a[144:145], v5 offset:16384
    ds_read_b64_tr_b16 a[146:147], v5 offset:18432
    ds_read_b64_tr_b16 a[148:149], v5 offset:20480
    ds_read_b64_tr_b16 a[150:151], v5 offset:22528
    ds_read_b64_tr_b16 a[152:153], v5 offset:24576
    ds_read_b64_tr_b16 a[154:155], v5 offset:26624
    ds_read_b64_tr_b16 a[156:157], v5 offset:28672
    ds_read_b64_tr_b16 a[158:159], v5 offset:30720
    s_waitcnt lgkmcnt(0)
    s_barrier
    s_waitcnt vmcnt(16)
    s_barrier
    v_add_u32 v5, 32768, v4
    ds_read_b64_tr_b16 a[160:161], v5 offset:0
    ds_read_b64_tr_b16 a[162:163], v5 offset:2048
    ds_read_b64_tr_b16 a[164:165], v5 offset:4096
    ds_read_b64_tr_b16 a[166:167], v5 offset:6144
    ds_read_b64_tr_b16 a[168:169], v5 offset:8192
    ds_read_b64_tr_b16 a[170:171], v5 offset:10240
    ds_read_b64_tr_b16 a[172:173], v5 offset:12288
    ds_read_b64_tr_b16 a[174:175], v5 offset:14336
    s_waitcnt lgkmcnt(0)
    ds_read_b64_tr_b16 a[176:177], v5 offset:16384
    ds_read_b64_tr_b16 a[178:179], v5 offset:18432
    ds_read_b64_tr_b16 a[180:181], v5 offset:20480
    ds_read_b64_tr_b16 a[182:183], v5 offset:22528
    ds_read_b64_tr_b16 a[184:185], v5 offset:24576
    ds_read_b64_tr_b16 a[186:187], v5 offset:26624
    ds_read_b64_tr_b16 a[188:189], v5 offset:28672
    ds_read_b64_tr_b16 a[190:191], v5 offset:30720
    s_waitcnt lgkmcnt(0)
    s_barrier
    s_waitcnt vmcnt(8)
    s_barrier
    v_add_u32 v5, 65536, v4
    ds_read_b64_tr_b16 a[192:193], v5 offset:0
    ds_read_b64_tr_b16 a[194:195], v5 offset:2048
    ds_read_b64_tr_b16 a[196:197], v5 offset:4096
    ds_read_b64_tr_b16 a[198:199], v5 offset:6144
    ds_read_b64_tr_b16 a[200:201], v5 offset:8192
    ds_read_b64_tr_b16 a[202:203], v5 offset:10240
    ds_read_b64_tr_b16 a[204:205], v5 offset:12288
    ds_read_b64_tr_b16 a[206:207], v5 offset:14336
    s_waitcnt lgkmcnt(0)
    ds_read_b64_tr_b16 a[208:209], v5 offset:16384
    ds_read_b64_tr_b16 a[210:211], v5 offset:18432
    ds_read_b64_tr_b16 a[212:213], v5 offset:20480
    ds_read_b64_tr_b16 a[214:215], v5 offset:22528
    ds_read_b64_tr_b16 a[216:217], v5 offset:24576
    ds_read_b64_tr_b16 a[218:219], v5 offset:26624
    ds_read_b64_tr_b16 a[220:221], v5 offset:28672
    ds_read_b64_tr_b16 a[222:223], v5 offset:30720
    s_waitcnt lgkmcnt(0)
    s_barrier
    s_waitcnt vmcnt(0)
    s_barrier
    v_add_u32 v5, 98304, v4
    ds_read_b64_tr_b16 a[224:225], v5 offset:0
    ds_read_b64_tr_b16 a[226:227], v5 offset:2048
    ds_read_b64_tr_b16 a[228:229], v5 offset:4096
    ds_read_b64_tr_b16 a[230:231], v5 offset:6144
    ds_read_b64_tr_b16 a[232:233], v5 offset:8192
    ds_read_b64_tr_b16 a[234:235], v5 offset:10240
    ds_read_b64_tr_b16 a[236:237], v5 offset:12288
    ds_read_b64_tr_b16 a[238:239], v5 offset:14336
    s_waitcnt lgkmcnt(0)
    ds_read_b64_tr_b16 a[240:241], v5 offset:16384
    ds_read_b64_tr_b16 a[242:243], v5 offset:18432
    ds_read_b64_tr_b16 a[244:245], v5 offset:20480
    ds_read_b64_tr_b16 a[246:247], v5 offset:22528
    ds_read_b64_tr_b16 a[248:249], v5 offset:24576
    ds_read_b64_tr_b16 a[250:251], v5 offset:26624
    ds_read_b64_tr_b16 a[252:253], v5 offset:28672
    ds_read_b64_tr_b16 a[254:255], v5 offset:30720
    s_waitcnt lgkmcnt(0)
    s_barrier
    s_lshl_b32 s44, s28, 16
    s_lshl_b32 s22, s19, 10
    s_add_u32 s44, s44, s22
    s_lshl_b32 s45, s19, 10
    s_lshl_b32 s22, s29, 2
    s_add_u32 s23, s22, s19
    s_lshl_b32 s23, s23, 2
    s_add_u32 s23, s23, s28
    s_lshl_b32 s46, s23, 12
    s_add_u32 s23, s22, s28
    s_lshl_b32 s47, s23, 14
    s_lshl_b32 s24, s23, 4
    s_add_u32 s24, s24, 1024
    v_mov_b32 v138, s24
    s_add_u32 s23, s22, s19
    s_lshl_b32 s23, s23, 4
    s_lshl_b32 s24, s28, 2
    s_add_u32 s23, s23, s24
    s_add_u32 s23, s23, 1024
    v_mov_b32 v137, s23
    v_and_b32 v84, 15, v1
    s_lshr_b32 s22, s19, 1
    s_lshl_b32 s22, s22, 4
    v_add_u32 v84, s22, v84
    v_bfe_u32 v85, v1, 4, 1
    v_lshrrev_b32 v86, 5, v1
    v_lshl_add_u32 v87, v85, 5, v84
    v_lshlrev_b32 v87, 4, v87
    s_and_b32 s22, s19, 1
    s_lshl_b32 s23, s22, 11
    v_lshl_add_u32 v136, v86, 10, v87
    v_add_u32 v136, s23, v136
    s_lshl_b32 s23, s29, 3
    s_lshl_b32 s24, s28, 1
    s_add_u32 s23, s23, s24
    s_add_u32 s23, s23, s22
    s_lshl_b32 s24, s23, 10
    v_lshl_add_u32 v139, v86, 3, v87
    v_add_u32 v139, s24, v139
    s_lshl_b32 s24, s23, 5
    v_lshlrev_b32 v140, 11, v84
    v_lshl_add_u32 v140, v86, 4, v140
    v_lshl_add_u32 v140, v85, 3, v140
    v_add_u32 v140, s24, v140
    v_mov_b32 v160, -1
    v_mov_b32 v161, -1
    v_mov_b32 v162, -1
    v_mov_b32 v163, -1
    s_mov_b32 s4, s40
    s_mov_b32 s5, s41
    s_and_b32 s5, s5, 0xffff
    s_mov_b32 s6, 0x400000
    s_mov_b32 s7, 0x00020000
    v_and_b32 v8, 7, v1
    v_lshlrev_b32 v8, 2, v8
    s_lshl_b32 s22, s28, 5
    s_add_u32 s22, s22, 0
    v_add_u32 v8, s22, v8
    s_lshl_b32 s22, s28, 3
    s_add_u32 s22, s22, s29
    s_lshl_b32 s22, s22, 4
    s_lshl_b32 s23, s19, 2
    s_add_u32 s22, s22, s23
    v_mov_b32 v16, s22
    v_mov_b32 v17, 1
    v_mov_b32 v18, 163584
    s_mov_b32 s92, 0
    s_mov_b32 s94, 0
    v_mov_b32 v7, v2
    v_lshlrev_b32 v19, 5, v1
    s_and_b32 s22, s29, 7
    s_lshl_b32 s22, s22, 13
    s_lshl_b32 s23, s19, 10
    s_add_u32 s22, s22, s23
    v_add_u32 v19, s22, v19
    v_mov_b32 v12, 0
WO_TOP:
    s_cmp_eq_u32 s94, 1
    s_cbranch_scc1 WO_HAVE
    s_cmp_eq_u32 s94, 2
    s_cbranch_scc1 WO_HAVE
    s_lshl_b32 s95, s92, 12
    s_add_u32 s95, s95, 14721024
WO_PL:
    v_cmp_eq_u32 vcc, 0, v12
    s_cbranch_vccz WO_ISS
    s_cmp_eq_u32 s93, 0
    s_cbranch_scc1 WO_ISS
    s_sub_u32 s93, s93, 1
    buffer_load_dword v12, v8, s[96:99], s95 offen sc1
    s_waitcnt vmcnt(0)
    s_branch WO_PL
WO_ISS:
    s_add_u32 s23, s92, 0
    s_mul_i32 s22, s23, 262144
    s_add_u32 s22, s22, s44
    s_and_b32 s23, s23, 1
    s_lshl_b32 s23, s23, 16
    s_add_u32 m0, s23, s45
    buffer_load_dword v18, v19, s[8:11], s22 offen
    s_nop 0
    buffer_load_dwordx4 v2, s[8:11], s22 offen lds
    s_add_u32 s22, s22, 4096
    s_add_u32 m0, m0, 4096
    s_nop 0
    buffer_load_dwordx4 v2, s[8:11], s22 offen lds
    s_add_u32 s22, s22, 4096
    s_add_u32 m0, m0, 4096
    s_nop 0
    buffer_load_dwordx4 v2, s[8:11], s22 offen lds
    s_add_u32 s22, s22, 4096
    s_add_u32 m0, m0, 4096
    s_nop 0
    buffer_load_dwordx4 v2, s[8:11], s22 offen lds
    s_add_u32 s22, s22, 4096
    s_add_u32 m0, m0, 4096
    s_nop 0
    buffer_load_dwordx4 v2, s[8:11], s22 offen lds
    s_add_u32 s22, s22, 4096
    s_add_u32 m0, m0, 4096
    s_nop 0
    buffer_load_dwordx4 v2, s[8:11], s22 offen lds
    s_add_u32 s22, s22, 4096
    s_add_u32 m0, m0, 4096
    s_nop 0
    buffer_load_dwordx4 v2, s[8:11], s22 offen lds
    s_add_u32 s22, s22, 4096
    s_add_u32 m0, m0, 4096
    s_nop 0
    buffer_load_dwordx4 v2, s[8:11], s22 offen lds
    s_cmp_eq_u32 s94, 3
    s_cbranch_scc0 WO_HAVE
    s_waitcnt vmcnt(13)
    s_lshl_b32 s95, s92, 12
    s_add_u32 s95, s95, 14716928
    s_mov_b64 exec, 1
    buffer_store_dword v17, v16, s[96:99], s95 offen offset:512 sc1
    s_mov_b64 exec, -1
WO_HAVE:
    s_cmp_eq_u32 s94, 1
    s_cbranch_scc1 WO_C1_16
    s_cmp_eq_u32 s94, 3
    s_cbranch_scc1 WO_C3_17
    s_waitcnt vmcnt(4)
    s_branch WO_CJ_15
WO_C3_17:
    s_waitcnt vmcnt(5)
    s_branch WO_CJ_15
WO_C1_16:
    s_waitcnt vmcnt(8)
WO_CJ_15:
    s_barrier
    ds_read_b128 v[20:23], v7 offset:0
    ds_read_b128 v[24:27], v7 offset:1024
    ds_read_b128 v[28:31], v7 offset:2048
    ds_read_b128 v[32:35], v7 offset:3072
    ds_read_b128 v[36:39], v7 offset:4096
    ds_read_b128 v[40:43], v7 offset:5120
    s_waitcnt lgkmcnt(5)
    v_mfma_f32_32x32x16_bf16 v[52:67], a[0:3], v[20:23], 0
    s_add_u32 s54, s92, 0
    s_mul_i32 s53, s54, 262144
    s_add_u32 s53, s53, s44
    s_and_b32 s54, s54, 1
    s_lshl_b32 s54, s54, 16
    s_add_u32 m0, s54, s45
    s_add_u32 s53, s53, 32768
    s_add_u32 m0, m0, 32768
    s_nop 0
    buffer_load_dwordx4 v2, s[8:11], s53 offen lds
    s_add_u32 s53, s53, 4096
    s_add_u32 m0, m0, 4096
    ds_read_b128 v[44:47], v7 offset:6144
    s_waitcnt lgkmcnt(5)
    v_mfma_f32_32x32x16_bf16 v[68:83], a[4:7], v[24:27], 0
    s_nop 0
    buffer_load_dwordx4 v2, s[8:11], s53 offen lds
    s_add_u32 s53, s53, 4096
    s_add_u32 m0, m0, 4096
    ds_read_b128 v[48:51], v7 offset:7168
    s_waitcnt lgkmcnt(5)
    v_mfma_f32_32x32x16_bf16 v[52:67], a[8:11], v[28:31], v[52:67]
    s_nop 0
    buffer_load_dwordx4 v2, s[8:11], s53 offen lds
    s_add_u32 s53, s53, 4096
    s_add_u32 m0, m0, 4096
    ds_read_b128 v[20:23], v7 offset:8192
    s_waitcnt lgkmcnt(5)
    v_mfma_f32_32x32x16_bf16 v[68:83], a[12:15], v[32:35], v[68:83]
    s_nop 0
    buffer_load_dwordx4 v2, s[8:11], s53 offen lds
    s_add_u32 s53, s53, 4096
    s_add_u32 m0, m0, 4096
    ds_read_b128 v[24:27], v7 offset:9216
    s_waitcnt lgkmcnt(5)
    v_mfma_f32_32x32x16_bf16 v[52:67], a[16:19], v[36:39], v[52:67]
    s_nop 0
    buffer_load_dwordx4 v2, s[8:11], s53 offen lds
    s_add_u32 s53, s53, 4096
    s_add_u32 m0, m0, 4096
    ds_read_b128 v[28:31], v7 offset:10240
    s_waitcnt lgkmcnt(5)
    v_mfma_f32_32x32x16_bf16 v[68:83], a[20:23], v[40:43], v[68:83]
    s_nop 0
    buffer_load_dwordx4 v2, s[8:11], s53 offen lds
    s_add_u32 s53, s53, 4096
    s_add_u32 m0, m0, 4096
    ds_read_b128 v[32:35], v7 offset:11264
    s_waitcnt lgkmcnt(5)
    v_mfma_f32_32x32x16_bf16 v[52:67], a[24:27], v[44:47], v[52:67]
    s_nop 0
    buffer_load_dwordx4 v2, s[8:11], s53 offen lds
    s_add_u32 s53, s53, 4096
    s_add_u32 m0, m0, 4096
    ds_read_b128 v[36:39], v7 offset:12288
    s_waitcnt lgkmcnt(5)
    v_mfma_f32_32x32x16_bf16 v[68:83], a[28:31], v[48:51], v[68:83]
    s_nop 0
    buffer_load_dwordx4 v2, s[8:11], s53 offen lds
    ds_read_b128 v[40:43], v7 offset:13312
    s_waitcnt lgkmcnt(5)
    v_mfma_f32_32x32x16_bf16 v[52:67], a[32:35], v[20:23], v[52:67]
    ds_read_b128 v[44:47], v7 offset:14336
    s_waitcnt lgkmcnt(5)
    v_mfma_f32_32x32x16_bf16 v[68:83], a[36:39], v[24:27], v[68:83]
    ds_read_b128 v[48:51], v7 offset:15360
    s_cmp_eq_u32 s94, 1
    s_cbranch_scc1 WO_C1_20
    s_cmp_eq_u32 s94, 3
    s_cbranch_scc1 WO_C3_21
    s_waitcnt vmcnt(8)
    s_cmp_eq_u32 s94, 2
    s_cbranch_scc0 WO_CJ_19
    buffer_load_dwordx4 v[144:147], v136, s[12:15], s49 offen sc1
    buffer_load_dwordx4 v[148:151], v136, s[12:15], s50 offen sc1
    buffer_load_dwordx4 v[152:155], v136, s[12:15], s51 offen sc1
    buffer_load_dwordx4 v[156:159], v136, s[12:15], s52 offen sc1
    s_branch WO_CJ_19
WO_C3_21:
    s_waitcnt vmcnt(9)
    s_branch WO_CJ_19
WO_C1_20:
    s_waitcnt vmcnt(12)
    buffer_load_dwordx4 v[144:147], v136, s[12:15], s49 offen sc1
    buffer_load_dwordx4 v[148:151], v136, s[12:15], s50 offen sc1
    buffer_load_dwordx4 v[152:155], v136, s[12:15], s51 offen sc1
    buffer_load_dwordx4 v[156:159], v136, s[12:15], s52 offen sc1
WO_CJ_19:
    s_lshl_b32 s95, s92, 12
    s_add_u32 s95, s95, 14725120
    buffer_load_dword v12, v8, s[96:99], s95 offen sc1
    s_barrier
    s_waitcnt lgkmcnt(5)
    v_mfma_f32_32x32x16_bf16 v[52:67], a[40:43], v[28:31], v[52:67]
    ds_read_b128 v[20:23], v7 offset:16384
    s_waitcnt lgkmcnt(5)
    v_mfma_f32_32x32x16_bf16 v[68:83], a[44:47], v[32:35], v[68:83]
    ds_read_b128 v[24:27], v7 offset:17408
    s_waitcnt lgkmcnt(5)
    v_mfma_f32_32x32x16_bf16 v[52:67], a[48:51], v[36:39], v[52:67]
    ds_read_b128 v[28:31], v7 offset:18432
    s_waitcnt lgkmcnt(5)
    v_mfma_f32_32x32x16_bf16 v[68:83], a[52:55], v[40:43], v[68:83]
    ds_read_b128 v[32:35], v7 offset:19456
    s_waitcnt lgkmcnt(5)
    v_mfma_f32_32x32x16_bf16 v[52:67], a[56:59], v[44:47], v[52:67]
    ds_read_b128 v[36:39], v7 offset:20480
    s_waitcnt lgkmcnt(5)
    v_mfma_f32_32x32x16_bf16 v[68:83], a[60:63], v[48:51], v[68:83]
    ds_read_b128 v[40:43], v7 offset:21504
    s_waitcnt lgkmcnt(5)
    v_mfma_f32_32x32x16_bf16 v[52:67], a[64:67], v[20:23], v[52:67]
    ds_read_b128 v[44:47], v7 offset:22528
    s_waitcnt lgkmcnt(5)
    v_mfma_f32_32x32x16_bf16 v[68:83], a[68:71], v[24:27], v[68:83]
    ds_read_b128 v[48:51], v7 offset:23552
    s_waitcnt lgkmcnt(5)
    v_mfma_f32_32x32x16_bf16 v[52:67], a[72:75], v[28:31], v[52:67]
    ds_read_b128 v[20:23], v7 offset:24576
    s_waitcnt lgkmcnt(5)
    v_mfma_f32_32x32x16_bf16 v[68:83], a[76:79], v[32:35], v[68:83]
    ds_read_b128 v[24:27], v7 offset:25600
    s_waitcnt lgkmcnt(5)
    v_mfma_f32_32x32x16_bf16 v[52:67], a[80:83], v[36:39], v[52:67]
    ds_read_b128 v[28:31], v7 offset:26624
    s_waitcnt lgkmcnt(5)
    v_mfma_f32_32x32x16_bf16 v[68:83], a[84:87], v[40:43], v[68:83]
    ds_read_b128 v[32:35], v7 offset:27648
    s_waitcnt lgkmcnt(5)
    v_mfma_f32_32x32x16_bf16 v[52:67], a[88:91], v[44:47], v[52:67]
    ds_read_b128 v[36:39], v7 offset:28672
    s_waitcnt lgkmcnt(5)
    v_mfma_f32_32x32x16_bf16 v[68:83], a[92:95], v[48:51], v[68:83]
    ds_read_b128 v[40:43], v7 offset:29696
    s_waitcnt lgkmcnt(5)
    v_mfma_f32_32x32x16_bf16 v[52:67], a[96:99], v[20:23], v[52:67]
    ds_read_b128 v[44:47], v7 offset:30720
    s_waitcnt lgkmcnt(5)
    v_mfma_f32_32x32x16_bf16 v[68:83], a[100:103], v[24:27], v[68:83]
    ds_read_b128 v[48:51], v7 offset:31744
    s_sub_u32 s22, s94, 1
    s_cmp_lt_u32 s22, 2
    s_cbranch_scc1 WO_C2_24
    s_waitcnt vmcnt(5)
    s_branch WO_CJ_23
WO_C2_24:
WO_X_25:
    s_waitcnt vmcnt(0)
    v_max3_u32 v5, v144, v145, v146
    v_max3_u32 v5, v5, v147, v148
    v_max3_u32 v5, v5, v149, v150
    v_max3_u32 v5, v5, v151, v152
    v_max3_u32 v5, v5, v153, v154
    v_max3_u32 v5, v5, v155, v156
    v_max3_u32 v5, v5, v157, v158
    v_max_u32 v5, v5, v159
    v_cmp_eq_u32 vcc, -1, v5
    s_cbranch_vccz WO_X_25_D
    s_cmp_eq_u32 s93, 0
    s_cbranch_scc1 WO_X_25_D
    s_sub_u32 s93, s93, 1
    buffer_load_dwordx4 v[144:147], v136, s[12:15], s49 offen sc1
    buffer_load_dwordx4 v[148:151], v136, s[12:15], s50 offen sc1
    buffer_load_dwordx4 v[152:155], v136, s[12:15], s51 offen sc1
    buffer_load_dwordx4 v[156:159], v136, s[12:15], s52 offen sc1
    s_branch WO_X_25
WO_X_25_D:
    v_pk_add_f32 v[144:145], v[144:145], v[148:149]
    v_pk_add_f32 v[146:147], v[146:147], v[150:151]
    v_pk_add_f32 v[152:153], v[152:153], v[156:157]
    v_pk_add_f32 v[154:155], v[154:155], v[158:159]
    v_pk_add_f32 v[144:145], v[144:145], v[152:153]
    v_pk_add_f32 v[146:147], v[146:147], v[154:155]
    v_lshlrev_b32 v152, 16, v142
    v_and_b32 v153, 0xffff0000, v142
    v_cvt_pk_bf16_f32 v144, v144, v145
    v_cvt_pk_bf16_f32 v146, v146, v147
    v_lshlrev_b32 v154, 16, v143
    v_and_b32 v155, 0xffff0000, v143
    v_lshlrev_b32 v148, 16, v144
    v_and_b32 v149, 0xffff0000, v144
    v_lshlrev_b32 v150, 16, v146
    v_and_b32 v151, 0xffff0000, v146
    v_pk_add_f32 v[148:149], v[148:149], v[152:153]
    v_pk_add_f32 v[150:151], v[150:151], v[154:155]
    s_lshl_b32 s24, s92, 16
    s_sub_u32 s24, s24, 65536
    v_cvt_pk_bf16_f32 v144, v148, v149
    v_cvt_pk_bf16_f32 v145, v150, v151
    buffer_store_dwordx2 v[144:145], v139, s[36:39], s24 offen sc1
    s_cmp_eq_u32 s87, 1
    s_cbranch_scc0 MS_26
    buffer_store_dwordx4 v[160:163], v136, s[12:15], s49 offen
    buffer_store_dwordx4 v[160:163], v136, s[12:15], s50 offen
    buffer_store_dwordx4 v[160:163], v136, s[12:15], s51 offen
    buffer_store_dwordx4 v[160:163], v136, s[12:15], s52 offen
    s_branch MS_27
MS_26:
    buffer_store_dwordx4 v[160:163], v136, s[12:15], s49 offen sc1
    buffer_store_dwordx4 v[160:163], v136, s[12:15], s50 offen sc1
    buffer_store_dwordx4 v[160:163], v136, s[12:15], s51 offen sc1
    buffer_store_dwordx4 v[160:163], v136, s[12:15], s52 offen sc1
MS_27:
WO_CJ_23:
    s_barrier
    s_waitcnt lgkmcnt(5)
    v_mfma_f32_32x32x16_bf16 v[52:67], a[104:107], v[28:31], v[52:67]
    ds_read_b128 v[20:23], v7 offset:32768
    s_waitcnt lgkmcnt(5)
    v_mfma_f32_32x32x16_bf16 v[68:83], a[108:111], v[32:35], v[68:83]
    ds_read_b128 v[24:27], v7 offset:33792
    s_waitcnt lgkmcnt(5)
    v_mfma_f32_32x32x16_bf16 v[52:67], a[112:115], v[36:39], v[52:67]
    ds_read_b128 v[28:31], v7 offset:34816
    s_waitcnt lgkmcnt(5)
    v_mfma_f32_32x32x16_bf16 v[68:83], a[116:119], v[40:43], v[68:83]
    ds_read_b128 v[32:35], v7 offset:35840
    s_waitcnt lgkmcnt(5)
    v_mfma_f32_32x32x16_bf16 v[52:67], a[120:123], v[44:47], v[52:67]
    ds_read_b128 v[36:39], v7 offset:36864
    s_waitcnt lgkmcnt(5)
    v_mfma_f32_32x32x16_bf16 v[68:83], a[124:127], v[48:51], v[68:83]
    ds_read_b128 v[40:43], v7 offset:37888
    s_waitcnt lgkmcnt(5)
    v_mfma_f32_32x32x16_bf16 v[52:67], a[128:131], v[20:23], v[52:67]
    ds_read_b128 v[44:47], v7 offset:38912
    s_waitcnt lgkmcnt(5)
    v_mfma_f32_32x32x16_bf16 v[68:83], a[132:135], v[24:27], v[68:83]
    ds_read_b128 v[48:51], v7 offset:39936
    s_waitcnt lgkmcnt(5)
    v_mfma_f32_32x32x16_bf16 v[52:67], a[136:139], v[28:31], v[52:67]
    ds_read_b128 v[20:23], v7 offset:40960
    s_waitcnt lgkmcnt(5)
    v_mfma_f32_32x32x16_bf16 v[68:83], a[140:143], v[32:35], v[68:83]
    ds_read_b128 v[24:27], v7 offset:41984
    s_waitcnt lgkmcnt(5)
    v_mfma_f32_32x32x16_bf16 v[52:67], a[144:147], v[36:39], v[52:67]
    ds_read_b128 v[28:31], v7 offset:43008
    s_waitcnt lgkmcnt(5)
    v_mfma_f32_32x32x16_bf16 v[68:83], a[148:151], v[40:43], v[68:83]
    ds_read_b128 v[32:35], v7 offset:44032
    s_waitcnt lgkmcnt(5)
    v_mfma_f32_32x32x16_bf16 v[52:67], a[152:155], v[44:47], v[52:67]
    ds_read_b128 v[36:39], v7 offset:45056
    s_waitcnt lgkmcnt(5)
    v_mfma_f32_32x32x16_bf16 v[68:83], a[156:159], v[48:51], v[68:83]
    ds_read_b128 v[40:43], v7 offset:46080
    s_waitcnt lgkmcnt(5)
    v_mfma_f32_32x32x16_bf16 v[52:67], a[160:163], v[20:23], v[52:67]
    ds_read_b128 v[44:47], v7 offset:47104
    s_waitcnt lgkmcnt(5)
    v_mfma_f32_32x32x16_bf16 v[68:83], a[164:167], v[24:27], v[68:83]
    ds_read_b128 v[48:51], v7 offset:48128
    s_sub_u32 s22, s94, 1
    s_cmp_lt_u32 s22, 2
    s_cselect_b32 s55, 1, 0
    s_cbranch_scc1 WO_CJ_28
    s_waitcnt vmcnt(0)
WO_CJ_28:
    v_cmp_eq_u32 vcc, 0, v12
    s_cmp_eq_u64 vcc, 0
    s_cselect_b32 s94, 1, 0
    s_cmp_ge_u32 s92, 63
    s_cselect_b32 s94, 0, s94
    s_barrier
    s_lshl_b32 s24, s92, 16
    buffer_load_dwordx2 v[142:143], v140, s[4:7], s24 offen
    s_cmp_eq_u32 s94, 0
    s_cbranch_scc1 WO_LB
    s_waitcnt lgkmcnt(5)
    v_mfma_f32_32x32x16_bf16 v[52:67], a[168:171], v[28:31], v[52:67]
    s_add_u32 s54, s92, 1
    s_mul_i32 s53, s54, 262144
    s_add_u32 s53, s53, s44
    s_and_b32 s54, s54, 1
    s_lshl_b32 s54, s54, 16
    s_add_u32 m0, s54, s45
    buffer_load_dword v18, v19, s[8:11], s53 offen
    s_nop 0
    buffer_load_dwordx4 v2, s[8:11], s53 offen lds
    s_add_u32 s53, s53, 4096
    s_add_u32 m0, m0, 4096
    ds_read_b128 v[20:23], v7 offset:49152
    s_waitcnt lgkmcnt(5)
    v_mfma_f32_32x32x16_bf16 v[68:83], a[172:175], v[32:35], v[68:83]
    s_nop 0
    buffer_load_dwordx4 v2, s[8:11], s53 offen lds
    s_add_u32 s53, s53, 4096
    s_add_u32 m0, m0, 4096
    ds_read_b128 v[24:27], v7 offset:50176
    s_waitcnt lgkmcnt(5)
    v_mfma_f32_32x32x16_bf16 v[52:67], a[176:179], v[36:39], v[52:67]
    s_nop 0
    buffer_load_dwordx4 v2, s[8:11], s53 offen lds
    s_add_u32 s53, s53, 4096
    s_add_u32 m0, m0, 4096
    ds_read_b128 v[28:31], v7 offset:51200
    s_waitcnt lgkmcnt(5)
    v_mfma_f32_32x32x16_bf16 v[68:83], a[180:183], v[40:43], v[68:83]
    s_nop 0
    buffer_load_dwordx4 v2, s[8:11], s53 offen lds
    s_add_u32 s53, s53, 4096
    s_add_u32 m0, m0, 4096
    ds_read_b128 v[32:35], v7 offset:52224
    s_waitcnt lgkmcnt(5)
    v_mfma_f32_32x32x16_bf16 v[52:67], a[184:187], v[44:47], v[52:67]
    ds_read_b128 v[36:39], v7 offset:53248
    s_waitcnt lgkmcnt(5)
    v_mfma_f32_32x32x16_bf16 v[68:83], a[188:191], v[48:51], v[68:83]
    ds_read_b128 v[40:43], v7 offset:54272
    s_waitcnt lgkmcnt(5)
    v_mfma_f32_32x32x16_bf16 v[52:67], a[192:195], v[20:23], v[52:67]
    ds_read_b128 v[44:47], v7 offset:55296
    s_waitcnt lgkmcnt(5)
    v_mfma_f32_32x32x16_bf16 v[68:83], a[196:199], v[24:27], v[68:83]
    ds_read_b128 v[48:51], v7 offset:56320
    s_waitcnt lgkmcnt(5)
    v_mfma_f32_32x32x16_bf16 v[52:67], a[200:203], v[28:31], v[52:67]
    ds_read_b128 v[20:23], v7 offset:57344
    s_waitcnt lgkmcnt(5)
    v_mfma_f32_32x32x16_bf16 v[68:83], a[204:207], v[32:35], v[68:83]
    ds_read_b128 v[24:27], v7 offset:58368
    s_waitcnt lgkmcnt(5)
    v_mfma_f32_32x32x16_bf16 v[52:67], a[208:211], v[36:39], v[52:67]
    ds_read_b128 v[28:31], v7 offset:59392
    s_cmp_eq_u32 s55, 0
    s_cbranch_scc1 WO_NF_29
    s_waitcnt vmcnt(10)
    s_lshl_b32 s95, s92, 12
    s_add_u32 s95, s95, 14716928
    s_mov_b64 exec, 1
    buffer_store_dword v17, v16, s[96:99], s95 offen offset:512 sc1
    s_mov_b64 exec, -1
WO_NF_29:
    s_waitcnt lgkmcnt(5)
    v_mfma_f32_32x32x16_bf16 v[68:83], a[212:215], v[40:43], v[68:83]
    s_nop 0
    buffer_load_dwordx4 v2, s[8:11], s53 offen lds
    s_add_u32 s53, s53, 4096
    s_add_u32 m0, m0, 4096
    ds_read_b128 v[32:35], v7 offset:60416
    s_waitcnt lgkmcnt(5)
    v_mfma_f32_32x32x16_bf16 v[52:67], a[216:219], v[44:47], v[52:67]
    s_nop 0
    buffer_load_dwordx4 v2, s[8:11], s53 offen lds
    s_add_u32 s53, s53, 4096
    s_add_u32 m0, m0, 4096
    ds_read_b128 v[36:39], v7 offset:61440
    s_waitcnt lgkmcnt(5)
    v_mfma_f32_32x32x16_bf16 v[68:83], a[220:223], v[48:51], v[68:83]
    s_nop 0
    buffer_load_dwordx4 v2, s[8:11], s53 offen lds
    s_add_u32 s53, s53, 4096
    s_add_u32 m0, m0, 4096
    ds_read_b128 v[40:43], v7 offset:62464
    s_waitcnt lgkmcnt(5)
    v_mfma_f32_32x32x16_bf16 v[52:67], a[224:227], v[20:23], v[52:67]
    s_nop 0
    buffer_load_dwordx4 v2, s[8:11], s53 offen lds
    ds_read_b128 v[44:47], v7 offset:63488
    s_waitcnt lgkmcnt(5)
    v_mfma_f32_32x32x16_bf16 v[68:83], a[228:231], v[24:27], v[68:83]
    ds_read_b128 v[48:51], v7 offset:64512
    s_waitcnt lgkmcnt(5)
    v_mfma_f32_32x32x16_bf16 v[52:67], a[232:235], v[28:31], v[52:67]
    s_waitcnt lgkmcnt(4)
    v_mfma_f32_32x32x16_bf16 v[68:83], a[236:239], v[32:35], v[68:83]
    s_waitcnt lgkmcnt(3)
    v_mfma_f32_32x32x16_bf16 v[52:67], a[240:243], v[36:39], v[52:67]
    s_waitcnt lgkmcnt(2)
    v_mfma_f32_32x32x16_bf16 v[68:83], a[244:247], v[40:43], v[68:83]
    s_waitcnt lgkmcnt(1)
    v_mfma_f32_32x32x16_bf16 v[52:67], a[248:251], v[44:47], v[52:67]
    s_waitcnt lgkmcnt(0)
    v_mfma_f32_32x32x16_bf16 v[68:83], a[252:255], v[48:51], v[68:83]
    s_branch WO_LJ
WO_LB:
    s_lshl_b32 s95, s92, 12
    s_add_u32 s95, s95, 14725120
    buffer_load_dword v12, v8, s[96:99], s95 offen sc1
    s_waitcnt lgkmcnt(5)
    v_mfma_f32_32x32x16_bf16 v[52:67], a[168:171], v[28:31], v[52:67]
    ds_read_b128 v[20:23], v7 offset:49152
    s_waitcnt lgkmcnt(5)
    v_mfma_f32_32x32x16_bf16 v[68:83], a[172:175], v[32:35], v[68:83]
    ds_read_b128 v[24:27], v7 offset:50176
    s_waitcnt lgkmcnt(5)
    v_mfma_f32_32x32x16_bf16 v[52:67], a[176:179], v[36:39], v[52:67]
    ds_read_b128 v[28:31], v7 offset:51200
    s_waitcnt lgkmcnt(5)
    v_mfma_f32_32x32x16_bf16 v[68:83], a[180:183], v[40:43], v[68:83]
    ds_read_b128 v[32:35], v7 offset:52224
    s_waitcnt lgkmcnt(5)
    v_mfma_f32_32x32x16_bf16 v[52:67], a[184:187], v[44:47], v[52:67]
    ds_read_b128 v[36:39], v7 offset:53248
    s_waitcnt lgkmcnt(5)
    v_mfma_f32_32x32x16_bf16 v[68:83], a[188:191], v[48:51], v[68:83]
    ds_read_b128 v[40:43], v7 offset:54272
    s_waitcnt lgkmcnt(5)
    v_mfma_f32_32x32x16_bf16 v[52:67], a[192:195], v[20:23], v[52:67]
    ds_read_b128 v[44:47], v7 offset:55296
    s_waitcnt lgkmcnt(5)
    v_mfma_f32_32x32x16_bf16 v[68:83], a[196:199], v[24:27], v[68:83]
    ds_read_b128 v[48:51], v7 offset:56320
    s_waitcnt lgkmcnt(5)
    v_mfma_f32_32x32x16_bf16 v[52:67], a[200:203], v[28:31], v[52:67]
    ds_read_b128 v[20:23], v7 offset:57344
    s_waitcnt lgkmcnt(5)
    v_mfma_f32_32x32x16_bf16 v[68:83], a[204:207], v[32:35], v[68:83]
    ds_read_b128 v[24:27], v7 offset:58368
    s_waitcnt lgkmcnt(5)
    v_mfma_f32_32x32x16_bf16 v[52:67], a[208:211], v[36:39], v[52:67]
    ds_read_b128 v[28:31], v7 offset:59392
    s_cmp_eq_u32 s55, 0
    s_cbranch_scc1 WO_NF_30
    s_waitcnt vmcnt(6)
    s_lshl_b32 s95, s92, 12
    s_add_u32 s95, s95, 14716928
    s_mov_b64 exec, 1
    buffer_store_dword v17, v16, s[96:99], s95 offen offset:512 sc1
    s_mov_b64 exec, -1
WO_NF_30:
    s_waitcnt lgkmcnt(5)
    v_mfma_f32_32x32x16_bf16 v[68:83], a[212:215], v[40:43], v[68:83]
    ds_read_b128 v[32:35], v7 offset:60416
    s_waitcnt lgkmcnt(5)
    v_mfma_f32_32x32x16_bf16 v[52:67], a[216:219], v[44:47], v[52:67]
    ds_read_b128 v[36:39], v7 offset:61440
    s_waitcnt lgkmcnt(5)
    v_mfma_f32_32x32x16_bf16 v[68:83], a[220:223], v[48:51], v[68:83]
    ds_read_b128 v[40:43], v7 offset:62464
    s_waitcnt lgkmcnt(5)
    v_mfma_f32_32x32x16_bf16 v[52:67], a[224:227], v[20:23], v[52:67]
    ds_read_b128 v[44:47], v7 offset:63488
    s_waitcnt lgkmcnt(5)
    v_mfma_f32_32x32x16_bf16 v[68:83], a[228:231], v[24:27], v[68:83]
    ds_read_b128 v[48:51], v7 offset:64512
    s_waitcnt lgkmcnt(5)
    v_mfma_f32_32x32x16_bf16 v[52:67], a[232:235], v[28:31], v[52:67]
    s_waitcnt lgkmcnt(4)
    v_mfma_f32_32x32x16_bf16 v[68:83], a[236:239], v[32:35], v[68:83]
    s_waitcnt lgkmcnt(3)
    v_mfma_f32_32x32x16_bf16 v[52:67], a[240:243], v[36:39], v[52:67]
    s_waitcnt lgkmcnt(2)
    v_mfma_f32_32x32x16_bf16 v[68:83], a[244:247], v[40:43], v[68:83]
    s_waitcnt lgkmcnt(1)
    v_mfma_f32_32x32x16_bf16 v[52:67], a[248:251], v[44:47], v[52:67]
    s_waitcnt lgkmcnt(0)
    v_mfma_f32_32x32x16_bf16 v[68:83], a[252:255], v[48:51], v[68:83]
WO_LJ:
    s_and_b32 s48, s92, 1
    s_lshl_b32 s48, s48, 19
    s_add_u32 s24, s48, s46
    v_xor_b32 v7, 0x10000, v7
    s_nop 7
    s_nop 4
    v_pk_add_f32 v[52:53], v[52:53], v[68:69]
    v_pk_add_f32 v[54:55], v[54:55], v[70:71]
    v_pk_add_f32 v[56:57], v[56:57], v[72:73]
    v_pk_add_f32 v[58:59], v[58:59], v[74:75]
    v_pk_add_f32 v[60:61], v[60:61], v[76:77]
    v_pk_add_f32 v[62:63], v[62:63], v[78:79]
    v_pk_add_f32 v[64:65], v[64:65], v[80:81]
    v_pk_add_f32 v[66:67], v[66:67], v[82:83]
    s_cmp_eq_u32 s87, 1
    s_cbranch_scc0 MS_31
    buffer_store_dwordx4 v[52:55], v2, s[12:15], s24 offen offset:0
    buffer_store_dwordx4 v[56:59], v2, s[12:15], s24 offen offset:1024
    buffer_store_dwordx4 v[60:63], v2, s[12:15], s24 offen offset:2048
    buffer_store_dwordx4 v[64:67], v2, s[12:15], s24 offen offset:3072
    s_branch MS_32
MS_31:
    buffer_store_dwordx4 v[52:55], v2, s[12:15], s24 offen offset:0 sc1
    buffer_store_dwordx4 v[56:59], v2, s[12:15], s24 offen offset:1024 sc1
    buffer_store_dwordx4 v[60:63], v2, s[12:15], s24 offen offset:2048 sc1
    buffer_store_dwordx4 v[64:67], v2, s[12:15], s24 offen offset:3072 sc1
MS_32:
    s_add_u32 s49, s48, s47
    s_add_u32 s50, s49, 4096
    s_add_u32 s51, s49, 8192
    s_add_u32 s52, s49, 12288
    s_cmp_lg_u32 s94, 0
    s_cbranch_scc1 WO_FIN
    s_cmp_eq_u32 s55, 0
    s_cbranch_scc1 WO_W4_33
    s_waitcnt vmcnt(5)
    s_branch WO_W5_34
WO_W4_33:
    s_waitcnt vmcnt(4)
WO_W5_34:
    v_cmp_eq_u32 vcc, 0, v12
    s_cmp_eq_u64 vcc, 0
    s_cselect_b32 s94, 2, 0
    s_cmp_ge_u32 s92, 63
    s_cselect_b32 s94, 0, s94
    s_cmp_lg_u32 s94, 0
    s_cbranch_scc1 WO_LATE
    s_lshl_b32 s95, s92, 12
    s_add_u32 s95, s95, 14725120
WO_XL:
    buffer_load_dwordx4 v[144:147], v136, s[12:15], s49 offen sc1
    buffer_load_dwordx4 v[148:151], v136, s[12:15], s50 offen sc1
    buffer_load_dwordx4 v[152:155], v136, s[12:15], s51 offen sc1
    buffer_load_dwordx4 v[156:159], v136, s[12:15], s52 offen sc1
    buffer_load_dword v12, v8, s[96:99], s95 offen sc1
    s_waitcnt vmcnt(0)
    v_max3_u32 v5, v144, v145, v146
    v_max3_u32 v5, v5, v147, v148
    v_max3_u32 v5, v5, v149, v150
    v_max3_u32 v5, v5, v151, v152
    v_max3_u32 v5, v5, v153, v154
    v_max3_u32 v5, v5, v155, v156
    v_max3_u32 v5, v5, v157, v158
    v_max_u32 v5, v5, v159
    v_cmp_eq_u32 vcc, -1, v5
    s_cbranch_vccz WO_XOK
    v_cmp_eq_u32 vcc, 0, v12
    s_cmp_eq_u64 vcc, 0
    s_cselect_b32 s94, 2, 0
    s_cmp_ge_u32 s92, 63
    s_cselect_b32 s94, 0, s94
    s_cmp_lg_u32 s94, 0
    s_cbranch_scc1 WO_LATE
    s_cmp_eq_u32 s93, 0
    s_cbranch_scc1 WO_XOK
    s_sub_u32 s93, s93, 1
    s_branch WO_XL
WO_LATE:
    s_add_u32 s23, s92, 1
    s_mul_i32 s22, s23, 262144
    s_add_u32 s22, s22, s44
    s_and_b32 s23, s23, 1
    s_lshl_b32 s23, s23, 16
    s_add_u32 m0, s23, s45
    buffer_load_dword v18, v19, s[8:11], s22 offen
    s_nop 0
    buffer_load_dwordx4 v2, s[8:11], s22 offen lds
    s_add_u32 s22, s22, 4096
    s_add_u32 m0, m0, 4096
    s_nop 0
    buffer_load_dwordx4 v2, s[8:11], s22 offen lds
    s_add_u32 s22, s22, 4096
    s_add_u32 m0, m0, 4096
    s_nop 0
    buffer_load_dwordx4 v2, s[8:11], s22 offen lds
    s_add_u32 s22, s22, 4096
    s_add_u32 m0, m0, 4096
    s_nop 0
    buffer_load_dwordx4 v2, s[8:11], s22 offen lds
    s_add_u32 s22, s22, 4096
    s_add_u32 m0, m0, 4096
    s_nop 0
    buffer_load_dwordx4 v2, s[8:11], s22 offen lds
    s_add_u32 s22, s22, 4096
    s_add_u32 m0, m0, 4096
    s_nop 0
    buffer_load_dwordx4 v2, s[8:11], s22 offen lds
    s_add_u32 s22, s22, 4096
    s_add_u32 m0, m0, 4096
    s_nop 0
    buffer_load_dwordx4 v2, s[8:11], s22 offen lds
    s_add_u32 s22, s22, 4096
    s_add_u32 m0, m0, 4096
    s_nop 0
    buffer_load_dwordx4 v2, s[8:11], s22 offen lds
    s_branch WO_FIN
WO_XOK:
    v_pk_add_f32 v[144:145], v[144:145], v[148:149]
    v_pk_add_f32 v[146:147], v[146:147], v[150:151]
    v_pk_add_f32 v[152:153], v[152:153], v[156:157]
    v_pk_add_f32 v[154:155], v[154:155], v[158:159]
    v_pk_add_f32 v[144:145], v[144:145], v[152:153]
    v_pk_add_f32 v[146:147], v[146:147], v[154:155]
    v_lshlrev_b32 v152, 16, v142
    v_and_b32 v153, 0xffff0000, v142
    v_cvt_pk_bf16_f32 v144, v144, v145
    v_cvt_pk_bf16_f32 v146, v146, v147
    v_lshlrev_b32 v154, 16, v143
    v_and_b32 v155, 0xffff0000, v143
    v_lshlrev_b32 v148, 16, v144
    v_and_b32 v149, 0xffff0000, v144
    v_lshlrev_b32 v150, 16, v146
    v_and_b32 v151, 0xffff0000, v146
    v_pk_add_f32 v[148:149], v[148:149], v[152:153]
    v_pk_add_f32 v[150:151], v[150:151], v[154:155]
    s_lshl_b32 s24, s92, 16
    v_cvt_pk_bf16_f32 v144, v148, v149
    v_cvt_pk_bf16_f32 v145, v150, v151
    buffer_store_dwordx2 v[144:145], v139, s[36:39], s24 offen sc1
    s_cmp_eq_u32 s87, 1
    s_cbranch_scc0 MS_35
    buffer_store_dwordx4 v[160:163], v136, s[12:15], s49 offen
    buffer_store_dwordx4 v[160:163], v136, s[12:15], s50 offen
    buffer_store_dwordx4 v[160:163], v136, s[12:15], s51 offen
    buffer_store_dwordx4 v[160:163], v136, s[12:15], s52 offen
    s_branch MS_36
MS_35:
    buffer_store_dwordx4 v[160:163], v136, s[12:15], s49 offen sc1
    buffer_store_dwordx4 v[160:163], v136, s[12:15], s50 offen sc1
    buffer_store_dwordx4 v[160:163], v136, s[12:15], s51 offen sc1
    buffer_store_dwordx4 v[160:163], v136, s[12:15], s52 offen sc1
MS_36:
    v_cmp_eq_u32 vcc, 0, v12
    s_cmp_eq_u64 vcc, 0
    s_cselect_b32 s94, 3, 0
    s_cmp_ge_u32 s92, 63
    s_cselect_b32 s94, 0, s94
    s_cmp_lg_u32 s94, 0
    s_cbranch_scc1 WO_FIN
    s_waitcnt vmcnt(4)
    s_lshl_b32 s95, s92, 12
    s_add_u32 s95, s95, 14721024
    s_mov_b64 exec, 1
    buffer_store_dword v17, v16, s[96:99], s95 offen offset:512 sc1
    s_mov_b64 exec, -1
WO_FIN:
    s_add_u32 s92, s92, 1
    s_cmp_lt_u32 s92, 64
    s_cbranch_scc1 WO_TOP
    s_endpgm
MG_DN:
    s_sub_u32 s29, s90, 32
    s_lshr_b32 s28, s29, 3
    s_and_b32 s29, s29, 7
    s_load_dwordx2 s[34:35], s[0:1], 104
    s_load_dwordx2 s[32:33], s[0:1], 80
    s_load_dwordx2 s[40:41], s[0:1], 88
    v_and_b32 v1, 63, v0
    v_lshlrev_b32 v2, 4, v1
    s_waitcnt lgkmcnt(0)
    s_mov_b32 s4, s32
    s_mov_b32 s5, s33
    s_and_b32 s5, s5, 0xffff
    s_mov_b32 s6, 0x700000
    s_mov_b32 s7, 0x00020000
    s_add_u32 s8, s34, 0x3c00000
    s_addc_u32 s9, s35, 0
    s_and_b32 s9, s9, 0xffff
    s_mov_b32 s10, 0xe00000
    s_mov_b32 s11, 0x00020000
    s_add_u32 s12, s34, 0x9000000
    s_addc_u32 s13, s35, 0
    s_and_b32 s13, s13, 0xffff
    s_mov_b32 s14, 0x100000
    s_mov_b32 s15, 0x00020000
    s_mov_b32 s36, s40
    s_mov_b32 s37, s41
    s_and_b32 s37, s37, 0xffff
    s_mov_b32 s38, 0x400000
    s_mov_b32 s39, 0x00020000
    v_lshrrev_b32 v5, 4, v1
    v_lshlrev_b32 v6, 2, v5
    v_and_b32 v3, 15, v1
    v_xor_b32 v3, v3, v6
    v_lshlrev_b32 v3, 4, v3
    v_lshl_add_u32 v3, v5, 11, v3
    s_mul_i32 s22, s28, 1835008
    s_lshl_b32 s23, s29, 8
    s_add_u32 s22, s22, s23
    s_lshl_b32 s23, s19, 16
    s_add_u32 s42, s22, s23
    s_lshl_b32 s43, s19, 13
    v_bfe_u32 v5, v1, 2, 2
    v_lshrrev_b32 v6, 5, v1
    v_lshl_add_u32 v6, v6, 2, v5
    v_lshlrev_b32 v4, 8, v6
    v_xor_b32 v5, s19, v5
    v_lshl_add_u32 v4, v5, 6, v4
    v_bfe_u32 v5, v1, 4, 1
    v_lshl_add_u32 v4, v5, 5, v4
    v_and_b32 v5, 3, v1
    v_lshl_add_u32 v4, v5, 3, v4
    s_add_u32 s22, s42, 0
    s_add_u32 m0, s43, 0
    s_nop 0
    buffer_load_dwordx4 v3, s[4:7], s22 offen lds
    s_add_u32 s22, s22, 8192
    s_add_u32 m0, m0, 1024
    s_nop 0
    buffer_load_dwordx4 v3, s[4:7], s22 offen lds
    s_add_u32 s22, s22, 8192
    s_add_u32 m0, m0, 1024
    s_nop 0
    buffer_load_dwordx4 v3, s[4:7], s22 offen lds
    s_add_u32 s22, s22, 8192
    s_add_u32 m0, m0, 1024
    s_nop 0
    buffer_load_dwordx4 v3, s[4:7], s22 offen lds
    s_add_u32 s22, s22, 8192
    s_add_u32 m0, m0, 1024
    s_nop 0
    buffer_load_dwordx4 v3, s[4:7], s22 offen lds
    s_add_u32 s22, s22, 8192
    s_add_u32 m0, m0, 1024
    s_nop 0
    buffer_load_dwordx4 v3, s[4:7], s22 offen lds
    s_add_u32 s22, s22, 8192
    s_add_u32 m0, m0, 1024
    s_nop 0
    buffer_load_dwordx4 v3, s[4:7], s22 offen lds
    s_add_u32 s22, s22, 8192
    s_add_u32 m0, m0, 1024
    s_nop 0
    buffer_load_dwordx4 v3, s[4:7], s22 offen lds
    s_add_u32 s22, s42, 262144
    s_add_u32 m0, s43, 32768
    s_nop 0
    buffer_load_dwordx4 v3, s[4:7], s22 offen lds
    s_add_u32 s22, s22, 8192
    s_add_u32 m0, m0, 1024
    s_nop 0
    buffer_load_dwordx4 v3, s[4:7], s22 offen lds
    s_add_u32 s22, s22, 8192
    s_add_u32 m0, m0, 1024
    s_nop 0
    buffer_load_dwordx4 v3, s[4:7], s22 offen lds
    s_add_u32 s22, s22, 8192
    s_add_u32 m0, m0, 1024
    s_nop 0
    buffer_load_dwordx4 v3, s[4:7], s22 offen lds
    s_add_u32 s22, s22, 8192
    s_add_u32 m0, m0, 1024
    s_nop 0
    buffer_load_dwordx4 v3, s[4:7], s22 offen lds
    s_add_u32 s22, s22, 8192
    s_add_u32 m0, m0, 1024
    s_nop 0
    buffer_load_dwordx4 v3, s[4:7], s22 offen lds
    s_add_u32 s22, s22, 8192
    s_add_u32 m0, m0, 1024
    s_nop 0
    buffer_load_dwordx4 v3, s[4:7], s22 offen lds
    s_add_u32 s22, s22, 8192
    s_add_u32 m0, m0, 1024
    s_nop 0
    buffer_load_dwordx4 v3, s[4:7], s22 offen lds
    s_add_u32 s22, s42, 524288
    s_add_u32 m0, s43, 65536
    s_nop 0
    buffer_load_dwordx4 v3, s[4:7], s22 offen lds
    s_add_u32 s22, s22, 8192
    s_add_u32 m0, m0, 1024
    s_nop 0
    buffer_load_dwordx4 v3, s[4:7], s22 offen lds
    s_add_u32 s22, s22, 8192
    s_add_u32 m0, m0, 1024
    s_nop 0
    buffer_load_dwordx4 v3, s[4:7], s22 offen lds
    s_add_u32 s22, s22, 8192
    s_add_u32 m0, m0, 1024
    s_nop 0
    buffer_load_dwordx4 v3, s[4:7], s22 offen lds
    s_add_u32 s22, s22, 8192
    s_add_u32 m0, m0, 1024
    s_nop 0
    buffer_load_dwordx4 v3, s[4:7], s22 offen lds
    s_add_u32 s22, s22, 8192
    s_add_u32 m0, m0, 1024
    s_nop 0
    buffer_load_dwordx4 v3, s[4:7], s22 offen lds
    s_add_u32 s22, s22, 8192
    s_add_u32 m0, m0, 1024
    s_nop 0
    buffer_load_dwordx4 v3, s[4:7], s22 offen lds
    s_add_u32 s22, s22, 8192
    s_add_u32 m0, m0, 1024
    s_nop 0
    buffer_load_dwordx4 v3, s[4:7], s22 offen lds
    s_add_u32 s22, s42, 786432
    s_add_u32 m0, s43, 98304
    s_nop 0
    buffer_load_dwordx4 v3, s[4:7], s22 offen lds
    s_add_u32 s22, s22, 8192
    s_add_u32 m0, m0, 1024
    s_nop 0
    buffer_load_dwordx4 v3, s[4:7], s22 offen lds
    s_add_u32 s22, s22, 8192
    s_add_u32 m0, m0, 1024
    s_nop 0
    buffer_load_dwordx4 v3, s[4:7], s22 offen lds
    s_add_u32 s22, s22, 8192
    s_add_u32 m0, m0, 1024
    s_nop 0
    buffer_load_dwordx4 v3, s[4:7], s22 offen lds
    s_add_u32 s22, s22, 8192
    s_add_u32 m0, m0, 1024
    s_nop 0
    buffer_load_dwordx4 v3, s[4:7], s22 offen lds
    s_add_u32 s22, s22, 8192
    s_add_u32 m0, m0, 1024
    s_nop 0
    buffer_load_dwordx4 v3, s[4:7], s22 offen lds
    s_add_u32 s22, s22, 8192
    s_add_u32 m0, m0, 1024
    s_nop 0
    buffer_load_dwordx4 v3, s[4:7], s22 offen lds
    s_add_u32 s22, s22, 8192
    s_add_u32 m0, m0, 1024
    s_nop 0
    buffer_load_dwordx4 v3, s[4:7], s22 offen lds
    s_waitcnt vmcnt(24)
    s_barrier
    v_add_u32 v5, 0, v4
    ds_read_b64_tr_b16 a[0:1], v5 offset:0
    ds_read_b64_tr_b16 a[2:3], v5 offset:2048
    ds_read_b64_tr_b16 a[4:5], v5 offset:4096
    ds_read_b64_tr_b16 a[6:7], v5 offset:6144
    ds_read_b64_tr_b16 a[8:9], v5 offset:8192
    ds_read_b64_tr_b16 a[10:11], v5 offset:10240
    ds_read_b64_tr_b16 a[12:13], v5 offset:12288
    ds_read_b64_tr_b16 a[14:15], v5 offset:14336
    s_waitcnt lgkmcnt(0)
    ds_read_b64_tr_b16 a[16:17], v5 offset:16384
    ds_read_b64_tr_b16 a[18:19], v5 offset:18432
    ds_read_b64_tr_b16 a[20:21], v5 offset:20480
    ds_read_b64_tr_b16 a[22:23], v5 offset:22528
    ds_read_b64_tr_b16 a[24:25], v5 offset:24576
    ds_read_b64_tr_b16 a[26:27], v5 offset:26624
    ds_read_b64_tr_b16 a[28:29], v5 offset:28672
    ds_read_b64_tr_b16 a[30:31], v5 offset:30720
    s_waitcnt lgkmcnt(0)
    s_barrier
    s_add_u32 s22, s42, 1048576
    s_add_u32 m0, s43, 0
    s_nop 0
    buffer_load_dwordx4 v3, s[4:7], s22 offen lds
    s_add_u32 s22, s22, 8192
    s_add_u32 m0, m0, 1024
    s_nop 0
    buffer_load_dwordx4 v3, s[4:7], s22 offen lds
    s_add_u32 s22, s22, 8192
    s_add_u32 m0, m0, 1024
    s_nop 0
    buffer_load_dwordx4 v3, s[4:7], s22 offen lds
    s_add_u32 s22, s22, 8192
    s_add_u32 m0, m0, 1024
    s_nop 0
    buffer_load_dwordx4 v3, s[4:7], s22 offen lds
    s_add_u32 s22, s22, 8192
    s_add_u32 m0, m0, 1024
    s_nop 0
    buffer_load_dwordx4 v3, s[4:7], s22 offen lds
    s_add_u32 s22, s22, 8192
    s_add_u32 m0, m0, 1024
    s_nop 0
    buffer_load_dwordx4 v3, s[4:7], s22 offen lds
    s_add_u32 s22, s22, 8192
    s_add_u32 m0, m0, 1024
    s_nop 0
    buffer_load_dwordx4 v3, s[4:7], s22 offen lds
    s_add_u32 s22, s22, 8192
    s_add_u32 m0, m0, 1024
    s_nop 0
    buffer_load_dwordx4 v3, s[4:7], s22 offen lds
    s_waitcnt vmcnt(24)
    s_barrier
    v_add_u32 v5, 32768, v4
    ds_read_b64_tr_b16 a[32:33], v5 offset:0
    ds_read_b64_tr_b16 a[34:35], v5 offset:2048
    ds_read_b64_tr_b16 a[36:37], v5 offset:4096
    ds_read_b64_tr_b16 a[38:39], v5 offset:6144
    ds_read_b64_tr_b16 a[40:41], v5 offset:8192
    ds_read_b64_tr_b16 a[42:43], v5 offset:10240
    ds_read_b64_tr_b16 a[44:45], v5 offset:12288
    ds_read_b64_tr_b16 a[46:47], v5 offset:14336
    s_waitcnt lgkmcnt(0)
    ds_read_b64_tr_b16 a[48:49], v5 offset:16384
    ds_read_b64_tr_b16 a[50:51], v5 offset:18432
    ds_read_b64_tr_b16 a[52:53], v5 offset:20480
    ds_read_b64_tr_b16 a[54:55], v5 offset:22528
    ds_read_b64_tr_b16 a[56:57], v5 offset:24576
    ds_read_b64_tr_b16 a[58:59], v5 offset:26624
    ds_read_b64_tr_b16 a[60:61], v5 offset:28672
    ds_read_b64_tr_b16 a[62:63], v5 offset:30720
    s_waitcnt lgkmcnt(0)
    s_barrier
    s_add_u32 s22, s42, 1310720
    s_add_u32 m0, s43, 32768
    s_nop 0
    buffer_load_dwordx4 v3, s[4:7], s22 offen lds
    s_add_u32 s22, s22, 8192
    s_add_u32 m0, m0, 1024
    s_nop 0
    buffer_load_dwordx4 v3, s[4:7], s22 offen lds
    s_add_u32 s22, s22, 8192
    s_add_u32 m0, m0, 1024
    s_nop 0
    buffer_load_dwordx4 v3, s[4:7], s22 offen lds
    s_add_u32 s22, s22, 8192
    s_add_u32 m0, m0, 1024
    s_nop 0
    buffer_load_dwordx4 v3, s[4:7], s22 offen lds
    s_add_u32 s22, s22, 8192
    s_add_u32 m0, m0, 1024
    s_nop 0
    buffer_load_dwordx4 v3, s[4:7], s22 offen lds
    s_add_u32 s22, s22, 8192
    s_add_u32 m0, m0, 1024
    s_nop 0
    buffer_load_dwordx4 v3, s[4:7], s22 offen lds
    s_add_u32 s22, s22, 8192
    s_add_u32 m0, m0, 1024
    s_nop 0
    buffer_load_dwordx4 v3, s[4:7], s22 offen lds
    s_add_u32 s22, s22, 8192
    s_add_u32 m0, m0, 1024
    s_nop 0
    buffer_load_dwordx4 v3, s[4:7], s22 offen lds
    s_waitcnt vmcnt(24)
    s_barrier
    v_add_u32 v5, 65536, v4
    ds_read_b64_tr_b16 a[64:65], v5 offset:0
    ds_read_b64_tr_b16 a[66:67], v5 offset:2048
    ds_read_b64_tr_b16 a[68:69], v5 offset:4096
    ds_read_b64_tr_b16 a[70:71], v5 offset:6144
    ds_read_b64_tr_b16 a[72:73], v5 offset:8192
    ds_read_b64_tr_b16 a[74:75], v5 offset:10240
    ds_read_b64_tr_b16 a[76:77], v5 offset:12288
    ds_read_b64_tr_b16 a[78:79], v5 offset:14336
    s_waitcnt lgkmcnt(0)
    ds_read_b64_tr_b16 a[80:81], v5 offset:16384
    ds_read_b64_tr_b16 a[82:83], v5 offset:18432
    ds_read_b64_tr_b16 a[84:85], v5 offset:20480
    ds_read_b64_tr_b16 a[86:87], v5 offset:22528
    ds_read_b64_tr_b16 a[88:89], v5 offset:24576
    ds_read_b64_tr_b16 a[90:91], v5 offset:26624
    ds_read_b64_tr_b16 a[92:93], v5 offset:28672
    ds_read_b64_tr_b16 a[94:95], v5 offset:30720
    s_waitcnt lgkmcnt(0)
    s_barrier
    s_add_u32 s22, s42, 1572864
    s_add_u32 m0, s43, 65536
    s_nop 0
    buffer_load_dwordx4 v3, s[4:7], s22 offen lds
    s_add_u32 s22, s22, 8192
    s_add_u32 m0, m0, 1024
    s_nop 0
    buffer_load_dwordx4 v3, s[4:7], s22 offen lds
    s_add_u32 s22, s22, 8192
    s_add_u32 m0, m0, 1024
    s_nop 0
    buffer_load_dwordx4 v3, s[4:7], s22 offen lds
    s_add_u32 s22, s22, 8192
    s_add_u32 m0, m0, 1024
    s_nop 0
    buffer_load_dwordx4 v3, s[4:7], s22 offen lds
    s_add_u32 s22, s22, 8192
    s_add_u32 m0, m0, 1024
    s_nop 0
    buffer_load_dwordx4 v3, s[4:7], s22 offen lds
    s_add_u32 s22, s22, 8192
    s_add_u32 m0, m0, 1024
    s_nop 0
    buffer_load_dwordx4 v3, s[4:7], s22 offen lds
    s_add_u32 s22, s22, 8192
    s_add_u32 m0, m0, 1024
    s_nop 0
    buffer_load_dwordx4 v3, s[4:7], s22 offen lds
    s_add_u32 s22, s22, 8192
    s_add_u32 m0, m0, 1024
    s_nop 0
    buffer_load_dwordx4 v3, s[4:7], s22 offen lds
    s_waitcnt vmcnt(24)
    s_barrier
    v_add_u32 v5, 98304, v4
    ds_read_b64_tr_b16 a[96:97], v5 offset:0
    ds_read_b64_tr_b16 a[98:99], v5 offset:2048
    ds_read_b64_tr_b16 a[100:101], v5 offset:4096
    ds_read_b64_tr_b16 a[102:103], v5 offset:6144
    ds_read_b64_tr_b16 a[104:105], v5 offset:8192
    ds_read_b64_tr_b16 a[106:107], v5 offset:10240
    ds_read_b64_tr_b16 a[108:109], v5 offset:12288
    ds_read_b64_tr_b16 a[110:111], v5 offset:14336
    s_waitcnt lgkmcnt(0)
    ds_read_b64_tr_b16 a[112:113], v5 offset:16384
    ds_read_b64_tr_b16 a[114:115], v5 offset:18432
    ds_read_b64_tr_b16 a[116:117], v5 offset:20480
    ds_read_b64_tr_b16 a[118:119], v5 offset:22528
    ds_read_b64_tr_b16 a[120:121], v5 offset:24576
    ds_read_b64_tr_b16 a[122:123], v5 offset:26624
    ds_read_b64_tr_b16 a[124:125], v5 offset:28672
    ds_read_b64_tr_b16 a[126:127], v5 offset:30720
    s_waitcnt lgkmcnt(0)
    s_barrier
    s_waitcnt vmcnt(16)
    s_barrier
    v_add_u32 v5, 0, v4
    ds_read_b64_tr_b16 a[128:129], v5 offset:0
    ds_read_b64_tr_b16 a[130:131], v5 offset:2048
    ds_read_b64_tr_b16 a[132:133], v5 offset:4096
    ds_read_b64_tr_b16 a[134:135], v5 offset:6144
    ds_read_b64_tr_b16 a[136:137], v5 offset:8192
    ds_read_b64_tr_b16 a[138:139], v5 offset:10240
    ds_read_b64_tr_b16 a[140:141], v5 offset:12288
    ds_read_b64_tr_b16 a[142:143], v5 offset:14336
    s_waitcnt lgkmcnt(0)
    ds_read_b64_tr_b16 a[144:145], v5 offset:16384
    ds_read_b64_tr_b16 a[146:147], v5 offset:18432
    ds_read_b64_tr_b16 a[148:149], v5 offset:20480
    ds_read_b64_tr_b16 a[150:151], v5 offset:22528
    ds_read_b64_tr_b16 a[152:153], v5 offset:24576
    ds_read_b64_tr_b16 a[154:155], v5 offset:26624
    ds_read_b64_tr_b16 a[156:157], v5 offset:28672
    ds_read_b64_tr_b16 a[158:159], v5 offset:30720
    s_waitcnt lgkmcnt(0)
    s_barrier
    s_waitcnt vmcnt(8)
    s_barrier
    v_add_u32 v5, 32768, v4
    ds_read_b64_tr_b16 a[160:161], v5 offset:0
    ds_read_b64_tr_b16 a[162:163], v5 offset:2048
    ds_read_b64_tr_b16 a[164:165], v5 offset:4096
    ds_read_b64_tr_b16 a[166:167], v5 offset:6144
    ds_read_b64_tr_b16 a[168:169], v5 offset:8192
    ds_read_b64_tr_b16 a[170:171], v5 offset:10240
    ds_read_b64_tr_b16 a[172:173], v5 offset:12288
    ds_read_b64_tr_b16 a[174:175], v5 offset:14336
    s_waitcnt lgkmcnt(0)
    ds_read_b64_tr_b16 a[176:177], v5 offset:16384
    ds_read_b64_tr_b16 a[178:179], v5 offset:18432
    ds_read_b64_tr_b16 a[180:181], v5 offset:20480
    ds_read_b64_tr_b16 a[182:183], v5 offset:22528
    ds_read_b64_tr_b16 a[184:185], v5 offset:24576
    ds_read_b64_tr_b16 a[186:187], v5 offset:26624
    ds_read_b64_tr_b16 a[188:189], v5 offset:28672
    ds_read_b64_tr_b16 a[190:191], v5 offset:30720
    s_waitcnt lgkmcnt(0)
    s_barrier
    s_waitcnt vmcnt(0)
    s_barrier
    v_add_u32 v5, 65536, v4
    ds_read_b64_tr_b16 a[192:193], v5 offset:0
    ds_read_b64_tr_b16 a[194:195], v5 offset:2048
    ds_read_b64_tr_b16 a[196:197], v5 offset:4096
    ds_read_b64_tr_b16 a[198:199], v5 offset:6144
    ds_read_b64_tr_b16 a[200:201], v5 offset:8192
    ds_read_b64_tr_b16 a[202:203], v5 offset:10240
    ds_read_b64_tr_b16 a[204:205], v5 offset:12288
    ds_read_b64_tr_b16 a[206:207], v5 offset:14336
    s_waitcnt lgkmcnt(0)
    ds_read_b64_tr_b16 a[208:209], v5 offset:16384
    ds_read_b64_tr_b16 a[210:211], v5 offset:18432
    ds_read_b64_tr_b16 a[212:213], v5 offset:20480
    ds_read_b64_tr_b16 a[214:215], v5 offset:22528
    ds_read_b64_tr_b16 a[216:217], v5 offset:24576
    ds_read_b64_tr_b16 a[218:219], v5 offset:26624
    ds_read_b64_tr_b16 a[220:221], v5 offset:28672
    ds_read_b64_tr_b16 a[222:223], v5 offset:30720
    s_waitcnt lgkmcnt(0)
    s_barrier
    s_mul_i32 s44, s28, 57344
    s_lshl_b32 s22, s19, 10
    s_add_u32 s44, s44, s22
    s_lshl_b32 s45, s19, 10
    s_lshl_b32 s22, s29, 2
    s_add_u32 s23, s22, s19
    s_lshl_b32 s23, s23, 2
    s_add_u32 s23, s23, s28
    s_lshl_b32 s46, s23, 12
    s_add_u32 s23, s22, s28
    s_lshl_b32 s47, s23, 14
    s_lshl_b32 s24, s23, 4
    s_add_u32 s24, s24, 2560
    v_mov_b32 v138, s24
    s_add_u32 s23, s22, s19
    s_lshl_b32 s23, s23, 4
    s_lshl_b32 s24, s28, 2
    s_add_u32 s23, s23, s24
    s_add_u32 s23, s23, 2560
    v_mov_b32 v137, s23
    v_and_b32 v84, 15, v1
    s_lshr_b32 s22, s19, 1
    s_lshl_b32 s22, s22, 4
    v_add_u32 v84, s22, v84
    v_bfe_u32 v85, v1, 4, 1
    v_lshrrev_b32 v86, 5, v1
    v_lshl_add_u32 v87, v85, 5, v84
    v_lshlrev_b32 v87, 4, v87
    s_and_b32 s22, s19, 1
    s_lshl_b32 s23, s22, 11
    v_lshl_add_u32 v136, v86, 10, v87
    v_add_u32 v136, s23, v136
    s_lshl_b32 s23, s29, 3
    s_lshl_b32 s24, s28, 1
    s_add_u32 s23, s23, s24
    s_add_u32 s23, s23, s22
    s_lshl_b32 s24, s23, 10
    v_lshl_add_u32 v139, v86, 3, v87
    v_add_u32 v139, s24, v139
    s_lshl_b32 s24, s23, 5
    v_lshlrev_b32 v140, 11, v84
    v_lshl_add_u32 v140, v86, 4, v140
    v_lshl_add_u32 v140, v85, 3, v140
    v_add_u32 v140, s24, v140
    v_mov_b32 v160, -1
    v_mov_b32 v161, -1
    v_mov_b32 v162, -1
    v_mov_b32 v163, -1
    s_add_u32 s4, s34, 0x3400000
    s_addc_u32 s5, s35, 0
    s_and_b32 s5, s5, 0xffff
    s_mov_b32 s6, 0x400000
    s_mov_b32 s7, 0x00020000
    v_min_u32 v8, 13, v1
    v_lshlrev_b32 v8, 4, v8
    s_mul_i32 s22, s28, 224
    s_add_u32 s22, s22, 1536
    v_add_u32 v8, s22, v8
    s_lshl_b32 s22, s28, 3
    s_add_u32 s22, s22, s29
    s_lshl_b32 s22, s22, 4
    s_lshl_b32 s23, s19, 2
    s_add_u32 s22, s22, s23
    v_mov_b32 v16, s22
    v_mov_b32 v17, 1
    v_mov_b32 v18, 163584
    s_mov_b32 s92, 0
    s_mov_b32 s94, 0
    v_mov_b32 v7, v2
    v_min_u32 v19, 55, v1
    v_lshlrev_b32 v19, 5, v19
    s_mul_i32 s22, s29, 7168
    s_mul_i32 s23, s19, 768
    s_add_u32 s22, s22, s23
    v_add_u32 v19, s22, v19
    v_mov_b32 v12, 0
    v_mov_b32 v13, 0
    v_mov_b32 v14, 0
    v_mov_b32 v15, 0
DN_TOP:
    s_cmp_eq_u32 s94, 1
    s_cbranch_scc1 DN_HAVE
    s_cmp_eq_u32 s94, 2
    s_cbranch_scc1 DN_HAVE
    s_lshl_b32 s95, s92, 12
    s_add_u32 s95, s95, 14721024
DN_PL:
    v_min3_u32 v5, v12, v13, v14
    v_min_u32 v5, v5, v15
    v_cmp_eq_u32 vcc, 0, v5
    s_cbranch_vccz DN_ISS
    s_cmp_eq_u32 s93, 0
    s_cbranch_scc1 DN_ISS
    s_sub_u32 s93, s93, 1
    buffer_load_dwordx4 v[12:15], v8, s[96:99], s95 offen sc1
    s_waitcnt vmcnt(0)
    s_branch DN_PL
DN_ISS:
    s_add_u32 s23, s92, 0
    s_mul_i32 s22, s23, 229376
    s_add_u32 s22, s22, s44
    s_and_b32 s23, s23, 1
    s_lshl_b32 s23, s23, 16
    s_add_u32 m0, s23, s45
    buffer_load_dword v18, v19, s[8:11], s22 offen
    s_nop 0
    buffer_load_dwordx4 v2, s[8:11], s22 offen lds
    s_add_u32 s22, s22, 4096
    s_add_u32 m0, m0, 4096
    s_nop 0
    buffer_load_dwordx4 v2, s[8:11], s22 offen lds
    s_add_u32 s22, s22, 4096
    s_add_u32 m0, m0, 4096
    s_nop 0
    buffer_load_dwordx4 v2, s[8:11], s22 offen lds
    s_add_u32 s22, s22, 4096
    s_add_u32 m0, m0, 4096
    s_nop 0
    buffer_load_dwordx4 v2, s[8:11], s22 offen lds
    s_add_u32 s22, s22, 4096
    s_add_u32 m0, m0, 4096
    s_nop 0
    buffer_load_dwordx4 v2, s[8:11], s22 offen lds
    s_add_u32 s22, s22, 4096
    s_add_u32 m0, m0, 4096
    s_nop 0
    buffer_load_dwordx4 v2, s[8:11], s22 offen lds
    s_add_u32 s22, s22, 4096
    s_add_u32 m0, m0, 4096
    s_nop 0
    buffer_load_dwordx4 v2, s[8:11], s22 offen lds
    s_add_u32 s22, s22, 4096
    s_add_u32 m0, m0, 4096
    s_nop 0
    buffer_load_dwordx4 v2, s[8:11], s22 offen lds
DN_HAVE:
    s_cmp_eq_u32 s94, 1
    s_cbranch_scc1 DN_C1_38
    s_waitcnt vmcnt(4)
    s_branch DN_CJ_37
DN_C1_38:
    s_waitcnt vmcnt(8)
DN_CJ_37:
    s_barrier
    ds_read_b128 v[20:23], v7 offset:0
    ds_read_b128 v[24:27], v7 offset:1024
    ds_read_b128 v[28:31], v7 offset:2048
    ds_read_b128 v[32:35], v7 offset:3072
    ds_read_b128 v[36:39], v7 offset:4096
    ds_read_b128 v[40:43], v7 offset:5120
    s_waitcnt lgkmcnt(5)
    v_mfma_f32_32x32x16_bf16 v[52:67], a[0:3], v[20:23], 0
    s_add_u32 s54, s92, 0
    s_mul_i32 s53, s54, 229376
    s_add_u32 s53, s53, s44
    s_and_b32 s54, s54, 1
    s_lshl_b32 s54, s54, 16
    s_add_u32 m0, s54, s45
    s_add_u32 s53, s53, 32768
    s_add_u32 m0, m0, 32768
    s_nop 0
    buffer_load_dwordx4 v2, s[8:11], s53 offen lds
    s_add_u32 s53, s53, 4096
    s_add_u32 m0, m0, 4096
    ds_read_b128 v[44:47], v7 offset:6144
    s_waitcnt lgkmcnt(5)
    v_mfma_f32_32x32x16_bf16 v[68:83], a[4:7], v[24:27], 0
    s_nop 0
    buffer_load_dwordx4 v2, s[8:11], s53 offen lds
    s_add_u32 s53, s53, 4096
    s_add_u32 m0, m0, 4096
    ds_read_b128 v[48:51], v7 offset:7168
    s_waitcnt lgkmcnt(5)
    v_mfma_f32_32x32x16_bf16 v[52:67], a[8:11], v[28:31], v[52:67]
    s_nop 0
    buffer_load_dwordx4 v2, s[8:11], s53 offen lds
    s_add_u32 s53, s53, 4096
    s_add_u32 m0, m0, 4096
    ds_read_b128 v[20:23], v7 offset:8192
    s_waitcnt lgkmcnt(5)
    v_mfma_f32_32x32x16_bf16 v[68:83], a[12:15], v[32:35], v[68:83]
    s_nop 0
    buffer_load_dwordx4 v2, s[8:11], s53 offen lds
    s_add_u32 s53, s53, 4096
    s_add_u32 m0, m0, 4096
    ds_read_b128 v[24:27], v7 offset:9216
    s_waitcnt lgkmcnt(5)
    v_mfma_f32_32x32x16_bf16 v[52:67], a[16:19], v[36:39], v[52:67]
    s_nop 0
    buffer_load_dwordx4 v2, s[8:11], s53 offen lds
    s_add_u32 s53, s53, 4096
    s_add_u32 m0, m0, 4096
    ds_read_b128 v[28:31], v7 offset:10240
    s_waitcnt lgkmcnt(5)
    v_mfma_f32_32x32x16_bf16 v[68:83], a[20:23], v[40:43], v[68:83]
    s_nop 0
    buffer_load_dwordx4 v2, s[8:11], s53 offen lds
    ds_read_b128 v[32:35], v7 offset:11264
    s_waitcnt lgkmcnt(5)
    v_mfma_f32_32x32x16_bf16 v[52:67], a[24:27], v[44:47], v[52:67]
    ds_read_b128 v[36:39], v7 offset:12288
    s_waitcnt lgkmcnt(5)
    v_mfma_f32_32x32x16_bf16 v[68:83], a[28:31], v[48:51], v[68:83]
    ds_read_b128 v[40:43], v7 offset:13312
    s_waitcnt lgkmcnt(5)
    v_mfma_f32_32x32x16_bf16 v[52:67], a[32:35], v[20:23], v[52:67]
    ds_read_b128 v[44:47], v7 offset:14336
    s_waitcnt lgkmcnt(5)
    v_mfma_f32_32x32x16_bf16 v[68:83], a[36:39], v[24:27], v[68:83]
    ds_read_b128 v[48:51], v7 offset:15360
    s_cmp_eq_u32 s94, 1
    s_cbranch_scc1 DN_C1_42
    s_waitcnt vmcnt(6)
    s_cmp_eq_u32 s94, 2
    s_cbranch_scc0 DN_CJ_41
    buffer_load_dwordx4 v[144:147], v136, s[12:15], s49 offen sc1
    buffer_load_dwordx4 v[148:151], v136, s[12:15], s50 offen sc1
    buffer_load_dwordx4 v[152:155], v136, s[12:15], s51 offen sc1
    buffer_load_dwordx4 v[156:159], v136, s[12:15], s52 offen sc1
    s_branch DN_CJ_41
DN_C1_42:
    s_waitcnt vmcnt(10)
    buffer_load_dwordx4 v[144:147], v136, s[12:15], s49 offen sc1
    buffer_load_dwordx4 v[148:151], v136, s[12:15], s50 offen sc1
    buffer_load_dwordx4 v[152:155], v136, s[12:15], s51 offen sc1
    buffer_load_dwordx4 v[156:159], v136, s[12:15], s52 offen sc1
DN_CJ_41:
    s_lshl_b32 s95, s92, 12
    s_add_u32 s95, s95, 14725120
    buffer_load_dwordx4 v[12:15], v8, s[96:99], s95 offen sc1
    s_barrier
    s_waitcnt lgkmcnt(5)
    v_mfma_f32_32x32x16_bf16 v[52:67], a[40:43], v[28:31], v[52:67]
    ds_read_b128 v[20:23], v7 offset:16384
    s_waitcnt lgkmcnt(5)
    v_mfma_f32_32x32x16_bf16 v[68:83], a[44:47], v[32:35], v[68:83]
    ds_read_b128 v[24:27], v7 offset:17408
    s_waitcnt lgkmcnt(5)
    v_mfma_f32_32x32x16_bf16 v[52:67], a[48:51], v[36:39], v[52:67]
    ds_read_b128 v[28:31], v7 offset:18432
    s_waitcnt lgkmcnt(5)
    v_mfma_f32_32x32x16_bf16 v[68:83], a[52:55], v[40:43], v[68:83]
    ds_read_b128 v[32:35], v7 offset:19456
    s_waitcnt lgkmcnt(5)
    v_mfma_f32_32x32x16_bf16 v[52:67], a[56:59], v[44:47], v[52:67]
    ds_read_b128 v[36:39], v7 offset:20480
    s_waitcnt lgkmcnt(5)
    v_mfma_f32_32x32x16_bf16 v[68:83], a[60:63], v[48:51], v[68:83]
    ds_read_b128 v[40:43], v7 offset:21504
    s_waitcnt lgkmcnt(5)
    v_mfma_f32_32x32x16_bf16 v[52:67], a[64:67], v[20:23], v[52:67]
    ds_read_b128 v[44:47], v7 offset:22528
    s_waitcnt lgkmcnt(5)
    v_mfma_f32_32x32x16_bf16 v[68:83], a[68:71], v[24:27], v[68:83]
    ds_read_b128 v[48:51], v7 offset:23552
    s_waitcnt lgkmcnt(5)
    v_mfma_f32_32x32x16_bf16 v[52:67], a[72:75], v[28:31], v[52:67]
    ds_read_b128 v[20:23], v7 offset:24576
    s_waitcnt lgkmcnt(5)
    v_mfma_f32_32x32x16_bf16 v[68:83], a[76:79], v[32:35], v[68:83]
    ds_read_b128 v[24:27], v7 offset:25600
    s_waitcnt lgkmcnt(5)
    v_mfma_f32_32x32x16_bf16 v[52:67], a[80:83], v[36:39], v[52:67]
    ds_read_b128 v[28:31], v7 offset:26624
    s_waitcnt lgkmcnt(5)
    v_mfma_f32_32x32x16_bf16 v[68:83], a[84:87], v[40:43], v[68:83]
    ds_read_b128 v[32:35], v7 offset:27648
    s_waitcnt lgkmcnt(5)
    v_mfma_f32_32x32x16_bf16 v[52:67], a[88:91], v[44:47], v[52:67]
    ds_read_b128 v[36:39], v7 offset:28672
    s_waitcnt lgkmcnt(5)
    v_mfma_f32_32x32x16_bf16 v[68:83], a[92:95], v[48:51], v[68:83]
    ds_read_b128 v[40:43], v7 offset:29696
    s_waitcnt lgkmcnt(5)
    v_mfma_f32_32x32x16_bf16 v[52:67], a[96:99], v[20:23], v[52:67]
    ds_read_b128 v[44:47], v7 offset:30720
    s_waitcnt lgkmcnt(5)
    v_mfma_f32_32x32x16_bf16 v[68:83], a[100:103], v[24:27], v[68:83]
    ds_read_b128 v[48:51], v7 offset:31744
    s_sub_u32 s22, s94, 1
    s_cmp_lt_u32 s22, 2
    s_cbranch_scc1 DN_C2_46
    s_waitcnt vmcnt(4)
    s_branch DN_CJ_45
DN_C2_46:
DN_X_47:
    s_waitcnt vmcnt(0)
    v_max3_u32 v5, v144, v145, v146
    v_max3_u32 v5, v5, v147, v148
    v_max3_u32 v5, v5, v149, v150
    v_max3_u32 v5, v5, v151, v152
    v_max3_u32 v5, v5, v153, v154
    v_max3_u32 v5, v5, v155, v156
    v_max3_u32 v5, v5, v157, v158
    v_max_u32 v5, v5, v159
    v_cmp_eq_u32 vcc, -1, v5
    s_cbranch_vccz DN_X_47_D
    s_cmp_eq_u32 s93, 0
    s_cbranch_scc1 DN_X_47_D
    s_sub_u32 s93, s93, 1
    buffer_load_dwordx4 v[144:147], v136, s[12:15], s49 offen sc1
    buffer_load_dwordx4 v[148:151], v136, s[12:15], s50 offen sc1
    buffer_load_dwordx4 v[152:155], v136, s[12:15], s51 offen sc1
    buffer_load_dwordx4 v[156:159], v136, s[12:15], s52 offen sc1
    s_branch DN_X_47
DN_X_47_D:
    v_pk_add_f32 v[144:145], v[144:145], v[148:149]
    v_pk_add_f32 v[146:147], v[146:147], v[150:151]
    v_pk_add_f32 v[152:153], v[152:153], v[156:157]
    v_pk_add_f32 v[154:155], v[154:155], v[158:159]
    v_pk_add_f32 v[144:145], v[144:145], v[152:153]
    v_pk_add_f32 v[146:147], v[146:147], v[154:155]
    v_lshlrev_b32 v152, 16, v142
    v_and_b32 v153, 0xffff0000, v142
    v_cvt_pk_bf16_f32 v144, v144, v145
    v_cvt_pk_bf16_f32 v146, v146, v147
    v_lshlrev_b32 v154, 16, v143
    v_and_b32 v155, 0xffff0000, v143
    v_lshlrev_b32 v148, 16, v144
    v_and_b32 v149, 0xffff0000, v144
    v_lshlrev_b32 v150, 16, v146
    v_and_b32 v151, 0xffff0000, v146
    v_pk_add_f32 v[148:149], v[148:149], v[152:153]
    v_pk_add_f32 v[150:151], v[150:151], v[154:155]
    s_lshl_b32 s24, s92, 16
    s_sub_u32 s24, s24, 65536
    v_cvt_pk_bf16_f32 v144, v148, v149
    v_cvt_pk_bf16_f32 v145, v150, v151
    buffer_store_dwordx2 v[144:145], v140, s[36:39], s24 offen
    s_cmp_eq_u32 s87, 1
    s_cbranch_scc0 MS_48
    buffer_store_dwordx4 v[160:163], v136, s[12:15], s49 offen
    buffer_store_dwordx4 v[160:163], v136, s[12:15], s50 offen
    buffer_store_dwordx4 v[160:163], v136, s[12:15], s51 offen
    buffer_store_dwordx4 v[160:163], v136, s[12:15], s52 offen
    s_branch MS_49
MS_48:
    buffer_store_dwordx4 v[160:163], v136, s[12:15], s49 offen sc1
    buffer_store_dwordx4 v[160:163], v136, s[12:15], s50 offen sc1
    buffer_store_dwordx4 v[160:163], v136, s[12:15], s51 offen sc1
    buffer_store_dwordx4 v[160:163], v136, s[12:15], s52 offen sc1
MS_49:
DN_CJ_45:
    s_barrier
    s_waitcnt lgkmcnt(5)
    v_mfma_f32_32x32x16_bf16 v[52:67], a[104:107], v[28:31], v[52:67]
    ds_read_b128 v[20:23], v7 offset:32768
    s_waitcnt lgkmcnt(5)
    v_mfma_f32_32x32x16_bf16 v[68:83], a[108:111], v[32:35], v[68:83]
    ds_read_b128 v[24:27], v7 offset:33792
    s_waitcnt lgkmcnt(5)
    v_mfma_f32_32x32x16_bf16 v[52:67], a[112:115], v[36:39], v[52:67]
    ds_read_b128 v[28:31], v7 offset:34816
    s_waitcnt lgkmcnt(5)
    v_mfma_f32_32x32x16_bf16 v[68:83], a[116:119], v[40:43], v[68:83]
    ds_read_b128 v[32:35], v7 offset:35840
    s_waitcnt lgkmcnt(5)
    v_mfma_f32_32x32x16_bf16 v[52:67], a[120:123], v[44:47], v[52:67]
    ds_read_b128 v[36:39], v7 offset:36864
    s_waitcnt lgkmcnt(5)
    v_mfma_f32_32x32x16_bf16 v[68:83], a[124:127], v[48:51], v[68:83]
    ds_read_b128 v[40:43], v7 offset:37888
    s_waitcnt lgkmcnt(5)
    v_mfma_f32_32x32x16_bf16 v[52:67], a[128:131], v[20:23], v[52:67]
    ds_read_b128 v[44:47], v7 offset:38912
    s_waitcnt lgkmcnt(5)
    v_mfma_f32_32x32x16_bf16 v[68:83], a[132:135], v[24:27], v[68:83]
    ds_read_b128 v[48:51], v7 offset:39936
    s_waitcnt lgkmcnt(5)
    v_mfma_f32_32x32x16_bf16 v[52:67], a[136:139], v[28:31], v[52:67]
    ds_read_b128 v[20:23], v7 offset:40960
    s_waitcnt lgkmcnt(5)
    v_mfma_f32_32x32x16_bf16 v[68:83], a[140:143], v[32:35], v[68:83]
    ds_read_b128 v[24:27], v7 offset:41984
    s_waitcnt lgkmcnt(5)
    v_mfma_f32_32x32x16_bf16 v[52:67], a[144:147], v[36:39], v[52:67]
    ds_read_b128 v[28:31], v7 offset:43008
    s_waitcnt lgkmcnt(5)
    v_mfma_f32_32x32x16_bf16 v[68:83], a[148:151], v[40:43], v[68:83]
    ds_read_b128 v[32:35], v7 offset:44032
    s_sub_u32 s22, s94, 1
    s_cmp_lt_u32 s22, 2
    s_cselect_b32 s55, 1, 0
    s_cbranch_scc1 DN_CJ_50
    s_waitcnt vmcnt(0)
DN_CJ_50:
    v_min3_u32 v5, v12, v13, v14
    v_min_u32 v5, v5, v15
    v_cmp_eq_u32 vcc, 0, v5
    s_cmp_eq_u64 vcc, 0
    s_cselect_b32 s94, 1, 0
    s_cmp_ge_u32 s92, 63
    s_cselect_b32 s94, 0, s94
    s_barrier
    s_lshl_b32 s24, s92, 16
    buffer_load_dwordx2 v[142:143], v139, s[4:7], s24 offen
    s_cmp_eq_u32 s94, 0
    s_cbranch_scc1 DN_LB
    s_waitcnt lgkmcnt(5)
    v_mfma_f32_32x32x16_bf16 v[52:67], a[152:155], v[44:47], v[52:67]
    s_add_u32 s54, s92, 1
    s_mul_i32 s53, s54, 229376
    s_add_u32 s53, s53, s44
    s_and_b32 s54, s54, 1
    s_lshl_b32 s54, s54, 16
    s_add_u32 m0, s54, s45
    buffer_load_dword v18, v19, s[8:11], s53 offen
    s_nop 0
    buffer_load_dwordx4 v2, s[8:11], s53 offen lds
    s_add_u32 s53, s53, 4096
    s_add_u32 m0, m0, 4096
    ds_read_b128 v[36:39], v7 offset:45056
    s_waitcnt lgkmcnt(5)
    v_mfma_f32_32x32x16_bf16 v[68:83], a[156:159], v[48:51], v[68:83]
    s_nop 0
    buffer_load_dwordx4 v2, s[8:11], s53 offen lds
    s_add_u32 s53, s53, 4096
    s_add_u32 m0, m0, 4096
    ds_read_b128 v[40:43], v7 offset:46080
    s_waitcnt lgkmcnt(5)
    v_mfma_f32_32x32x16_bf16 v[52:67], a[160:163], v[20:23], v[52:67]
    s_nop 0
    buffer_load_dwordx4 v2, s[8:11], s53 offen lds
    s_add_u32 s53, s53, 4096
    s_add_u32 m0, m0, 4096
    ds_read_b128 v[44:47], v7 offset:47104
    s_waitcnt lgkmcnt(5)
    v_mfma_f32_32x32x16_bf16 v[68:83], a[164:167], v[24:27], v[68:83]
    s_nop 0
    buffer_load_dwordx4 v2, s[8:11], s53 offen lds
    s_add_u32 s53, s53, 4096
    s_add_u32 m0, m0, 4096
    ds_read_b128 v[48:51], v7 offset:48128
    s_waitcnt lgkmcnt(5)
    v_mfma_f32_32x32x16_bf16 v[52:67], a[168:171], v[28:31], v[52:67]
    s_nop 0
    buffer_load_dwordx4 v2, s[8:11], s53 offen lds
    s_add_u32 s53, s53, 4096
    s_add_u32 m0, m0, 4096
    ds_read_b128 v[20:23], v7 offset:49152
    s_waitcnt lgkmcnt(5)
    v_mfma_f32_32x32x16_bf16 v[68:83], a[172:175], v[32:35], v[68:83]
    s_nop 0
    buffer_load_dwordx4 v2, s[8:11], s53 offen lds
    s_add_u32 s53, s53, 4096
    s_add_u32 m0, m0, 4096
    ds_read_b128 v[24:27], v7 offset:50176
    s_waitcnt lgkmcnt(5)
    v_mfma_f32_32x32x16_bf16 v[52:67], a[176:179], v[36:39], v[52:67]
    s_nop 0
    buffer_load_dwordx4 v2, s[8:11], s53 offen lds
    s_add_u32 s53, s53, 4096
    s_add_u32 m0, m0, 4096
    ds_read_b128 v[28:31], v7 offset:51200
    s_waitcnt lgkmcnt(5)
    v_mfma_f32_32x32x16_bf16 v[68:83], a[180:183], v[40:43], v[68:83]
    s_nop 0
    buffer_load_dwordx4 v2, s[8:11], s53 offen lds
    ds_read_b128 v[32:35], v7 offset:52224
    s_waitcnt lgkmcnt(5)
    v_mfma_f32_32x32x16_bf16 v[52:67], a[184:187], v[44:47], v[52:67]
    ds_read_b128 v[36:39], v7 offset:53248
    s_waitcnt lgkmcnt(5)
    v_mfma_f32_32x32x16_bf16 v[68:83], a[188:191], v[48:51], v[68:83]
    ds_read_b128 v[40:43], v7 offset:54272
    s_waitcnt lgkmcnt(5)
    v_mfma_f32_32x32x16_bf16 v[52:67], a[192:195], v[20:23], v[52:67]
    ds_read_b128 v[44:47], v7 offset:55296
    s_waitcnt lgkmcnt(5)
    v_mfma_f32_32x32x16_bf16 v[68:83], a[196:199], v[24:27], v[68:83]
    ds_read_b128 v[48:51], v7 offset:56320
    s_waitcnt lgkmcnt(5)
    v_mfma_f32_32x32x16_bf16 v[52:67], a[200:203], v[28:31], v[52:67]
    s_waitcnt lgkmcnt(4)
    v_mfma_f32_32x32x16_bf16 v[68:83], a[204:207], v[32:35], v[68:83]
    s_waitcnt lgkmcnt(3)
    v_mfma_f32_32x32x16_bf16 v[52:67], a[208:211], v[36:39], v[52:67]
    s_waitcnt lgkmcnt(2)
    v_mfma_f32_32x32x16_bf16 v[68:83], a[212:215], v[40:43], v[68:83]
    s_waitcnt lgkmcnt(1)
    v_mfma_f32_32x32x16_bf16 v[52:67], a[216:219], v[44:47], v[52:67]
    s_waitcnt lgkmcnt(0)
    v_mfma_f32_32x32x16_bf16 v[68:83], a[220:223], v[48:51], v[68:83]
    s_branch DN_LJ
DN_LB:
    s_lshl_b32 s95, s92, 12
    s_add_u32 s95, s95, 14725120
    buffer_load_dwordx4 v[12:15], v8, s[96:99], s95 offen sc1
    s_waitcnt lgkmcnt(5)
    v_mfma_f32_32x32x16_bf16 v[52:67], a[152:155], v[44:47], v[52:67]
    ds_read_b128 v[36:39], v7 offset:45056
    s_waitcnt lgkmcnt(5)
    v_mfma_f32_32x32x16_bf16 v[68:83], a[156:159], v[48:51], v[68:83]
    ds_read_b128 v[40:43], v7 offset:46080
    s_waitcnt lgkmcnt(5)
    v_mfma_f32_32x32x16_bf16 v[52:67], a[160:163], v[20:23], v[52:67]
    ds_read_b128 v[44:47], v7 offset:47104
    s_waitcnt lgkmcnt(5)
    v_mfma_f32_32x32x16_bf16 v[68:83], a[164:167], v[24:27], v[68:83]
    ds_read_b128 v[48:51], v7 offset:48128
    s_waitcnt lgkmcnt(5)
    v_mfma_f32_32x32x16_bf16 v[52:67], a[168:171], v[28:31], v[52:67]
    ds_read_b128 v[20:23], v7 offset:49152
    s_waitcnt lgkmcnt(5)
    v_mfma_f32_32x32x16_bf16 v[68:83], a[172:175], v[32:35], v[68:83]
    ds_read_b128 v[24:27], v7 offset:50176
    s_waitcnt lgkmcnt(5)
    v_mfma_f32_32x32x16_bf16 v[52:67], a[176:179], v[36:39], v[52:67]
    ds_read_b128 v[28:31], v7 offset:51200
    s_waitcnt lgkmcnt(5)
    v_mfma_f32_32x32x16_bf16 v[68:83], a[180:183], v[40:43], v[68:83]
    ds_read_b128 v[32:35], v7 offset:52224
    s_waitcnt lgkmcnt(5)
    v_mfma_f32_32x32x16_bf16 v[52:67], a[184:187], v[44:47], v[52:67]
    ds_read_b128 v[36:39], v7 offset:53248
    s_waitcnt lgkmcnt(5)
    v_mfma_f32_32x32x16_bf16 v[68:83], a[188:191], v[48:51], v[68:83]
    ds_read_b128 v[40:43], v7 offset:54272
    s_waitcnt lgkmcnt(5)
    v_mfma_f32_32x32x16_bf16 v[52:67], a[192:195], v[20:23], v[52:67]
    ds_read_b128 v[44:47], v7 offset:55296
    s_waitcnt lgkmcnt(5)
    v_mfma_f32_32x32x16_bf16 v[68:83], a[196:199], v[24:27], v[68:83]
    ds_read_b128 v[48:51], v7 offset:56320
    s_waitcnt lgkmcnt(5)
    v_mfma_f32_32x32x16_bf16 v[52:67], a[200:203], v[28:31], v[52:67]
    s_waitcnt lgkmcnt(4)
    v_mfma_f32_32x32x16_bf16 v[68:83], a[204:207], v[32:35], v[68:83]
    s_waitcnt lgkmcnt(3)
    v_mfma_f32_32x32x16_bf16 v[52:67], a[208:211], v[36:39], v[52:67]
    s_waitcnt lgkmcnt(2)
    v_mfma_f32_32x32x16_bf16 v[68:83], a[212:215], v[40:43], v[68:83]
    s_waitcnt lgkmcnt(1)
    v_mfma_f32_32x32x16_bf16 v[52:67], a[216:219], v[44:47], v[52:67]
    s_waitcnt lgkmcnt(0)
    v_mfma_f32_32x32x16_bf16 v[68:83], a[220:223], v[48:51], v[68:83]
DN_LJ:
    s_and_b32 s48, s92, 1
    s_lshl_b32 s48, s48, 19
    s_add_u32 s24, s48, s46
    v_xor_b32 v7, 0x10000, v7
    s_nop 7
    s_nop 4
    v_pk_add_f32 v[52:53], v[52:53], v[68:69]
    v_pk_add_f32 v[54:55], v[54:55], v[70:71]
    v_pk_add_f32 v[56:57], v[56:57], v[72:73]
    v_pk_add_f32 v[58:59], v[58:59], v[74:75]
    v_pk_add_f32 v[60:61], v[60:61], v[76:77]
    v_pk_add_f32 v[62:63], v[62:63], v[78:79]
    v_pk_add_f32 v[64:65], v[64:65], v[80:81]
    v_pk_add_f32 v[66:67], v[66:67], v[82:83]
    s_cmp_eq_u32 s87, 1
    s_cbranch_scc0 MS_51
    buffer_store_dwordx4 v[52:55], v2, s[12:15], s24 offen offset:0
    buffer_store_dwordx4 v[56:59], v2, s[12:15], s24 offen offset:1024
    buffer_store_dwordx4 v[60:63], v2, s[12:15], s24 offen offset:2048
    buffer_store_dwordx4 v[64:67], v2, s[12:15], s24 offen offset:3072
    s_branch MS_52
MS_51:
    buffer_store_dwordx4 v[52:55], v2, s[12:15], s24 offen offset:0 sc1
    buffer_store_dwordx4 v[56:59], v2, s[12:15], s24 offen offset:1024 sc1
    buffer_store_dwordx4 v[60:63], v2, s[12:15], s24 offen offset:2048 sc1
    buffer_store_dwordx4 v[64:67], v2, s[12:15], s24 offen offset:3072 sc1
MS_52:
    s_add_u32 s49, s48, s47
    s_add_u32 s50, s49, 4096
    s_add_u32 s51, s49, 8192
    s_add_u32 s52, s49, 12288
    s_cmp_lg_u32 s94, 0
    s_cbranch_scc1 DN_FIN
    s_waitcnt vmcnt(4)
    v_min3_u32 v5, v12, v13, v14
    v_min_u32 v5, v5, v15
    v_cmp_eq_u32 vcc, 0, v5
    s_cmp_eq_u64 vcc, 0
    s_cselect_b32 s94, 2, 0
    s_cmp_ge_u32 s92, 63
    s_cselect_b32 s94, 0, s94
    s_cmp_lg_u32 s94, 0
    s_cbranch_scc1 DN_LATE
    s_lshl_b32 s95, s92, 12
    s_add_u32 s95, s95, 14725120
DN_XL:
    buffer_load_dwordx4 v[144:147], v136, s[12:15], s49 offen sc1
    buffer_load_dwordx4 v[148:151], v136, s[12:15], s50 offen sc1
    buffer_load_dwordx4 v[152:155], v136, s[12:15], s51 offen sc1
    buffer_load_dwordx4 v[156:159], v136, s[12:15], s52 offen sc1
    buffer_load_dwordx4 v[12:15], v8, s[96:99], s95 offen sc1
    s_waitcnt vmcnt(0)
    v_max3_u32 v5, v144, v145, v146
    v_max3_u32 v5, v5, v147, v148
    v_max3_u32 v5, v5, v149, v150
    v_max3_u32 v5, v5, v151, v152
    v_max3_u32 v5, v5, v153, v154
    v_max3_u32 v5, v5, v155, v156
    v_max3_u32 v5, v5, v157, v158
    v_max_u32 v5, v5, v159
    v_cmp_eq_u32 vcc, -1, v5
    s_cbranch_vccz DN_XOK
    v_min3_u32 v5, v12, v13, v14
    v_min_u32 v5, v5, v15
    v_cmp_eq_u32 vcc, 0, v5
    s_cmp_eq_u64 vcc, 0
    s_cselect_b32 s94, 2, 0
    s_cmp_ge_u32 s92, 63
    s_cselect_b32 s94, 0, s94
    s_cmp_lg_u32 s94, 0
    s_cbranch_scc1 DN_LATE
    s_cmp_eq_u32 s93, 0
    s_cbranch_scc1 DN_XOK
    s_sub_u32 s93, s93, 1
    s_branch DN_XL
DN_LATE:
    s_add_u32 s23, s92, 1
    s_mul_i32 s22, s23, 229376
    s_add_u32 s22, s22, s44
    s_and_b32 s23, s23, 1
    s_lshl_b32 s23, s23, 16
    s_add_u32 m0, s23, s45
    buffer_load_dword v18, v19, s[8:11], s22 offen
    s_nop 0
    buffer_load_dwordx4 v2, s[8:11], s22 offen lds
    s_add_u32 s22, s22, 4096
    s_add_u32 m0, m0, 4096
    s_nop 0
    buffer_load_dwordx4 v2, s[8:11], s22 offen lds
    s_add_u32 s22, s22, 4096
    s_add_u32 m0, m0, 4096
    s_nop 0
    buffer_load_dwordx4 v2, s[8:11], s22 offen lds
    s_add_u32 s22, s22, 4096
    s_add_u32 m0, m0, 4096
    s_nop 0
    buffer_load_dwordx4 v2, s[8:11], s22 offen lds
    s_add_u32 s22, s22, 4096
    s_add_u32 m0, m0, 4096
    s_nop 0
    buffer_load_dwordx4 v2, s[8:11], s22 offen lds
    s_add_u32 s22, s22, 4096
    s_add_u32 m0, m0, 4096
    s_nop 0
    buffer_load_dwordx4 v2, s[8:11], s22 offen lds
    s_add_u32 s22, s22, 4096
    s_add_u32 m0, m0, 4096
    s_nop 0
    buffer_load_dwordx4 v2, s[8:11], s22 offen lds
    s_add_u32 s22, s22, 4096
    s_add_u32 m0, m0, 4096
    s_nop 0
    buffer_load_dwordx4 v2, s[8:11], s22 offen lds
    s_branch DN_FIN
DN_XOK:
    v_pk_add_f32 v[144:145], v[144:145], v[148:149]
    v_pk_add_f32 v[146:147], v[146:147], v[150:151]
    v_pk_add_f32 v[152:153], v[152:153], v[156:157]
    v_pk_add_f32 v[154:155], v[154:155], v[158:159]
    v_pk_add_f32 v[144:145], v[144:145], v[152:153]
    v_pk_add_f32 v[146:147], v[146:147], v[154:155]
    v_lshlrev_b32 v152, 16, v142
    v_and_b32 v153, 0xffff0000, v142
    v_cvt_pk_bf16_f32 v144, v144, v145
    v_cvt_pk_bf16_f32 v146, v146, v147
    v_lshlrev_b32 v154, 16, v143
    v_and_b32 v155, 0xffff0000, v143
    v_lshlrev_b32 v148, 16, v144
    v_and_b32 v149, 0xffff0000, v144
    v_lshlrev_b32 v150, 16, v146
    v_and_b32 v151, 0xffff0000, v146
    v_pk_add_f32 v[148:149], v[148:149], v[152:153]
    v_pk_add_f32 v[150:151], v[150:151], v[154:155]
    s_lshl_b32 s24, s92, 16
    v_cvt_pk_bf16_f32 v144, v148, v149
    v_cvt_pk_bf16_f32 v145, v150, v151
    buffer_store_dwordx2 v[144:145], v140, s[36:39], s24 offen
    s_cmp_eq_u32 s87, 1
    s_cbranch_scc0 MS_53
    buffer_store_dwordx4 v[160:163], v136, s[12:15], s49 offen
    buffer_store_dwordx4 v[160:163], v136, s[12:15], s50 offen
    buffer_store_dwordx4 v[160:163], v136, s[12:15], s51 offen
    buffer_store_dwordx4 v[160:163], v136, s[12:15], s52 offen
    s_branch MS_54
MS_53:
    buffer_store_dwordx4 v[160:163], v136, s[12:15], s49 offen sc1
    buffer_store_dwordx4 v[160:163], v136, s[12:15], s50 offen sc1
    buffer_store_dwordx4 v[160:163], v136, s[12:15], s51 offen sc1
    buffer_store_dwordx4 v[160:163], v136, s[12:15], s52 offen sc1
MS_54:
DN_FIN:
    s_add_u32 s92, s92, 1
    s_cmp_lt_u32 s92, 64
    s_cbranch_scc1 DN_TOP
    s_endpgm
MG_AT:
    s_lshl_b32 s28, s46, 1
    s_add_u32 s28, s28, s47
    s_sub_u32 s28, s28, 14
    s_load_dwordx2 s[34:35], s[0:1], 104
    v_and_b32 v1, 63, v0
    s_lshl_b32 s22, s28, 2
    s_add_u32 s40, s22, s19
    v_lshlrev_b32 v2, 4, v1
    v_lshrrev_b32 v4, 5, v1
    v_and_b32 v3, 7, v1
    v_lshlrev_b32 v3, 4, v3
    v_lshl_add_u32 v3, v4, 7, v3
    v_and_b32 v5, 31, v1
    v_lshlrev_b32 v6, 3, v5
    v_lshl_add_u32 v6, v4, 8, v6
    v_lshlrev_b32 v7, 2, v4
    v_sub_u32 v7, v5, v7
    s_lshl_b32 s22, s40, 2
    v_mov_b32 v8, s22
    v_mov_b32 v9, 1
    s_lshr_b32 s22, s40, 1
    s_lshl_b32 s22, s22, 7
    v_mov_b32 v10, s22
    s_waitcnt lgkmcnt(0)
    s_add_u32 s4, s34, 0x6000000
    s_addc_u32 s5, s35, 0
    s_and_b32 s5, s5, 0xffff
    s_mov_b32 s6, 0x1000000
    s_mov_b32 s7, 0x00020000
    s_add_u32 s8, s34, 0x400000
    s_addc_u32 s9, s35, 0
    s_and_b32 s9, s9, 0xffff
    s_mov_b32 s10, 0x1000000
    s_mov_b32 s11, 0x00020000
    s_add_u32 s12, s34, 0x1400000
    s_addc_u32 s13, s35, 0
    s_and_b32 s13, s13, 0xffff
    s_mov_b32 s14, 0x1000000
    s_mov_b32 s15, 0x00020000
    s_add_u32 s36, s34, 0x2400000
    s_addc_u32 s37, s35, 0
    s_and_b32 s37, s37, 0xffff
    s_mov_b32 s38, 0x1000000
    s_mov_b32 s39, 0x00020000
    v_cmp_le_i32 s[52:53], 0, v7
    v_cmp_le_i32 s[54:55], 1, v7
    v_cmp_le_i32 s[56:57], 2, v7
    v_cmp_le_i32 s[58:59], 3, v7
    v_cmp_le_i32 s[60:61], 8, v7
    v_cmp_le_i32 s[62:63], 9, v7
    v_cmp_le_i32 s[64:65], 10, v7
    v_cmp_le_i32 s[66:67], 11, v7
    v_cmp_le_i32 s[68:69], 16, v7
    v_cmp_le_i32 s[70:71], 17, v7
    v_cmp_le_i32 s[72:73], 18, v7
    v_cmp_le_i32 s[74:75], 19, v7
    v_cmp_le_i32 s[76:77], 24, v7
    v_cmp_le_i32 s[78:79], 25, v7
    v_cmp_le_i32 s[80:81], 26, v7
    v_cmp_le_i32 s[82:83], 27, v7
    v_mov_b32 v146, 0
    v_mov_b32 v147, 0
    v_mov_b32 v150, 0
    v_mov_b32 v151, 0
    v_mov_b32 v154, 0
    v_mov_b32 v155, 0
    v_mov_b32 v158, 0
    v_mov_b32 v159, 0
    v_mov_b32 v202, 0
    v_mov_b32 v203, 0
    s_mov_b32 s92, 0
    s_add_u32 s22, s92, 0
    s_and_b32 s23, s22, 3
    s_cmp_lg_u32 s23, 0
    s_cbranch_scc1 AT_NB_55
    s_lshr_b32 s22, s22, 2
    s_lshl_b32 s22, s22, 11
    s_add_u32 s95, s22, 14688256
AT_KF_56:
    buffer_load_dwordx4 v[208:211], v10, s[96:99], s95 offen sc1
    s_waitcnt vmcnt(0)
    v_and_b32 v208, v208, v209
    v_and_b32 v208, v208, v210
    v_cmp_ne_u32 vcc, 0x1010101, v208
    s_cbranch_vccz AT_KF_56_D
    s_cmp_eq_u32 s93, 0
    s_cbranch_scc1 AT_KF_56_D
    s_sub_u32 s93, s93, 1
    s_branch AT_KF_56
AT_KF_56_D:
AT_NB_55:
    s_add_u32 s22, s92, 0
    s_lshl_b32 s22, s22, 5
    s_add_u32 s22, s22, s40
    s_lshl_b32 s41, s22, 13
    s_add_u32 s42, s41, 0x1000
    buffer_load_dwordx4 v[48:51], v2, s[8:11], s41 offen offset:0
    buffer_load_dwordx4 v[16:19], v2, s[4:7], s41 offen offset:0
    buffer_load_dwordx4 v[52:55], v2, s[8:11], s41 offen offset:1024
    buffer_load_dwordx4 v[20:23], v2, s[4:7], s41 offen offset:1024
    buffer_load_dwordx4 v[56:59], v2, s[8:11], s41 offen offset:2048
    buffer_load_dwordx4 v[24:27], v2, s[4:7], s41 offen offset:2048
    buffer_load_dwordx4 v[60:63], v2, s[8:11], s41 offen offset:3072
    buffer_load_dwordx4 v[28:31], v2, s[4:7], s41 offen offset:3072
    buffer_load_dwordx4 v[64:67], v2, s[8:11], s42 offen offset:0
    buffer_load_dwordx4 v[32:35], v2, s[4:7], s42 offen offset:0
    buffer_load_dwordx4 v[68:71], v2, s[8:11], s42 offen offset:1024
    buffer_load_dwordx4 v[36:39], v2, s[4:7], s42 offen offset:1024
    buffer_load_dwordx4 v[72:75], v2, s[8:11], s42 offen offset:2048
    buffer_load_dwordx4 v[40:43], v2, s[4:7], s42 offen offset:2048
    buffer_load_dwordx4 v[76:79], v2, s[8:11], s42 offen offset:3072
    buffer_load_dwordx4 v[44:47], v2, s[4:7], s42 offen offset:3072
    buffer_load_dwordx4 v[112:115], v2, s[12:15], s41 offen offset:0
    buffer_load_dwordx4 v[116:119], v2, s[12:15], s41 offen offset:1024
    buffer_load_dwordx4 v[120:123], v2, s[12:15], s41 offen offset:2048
    buffer_load_dwordx4 v[124:127], v2, s[12:15], s41 offen offset:3072
    buffer_load_dwordx4 v[128:131], v2, s[12:15], s42 offen offset:0
    buffer_load_dwordx4 v[132:135], v2, s[12:15], s42 offen offset:1024
    buffer_load_dwordx4 v[136:139], v2, s[12:15], s42 offen offset:2048
    buffer_load_dwordx4 v[140:143], v2, s[12:15], s42 offen offset:3072
AT_TOP:
    s_waitcnt vmcnt(22)
    v_mfma_f32_32x32x16_bf16 v[160:175], v[48:51], v[16:19], 0
    s_waitcnt vmcnt(20)
    v_mfma_f32_32x32x16_bf16 v[160:175], v[52:55], v[20:23], v[160:175]
    s_waitcnt vmcnt(18)
    v_mfma_f32_32x32x16_bf16 v[160:175], v[56:59], v[24:27], v[160:175]
    s_waitcnt vmcnt(16)
    v_mfma_f32_32x32x16_bf16 v[160:175], v[60:63], v[28:31], v[160:175]
    s_waitcnt vmcnt(14)
    v_mfma_f32_32x32x16_bf16 v[160:175], v[64:67], v[32:35], v[160:175]
    s_waitcnt vmcnt(12)
    v_mfma_f32_32x32x16_bf16 v[160:175], v[68:71], v[36:39], v[160:175]
    s_waitcnt vmcnt(10)
    v_mfma_f32_32x32x16_bf16 v[160:175], v[72:75], v[40:43], v[160:175]
    s_waitcnt vmcnt(8)
    v_mfma_f32_32x32x16_bf16 v[160:175], v[76:79], v[44:47], v[160:175]
    s_lshl_b32 s22, s92, 5
    s_add_u32 s22, s22, s40
    s_lshl_b32 s43, s22, 12
    s_add_u32 s43, s43, 2048
    s_lshl_b32 s44, s22, 11
    s_add_u32 s44, s44, 8388608
    buffer_load_dwordx4 v[80:83], v3, s[96:99], s43 offen offset:0 sc1
    buffer_load_dwordx4 v[84:87], v3, s[96:99], s43 offen offset:256 sc1
    buffer_load_dwordx4 v[88:91], v3, s[96:99], s43 offen offset:512 sc1
    buffer_load_dwordx4 v[92:95], v3, s[96:99], s43 offen offset:768 sc1
    buffer_load_dwordx4 v[96:99], v3, s[96:99], s43 offen offset:1024 sc1
    buffer_load_dwordx4 v[100:103], v3, s[96:99], s43 offen offset:1280 sc1
    buffer_load_dwordx4 v[104:107], v3, s[96:99], s43 offen offset:1536 sc1
    buffer_load_dwordx4 v[108:111], v3, s[96:99], s43 offen offset:1792 sc1
    buffer_load_dwordx2 v[144:145], v6, s[96:99], s44 offen offset:0 sc1
    buffer_load_dwordx2 v[148:149], v6, s[96:99], s44 offen offset:512 sc1
    buffer_load_dwordx2 v[152:153], v6, s[96:99], s44 offen offset:1024 sc1
    buffer_load_dwordx2 v[156:157], v6, s[96:99], s44 offen offset:1536 sc1
    s_nop 7
    v_cvt_pk_bf16_f32 v208, v160, v161
    v_cvt_pk_bf16_f32 v209, v162, v163
    v_cvt_pk_bf16_f32 v210, v164, v165
    v_cvt_pk_bf16_f32 v211, v166, v167
    v_cvt_pk_bf16_f32 v212, v168, v169
    v_cvt_pk_bf16_f32 v213, v170, v171
    v_cvt_pk_bf16_f32 v214, v172, v173
    v_cvt_pk_bf16_f32 v215, v174, v175
    v_lshlrev_b32 v160, 16, v208
    v_and_b32 v161, 0xffff0000, v208
    v_lshlrev_b32 v162, 16, v209
    v_and_b32 v163, 0xffff0000, v209
    v_lshlrev_b32 v164, 16, v210
    v_and_b32 v165, 0xffff0000, v210
    v_lshlrev_b32 v166, 16, v211
    v_and_b32 v167, 0xffff0000, v211
    v_lshlrev_b32 v168, 16, v212
    v_and_b32 v169, 0xffff0000, v212
    v_lshlrev_b32 v170, 16, v213
    v_and_b32 v171, 0xffff0000, v213
    v_lshlrev_b32 v172, 16, v214
    v_and_b32 v173, 0xffff0000, v214
    v_lshlrev_b32 v174, 16, v215
    v_and_b32 v175, 0xffff0000, v215
    v_mul_f32 v160, 0x3db504f3, v160
    v_mul_f32 v161, 0x3db504f3, v161
    v_mul_f32 v162, 0x3db504f3, v162
    v_mul_f32 v163, 0x3db504f3, v163
    v_mul_f32 v164, 0x3db504f3, v164
    v_mul_f32 v165, 0x3db504f3, v165
    v_mul_f32 v166, 0x3db504f3, v166
    v_mul_f32 v167, 0x3db504f3, v167
    v_mul_f32 v168, 0x3db504f3, v168
    v_mul_f32 v169, 0x3db504f3, v169
    v_mul_f32 v170, 0x3db504f3, v170
    v_mul_f32 v171, 0x3db504f3, v171
    v_mul_f32 v172, 0x3db504f3, v172
    v_mul_f32 v173, 0x3db504f3, v173
    v_mul_f32 v174, 0x3db504f3, v174
    v_mul_f32 v175, 0x3db504f3, v175
    v_cvt_pk_bf16_f32 v208, v160, v161
    v_cvt_pk_bf16_f32 v209, v162, v163
    v_cvt_pk_bf16_f32 v210, v164, v165
    v_cvt_pk_bf16_f32 v211, v166, v167
    v_cvt_pk_bf16_f32 v212, v168, v169
    v_cvt_pk_bf16_f32 v213, v170, v171
    v_cvt_pk_bf16_f32 v214, v172, v173
    v_cvt_pk_bf16_f32 v215, v174, v175
    v_lshlrev_b32 v160, 16, v208
    v_and_b32 v161, 0xffff0000, v208
    v_lshlrev_b32 v162, 16, v209
    v_and_b32 v163, 0xffff0000, v209
    v_lshlrev_b32 v164, 16, v210
    v_and_b32 v165, 0xffff0000, v210
    v_lshlrev_b32 v166, 16, v211
    v_and_b32 v167, 0xffff0000, v211
    v_lshlrev_b32 v168, 16, v212
    v_and_b32 v169, 0xffff0000, v212
    v_lshlrev_b32 v170, 16, v213
    v_and_b32 v171, 0xffff0000, v213
    v_lshlrev_b32 v172, 16, v214
    v_and_b32 v173, 0xffff0000, v214
    v_lshlrev_b32 v174, 16, v215
    v_and_b32 v175, 0xffff0000, v215
    v_mov_b32 v218, 0xce6e6b28
    v_cndmask_b32 v160, v218, v160, s[52:53]
    v_cndmask_b32 v161, v218, v161, s[54:55]
    v_cndmask_b32 v162, v218, v162, s[56:57]
    v_cndmask_b32 v163, v218, v163, s[58:59]
    v_cndmask_b32 v164, v218, v164, s[60:61]
    v_cndmask_b32 v165, v218, v165, s[62:63]
    v_cndmask_b32 v166, v218, v166, s[64:65]
    v_cndmask_b32 v167, v218, v167, s[66:67]
    v_cndmask_b32 v168, v218, v168, s[68:69]
    v_cndmask_b32 v169, v218, v169, s[70:71]
    v_cndmask_b32 v170, v218, v170, s[72:73]
    v_cndmask_b32 v171, v218, v171, s[74:75]
    v_cndmask_b32 v172, v218, v172, s[76:77]
    v_cndmask_b32 v173, v218, v173, s[78:79]
    v_cndmask_b32 v174, v218, v174, s[80:81]
    v_cndmask_b32 v175, v218, v175, s[82:83]
    v_max3_f32 v219, v160, v161, v162
    v_max3_f32 v220, v163, v164, v165
    v_max3_f32 v219, v219, v166, v167
    v_max3_f32 v220, v220, v168, v169
    v_max3_f32 v219, v219, v170, v171
    v_max3_f32 v220, v220, v172, v173
    v_max3_f32 v219, v219, v174, v175
    v_max_f32 v219, v219, v220
    s_waitcnt vmcnt(0)
    v_max3_u32 v208, v80, v81, v82
    v_max3_u32 v208, v208, v83, v84
    v_max3_u32 v208, v208, v85, v86
    v_max3_u32 v208, v208, v87, v88
    v_max3_u32 v208, v208, v89, v90
    v_max3_u32 v208, v208, v91, v92
    v_max3_u32 v208, v208, v93, v94
    v_max3_u32 v208, v208, v95, v96
    v_max3_u32 v208, v208, v97, v98
    v_max3_u32 v208, v208, v99, v100
    v_max3_u32 v208, v208, v101, v102
    v_max3_u32 v208, v208, v103, v104
    v_max3_u32 v208, v208, v105, v106
    v_max3_u32 v208, v208, v107, v108
    v_max3_u32 v208, v208, v109, v110
    v_max3_u32 v208, v208, v111, v144
    v_max3_u32 v208, v208, v145, v148
    v_max3_u32 v208, v208, v149, v152
    v_max3_u32 v208, v208, v153, v156
    v_max_u32 v208, v208, v157
    v_cmp_eq_u32 vcc, -1, v208
    s_cbranch_vccz AT_GO
AT_PL:
    buffer_load_dwordx4 v[80:83], v3, s[96:99], s43 offen offset:0 sc1
    buffer_load_dwordx4 v[84:87], v3, s[96:99], s43 offen offset:256 sc1
    buffer_load_dwordx4 v[88:91], v3, s[96:99], s43 offen offset:512 sc1
    buffer_load_dwordx4 v[92:95], v3, s[96:99], s43 offen offset:768 sc1
    buffer_load_dwordx4 v[96:99], v3, s[96:99], s43 offen offset:1024 sc1
    buffer_load_dwordx4 v[100:103], v3, s[96:99], s43 offen offset:1280 sc1
    buffer_load_dwordx4 v[104:107], v3, s[96:99], s43 offen offset:1536 sc1
    buffer_load_dwordx4 v[108:111], v3, s[96:99], s43 offen offset:1792 sc1
    buffer_load_dwordx2 v[144:145], v6, s[96:99], s44 offen offset:0 sc1
    buffer_load_dwordx2 v[148:149], v6, s[96:99], s44 offen offset:512 sc1
    buffer_load_dwordx2 v[152:153], v6, s[96:99], s44 offen offset:1024 sc1
    buffer_load_dwordx2 v[156:157], v6, s[96:99], s44 offen offset:1536 sc1
    s_waitcnt vmcnt(0)
    v_max3_u32 v208, v80, v81, v82
    v_max3_u32 v208, v208, v83, v84
    v_max3_u32 v208, v208, v85, v86
    v_max3_u32 v208, v208, v87, v88
    v_max3_u32 v208, v208, v89, v90
    v_max3_u32 v208, v208, v91, v92
    v_max3_u32 v208, v208, v93, v94
    v_max3_u32 v208, v208, v95, v96
    v_max3_u32 v208, v208, v97, v98
    v_max3_u32 v208, v208, v99, v100
    v_max3_u32 v208, v208, v101, v102
    v_max3_u32 v208, v208, v103, v104
    v_max3_u32 v208, v208, v105, v106
    v_max3_u32 v208, v208, v107, v108
    v_max3_u32 v208, v208, v109, v110
    v_max3_u32 v208, v208, v111, v144
    v_max3_u32 v208, v208, v145, v148
    v_max3_u32 v208, v208, v149, v152
    v_max3_u32 v208, v208, v153, v156
    v_max_u32 v208, v208, v157
    v_cmp_eq_u32 vcc, -1, v208
    s_cbranch_vccz AT_GO
    s_cmp_eq_u32 s93, 0
    s_cbranch_scc1 AT_GO
    s_sub_u32 s93, s93, 1
    s_branch AT_PL
AT_GO:
    v_mfma_f32_32x32x16_bf16 v[176:191], v[80:83], v[16:19], 0
    v_mfma_f32_32x32x16_bf16 v[176:191], v[84:87], v[20:23], v[176:191]
    v_mfma_f32_32x32x16_bf16 v[176:191], v[88:91], v[24:27], v[176:191]
    v_mfma_f32_32x32x16_bf16 v[176:191], v[92:95], v[28:31], v[176:191]
    v_mfma_f32_32x32x16_bf16 v[176:191], v[96:99], v[32:35], v[176:191]
    v_mfma_f32_32x32x16_bf16 v[176:191], v[100:103], v[36:39], v[176:191]
    v_mfma_f32_32x32x16_bf16 v[176:191], v[104:107], v[40:43], v[176:191]
    v_mfma_f32_32x32x16_bf16 v[176:191], v[108:111], v[44:47], v[176:191]
    s_nop 7
    s_nop 7
    v_cvt_pk_bf16_f32 v208, v176, v177
    v_cvt_pk_bf16_f32 v209, v178, v179
    v_lshlrev_b32 v176, 16, v208
    v_and_b32 v177, 0xffff0000, v208
    v_lshlrev_b32 v178, 16, v209
    v_and_b32 v179, 0xffff0000, v209
    v_mul_f32 v176, 0x3db504f3, v176
    v_mul_f32 v177, 0x3db504f3, v177
    v_mul_f32 v178, 0x3db504f3, v178
    v_mul_f32 v179, 0x3db504f3, v179
    v_cvt_pk_bf16_f32 v208, v176, v177
    v_cvt_pk_bf16_f32 v209, v178, v179
    v_lshlrev_b32 v176, 16, v208
    v_and_b32 v177, 0xffff0000, v208
    v_lshlrev_b32 v178, 16, v209
    v_and_b32 v179, 0xffff0000, v209
    v_max3_f32 v219, v219, v176, v177
    v_max3_f32 v219, v219, v178, v179
    v_mov_b32 v220, v219
    s_nop 1
    v_permlane32_swap_b32 v219, v220
    s_nop 1
    v_max_f32 v219, v219, v220
    v_sub_f32 v160, v160, v219
    v_sub_f32 v161, v161, v219
    v_sub_f32 v162, v162, v219
    v_sub_f32 v163, v163, v219
    v_sub_f32 v164, v164, v219
    v_sub_f32 v165, v165, v219
    v_sub_f32 v166, v166, v219
    v_sub_f32 v167, v167, v219
    v_sub_f32 v168, v168, v219
    v_sub_f32 v169, v169, v219
    v_sub_f32 v170, v170, v219
    v_sub_f32 v171, v171, v219
    v_sub_f32 v172, v172, v219
    v_sub_f32 v173, v173, v219
    v_sub_f32 v174, v174, v219
    v_sub_f32 v175, v175, v219
    v_sub_f32 v176, v176, v219
    v_sub_f32 v177, v177, v219
    v_sub_f32 v178, v178, v219
    v_sub_f32 v179, v179, v219
    v_mul_f32 v160, 0x3fb8aa3b, v160
    v_mul_f32 v161, 0x3fb8aa3b, v161
    v_mul_f32 v162, 0x3fb8aa3b, v162
    v_mul_f32 v163, 0x3fb8aa3b, v163
    v_mul_f32 v164, 0x3fb8aa3b, v164
    v_mul_f32 v165, 0x3fb8aa3b, v165
    v_mul_f32 v166, 0x3fb8aa3b, v166
    v_mul_f32 v167, 0x3fb8aa3b, v167
    v_mul_f32 v168, 0x3fb8aa3b, v168
    v_mul_f32 v169, 0x3fb8aa3b, v169
    v_mul_f32 v170, 0x3fb8aa3b, v170
    v_mul_f32 v171, 0x3fb8aa3b, v171
    v_mul_f32 v172, 0x3fb8aa3b, v172
    v_mul_f32 v173, 0x3fb8aa3b, v173
    v_mul_f32 v174, 0x3fb8aa3b, v174
    v_mul_f32 v175, 0x3fb8aa3b, v175
    v_mul_f32 v176, 0x3fb8aa3b, v176
    v_mul_f32 v177, 0x3fb8aa3b, v177
    v_mul_f32 v178, 0x3fb8aa3b, v178
    v_mul_f32 v179, 0x3fb8aa3b, v179
    v_exp_f32 v160, v160
    v_exp_f32 v161, v161
    v_exp_f32 v162, v162
    v_exp_f32 v163, v163
    v_exp_f32 v164, v164
    v_exp_f32 v165, v165
    v_exp_f32 v166, v166
    v_exp_f32 v167, v167
    v_exp_f32 v168, v168
    v_exp_f32 v169, v169
    v_exp_f32 v170, v170
    v_exp_f32 v171, v171
    v_exp_f32 v172, v172
    v_exp_f32 v173, v173
    v_exp_f32 v174, v174
    v_exp_f32 v175, v175
    v_exp_f32 v176, v176
    v_exp_f32 v177, v177
    v_exp_f32 v178, v178
    v_exp_f32 v179, v179
    v_add_f32 v219, v160, v161
    v_add_f32 v220, v162, v163
    v_add_f32 v219, v219, v164
    v_add_f32 v220, v220, v165
    v_add_f32 v219, v219, v166
    v_add_f32 v220, v220, v167
    v_add_f32 v219, v219, v168
    v_add_f32 v220, v220, v169
    v_add_f32 v219, v219, v170
    v_add_f32 v220, v220, v171
    v_add_f32 v219, v219, v172
    v_add_f32 v220, v220, v173
    v_add_f32 v219, v219, v174
    v_add_f32 v220, v220, v175
    v_add_f32 v219, v219, v176
    v_add_f32 v220, v220, v177
    v_add_f32 v219, v219, v178
    v_add_f32 v220, v220, v179
    v_add_f32 v219, v219, v220
    v_mov_b32 v220, v219
    s_nop 1
    v_permlane32_swap_b32 v219, v220
    s_nop 1
    v_add_f32 v219, v219, v220
    v_rcp_f32 v219, v219
    s_nop 0
    v_mul_f32 v160, v160, v219
    v_mul_f32 v161, v161, v219
    v_mul_f32 v162, v162, v219
    v_mul_f32 v163, v163, v219
    v_mul_f32 v164, v164, v219
    v_mul_f32 v165, v165, v219
    v_mul_f32 v166, v166, v219
    v_mul_f32 v167, v167, v219
    v_mul_f32 v168, v168, v219
    v_mul_f32 v169, v169, v219
    v_mul_f32 v170, v170, v219
    v_mul_f32 v171, v171, v219
    v_mul_f32 v172, v172, v219
    v_mul_f32 v173, v173, v219
    v_mul_f32 v174, v174, v219
    v_mul_f32 v175, v175, v219
    v_mul_f32 v176, v176, v219
    v_mul_f32 v177, v177, v219
    v_mul_f32 v178, v178, v219
    v_mul_f32 v179, v179, v219
    v_cvt_pk_bf16_f32 v192, v160, v161
    v_cvt_pk_bf16_f32 v193, v162, v163
    v_cvt_pk_bf16_f32 v194, v164, v165
    v_cvt_pk_bf16_f32 v195, v166, v167
    v_cvt_pk_bf16_f32 v196, v168, v169
    v_cvt_pk_bf16_f32 v197, v170, v171
    v_cvt_pk_bf16_f32 v198, v172, v173
    v_cvt_pk_bf16_f32 v199, v174, v175
    v_cvt_pk_bf16_f32 v200, v176, v177
    v_cvt_pk_bf16_f32 v201, v178, v179
    s_nop 1
    v_mfma_f32_32x32x16_bf16 v[16:31], v[112:115], v[192:195], 0
    v_mfma_f32_32x32x16_bf16 v[32:47], v[120:123], v[192:195], 0
    v_mfma_f32_32x32x16_bf16 v[48:63], v[128:131], v[192:195], 0
    v_mfma_f32_32x32x16_bf16 v[64:79], v[136:139], v[192:195], 0
    v_mfma_f32_32x32x16_bf16 v[16:31], v[116:119], v[196:199], v[16:31]
    v_mfma_f32_32x32x16_bf16 v[32:47], v[124:127], v[196:199], v[32:47]
    v_mfma_f32_32x32x16_bf16 v[48:63], v[132:135], v[196:199], v[48:63]
    v_mfma_f32_32x32x16_bf16 v[64:79], v[140:143], v[196:199], v[64:79]
    v_mfma_f32_32x32x16_bf16 v[16:31], v[144:147], v[200:203], v[16:31]
    v_mfma_f32_32x32x16_bf16 v[32:47], v[148:151], v[200:203], v[32:47]
    v_mfma_f32_32x32x16_bf16 v[48:63], v[152:155], v[200:203], v[48:63]
    v_mfma_f32_32x32x16_bf16 v[64:79], v[156:159], v[200:203], v[64:79]
    s_add_u32 s42, s41, 0x1000
    s_nop 7
    v_cvt_pk_bf16_f32 v224, v16, v17
    v_cvt_pk_bf16_f32 v225, v18, v19
    v_cvt_pk_bf16_f32 v226, v20, v21
    v_cvt_pk_bf16_f32 v227, v22, v23
    v_cvt_pk_bf16_f32 v228, v24, v25
    v_cvt_pk_bf16_f32 v229, v26, v27
    v_cvt_pk_bf16_f32 v230, v28, v29
    v_cvt_pk_bf16_f32 v231, v30, v31
    buffer_store_dwordx4 v[224:227], v2, s[36:39], s41 offen offset:0 sc1
    buffer_store_dwordx4 v[228:231], v2, s[36:39], s41 offen offset:1024 sc1
    v_cvt_pk_bf16_f32 v232, v32, v33
    v_cvt_pk_bf16_f32 v233, v34, v35
    v_cvt_pk_bf16_f32 v234, v36, v37
    v_cvt_pk_bf16_f32 v235, v38, v39
    v_cvt_pk_bf16_f32 v236, v40, v41
    v_cvt_pk_bf16_f32 v237, v42, v43
    v_cvt_pk_bf16_f32 v238, v44, v45
    v_cvt_pk_bf16_f32 v239, v46, v47
    buffer_store_dwordx4 v[232:235], v2, s[36:39], s41 offen offset:2048 sc1
    buffer_store_dwordx4 v[236:239], v2, s[36:39], s41 offen offset:3072 sc1
    v_cvt_pk_bf16_f32 v240, v48, v49
    v_cvt_pk_bf16_f32 v241, v50, v51
    v_cvt_pk_bf16_f32 v242, v52, v53
    v_cvt_pk_bf16_f32 v243, v54, v55
    v_cvt_pk_bf16_f32 v244, v56, v57
    v_cvt_pk_bf16_f32 v245, v58, v59
    v_cvt_pk_bf16_f32 v246, v60, v61
    v_cvt_pk_bf16_f32 v247, v62, v63
    buffer_store_dwordx4 v[240:243], v2, s[36:39], s42 offen offset:0 sc1
    buffer_store_dwordx4 v[244:247], v2, s[36:39], s42 offen offset:1024 sc1
    s_nop 7
    v_cvt_pk_bf16_f32 v248, v64, v65
    v_cvt_pk_bf16_f32 v249, v66, v67
    v_cvt_pk_bf16_f32 v250, v68, v69
    v_cvt_pk_bf16_f32 v251, v70, v71
    v_cvt_pk_bf16_f32 v252, v72, v73
    v_cvt_pk_bf16_f32 v253, v74, v75
    v_cvt_pk_bf16_f32 v254, v76, v77
    v_cvt_pk_bf16_f32 v255, v78, v79
    buffer_store_dwordx4 v[248:251], v2, s[36:39], s42 offen offset:2048 sc1
    buffer_store_dwordx4 v[252:255], v2, s[36:39], s42 offen offset:3072 sc1
    s_cmp_ge_u32 s92, 63
    s_cbranch_scc1 AT_LAST
    s_add_u32 s22, s92, 1
    s_and_b32 s22, s22, 3
    s_cmp_lg_u32 s22, 0
    s_cbranch_scc1 AT_NF
    s_waitcnt vmcnt(0)
    s_lshl_b32 s95, s92, 12
    s_add_u32 s95, s95, 14721024
    s_mov_b64 exec, 1
    buffer_store_dword v9, v8, s[96:99], s95 offen offset:0 sc1
    s_mov_b64 exec, -1
    s_add_u32 s22, s92, 1
    s_and_b32 s23, s22, 3
    s_cmp_lg_u32 s23, 0
    s_cbranch_scc1 AT_NB_57
    s_lshr_b32 s22, s22, 2
    s_lshl_b32 s22, s22, 11
    s_add_u32 s95, s22, 14688256
AT_KF_58:
    buffer_load_dwordx4 v[208:211], v10, s[96:99], s95 offen sc1
    s_waitcnt vmcnt(0)
    v_and_b32 v208, v208, v209
    v_and_b32 v208, v208, v210
    v_cmp_ne_u32 vcc, 0x1010101, v208
    s_cbranch_vccz AT_KF_58_D
    s_cmp_eq_u32 s93, 0
    s_cbranch_scc1 AT_KF_58_D
    s_sub_u32 s93, s93, 1
    s_branch AT_KF_58
AT_KF_58_D:
AT_NB_57:
    s_add_u32 s22, s92, 1
    s_lshl_b32 s22, s22, 5
    s_add_u32 s22, s22, s40
    s_lshl_b32 s41, s22, 13
    s_add_u32 s42, s41, 0x1000
    buffer_load_dwordx4 v[48:51], v2, s[8:11], s41 offen offset:0
    buffer_load_dwordx4 v[16:19], v2, s[4:7], s41 offen offset:0
    buffer_load_dwordx4 v[52:55], v2, s[8:11], s41 offen offset:1024
    buffer_load_dwordx4 v[20:23], v2, s[4:7], s41 offen offset:1024
    buffer_load_dwordx4 v[56:59], v2, s[8:11], s41 offen offset:2048
    buffer_load_dwordx4 v[24:27], v2, s[4:7], s41 offen offset:2048
    buffer_load_dwordx4 v[60:63], v2, s[8:11], s41 offen offset:3072
    buffer_load_dwordx4 v[28:31], v2, s[4:7], s41 offen offset:3072
    buffer_load_dwordx4 v[64:67], v2, s[8:11], s42 offen offset:0
    buffer_load_dwordx4 v[32:35], v2, s[4:7], s42 offen offset:0
    buffer_load_dwordx4 v[68:71], v2, s[8:11], s42 offen offset:1024
    buffer_load_dwordx4 v[36:39], v2, s[4:7], s42 offen offset:1024
    buffer_load_dwordx4 v[72:75], v2, s[8:11], s42 offen offset:2048
    buffer_load_dwordx4 v[40:43], v2, s[4:7], s42 offen offset:2048
    buffer_load_dwordx4 v[76:79], v2, s[8:11], s42 offen offset:3072
    buffer_load_dwordx4 v[44:47], v2, s[4:7], s42 offen offset:3072
    buffer_load_dwordx4 v[112:115], v2, s[12:15], s41 offen offset:0
    buffer_load_dwordx4 v[116:119], v2, s[12:15], s41 offen offset:1024
    buffer_load_dwordx4 v[120:123], v2, s[12:15], s41 offen offset:2048
    buffer_load_dwordx4 v[124:127], v2, s[12:15], s41 offen offset:3072
    buffer_load_dwordx4 v[128:131], v2, s[12:15], s42 offen offset:0
    buffer_load_dwordx4 v[132:135], v2, s[12:15], s42 offen offset:1024
    buffer_load_dwordx4 v[136:139], v2, s[12:15], s42 offen offset:2048
    buffer_load_dwordx4 v[140:143], v2, s[12:15], s42 offen offset:3072
    s_branch AT_NX
AT_NF:
    s_add_u32 s22, s92, 1
    s_lshl_b32 s22, s22, 5
    s_add_u32 s22, s22, s40
    s_lshl_b32 s41, s22, 13
    s_add_u32 s42, s41, 0x1000
    buffer_load_dwordx4 v[48:51], v2, s[8:11], s41 offen offset:0
    buffer_load_dwordx4 v[16:19], v2, s[4:7], s41 offen offset:0
    buffer_load_dwordx4 v[52:55], v2, s[8:11], s41 offen offset:1024
    buffer_load_dwordx4 v[20:23], v2, s[4:7], s41 offen offset:1024
    buffer_load_dwordx4 v[56:59], v2, s[8:11], s41 offen offset:2048
    buffer_load_dwordx4 v[24:27], v2, s[4:7], s41 offen offset:2048
    buffer_load_dwordx4 v[60:63], v2, s[8:11], s41 offen offset:3072
    buffer_load_dwordx4 v[28:31], v2, s[4:7], s41 offen offset:3072
    buffer_load_dwordx4 v[64:67], v2, s[8:11], s42 offen offset:0
    buffer_load_dwordx4 v[32:35], v2, s[4:7], s42 offen offset:0
    buffer_load_dwordx4 v[68:71], v2, s[8:11], s42 offen offset:1024
    buffer_load_dwordx4 v[36:39], v2, s[4:7], s42 offen offset:1024
    buffer_load_dwordx4 v[72:75], v2, s[8:11], s42 offen offset:2048
    buffer_load_dwordx4 v[40:43], v2, s[4:7], s42 offen offset:2048
    buffer_load_dwordx4 v[76:79], v2, s[8:11], s42 offen offset:3072
    buffer_load_dwordx4 v[44:47], v2, s[4:7], s42 offen offset:3072
    buffer_load_dwordx4 v[112:115], v2, s[12:15], s41 offen offset:0
    buffer_load_dwordx4 v[116:119], v2, s[12:15], s41 offen offset:1024
    buffer_load_dwordx4 v[120:123], v2, s[12:15], s41 offen offset:2048
    buffer_load_dwordx4 v[124:127], v2, s[12:15], s41 offen offset:3072
    buffer_load_dwordx4 v[128:131], v2, s[12:15], s42 offen offset:0
    buffer_load_dwordx4 v[132:135], v2, s[12:15], s42 offen offset:1024
    buffer_load_dwordx4 v[136:139], v2, s[12:15], s42 offen offset:2048
    buffer_load_dwordx4 v[140:143], v2, s[12:15], s42 offen offset:3072
    s_waitcnt vmcnt(24)
    s_lshl_b32 s95, s92, 12
    s_add_u32 s95, s95, 14721024
    s_mov_b64 exec, 1
    buffer_store_dword v9, v8, s[96:99], s95 offen offset:0 sc1
    s_mov_b64 exec, -1
AT_NX:
    s_add_u32 s92, s92, 1
    s_branch AT_TOP
AT_LAST:
    s_waitcnt vmcnt(0)
    s_lshl_b32 s95, s92, 12
    s_add_u32 s95, s95, 14721024
    s_mov_b64 exec, 1
    buffer_store_dword v9, v8, s[96:99], s95 offen offset:0 sc1
    s_mov_b64 exec, -1
MG_EXIT:
    s_endpgm
.section .rodata,"a"
.p2align 6
.amdhsa_kernel sequential_preLN__memory_aug_recurrent_mem_tr__glu_gated_glu__prompt_kernel
  .amdhsa_next_free_vgpr 512
  .amdhsa_next_free_sgpr 102
  .amdhsa_accum_offset 256
  .amdhsa_group_segment_fixed_size 0
  .amdhsa_kernarg_size 112
  .amdhsa_user_sgpr_count 2
  .amdhsa_user_sgpr_kernarg_segment_ptr 1
  .amdhsa_system_sgpr_workgroup_id_x 1
.end_amdhsa_kernel
```
